```python
import torch

def _softmax(x, axis=-1):
    return torch.softmax(x, dim=axis)
def _gelu(x):
    return torch.nn.functional.gelu(x, approximate="tanh")
def _silu(x):
    return torch.nn.functional.silu(x)
def _sigmoid(x):
    return torch.sigmoid(x)
def _layernorm(x, axis=-1, eps=1e-5):
    m = x.mean(dim=axis, keepdim=True)
    v = x.var(dim=axis, keepdim=True, unbiased=False)
    return (x - m) / torch.sqrt(v + eps)
def _scatter_add(tgt, idx, src, axis=0):
    return tgt.clone().index_add_(axis, idx, src)
def _segment_sum(src, seg, n):
    out = torch.zeros((n,) + src.shape[1:], dtype=src.dtype)
    return out.index_add_(0, seg, src)
def _pad(x, pw):
    flat = tuple(v for pair in reversed(pw) for v in pair)
    return torch.nn.functional.pad(x, flat)

kernel_name = 'concat_heads__ssm_conv_s5__grouped_kv_mqa__prompt'

def setup_inputs():

    _w = (lambda a: (lambda t: t.to(torch.bfloat16) if t.is_floating_point() else t)(torch.as_tensor(a)))
    def _A_setup():
        B, S, D = 1, 2048, 1024
        P = D
        Lambda_re = -0.5 * (lambda _x: torch.exp(torch.as_tensor(_x)))((lambda *s: torch.randn(*s, dtype=torch.bfloat16) * 0.4)(P))
        Lambda_im = (lambda *s: torch.randn(*s, dtype=torch.bfloat16) * 0.4)(P) * 1.0
        B_re = (lambda *s: torch.randn(*s, dtype=torch.bfloat16) * 0.4)(P, D) * (D ** -0.5)
        B_im = (lambda *s: torch.randn(*s, dtype=torch.bfloat16) * 0.4)(P, D) * (D ** -0.5)
        C_re = (lambda *s: torch.randn(*s, dtype=torch.bfloat16) * 0.4)(D, P) * (P ** -0.5)
        C_im = (lambda *s: torch.randn(*s, dtype=torch.bfloat16) * 0.4)(D, P) * (P ** -0.5)
        log_dt = (lambda *s: torch.randn(*s, dtype=torch.bfloat16) * 0.4)(P) * 0.3 - 2.0
        Dskip = (lambda *s: torch.randn(*s, dtype=torch.bfloat16) * 0.05)(D)
        return {
            "x": _w((lambda *s: torch.randn(*s, dtype=torch.bfloat16) * 0.05)(B, S, D)),
            "Lambda_re": _w(Lambda_re),
            "Lambda_im": _w(Lambda_im),
            "B_re": _w(B_re),
            "B_im": _w(B_im),
            "C_re": _w(C_re),
            "C_im": _w(C_im),
            "log_dt": _w(log_dt),
            "Dskip": _w(Dskip),
        }
    _A_in = _A_setup()

    def _B_setup():
        B, S, D, H = 1, 2048, 1024, 32
        Dh = D // H
        return {
            "x": _w((lambda *s: torch.randn(*s, dtype=torch.bfloat16) * 0.05)(B, S, D)),
            "wq": _w((lambda *s: torch.randn(*s, dtype=torch.bfloat16) * 0.8)(D, H * Dh)),
            "wk": _w((lambda *s: torch.randn(*s, dtype=torch.bfloat16) * 0.8)(D, Dh)),
            "wv": _w((lambda *s: torch.randn(*s, dtype=torch.bfloat16) * 0.05)(D, Dh)),
            "wo": _w((lambda *s: torch.randn(*s, dtype=torch.bfloat16) * 0.05)(H * Dh, D)),
        }
    _B_in = _B_setup()

    return {
        "A_x": _A_in["x"],
        "A_Lambda_re": _A_in["Lambda_re"],
        "A_Lambda_im": _A_in["Lambda_im"],
        "A_B_re": _A_in["B_re"],
        "A_B_im": _A_in["B_im"],
        "A_C_re": _A_in["C_re"],
        "A_C_im": _A_in["C_im"],
        "A_log_dt": _A_in["log_dt"],
        "A_Dskip": _A_in["Dskip"],
        "B_x": _B_in["x"],
        "B_wq": _B_in["wq"],
        "B_wk": _B_in["wk"],
        "B_wv": _B_in["wv"],
        "B_wo": _B_in["wo"],
    }

def reference(A_x, A_Lambda_re, A_Lambda_im, A_B_re, A_B_im, A_C_re, A_C_im, A_log_dt, A_Dskip, B_x, B_wq, B_wk, B_wv, B_wo):
    def _A_ref(x, Lambda_re, Lambda_im, B_re, B_im, C_re, C_im, log_dt, Dskip):
        Bsz, L, H = x.shape
        Lam = Lambda_re + 1j * Lambda_im
        Bmat = B_re + 1j * B_im
        Cmat = C_re + 1j * C_im
        dt = torch.exp(log_dt)
        Lam_bar = torch.exp(dt * Lam)
        B_bar = ((Lam_bar - 1.0) / Lam)[:, None] * Bmat
        Bu = torch.einsum("bld,pd->blp", x + 0j, B_bar)
        h = torch.zeros_like(Bu[:, 0, :])
        hs = []
        for t in range(L):
            h = Lam_bar[None, :] * h + Bu[:, t, :]
            hs.append(h)
        hseq = torch.stack(hs, 1)
        y = 2.0 * torch.einsum("blp,dp->bld", hseq, Cmat).real + x * Dskip[None, None, :]
        return y

    def _B_ref(x, wq, wk, wv, wo):
        B, S, D = x.shape
        H = 32
        Dh = D // H
        q = (lambda x, *d: x.permute(*d))((x @ wq).reshape(B, S, H, Dh), 0, 2, 1, 3)
        k = x @ wk
        v = x @ wv
        scores = torch.einsum("bhqd,bkd->bhqk", q, k) * (Dh ** -0.5)
        p = _softmax(scores, axis=-1)
        o = torch.einsum("bhqk,bkd->bhqd", p, v)
        return (lambda x, *d: x.permute(*d))(o, 0, 2, 1, 3).reshape(B, S, H * Dh) @ wo

    a = _A_ref(A_x, A_Lambda_re, A_Lambda_im, A_B_re, A_B_im, A_C_re, A_C_im, A_log_dt, A_Dskip)
    b = _B_ref(B_x, B_wq, B_wk, B_wv, B_wo)
    return torch.concatenate([a, b], axis=-1)
```

```asm
; @launch grid=(256,1,1) block=(512,1,1) lds=163840
.amdgcn_target "amdgcn-amd-amdhsa--gfx950"
.text
.p2align 12
.globl concat_heads__ssm_conv_s5__grouped_kv_mqa__prompt_kernel
.p2align 8
.type concat_heads__ssm_conv_s5__grouped_kv_mqa__prompt_kernel,@function
concat_heads__ssm_conv_s5__grouped_kv_mqa__prompt_kernel:
    s_cmp_ge_u32 s2, 256
    s_cbranch_scc1 L_end
    s_load_dwordx16 s[36:51], s[0:1], 0
    s_load_dwordx16 s[52:67], s[0:1], 64
    s_load_dwordx2 s[68:69], s[0:1], 128
    v_lshrrev_b32 v1, 6, v0
    s_bfe_u32 s74, s2, 0x20003
    v_readfirstlane_b32 s3, v1
    s_lshr_b32 s75, s2, 5
    s_bitcmp1_b32 s2, 0
    s_cselect_b32 s7, 1, 0
    s_bfe_u32 s71, s2, 0x20001
    s_and_b32 s70, s71, 1
    s_lshl_b32 s70, s70, 2
    s_add_u32 s79, s70, s74
    s_and_b32 s72, s71, 2
    s_lshl_b32 s72, s72, 2
    s_add_u32 s80, s72, s75
    s_lshl_b32 s70, s71, 2
    s_add_u32 s4, s70, s74
    s_mov_b32 s5, s75
    s_add_u32 s70, s74, s75
    s_and_b32 s70, s70, 3
    s_lshl_b32 s78, s70, 7
    s_and_b32 s6, s3, 3
    s_and_b32 s76, s3, 1
    s_lshr_b32 s77, s6, 1
    s_lshl_b32 s81, s6, 12
    s_lshl_b32 s82, s6, 11
    s_add_u32 s82, s82, 0x10000
    v_and_b32 v0, 63, v0
    s_cmp_eq_u32 s7, 1
    s_cbranch_scc1 L_X
    s_cmp_ge_u32 s3, 4
    s_cbranch_scc1 L_YA
    s_cmp_eq_u32 s6, 0
    s_cbranch_scc1 L_idle
    s_mov_b64 exec, 0
    s_cmp_eq_u32 s6, 1
    s_cbranch_scc1 L_pad_1
    s_cmp_eq_u32 s6, 2
    s_cbranch_scc1 L_pad_att
    s_branch L_pad_3
    s_branch L_idle
L_X:
    s_cmp_lt_u32 s3, 4
    s_cbranch_scc1 L_XB
    s_cmp_eq_u32 s6, 0
    s_cbranch_scc1 L_idle
    s_mov_b64 exec, 0
    s_cmp_eq_u32 s6, 1
    s_cbranch_scc1 L_pad_xa
    s_cmp_eq_u32 s6, 2
    s_cbranch_scc1 L_pad_att
    s_branch L_pad_3
    s_branch L_idle
L_end:
    s_endpgm
L_XB:
    v_lshrrev_b32 v48, 4, v0
    v_and_b32 v49, 7, v0
    v_xor_b32 v48, v48, v49
    v_lshlrev_b32 v48, 4, v48
    v_bfe_u32 v50, v0, 3, 2
    v_lshl_add_u32 v50, v50, 11, v48
    v_lshrrev_b32 v2, 5, v0
    v_lshl_add_u32 v51, v2, 14, v50
    v_bfe_u32 v50, v0, 3, 1
    v_lshl_add_u32 v50, v50, 16, v48
    v_bfe_u32 v49, v0, 4, 1
    v_lshl_add_u32 v50, v49, 11, v50
    v_lshl_add_u32 v50, v2, 15, v50
    s_lshl_b32 s72, s79, 19
    s_lshl_b32 s73, s77, 18
    s_add_u32 s73, s73, s72
    s_lshl_b32 s74, s76, 14
    s_add_u32 s73, s73, s74
    v_add_u32 v50, s73, v50
    s_lshl_b32 s74, s80, 17
    s_lshl_b32 s75, s77, 16
    s_add_u32 s74, s74, s75
    v_add_u32 v51, s74, v51
    v_xor_b32 v49, 64, v50
    v_xor_b32 v48, 64, v51
    v_add_u32 v40, 0x0, v50
    v_add_u32 v44, 0x0, v51
    v_add_u32 v41, 0x1fc00, v49
    v_add_u32 v45, 0x1c00, v48
    v_add_u32 v42, 0x800, v50
    v_add_u32 v46, 0x7800, v51
    v_add_u32 v43, 0x20400, v49
    v_add_u32 v47, 0x9400, v48
    s_and_b32 s97, s80, 12
    s_lshl_b32 s97, s97, 7
    s_mul_i32 s32, s77, 0xc000
    s_lshl_b32 s70, s76, 13
    s_add_u32 s32, s32, s70
    s_and_b32 s70, s80, 4
    s_lshl_b32 s34, s70, 11
    s_xor_b32 s35, s34, 0x2000
    s_lshl_b32 s70, s70, 10
    s_add_u32 s32, s32, s70
    s_xor_b32 s33, s32, 0x1000
    s_mov_b32 s100, s78
    s_mov_b32 s101, 0
    s_lshr_b32 s70, s100, 2
    s_and_b32 s70, s70, 0x180
    s_lshl_b32 s100, s100, 2
    s_and_b32 s100, s100, 0x600
    s_or_b32 s100, s100, s70
    s_cmp_eq_u32 s76, 0
    s_waitcnt lgkmcnt(0)
    s_cselect_b32 s20, s42, s44
    s_cselect_b32 s21, s43, s45
    s_mov_b32 s22, 0x200000
    s_mov_b32 s23, 0x20000
    s_mov_b32 s12, s36
    s_mov_b32 s13, s37
    s_mov_b32 s14, 0x400000
    s_mov_b32 s15, 0x20000
    s_add_u32 m0, s32, 0x0
    s_add_u32 s71, s100, s34
    buffer_load_dwordx4 v40, s[12:15], s71 offen lds
    buffer_load_dwordx4 v41, s[12:15], s71 offen offset:1024 lds
    buffer_load_dwordx4 v42, s[12:15], s71 offen offset:2048 lds
    buffer_load_dwordx4 v43, s[12:15], s71 offen offset:3072 lds
    s_add_u32 m0, s81, 0x18000
    s_nop 0
    buffer_load_dwordx4 v44, s[20:23], s100 offen lds
    buffer_load_dwordx4 v45, s[20:23], s100 offen offset:1024 lds
    buffer_load_dwordx4 v46, s[20:23], s100 offen offset:2048 lds
    buffer_load_dwordx4 v47, s[20:23], s100 offen offset:3072 lds
    s_add_u32 m0, s33, 0x0
    s_add_u32 s71, s100, s35
    buffer_load_dwordx4 v40, s[12:15], s71 offen lds
    buffer_load_dwordx4 v41, s[12:15], s71 offen offset:1024 lds
    buffer_load_dwordx4 v42, s[12:15], s71 offen offset:2048 lds
    buffer_load_dwordx4 v43, s[12:15], s71 offen offset:3072 lds
    s_add_u32 s70, s78, 1536
    s_cmp_eq_u32 s101, s70
    s_cselect_b32 s70, 128, 0
    s_add_u32 s101, s101, s70
    s_and_b32 s70, s101, 384
    s_cmp_eq_u32 s70, s78
    s_cselect_b32 s70, 512, 0
    s_add_u32 s100, s101, s70
    s_add_u32 s101, s101, 128
    s_lshr_b32 s70, s100, 2
    s_and_b32 s70, s70, 0x180
    s_lshl_b32 s100, s100, 2
    s_and_b32 s100, s100, 0x600
    s_or_b32 s100, s100, s70
    s_mov_b64 exec, 0
    s_cmp_eq_u32 s6, 0
    s_cbranch_scc1 L_pad_xb
    s_cmp_eq_u32 s6, 1
    s_cbranch_scc1 L_pad_6
    s_cmp_eq_u32 s6, 2
    s_cbranch_scc1 L_pad_7
    s_branch L_pad_8
L_ret_x1:
    s_mov_b64 exec, -1
    s_add_u32 m0, s32, 0x4000
    s_add_u32 s71, s100, s34
    buffer_load_dwordx4 v40, s[12:15], s71 offen lds
    buffer_load_dwordx4 v41, s[12:15], s71 offen offset:1024 lds
    buffer_load_dwordx4 v42, s[12:15], s71 offen offset:2048 lds
    buffer_load_dwordx4 v43, s[12:15], s71 offen offset:3072 lds
    s_add_u32 m0, s81, 0x1c000
    s_nop 0
    buffer_load_dwordx4 v44, s[20:23], s100 offen lds
    buffer_load_dwordx4 v45, s[20:23], s100 offen offset:1024 lds
    buffer_load_dwordx4 v46, s[20:23], s100 offen offset:2048 lds
    buffer_load_dwordx4 v47, s[20:23], s100 offen offset:3072 lds
    s_add_u32 m0, s33, 0x4000
    s_add_u32 s71, s100, s35
    s_waitcnt vmcnt(8)
    s_barrier
    buffer_load_dwordx4 v40, s[12:15], s71 offen lds
    buffer_load_dwordx4 v41, s[12:15], s71 offen offset:1024 lds
    buffer_load_dwordx4 v42, s[12:15], s71 offen offset:2048 lds
    buffer_load_dwordx4 v43, s[12:15], s71 offen offset:3072 lds
    s_add_u32 s70, s78, 1536
    s_cmp_eq_u32 s101, s70
    s_cselect_b32 s70, 128, 0
    s_add_u32 s101, s101, s70
    s_and_b32 s70, s101, 384
    s_cmp_eq_u32 s70, s78
    s_cselect_b32 s70, 512, 0
    s_add_u32 s100, s101, s70
    s_add_u32 s101, s101, 128
    s_lshr_b32 s70, s100, 2
    s_and_b32 s70, s70, 0x180
    s_lshl_b32 s100, s100, 2
    s_and_b32 s100, s100, 0x600
    s_or_b32 s100, s100, s70
    s_branch L_XB2
L_YA:
    v_lshrrev_b32 v3, 4, v0
    v_and_b32 v4, 7, v0
    v_xor_b32 v3, v3, v4
    v_lshlrev_b32 v3, 4, v3
    v_lshrrev_b32 v5, 3, v0
    v_lshl_add_u32 v5, v5, 11, v3
    v_xor_b32 v6, 64, v5
    s_lshl_b32 s72, s4, 18
    s_and_b32 s70, s5, 3
    s_lshl_b32 s70, s70, 16
    s_add_u32 s70, s70, s72
    s_lshl_b32 s71, s6, 7
    s_add_u32 s73, s70, s71
    s_add_u32 s70, s73, 0x0
    v_add_u32 v36, s70, v5
    s_add_u32 s70, s73, 0x3c00
    v_add_u32 v37, s70, v6
    s_add_u32 s70, s73, 0x7800
    v_add_u32 v38, s70, v5
    s_add_u32 s70, s73, 0xb400
    v_add_u32 v39, s70, v6
    v_lshlrev_b32 v7, 4, v0
    v_and_b32 v3, 32, v0
    v_xor_b32 v23, v3, v7
    s_lshr_b32 s75, s5, 2
    s_lshl_b32 s75, s75, 2
    s_add_u32 s75, s75, s4
    s_cmp_lt_u32 s5, 4
    s_waitcnt lgkmcnt(0)
    s_cselect_b32 s12, s58, s60
    s_cselect_b32 s13, s59, s61
    s_mov_b32 s14, 0x10000
    s_mov_b32 s15, 0x20000
    s_mov_b32 s20, s54
    s_mov_b32 s21, s55
    s_mov_b32 s22, 0x400000
    s_mov_b32 s23, 0x20000
    s_add_u32 m0, s81, 0x0
    s_add_u32 s70, s75, 0
    s_and_b32 s70, s70, 3
    s_lshl_b32 s70, s70, 9
    buffer_load_dwordx4 v36, s[20:23], s70 offen nt lds
    buffer_load_dwordx4 v37, s[20:23], s70 offen offset:1024 nt lds
    buffer_load_dwordx4 v38, s[20:23], s70 offen offset:2048 nt lds
    buffer_load_dwordx4 v39, s[20:23], s70 offen offset:3072 nt lds
    s_add_u32 m0, s81, 0x4000
    s_add_u32 s70, s75, 1
    s_and_b32 s70, s70, 3
    s_lshl_b32 s70, s70, 9
    buffer_load_dwordx4 v36, s[20:23], s70 offen nt lds
    buffer_load_dwordx4 v37, s[20:23], s70 offen offset:1024 nt lds
    buffer_load_dwordx4 v38, s[20:23], s70 offen offset:2048 nt lds
    buffer_load_dwordx4 v39, s[20:23], s70 offen offset:3072 nt lds
    s_lshl_b32 s74, s6, 16
    s_add_u32 s74, s74, s72
    s_add_u32 s70, s74, 0x0
    v_add_u32 v24, s70, v5
    s_add_u32 s70, s74, 0x3c00
    v_add_u32 v25, s70, v6
    s_add_u32 s70, s74, 0x7800
    v_add_u32 v26, s70, v5
    s_add_u32 s70, s74, 0xb400
    v_add_u32 v27, s70, v6
    v_bfe_u32 v3, v0, 4, 1
    v_lshlrev_b32 v3, 1, v3
    v_xor_b32 v3, v3, v4
    v_lshrrev_b32 v4, 3, v0
    v_lshlrev_b32 v4, 11, v4
    v_lshl_add_u32 v3, v3, 4, v4
    s_lshl_b32 s70, s5, 8
    s_lshl_b32 s73, s6, 15
    s_add_u32 s73, s73, s70
    v_add_u32 v11, s73, v3
    v_xor_b32 v12, 64, v11
    v_add_u32 v12, 0x3c00, v12
    s_and_b32 s80, s4, 12
    s_lshl_b32 s80, s80, 7
    s_lshl_b32 s71, s77, 6
    s_add_u32 s74, s70, s71
    v_and_b32 v5, 15, v0
    v_lshlrev_b32 v5, 1, v5
    s_mov_b32 s24, s56
    s_mov_b32 s25, s57
    s_mov_b32 s26, 0x200000
    s_mov_b32 s27, 0x20000
    s_mov_b32 s96, s52
    s_mov_b32 s97, s53
    s_mov_b32 s98, 0x800
    s_mov_b32 s99, 0x20000
    s_mov_b32 s100, s78
    s_mov_b32 s101, 0
    s_add_u32 s100, s100, s80
    s_and_b32 s100, s100, 2047
    s_mov_b64 exec, 0
    s_cmp_eq_u32 s6, 0
    s_cbranch_scc1 L_pad_2
    s_cmp_eq_u32 s6, 1
    s_cbranch_scc1 L_pad_ya
    s_cmp_eq_u32 s6, 2
    s_cbranch_scc1 L_pad_14
    s_branch L_ret_y1
L_ret_y1:
    s_mov_b64 exec, -1
    buffer_load_ushort v13, v5, s[96:99], s74 offen offset:0
    buffer_load_ushort v14, v5, s[96:99], s74 offen offset:32
    buffer_load_ushort v15, v5, s[96:99], s74 offen offset:128
    buffer_load_ushort v16, v5, s[96:99], s74 offen offset:160
    s_add_u32 m0, s81, 0x8000
    s_add_u32 s70, s75, 2
    s_and_b32 s70, s70, 3
    s_lshl_b32 s70, s70, 9
    buffer_load_dwordx4 v36, s[20:23], s70 offen nt lds
    buffer_load_dwordx4 v37, s[20:23], s70 offen offset:1024 nt lds
    buffer_load_dwordx4 v38, s[20:23], s70 offen offset:2048 nt lds
    buffer_load_dwordx4 v39, s[20:23], s70 offen offset:3072 nt lds
    s_add_u32 m0, s81, 0xc000
    s_add_u32 s70, s75, 3
    s_and_b32 s70, s70, 3
    s_lshl_b32 s70, s70, 9
    buffer_load_dwordx4 v36, s[20:23], s70 offen nt lds
    buffer_load_dwordx4 v37, s[20:23], s70 offen offset:1024 nt lds
    buffer_load_dwordx4 v38, s[20:23], s70 offen offset:2048 nt lds
    buffer_load_dwordx4 v39, s[20:23], s70 offen offset:3072 nt lds
    s_add_u32 m0, s81, 0x10000
    s_add_u32 s70, s75, 0
    s_and_b32 s70, s70, 3
    s_lshl_b32 s70, s70, 14
    s_add_u32 s70, s70, s81
    buffer_load_dwordx4 v23, s[12:15], s70 offen lds
    buffer_load_dwordx4 v23, s[12:15], s70 offen offset:1024 lds
    buffer_load_dwordx4 v23, s[12:15], s70 offen offset:2048 lds
    buffer_load_dwordx4 v23, s[12:15], s70 offen offset:3072 lds
    s_add_u32 m0, s81, 0x14000
    s_add_u32 s70, s75, 1
    s_and_b32 s70, s70, 3
    s_lshl_b32 s70, s70, 14
    s_add_u32 s70, s70, s81
    buffer_load_dwordx4 v23, s[12:15], s70 offen lds
    buffer_load_dwordx4 v23, s[12:15], s70 offen offset:1024 lds
    buffer_load_dwordx4 v23, s[12:15], s70 offen offset:2048 lds
    buffer_load_dwordx4 v23, s[12:15], s70 offen offset:3072 lds
    s_waitcnt vmcnt(4)
    s_barrier
    s_add_u32 m0, s81, 0x18000
    s_add_u32 s70, s75, 2
    s_and_b32 s70, s70, 3
    s_lshl_b32 s70, s70, 14
    s_add_u32 s70, s70, s81
    buffer_load_dwordx4 v23, s[12:15], s70 offen lds
    buffer_load_dwordx4 v23, s[12:15], s70 offen offset:1024 lds
    buffer_load_dwordx4 v23, s[12:15], s70 offen offset:2048 lds
    buffer_load_dwordx4 v23, s[12:15], s70 offen offset:3072 lds
    s_add_u32 m0, s81, 0x1c000
    s_add_u32 s70, s75, 3
    s_and_b32 s70, s70, 3
    s_lshl_b32 s70, s70, 14
    s_add_u32 s70, s70, s81
    buffer_load_dwordx4 v23, s[12:15], s70 offen lds
    buffer_load_dwordx4 v23, s[12:15], s70 offen offset:1024 lds
    buffer_load_dwordx4 v23, s[12:15], s70 offen offset:2048 lds
    buffer_load_dwordx4 v23, s[12:15], s70 offen offset:3072 lds
    s_branch L_YA2
.p2align 12
L_base:
L_idle:
    s_mov_b64 exec, -1
    s_waitcnt lgkmcnt(0)
    s_mov_b32 s8, s68
    s_mov_b32 s9, s69
    s_mov_b32 s10, 0x1000000
    s_mov_b32 s11, 0x20000
    s_mov_b32 s16, s66
    s_mov_b32 s17, s67
    s_mov_b32 s18, 0x100
    s_mov_b32 s19, 0x20000
    s_or_b32 s70, s2, s6
    s_cmp_lg_u32 s70, 0
    s_cbranch_scc1 L_notag
    s_add_u32 s70, s68, 0xca1000
    s_addc_u32 s71, s69, 0
    s_load_dword s72, s[70:71], 0
    v_mov_b32 v5, 0
    v_mov_b32 v6, 0xca1000
    s_waitcnt lgkmcnt(0)
    s_add_u32 s72, s72, 0x9e3779ba
    s_or_b32 s72, s72, 1
    v_mov_b32 v4, s72
    buffer_store_dword v4, v5, s[16:19], 0 offen sc1
    buffer_store_dword v4, v6, s[8:11], 0 offen
L_notag:
    s_getpc_b64 s[70:71]
    s_lshr_b32 s72, s2, 3
    s_lshl_b32 s72, s72, 2
    s_add_u32 s72, s72, s6
    s_mul_i32 s72, s72, 640
    v_lshl_add_u32 v5, v0, 7, s72
    v_cmp_gt_u32 vcc, 5, v0
    v_mov_b32 v6, 0x40000000
    s_and_b32 s96, s70, 0xffffff80
    s_mov_b32 s97, s71
    s_mov_b32 s98, L_code_end - L_notag - 512
    s_mov_b32 s99, 0x20000
    v_cndmask_b32 v5, v6, v5, vcc
    buffer_load_dword v8, v5, s[96:99], 0 offen
    v_and_b32 v1, 31, v0
    v_lshrrev_b32 v2, 5, v0
    v_lshlrev_b32 v7, 4, v0
    s_lshl_b32 s70, s4, 3
    s_add_u32 s70, s70, s5
    s_lshl_b32 s71, s70, 1
    s_add_u32 s71, s71, s7
    s_lshl_b32 s72, s79, 4
    s_add_u32 s72, s72, s80
    s_add_u32 s70, s70, 384
    s_add_u32 s72, s72, 256
    s_cmp_eq_u32 s7, 1
    s_cselect_b32 s70, s72, s70
    s_lshl_b32 s73, s6, 7
    s_add_u32 s73, s73, 0xc60000
    v_lshl_add_u32 v3, v1, 2, s73
    v_lshl_add_u32 v3, v2, 30, v3
    s_lshl_b32 s70, s70, 9
    v_add_u32 v9, s70, v3
    s_lshl_b32 s72, s71, 9
    v_mov_b32 v4, 0
    buffer_store_dword v4, v3, s[8:11], s72 offen sc1
    buffer_store_dword v4, v9, s[8:11], 0 offen sc1
    s_lshl_b32 s71, s71, 4
    s_add_u32 s71, s71, 0xca0000
    buffer_load_dword v8, v4, s[8:11], s71 offen sc1
    s_cmp_eq_u32 s7, 1
    s_cbranch_scc1 L_XA
    v_add_u32 v22, 0x20000, v7
    v_and_b32 v3, 6, v0
    v_mov_b32 v4, 0x3f803f80
    v_cmp_eq_u32 vcc, 0, v3
    v_and_b32 v5, 1, v0
    v_mov_b32 v6, 0x44444444
    v_cndmask_b32 v36, 0, v4, vcc
    v_cndmask_b32 v37, 0, v4, vcc
    v_cmp_eq_u32 vcc, 4, v3
    v_mov_b32 v3, 0xeeeeeeee
    s_lshl_b32 s72, s5, 1
    v_cndmask_b32 v38, 0, v4, vcc
    v_cndmask_b32 v39, 0, v4, vcc
    v_cmp_eq_u32 vcc, 0, v5
    s_add_u32 s72, s72, s7
    s_lshl_b32 s73, s4, 4
    v_cndmask_b32 v26, v3, v6, vcc
    s_add_u32 s73, s73, s72
    s_lshl_b32 s73, s73, 2
    s_add_u32 s73, s73, s6
    s_lshl_b32 s73, s73, 7
    s_add_u32 s73, s73, 0xc60000
    v_lshl_add_u32 v4, v1, 2, s73
    v_lshl_add_u32 v23, v2, 30, v4
    s_lshl_b32 s73, s4, 1
    s_add_u32 s73, s73, s76
    s_lshl_b32 s73, s73, 5
    s_add_u32 s73, s73, s72
    s_lshl_b32 s73, s73, 1
    s_add_u32 s73, s73, s77
    s_lshl_b32 s28, s73, 11
    s_add_u32 s29, s28, 0x10000
    s_lshl_b32 s73, s4, 3
    s_add_u32 s73, s73, s5
    s_lshl_b32 s73, s73, 2
    s_add_u32 s30, s73, s6
    s_mov_b32 s87, 0x20000
    s_mov_b32 s96, 0x8000
    v_mov_b32 v72, 0
    v_mov_b32 v73, 0
    v_mov_b32 v74, 0
    v_mov_b32 v75, 0
    v_mov_b32 v76, 0
    v_mov_b32 v77, 0
    v_mov_b32 v78, 0
    v_mov_b32 v79, 0
    v_lshrrev_b32 v3, 4, v0
    v_and_b32 v4, 7, v0
    v_xor_b32 v3, v3, v4
    v_lshlrev_b32 v3, 4, v3
    v_lshrrev_b32 v5, 3, v0
    v_lshl_add_u32 v5, v5, 11, v3
    v_xor_b32 v6, 64, v5
    s_lshl_b32 s70, s76, 1
    s_add_u32 s70, s70, s77
    s_lshl_b32 s73, s5, 2
    s_add_u32 s73, s73, s70
    s_lshl_b32 s73, s73, 16
    s_add_u32 s72, s73, 0x0
    v_add_u32 v18, s72, v5
    s_add_u32 s72, s73, 0x3c00
    v_add_u32 v19, s72, v6
    s_add_u32 s72, s73, 0x7800
    v_add_u32 v20, s72, v5
    s_add_u32 s72, s73, 0xb400
    v_add_u32 v21, s72, v6
    s_lshl_b32 s72, s4, 2
    s_add_u32 s72, s72, s6
    s_lshl_b32 s72, s72, 17
    s_add_u32 s86, s72, 0x400000
    s_mov_b32 s24, s46
    s_mov_b32 s25, s47
    s_mov_b32 s26, 0x200000
    s_mov_b32 s27, 0x20000
    v_bfe_u32 v3, v0, 1, 3
    v_lshrrev_b32 v4, 4, v0
    v_xor_b32 v3, v3, v4
    v_lshlrev_b32 v3, 4, v3
    v_and_b32 v5, 15, v0
    v_lshl_add_u32 v3, v5, 7, v3
    v_xor_b32 v4, 64, v3
    s_lshl_b32 s70, s76, 13
    v_add_u32 v10, s70, v3
    v_add_u32 v11, s70, v4
    s_cmp_lt_u32 s5, 4
    s_cselect_b32 s71, s77, s76
    s_cselect_b32 s85, s76, s77
    s_lshl_b32 s71, s71, 11
    v_add_u32 v14, s71, v3
    v_add_u32 v15, s71, v4
    v_lshlrev_b32 v5, 4, v5
    v_bfe_u32 v4, v0, 4, 1
    v_lshl_add_u32 v5, v4, 9, v5
    v_lshl_add_u32 v27, v2, 30, v5
    v_bfe_u32 v3, v0, 2, 2
    v_lshrrev_b32 v4, 4, v0
    v_lshl_add_u32 v5, v4, 3, v3
    v_bfe_u32 v4, v0, 3, 2
    s_lshl_b32 s70, s77, 1
    v_xor_b32 v4, s70, v4
    v_lshlrev_b32 v4, 5, v4
    v_lshl_add_u32 v4, v5, 7, v4
    v_and_b32 v3, 1, v0
    v_bfe_u32 v6, v0, 1, 1
    v_lshl_add_u32 v4, v3, 4, v4
    v_lshl_add_u32 v4, v6, 3, v4
    v_add_u32 v12, 0x10000, v4
    v_xor_b32 v13, 32, v12
    v_and_b32 v3, 3, v0
    v_lshlrev_b32 v3, 3, v3
    v_lshl_add_u32 v3, v5, 6, v3
    v_bfe_u32 v4, v0, 4, 1
    v_xor_b32 v4, s85, v4
    v_lshl_add_u32 v3, v4, 5, v3
    v_add_u32 v16, 0x10000, v3
    s_lshl_b32 s72, s77, 30
    s_lshl_b32 s70, s4, 3
    s_add_u32 s70, s70, s5
    s_lshl_b32 s70, s70, 1
    s_add_u32 s70, s70, s76
    s_lshl_b32 s70, s70, 4
    s_add_u32 s70, s70, 0xca0000
    s_add_u32 s70, s70, s72
    v_cmp_eq_u32 vcc, 0, v0
    v_mov_b32 v4, s70
    v_mov_b32 v5, 0x40000000
    v_cndmask_b32 v24, v5, v4, vcc
    s_lshl_b32 s70, s4, 2
    s_and_b32 s71, s5, 3
    s_add_u32 s70, s70, s71
    s_lshl_b32 s70, s70, 1
    s_lshr_b32 s71, s5, 2
    s_add_u32 s70, s70, s71
    s_lshl_b32 s70, s70, 1
    s_add_u32 s70, s70, s76
    s_lshl_b32 s70, s70, 2
    s_add_u32 s70, s70, s77
    s_lshl_b32 s70, s70, 8
    s_add_u32 s84, s70, 0xc00000
    s_cmp_lt_u32 s5, 4
    s_cselect_b32 s85, 0x3e8293ee, 1.0
    s_cselect_b64 s[74:75], -1, 0
    v_mov_b32 v5, 0
    s_barrier
    ds_read_b128 v[80:83], v14 offset:0
    ds_read_b64_tr_b16 v[84:85], v16 offset:0
    ds_read_b64_tr_b16 v[86:87], v16 offset:256
    ds_read_b128 v[88:91], v15 offset:0
    ds_read_b64_tr_b16 v[92:93], v16 offset:2048
    ds_read_b64_tr_b16 v[94:95], v16 offset:2304
    ds_read_b128 v[96:99], v14 offset:4096
    ds_read_b64_tr_b16 v[100:101], v16 offset:4096
    ds_read_b64_tr_b16 v[102:103], v16 offset:4352
    ds_read_b128 v[104:107], v15 offset:4096
    ds_read_b64_tr_b16 v[108:109], v16 offset:6144
    ds_read_b64_tr_b16 v[110:111], v16 offset:6400
    ds_read_b128 v[112:115], v14 offset:8192
    ds_read_b64_tr_b16 v[116:117], v16 offset:8192
    ds_read_b64_tr_b16 v[118:119], v16 offset:8448
    s_waitcnt lgkmcnt(12)
    v_mfma_f32_16x16x32_bf16 v[144:147], v[84:87], v[80:83], 0
    ds_read_b128 v[120:123], v15 offset:8192
    ds_read_b64_tr_b16 v[124:125], v16 offset:10240
    v_mfma_f32_16x16x32_bf16 v[160:163], v[80:83], v[84:87], 0
    ds_read_b64_tr_b16 v[126:127], v16 offset:10496
    s_waitcnt lgkmcnt(14)
    ds_read_b128 v[128:131], v14 offset:12288
    s_waitcnt lgkmcnt(13)
    v_mfma_f32_16x16x32_bf16 v[148:151], v[92:95], v[88:91], 0
    ds_read_b64_tr_b16 v[132:133], v16 offset:12288
    ds_read_b64_tr_b16 v[134:135], v16 offset:12544
    v_mfma_f32_16x16x32_bf16 v[164:167], v[88:91], v[92:95], 0
    s_waitcnt lgkmcnt(14)
    ds_read_b128 v[136:139], v15 offset:12288
    s_waitcnt lgkmcnt(14)
    ds_read_b64_tr_b16 v[140:141], v16 offset:14336
    s_waitcnt lgkmcnt(14)
    v_mfma_f32_16x16x32_bf16 v[144:147], v[100:103], v[96:99], v[144:147]
    ds_read_b64_tr_b16 v[142:143], v16 offset:14592
    v_mfma_f32_16x16x32_bf16 v[160:163], v[96:99], v[100:103], v[160:163]
    s_waitcnt lgkmcnt(12)
    v_mfma_f32_16x16x32_bf16 v[148:151], v[108:111], v[104:107], v[148:151]
    v_mfma_f32_16x16x32_bf16 v[164:167], v[104:107], v[108:111], v[164:167]
    s_waitcnt lgkmcnt(0)
    s_barrier
    v_mfma_f32_16x16x32_bf16 v[144:147], v[116:119], v[112:115], v[144:147]
    ds_read_b128 v[80:83], v14 offset:16384
    ds_read_b64_tr_b16 v[84:85], v16 offset:16384
    v_mfma_f32_16x16x32_bf16 v[160:163], v[112:115], v[116:119], v[160:163]
    ds_read_b64_tr_b16 v[86:87], v16 offset:16640
    ds_read_b128 v[88:91], v15 offset:16384
    v_mfma_f32_16x16x32_bf16 v[148:151], v[124:127], v[120:123], v[148:151]
    ds_read_b64_tr_b16 v[92:93], v16 offset:18432
    ds_read_b64_tr_b16 v[94:95], v16 offset:18688
    v_mfma_f32_16x16x32_bf16 v[164:167], v[120:123], v[124:127], v[164:167]
    ds_read_b128 v[96:99], v14 offset:20480
    ds_read_b64_tr_b16 v[100:101], v16 offset:20480
    v_mfma_f32_16x16x32_bf16 v[144:147], v[132:135], v[128:131], v[144:147]
    ds_read_b64_tr_b16 v[102:103], v16 offset:20736
    ds_read_b128 v[104:107], v15 offset:20480
    v_mfma_f32_16x16x32_bf16 v[160:163], v[128:131], v[132:135], v[160:163]
    ds_read_b64_tr_b16 v[108:109], v16 offset:22528
    ds_read_b64_tr_b16 v[110:111], v16 offset:22784
    v_mfma_f32_16x16x32_bf16 v[148:151], v[140:143], v[136:139], v[148:151]
    ds_read_b128 v[112:115], v14 offset:24576
    ds_read_b64_tr_b16 v[116:117], v16 offset:24576
    v_mfma_f32_16x16x32_bf16 v[164:167], v[136:139], v[140:143], v[164:167]
    ds_read_b64_tr_b16 v[118:119], v16 offset:24832
    s_waitcnt lgkmcnt(14)
    ds_read_b128 v[120:123], v15 offset:24576
    s_waitcnt lgkmcnt(13)
    v_mfma_f32_16x16x32_bf16 v[144:147], v[84:87], v[80:83], v[144:147]
    ds_read_b64_tr_b16 v[124:125], v16 offset:26624
    ds_read_b64_tr_b16 v[126:127], v16 offset:26880
    v_mfma_f32_16x16x32_bf16 v[160:163], v[80:83], v[84:87], v[160:163]
    s_waitcnt lgkmcnt(14)
    ds_read_b128 v[128:131], v14 offset:28672
    s_waitcnt lgkmcnt(14)
    ds_read_b64_tr_b16 v[132:133], v16 offset:28672
    s_waitcnt lgkmcnt(14)
    v_mfma_f32_16x16x32_bf16 v[148:151], v[92:95], v[88:91], v[148:151]
    ds_read_b64_tr_b16 v[134:135], v16 offset:28928
    s_waitcnt lgkmcnt(14)
    ds_read_b128 v[136:139], v15 offset:28672
    v_mfma_f32_16x16x32_bf16 v[164:167], v[88:91], v[92:95], v[164:167]
    s_waitcnt lgkmcnt(14)
    ds_read_b64_tr_b16 v[140:141], v16 offset:30720
    s_waitcnt lgkmcnt(14)
    ds_read_b64_tr_b16 v[142:143], v16 offset:30976
    v_mfma_f32_16x16x32_bf16 v[144:147], v[100:103], v[96:99], v[144:147]
    v_mfma_f32_16x16x32_bf16 v[160:163], v[96:99], v[100:103], v[160:163]
    s_waitcnt lgkmcnt(12)
    v_mfma_f32_16x16x32_bf16 v[148:151], v[108:111], v[104:107], v[148:151]
    v_mfma_f32_16x16x32_bf16 v[164:167], v[104:107], v[108:111], v[164:167]
    s_waitcnt lgkmcnt(0)
    s_barrier
    v_mfma_f32_16x16x32_bf16 v[144:147], v[116:119], v[112:115], v[144:147]
    ds_read_b128 v[80:83], v14 offset:32768
    ds_read_b64_tr_b16 v[84:85], v16 offset:32768
    v_mfma_f32_16x16x32_bf16 v[160:163], v[112:115], v[116:119], v[160:163]
    ds_read_b64_tr_b16 v[86:87], v16 offset:33024
    ds_read_b128 v[88:91], v15 offset:32768
    v_mfma_f32_16x16x32_bf16 v[148:151], v[124:127], v[120:123], v[148:151]
    ds_read_b64_tr_b16 v[92:93], v16 offset:34816
    ds_read_b64_tr_b16 v[94:95], v16 offset:35072
    v_mfma_f32_16x16x32_bf16 v[164:167], v[120:123], v[124:127], v[164:167]
    ds_read_b128 v[96:99], v14 offset:36864
    ds_read_b64_tr_b16 v[100:101], v16 offset:36864
    v_mfma_f32_16x16x32_bf16 v[144:147], v[132:135], v[128:131], v[144:147]
    ds_read_b64_tr_b16 v[102:103], v16 offset:37120
    ds_read_b128 v[104:107], v15 offset:36864
    v_mfma_f32_16x16x32_bf16 v[160:163], v[128:131], v[132:135], v[160:163]
    ds_read_b64_tr_b16 v[108:109], v16 offset:38912
    ds_read_b64_tr_b16 v[110:111], v16 offset:39168
    v_mfma_f32_16x16x32_bf16 v[148:151], v[140:143], v[136:139], v[148:151]
    ds_read_b128 v[112:115], v14 offset:40960
    ds_read_b64_tr_b16 v[116:117], v16 offset:40960
    v_mfma_f32_16x16x32_bf16 v[164:167], v[136:139], v[140:143], v[164:167]
    ds_read_b64_tr_b16 v[118:119], v16 offset:41216
    s_waitcnt lgkmcnt(14)
    ds_read_b128 v[120:123], v15 offset:40960
    s_waitcnt lgkmcnt(13)
    v_mfma_f32_16x16x32_bf16 v[144:147], v[84:87], v[80:83], v[144:147]
    ds_read_b64_tr_b16 v[124:125], v16 offset:43008
    ds_read_b64_tr_b16 v[126:127], v16 offset:43264
    v_mfma_f32_16x16x32_bf16 v[160:163], v[80:83], v[84:87], v[160:163]
    s_waitcnt lgkmcnt(14)
    ds_read_b128 v[128:131], v14 offset:45056
    s_waitcnt lgkmcnt(14)
    ds_read_b64_tr_b16 v[132:133], v16 offset:45056
    s_waitcnt lgkmcnt(14)
    v_mfma_f32_16x16x32_bf16 v[148:151], v[92:95], v[88:91], v[148:151]
    ds_read_b64_tr_b16 v[134:135], v16 offset:45312
    s_waitcnt lgkmcnt(14)
    ds_read_b128 v[136:139], v15 offset:45056
    v_mfma_f32_16x16x32_bf16 v[164:167], v[88:91], v[92:95], v[164:167]
    s_waitcnt lgkmcnt(14)
    ds_read_b64_tr_b16 v[140:141], v16 offset:47104
    s_waitcnt lgkmcnt(14)
    ds_read_b64_tr_b16 v[142:143], v16 offset:47360
    v_mfma_f32_16x16x32_bf16 v[144:147], v[100:103], v[96:99], v[144:147]
    v_mfma_f32_16x16x32_bf16 v[160:163], v[96:99], v[100:103], v[160:163]
    s_waitcnt lgkmcnt(12)
    v_mfma_f32_16x16x32_bf16 v[148:151], v[108:111], v[104:107], v[148:151]
    v_mfma_f32_16x16x32_bf16 v[164:167], v[104:107], v[108:111], v[164:167]
    s_waitcnt lgkmcnt(0)
    s_barrier
    v_mfma_f32_16x16x32_bf16 v[144:147], v[116:119], v[112:115], v[144:147]
    ds_read_b128 v[80:83], v14 offset:49152
    ds_read_b64_tr_b16 v[84:85], v16 offset:49152
    v_mfma_f32_16x16x32_bf16 v[160:163], v[112:115], v[116:119], v[160:163]
    ds_read_b64_tr_b16 v[86:87], v16 offset:49408
    ds_read_b128 v[88:91], v15 offset:49152
    v_mfma_f32_16x16x32_bf16 v[148:151], v[124:127], v[120:123], v[148:151]
    ds_read_b64_tr_b16 v[92:93], v16 offset:51200
    ds_read_b64_tr_b16 v[94:95], v16 offset:51456
    v_mfma_f32_16x16x32_bf16 v[164:167], v[120:123], v[124:127], v[164:167]
    ds_read_b128 v[96:99], v14 offset:53248
    ds_read_b64_tr_b16 v[100:101], v16 offset:53248
    v_mfma_f32_16x16x32_bf16 v[144:147], v[132:135], v[128:131], v[144:147]
    ds_read_b64_tr_b16 v[102:103], v16 offset:53504
    ds_read_b128 v[104:107], v15 offset:53248
    v_mfma_f32_16x16x32_bf16 v[160:163], v[128:131], v[132:135], v[160:163]
    ds_read_b64_tr_b16 v[108:109], v16 offset:55296
    ds_read_b64_tr_b16 v[110:111], v16 offset:55552
    v_mfma_f32_16x16x32_bf16 v[148:151], v[140:143], v[136:139], v[148:151]
    ds_read_b128 v[112:115], v14 offset:57344
    ds_read_b64_tr_b16 v[116:117], v16 offset:57344
    v_mfma_f32_16x16x32_bf16 v[164:167], v[136:139], v[140:143], v[164:167]
    ds_read_b64_tr_b16 v[118:119], v16 offset:57600
    s_waitcnt lgkmcnt(14)
    ds_read_b128 v[120:123], v15 offset:57344
    s_waitcnt lgkmcnt(13)
    v_mfma_f32_16x16x32_bf16 v[144:147], v[84:87], v[80:83], v[144:147]
    ds_read_b64_tr_b16 v[124:125], v16 offset:59392
    ds_read_b64_tr_b16 v[126:127], v16 offset:59648
    v_mfma_f32_16x16x32_bf16 v[160:163], v[80:83], v[84:87], v[160:163]
    s_waitcnt lgkmcnt(14)
    ds_read_b128 v[128:131], v14 offset:61440
    s_waitcnt lgkmcnt(14)
    ds_read_b64_tr_b16 v[132:133], v16 offset:61440
    s_waitcnt lgkmcnt(14)
    v_mfma_f32_16x16x32_bf16 v[148:151], v[92:95], v[88:91], v[148:151]
    ds_read_b64_tr_b16 v[134:135], v16 offset:61696
    s_waitcnt lgkmcnt(14)
    ds_read_b128 v[136:139], v15 offset:61440
    v_mfma_f32_16x16x32_bf16 v[164:167], v[88:91], v[92:95], v[164:167]
    s_waitcnt lgkmcnt(14)
    ds_read_b64_tr_b16 v[140:141], v16 offset:63488
    s_waitcnt lgkmcnt(14)
    ds_read_b64_tr_b16 v[142:143], v16 offset:63744
    v_mfma_f32_16x16x32_bf16 v[144:147], v[100:103], v[96:99], v[144:147]
    v_mfma_f32_16x16x32_bf16 v[160:163], v[96:99], v[100:103], v[160:163]
    s_waitcnt lgkmcnt(12)
    v_mfma_f32_16x16x32_bf16 v[148:151], v[108:111], v[104:107], v[148:151]
    v_mfma_f32_16x16x32_bf16 v[164:167], v[104:107], v[108:111], v[164:167]
    s_waitcnt lgkmcnt(0)
    s_barrier
    v_mfma_f32_16x16x32_bf16 v[144:147], v[116:119], v[112:115], v[144:147]
    v_mfma_f32_16x16x32_bf16 v[160:163], v[112:115], v[116:119], v[160:163]
    v_mfma_f32_16x16x32_bf16 v[148:151], v[124:127], v[120:123], v[148:151]
    v_mfma_f32_16x16x32_bf16 v[164:167], v[120:123], v[124:127], v[164:167]
    v_mfma_f32_16x16x32_bf16 v[144:147], v[132:135], v[128:131], v[144:147]
    v_mfma_f32_16x16x32_bf16 v[160:163], v[128:131], v[132:135], v[160:163]
    v_mfma_f32_16x16x32_bf16 v[148:151], v[140:143], v[136:139], v[148:151]
    v_mfma_f32_16x16x32_bf16 v[164:167], v[136:139], v[140:143], v[164:167]
    ds_read_b128 v[96:99], v10 offset:0
    ds_read_b64_tr_b16 v[112:113], v12 offset:0
    ds_read_b64_tr_b16 v[114:115], v12 offset:512
    ds_read_b64_tr_b16 v[116:117], v13 offset:0
    ds_read_b64_tr_b16 v[118:119], v13 offset:512
    ds_read_b64_tr_b16 v[120:121], v12 offset:8192
    ds_read_b64_tr_b16 v[122:123], v12 offset:8704
    ds_read_b64_tr_b16 v[124:125], v13 offset:8192
    ds_read_b64_tr_b16 v[126:127], v13 offset:8704
    ds_read_b128 v[100:103], v10 offset:2048
    ds_read_b128 v[104:107], v10 offset:4096
    ds_read_b128 v[108:111], v10 offset:6144
    ds_read_b128 v[208:211], v11 offset:0
    ds_read_b64_tr_b16 v[224:225], v12 offset:4096
    ds_read_b64_tr_b16 v[226:227], v12 offset:4608
    buffer_load_dword v25, v5, s[16:19], 0 offen sc1
    v_cndmask_b32 v144, v160, v144, s[74:75]
    v_cndmask_b32 v145, v161, v145, s[74:75]
    v_cndmask_b32 v146, v162, v146, s[74:75]
    v_cndmask_b32 v147, v163, v147, s[74:75]
    v_cndmask_b32 v148, v164, v148, s[74:75]
    v_cndmask_b32 v149, v165, v149, s[74:75]
    v_cndmask_b32 v150, v166, v150, s[74:75]
    v_cndmask_b32 v151, v167, v151, s[74:75]
    v_add_f32 v144, v144, v148
    v_add_f32 v145, v145, v149
    v_add_f32 v146, v146, v150
    v_add_f32 v147, v147, v151
    v_mul_f32 v144, s85, v144
    v_mul_f32 v145, s85, v145
    v_mul_f32 v146, s85, v146
    v_mul_f32 v147, s85, v147
    v_cvt_pk_bf16_f32 v32, v144, v145
    v_cvt_pk_bf16_f32 v33, v146, v147
    v_cvt_pk_bf16_f32 v34, v144, v145
    v_cvt_pk_bf16_f32 v35, v146, v147
    s_nop 1
    v_permlane32_swap_b32 v32, v34
    v_permlane32_swap_b32 v33, v35
    buffer_store_dwordx4 v[32:35], v27, s[8:11], s84 offen sc1
    s_waitcnt lgkmcnt(12)
    v_mfma_f32_16x16x32_bf16 v[40:43], v[112:115], v[96:99], 0
    ds_read_b64_tr_b16 v[228:229], v13 offset:4096
    s_waitcnt lgkmcnt(11)
    v_mfma_f32_16x16x32_bf16 v[44:47], v[116:119], v[96:99], 0
    ds_read_b64_tr_b16 v[230:231], v13 offset:4608
    s_waitcnt lgkmcnt(10)
    v_mfma_f32_16x16x32_bf16 v[176:179], v[120:123], v[96:99], 0
    ds_read_b64_tr_b16 v[232:233], v12 offset:12288
    s_waitcnt lgkmcnt(9)
    v_mfma_f32_16x16x32_bf16 v[180:183], v[124:127], v[96:99], 0
    ds_read_b64_tr_b16 v[234:235], v12 offset:12800
    s_waitcnt lgkmcnt(9)
    v_mfma_f32_16x16x32_bf16 v[188:191], v[124:127], v[100:103], 0
    ds_read_b64_tr_b16 v[236:237], v13 offset:12288
    v_mfma_f32_16x16x32_bf16 v[184:187], v[120:123], v[100:103], 0
    ds_read_b64_tr_b16 v[238:239], v13 offset:12800
    v_mfma_f32_16x16x32_bf16 v[52:55], v[116:119], v[100:103], 0
    ds_read_b128 v[212:215], v11 offset:2048
    v_mfma_f32_16x16x32_bf16 v[48:51], v[112:115], v[100:103], 0
    ds_read_b128 v[216:219], v11 offset:4096
    s_waitcnt lgkmcnt(12)
    v_mfma_f32_16x16x32_bf16 v[56:59], v[112:115], v[104:107], 0
    ds_read_b128 v[220:223], v11 offset:6144
    v_mfma_f32_16x16x32_bf16 v[60:63], v[116:119], v[104:107], 0
    v_mfma_f32_16x16x32_bf16 v[192:195], v[120:123], v[104:107], 0
    v_mfma_f32_16x16x32_bf16 v[196:199], v[124:127], v[104:107], 0
    s_waitcnt lgkmcnt(0)
    s_barrier
    v_mfma_f32_16x16x32_bf16 v[204:207], v[124:127], v[108:111], 0
    ds_read_b128 v[80:83], v10 offset:16384
    v_mfma_f32_16x16x32_bf16 v[200:203], v[120:123], v[108:111], 0
    ds_read_b64_tr_b16 v[128:129], v12 offset:16384
    v_mfma_f32_16x16x32_bf16 v[68:71], v[116:119], v[108:111], 0
    ds_read_b64_tr_b16 v[130:131], v12 offset:16896
    v_mfma_f32_16x16x32_bf16 v[64:67], v[112:115], v[108:111], 0
    ds_read_b64_tr_b16 v[132:133], v13 offset:16384
    v_mfma_f32_16x16x32_bf16 v[40:43], v[224:227], v[208:211], v[40:43]
    ds_read_b64_tr_b16 v[134:135], v13 offset:16896
    v_mfma_f32_16x16x32_bf16 v[44:47], v[228:231], v[208:211], v[44:47]
    ds_read_b64_tr_b16 v[136:137], v12 offset:24576
    v_mfma_f32_16x16x32_bf16 v[176:179], v[232:235], v[208:211], v[176:179]
    ds_read_b64_tr_b16 v[138:139], v12 offset:25088
    v_mfma_f32_16x16x32_bf16 v[180:183], v[236:239], v[208:211], v[180:183]
    ds_read_b64_tr_b16 v[140:141], v13 offset:24576
    v_mfma_f32_16x16x32_bf16 v[188:191], v[236:239], v[212:215], v[188:191]
    ds_read_b64_tr_b16 v[142:143], v13 offset:25088
    v_mfma_f32_16x16x32_bf16 v[184:187], v[232:235], v[212:215], v[184:187]
    ds_read_b128 v[84:87], v10 offset:18432
    v_mfma_f32_16x16x32_bf16 v[52:55], v[228:231], v[212:215], v[52:55]
    ds_read_b128 v[88:91], v10 offset:20480
    v_mfma_f32_16x16x32_bf16 v[48:51], v[224:227], v[212:215], v[48:51]
    ds_read_b128 v[92:95], v10 offset:22528
    v_mfma_f32_16x16x32_bf16 v[56:59], v[224:227], v[216:219], v[56:59]
    ds_read_b128 v[96:99], v11 offset:16384
    v_mfma_f32_16x16x32_bf16 v[60:63], v[228:231], v[216:219], v[60:63]
    ds_read_b64_tr_b16 v[112:113], v12 offset:20480
    v_mfma_f32_16x16x32_bf16 v[192:195], v[232:235], v[216:219], v[192:195]
    ds_read_b64_tr_b16 v[114:115], v12 offset:20992
    v_mfma_f32_16x16x32_bf16 v[196:199], v[236:239], v[216:219], v[196:199]
    s_waitcnt lgkmcnt(14)
    ds_read_b64_tr_b16 v[116:117], v13 offset:20480
    v_mfma_f32_16x16x32_bf16 v[204:207], v[236:239], v[220:223], v[204:207]
    s_waitcnt lgkmcnt(14)
    ds_read_b64_tr_b16 v[118:119], v13 offset:20992
    v_mfma_f32_16x16x32_bf16 v[200:203], v[232:235], v[220:223], v[200:203]
    s_waitcnt lgkmcnt(14)
    ds_read_b64_tr_b16 v[120:121], v12 offset:28672
    v_mfma_f32_16x16x32_bf16 v[68:71], v[228:231], v[220:223], v[68:71]
    s_waitcnt lgkmcnt(14)
    ds_read_b64_tr_b16 v[122:123], v12 offset:29184
    v_mfma_f32_16x16x32_bf16 v[64:67], v[224:227], v[220:223], v[64:67]
    s_waitcnt lgkmcnt(14)
    ds_read_b64_tr_b16 v[124:125], v13 offset:28672
    v_mfma_f32_16x16x32_bf16 v[40:43], v[128:131], v[80:83], v[40:43]
    s_waitcnt lgkmcnt(14)
    ds_read_b64_tr_b16 v[126:127], v13 offset:29184
    v_mfma_f32_16x16x32_bf16 v[44:47], v[132:135], v[80:83], v[44:47]
    s_waitcnt lgkmcnt(14)
    ds_read_b128 v[100:103], v11 offset:18432
    v_mfma_f32_16x16x32_bf16 v[176:179], v[136:139], v[80:83], v[176:179]
    s_waitcnt lgkmcnt(14)
    ds_read_b128 v[104:107], v11 offset:20480
    s_waitcnt lgkmcnt(14)
    v_mfma_f32_16x16x32_bf16 v[180:183], v[140:143], v[80:83], v[180:183]
    ds_read_b128 v[108:111], v11 offset:22528
    s_waitcnt lgkmcnt(14)
    v_mfma_f32_16x16x32_bf16 v[188:191], v[140:143], v[84:87], v[188:191]
    v_mfma_f32_16x16x32_bf16 v[184:187], v[136:139], v[84:87], v[184:187]
    v_mfma_f32_16x16x32_bf16 v[52:55], v[132:135], v[84:87], v[52:55]
    v_mfma_f32_16x16x32_bf16 v[48:51], v[128:131], v[84:87], v[48:51]
    s_waitcnt lgkmcnt(13)
    v_mfma_f32_16x16x32_bf16 v[56:59], v[128:131], v[88:91], v[56:59]
    s_waitcnt vmcnt(0)
    v_mfma_f32_16x16x32_bf16 v[60:63], v[132:135], v[88:91], v[60:63]
    v_readfirstlane_b32 s83, v25
    s_nop 0
    s_cmp_eq_u32 s83, 0
    s_cbranch_scc1 L_tagwaitYB
L_tagokYB:
    v_mfma_f32_16x16x32_bf16 v[192:195], v[136:139], v[88:91], v[192:195]
    v_mfma_f32_16x16x32_bf16 v[196:199], v[140:143], v[88:91], v[196:199]
    s_waitcnt lgkmcnt(0)
    s_barrier
    v_mfma_f32_16x16x32_bf16 v[204:207], v[140:143], v[92:95], v[204:207]
    ds_read_b128 v[208:211], v10 offset:32768
    buffer_store_dword v25, v24, s[8:11], 0 offen sc1
    v_mfma_f32_16x16x32_bf16 v[200:203], v[136:139], v[92:95], v[200:203]
    ds_read_b64_tr_b16 v[224:225], v12 offset:32768
    v_mfma_f32_16x16x32_bf16 v[68:71], v[132:135], v[92:95], v[68:71]
    ds_read_b64_tr_b16 v[226:227], v12 offset:33280
    v_mfma_f32_16x16x32_bf16 v[64:67], v[128:131], v[92:95], v[64:67]
    ds_read_b64_tr_b16 v[228:229], v13 offset:32768
    v_mfma_f32_16x16x32_bf16 v[40:43], v[112:115], v[96:99], v[40:43]
    ds_read_b64_tr_b16 v[230:231], v13 offset:33280
    v_mfma_f32_16x16x32_bf16 v[44:47], v[116:119], v[96:99], v[44:47]
    ds_read_b64_tr_b16 v[232:233], v12 offset:40960
    v_mfma_f32_16x16x32_bf16 v[176:179], v[120:123], v[96:99], v[176:179]
    ds_read_b64_tr_b16 v[234:235], v12 offset:41472
    v_mfma_f32_16x16x32_bf16 v[180:183], v[124:127], v[96:99], v[180:183]
    ds_read_b64_tr_b16 v[236:237], v13 offset:40960
    v_mfma_f32_16x16x32_bf16 v[188:191], v[124:127], v[100:103], v[188:191]
    ds_read_b64_tr_b16 v[238:239], v13 offset:41472
    v_mfma_f32_16x16x32_bf16 v[184:187], v[120:123], v[100:103], v[184:187]
    ds_read_b128 v[212:215], v10 offset:34816
    v_mfma_f32_16x16x32_bf16 v[52:55], v[116:119], v[100:103], v[52:55]
    ds_read_b128 v[216:219], v10 offset:36864
    v_mfma_f32_16x16x32_bf16 v[48:51], v[112:115], v[100:103], v[48:51]
    ds_read_b128 v[220:223], v10 offset:38912
    v_mfma_f32_16x16x32_bf16 v[56:59], v[112:115], v[104:107], v[56:59]
    ds_read_b128 v[80:83], v11 offset:32768
    v_mfma_f32_16x16x32_bf16 v[60:63], v[116:119], v[104:107], v[60:63]
    ds_read_b64_tr_b16 v[128:129], v12 offset:36864
    v_mfma_f32_16x16x32_bf16 v[192:195], v[120:123], v[104:107], v[192:195]
    ds_read_b64_tr_b16 v[130:131], v12 offset:37376
    v_mfma_f32_16x16x32_bf16 v[196:199], v[124:127], v[104:107], v[196:199]
    s_waitcnt lgkmcnt(14)
    ds_read_b64_tr_b16 v[132:133], v13 offset:36864
    v_mfma_f32_16x16x32_bf16 v[204:207], v[124:127], v[108:111], v[204:207]
    s_waitcnt lgkmcnt(14)
    ds_read_b64_tr_b16 v[134:135], v13 offset:37376
    v_mfma_f32_16x16x32_bf16 v[200:203], v[120:123], v[108:111], v[200:203]
    s_waitcnt lgkmcnt(14)
    ds_read_b64_tr_b16 v[136:137], v12 offset:45056
    v_mfma_f32_16x16x32_bf16 v[68:71], v[116:119], v[108:111], v[68:71]
    s_waitcnt lgkmcnt(14)
    ds_read_b64_tr_b16 v[138:139], v12 offset:45568
    v_mfma_f32_16x16x32_bf16 v[64:67], v[112:115], v[108:111], v[64:67]
    s_waitcnt lgkmcnt(14)
    ds_read_b64_tr_b16 v[140:141], v13 offset:45056
    v_mfma_f32_16x16x32_bf16 v[40:43], v[224:227], v[208:211], v[40:43]
    s_waitcnt lgkmcnt(14)
    ds_read_b64_tr_b16 v[142:143], v13 offset:45568
    v_mfma_f32_16x16x32_bf16 v[44:47], v[228:231], v[208:211], v[44:47]
    s_waitcnt lgkmcnt(14)
    ds_read_b128 v[84:87], v11 offset:34816
    v_mfma_f32_16x16x32_bf16 v[176:179], v[232:235], v[208:211], v[176:179]
    s_waitcnt lgkmcnt(14)
    ds_read_b128 v[88:91], v11 offset:36864
    s_waitcnt lgkmcnt(14)
    v_mfma_f32_16x16x32_bf16 v[180:183], v[236:239], v[208:211], v[180:183]
    ds_read_b128 v[92:95], v11 offset:38912
    s_waitcnt lgkmcnt(14)
    v_mfma_f32_16x16x32_bf16 v[188:191], v[236:239], v[212:215], v[188:191]
    v_mfma_f32_16x16x32_bf16 v[184:187], v[232:235], v[212:215], v[184:187]
    v_mfma_f32_16x16x32_bf16 v[52:55], v[228:231], v[212:215], v[52:55]
    v_mfma_f32_16x16x32_bf16 v[48:51], v[224:227], v[212:215], v[48:51]
    s_waitcnt lgkmcnt(13)
    v_mfma_f32_16x16x32_bf16 v[56:59], v[224:227], v[216:219], v[56:59]
    v_mfma_f32_16x16x32_bf16 v[60:63], v[228:231], v[216:219], v[60:63]
    v_mfma_f32_16x16x32_bf16 v[192:195], v[232:235], v[216:219], v[192:195]
    v_mfma_f32_16x16x32_bf16 v[196:199], v[236:239], v[216:219], v[196:199]
    s_waitcnt lgkmcnt(0)
    s_barrier
    v_mfma_f32_16x16x32_bf16 v[204:207], v[236:239], v[220:223], v[204:207]
    ds_read_b128 v[96:99], v10 offset:49152
    v_mfma_f32_16x16x32_bf16 v[200:203], v[232:235], v[220:223], v[200:203]
    ds_read_b64_tr_b16 v[112:113], v12 offset:49152
    v_mfma_f32_16x16x32_bf16 v[68:71], v[228:231], v[220:223], v[68:71]
    ds_read_b64_tr_b16 v[114:115], v12 offset:49664
    v_mfma_f32_16x16x32_bf16 v[64:67], v[224:227], v[220:223], v[64:67]
L_pad_1:
    s_cbranch_execz L_idle
    ds_read_b64_tr_b16 v[116:117], v13 offset:49152
    v_mfma_f32_16x16x32_bf16 v[40:43], v[128:131], v[80:83], v[40:43]
    ds_read_b64_tr_b16 v[118:119], v13 offset:49664
    v_mfma_f32_16x16x32_bf16 v[44:47], v[132:135], v[80:83], v[44:47]
    ds_read_b64_tr_b16 v[120:121], v12 offset:57344
    v_mfma_f32_16x16x32_bf16 v[176:179], v[136:139], v[80:83], v[176:179]
    ds_read_b64_tr_b16 v[122:123], v12 offset:57856
    v_mfma_f32_16x16x32_bf16 v[180:183], v[140:143], v[80:83], v[180:183]
    ds_read_b64_tr_b16 v[124:125], v13 offset:57344
    v_mfma_f32_16x16x32_bf16 v[188:191], v[140:143], v[84:87], v[188:191]
    ds_read_b64_tr_b16 v[126:127], v13 offset:57856
    v_mfma_f32_16x16x32_bf16 v[184:187], v[136:139], v[84:87], v[184:187]
    ds_read_b128 v[100:103], v10 offset:51200
    v_mfma_f32_16x16x32_bf16 v[52:55], v[132:135], v[84:87], v[52:55]
    ds_read_b128 v[104:107], v10 offset:53248
    v_mfma_f32_16x16x32_bf16 v[48:51], v[128:131], v[84:87], v[48:51]
    ds_read_b128 v[108:111], v10 offset:55296
    v_mfma_f32_16x16x32_bf16 v[56:59], v[128:131], v[88:91], v[56:59]
    ds_read_b128 v[208:211], v11 offset:49152
    v_mfma_f32_16x16x32_bf16 v[60:63], v[132:135], v[88:91], v[60:63]
    ds_read_b64_tr_b16 v[224:225], v12 offset:53248
    v_mfma_f32_16x16x32_bf16 v[192:195], v[136:139], v[88:91], v[192:195]
    ds_read_b64_tr_b16 v[226:227], v12 offset:53760
    v_mfma_f32_16x16x32_bf16 v[196:199], v[140:143], v[88:91], v[196:199]
    s_waitcnt lgkmcnt(14)
    ds_read_b64_tr_b16 v[228:229], v13 offset:53248
    v_mfma_f32_16x16x32_bf16 v[204:207], v[140:143], v[92:95], v[204:207]
    s_waitcnt lgkmcnt(14)
    ds_read_b64_tr_b16 v[230:231], v13 offset:53760
    v_mfma_f32_16x16x32_bf16 v[200:203], v[136:139], v[92:95], v[200:203]
    s_waitcnt lgkmcnt(14)
    ds_read_b64_tr_b16 v[232:233], v12 offset:61440
    v_mfma_f32_16x16x32_bf16 v[68:71], v[132:135], v[92:95], v[68:71]
    s_waitcnt lgkmcnt(14)
    ds_read_b64_tr_b16 v[234:235], v12 offset:61952
    v_mfma_f32_16x16x32_bf16 v[64:67], v[128:131], v[92:95], v[64:67]
    s_waitcnt lgkmcnt(14)
    ds_read_b64_tr_b16 v[236:237], v13 offset:61440
    v_mfma_f32_16x16x32_bf16 v[40:43], v[112:115], v[96:99], v[40:43]
    s_waitcnt lgkmcnt(14)
    ds_read_b64_tr_b16 v[238:239], v13 offset:61952
    v_mfma_f32_16x16x32_bf16 v[44:47], v[116:119], v[96:99], v[44:47]
    s_waitcnt lgkmcnt(14)
    ds_read_b128 v[212:215], v11 offset:51200
    v_mfma_f32_16x16x32_bf16 v[176:179], v[120:123], v[96:99], v[176:179]
    s_waitcnt lgkmcnt(14)
    ds_read_b128 v[216:219], v11 offset:53248
    s_waitcnt lgkmcnt(14)
    v_mfma_f32_16x16x32_bf16 v[180:183], v[124:127], v[96:99], v[180:183]
    ds_read_b128 v[220:223], v11 offset:55296
    s_waitcnt lgkmcnt(14)
    v_mfma_f32_16x16x32_bf16 v[188:191], v[124:127], v[100:103], v[188:191]
    v_mfma_f32_16x16x32_bf16 v[184:187], v[120:123], v[100:103], v[184:187]
    v_mfma_f32_16x16x32_bf16 v[52:55], v[116:119], v[100:103], v[52:55]
    v_mfma_f32_16x16x32_bf16 v[48:51], v[112:115], v[100:103], v[48:51]
    s_waitcnt lgkmcnt(13)
    v_mfma_f32_16x16x32_bf16 v[56:59], v[112:115], v[104:107], v[56:59]
    v_mfma_f32_16x16x32_bf16 v[60:63], v[116:119], v[104:107], v[60:63]
    v_mfma_f32_16x16x32_bf16 v[192:195], v[120:123], v[104:107], v[192:195]
    v_mfma_f32_16x16x32_bf16 v[196:199], v[124:127], v[104:107], v[196:199]
    s_waitcnt lgkmcnt(0)
    s_barrier
    v_mfma_f32_16x16x32_bf16 v[204:207], v[124:127], v[108:111], v[204:207]
    ds_read_b128 v[80:83], v10 offset:0
    v_mfma_f32_16x16x32_bf16 v[200:203], v[120:123], v[108:111], v[200:203]
    ds_read_b64_tr_b16 v[128:129], v12 offset:0
    v_mfma_f32_16x16x32_bf16 v[68:71], v[116:119], v[108:111], v[68:71]
    ds_read_b64_tr_b16 v[130:131], v12 offset:512
    v_mfma_f32_16x16x32_bf16 v[64:67], v[112:115], v[108:111], v[64:67]
    ds_read_b64_tr_b16 v[132:133], v13 offset:0
    v_mfma_f32_16x16x32_bf16 v[40:43], v[224:227], v[208:211], v[40:43]
    ds_read_b64_tr_b16 v[134:135], v13 offset:512
    v_mfma_f32_16x16x32_bf16 v[44:47], v[228:231], v[208:211], v[44:47]
    ds_read_b64_tr_b16 v[136:137], v12 offset:8192
    v_mfma_f32_16x16x32_bf16 v[176:179], v[232:235], v[208:211], v[176:179]
    ds_read_b64_tr_b16 v[138:139], v12 offset:8704
    v_mfma_f32_16x16x32_bf16 v[180:183], v[236:239], v[208:211], v[180:183]
    ds_read_b64_tr_b16 v[140:141], v13 offset:8192
    v_mfma_f32_16x16x32_bf16 v[188:191], v[236:239], v[212:215], v[188:191]
    ds_read_b64_tr_b16 v[142:143], v13 offset:8704
    v_mfma_f32_16x16x32_bf16 v[184:187], v[232:235], v[212:215], v[184:187]
    ds_read_b128 v[84:87], v10 offset:2048
    v_mfma_f32_16x16x32_bf16 v[52:55], v[228:231], v[212:215], v[52:55]
    ds_read_b128 v[88:91], v10 offset:4096
    v_mfma_f32_16x16x32_bf16 v[48:51], v[224:227], v[212:215], v[48:51]
    ds_read_b128 v[92:95], v10 offset:6144
    v_mfma_f32_16x16x32_bf16 v[56:59], v[224:227], v[216:219], v[56:59]
    ds_read_b128 v[96:99], v11 offset:0
    v_mfma_f32_16x16x32_bf16 v[60:63], v[228:231], v[216:219], v[60:63]
    ds_read_b64_tr_b16 v[112:113], v12 offset:4096
    v_mfma_f32_16x16x32_bf16 v[192:195], v[232:235], v[216:219], v[192:195]
    ds_read_b64_tr_b16 v[114:115], v12 offset:4608
    v_mfma_f32_16x16x32_bf16 v[196:199], v[236:239], v[216:219], v[196:199]
    s_waitcnt lgkmcnt(14)
    ds_read_b64_tr_b16 v[116:117], v13 offset:4096
    v_mfma_f32_16x16x32_bf16 v[204:207], v[236:239], v[220:223], v[204:207]
    s_waitcnt lgkmcnt(14)
    ds_read_b64_tr_b16 v[118:119], v13 offset:4608
    v_mfma_f32_16x16x32_bf16 v[200:203], v[232:235], v[220:223], v[200:203]
    s_waitcnt lgkmcnt(14)
    ds_read_b64_tr_b16 v[120:121], v12 offset:12288
    v_mfma_f32_16x16x32_bf16 v[68:71], v[228:231], v[220:223], v[68:71]
    s_waitcnt lgkmcnt(14)
    ds_read_b64_tr_b16 v[122:123], v12 offset:12800
    v_mfma_f32_16x16x32_bf16 v[64:67], v[224:227], v[220:223], v[64:67]
    s_waitcnt lgkmcnt(14)
    ds_read_b64_tr_b16 v[124:125], v13 offset:12288
    v_mfma_f32_16x16x32_bf16 v[40:43], v[128:131], v[80:83], v[40:43]
    s_waitcnt lgkmcnt(14)
    ds_read_b64_tr_b16 v[126:127], v13 offset:12800
    v_mfma_f32_16x16x32_bf16 v[44:47], v[132:135], v[80:83], v[44:47]
    s_waitcnt lgkmcnt(14)
    ds_read_b128 v[100:103], v11 offset:2048
    v_mfma_f32_16x16x32_bf16 v[176:179], v[136:139], v[80:83], v[176:179]
    s_waitcnt lgkmcnt(14)
    ds_read_b128 v[104:107], v11 offset:4096
    s_waitcnt lgkmcnt(14)
    v_mfma_f32_16x16x32_bf16 v[180:183], v[140:143], v[80:83], v[180:183]
    ds_read_b128 v[108:111], v11 offset:6144
    s_waitcnt lgkmcnt(14)
    v_mfma_f32_16x16x32_bf16 v[188:191], v[140:143], v[84:87], v[188:191]
    v_mfma_f32_16x16x32_bf16 v[184:187], v[136:139], v[84:87], v[184:187]
    v_mfma_f32_16x16x32_bf16 v[52:55], v[132:135], v[84:87], v[52:55]
    v_mfma_f32_16x16x32_bf16 v[48:51], v[128:131], v[84:87], v[48:51]
    s_waitcnt lgkmcnt(13)
    v_mfma_f32_16x16x32_bf16 v[56:59], v[128:131], v[88:91], v[56:59]
    v_mfma_f32_16x16x32_bf16 v[60:63], v[132:135], v[88:91], v[60:63]
    v_mfma_f32_16x16x32_bf16 v[192:195], v[136:139], v[88:91], v[192:195]
    v_mfma_f32_16x16x32_bf16 v[196:199], v[140:143], v[88:91], v[196:199]
    s_waitcnt lgkmcnt(0)
    s_barrier
    v_mfma_f32_16x16x32_bf16 v[204:207], v[140:143], v[92:95], v[204:207]
    ds_read_b128 v[208:211], v10 offset:16384
    v_mfma_f32_16x16x32_bf16 v[200:203], v[136:139], v[92:95], v[200:203]
    ds_read_b64_tr_b16 v[224:225], v12 offset:16384
    v_mfma_f32_16x16x32_bf16 v[68:71], v[132:135], v[92:95], v[68:71]
    ds_read_b64_tr_b16 v[226:227], v12 offset:16896
    v_mfma_f32_16x16x32_bf16 v[64:67], v[128:131], v[92:95], v[64:67]
    ds_read_b64_tr_b16 v[228:229], v13 offset:16384
    v_mfma_f32_16x16x32_bf16 v[40:43], v[112:115], v[96:99], v[40:43]
    ds_read_b64_tr_b16 v[230:231], v13 offset:16896
    v_mfma_f32_16x16x32_bf16 v[44:47], v[116:119], v[96:99], v[44:47]
    ds_read_b64_tr_b16 v[232:233], v12 offset:24576
    v_mfma_f32_16x16x32_bf16 v[176:179], v[120:123], v[96:99], v[176:179]
    ds_read_b64_tr_b16 v[234:235], v12 offset:25088
    v_mfma_f32_16x16x32_bf16 v[180:183], v[124:127], v[96:99], v[180:183]
    ds_read_b64_tr_b16 v[236:237], v13 offset:24576
    v_mfma_f32_16x16x32_bf16 v[188:191], v[124:127], v[100:103], v[188:191]
    ds_read_b64_tr_b16 v[238:239], v13 offset:25088
    v_mfma_f32_16x16x32_bf16 v[184:187], v[120:123], v[100:103], v[184:187]
    ds_read_b128 v[212:215], v10 offset:18432
    v_mfma_f32_16x16x32_bf16 v[52:55], v[116:119], v[100:103], v[52:55]
    ds_read_b128 v[216:219], v10 offset:20480
    v_mfma_f32_16x16x32_bf16 v[48:51], v[112:115], v[100:103], v[48:51]
    ds_read_b128 v[220:223], v10 offset:22528
    v_mfma_f32_16x16x32_bf16 v[56:59], v[112:115], v[104:107], v[56:59]
    ds_read_b128 v[80:83], v11 offset:16384
    v_mfma_f32_16x16x32_bf16 v[60:63], v[116:119], v[104:107], v[60:63]
    ds_read_b64_tr_b16 v[128:129], v12 offset:20480
    v_mfma_f32_16x16x32_bf16 v[192:195], v[120:123], v[104:107], v[192:195]
    ds_read_b64_tr_b16 v[130:131], v12 offset:20992
    v_mfma_f32_16x16x32_bf16 v[196:199], v[124:127], v[104:107], v[196:199]
    s_waitcnt lgkmcnt(14)
    ds_read_b64_tr_b16 v[132:133], v13 offset:20480
    v_mfma_f32_16x16x32_bf16 v[204:207], v[124:127], v[108:111], v[204:207]
    s_waitcnt lgkmcnt(14)
    ds_read_b64_tr_b16 v[134:135], v13 offset:20992
    v_mfma_f32_16x16x32_bf16 v[200:203], v[120:123], v[108:111], v[200:203]
    s_waitcnt lgkmcnt(14)
    ds_read_b64_tr_b16 v[136:137], v12 offset:28672
    v_mfma_f32_16x16x32_bf16 v[68:71], v[116:119], v[108:111], v[68:71]
    s_waitcnt lgkmcnt(14)
    ds_read_b64_tr_b16 v[138:139], v12 offset:29184
    v_mfma_f32_16x16x32_bf16 v[64:67], v[112:115], v[108:111], v[64:67]
    s_waitcnt lgkmcnt(14)
    ds_read_b64_tr_b16 v[140:141], v13 offset:28672
    v_mfma_f32_16x16x32_bf16 v[40:43], v[224:227], v[208:211], v[40:43]
    s_waitcnt lgkmcnt(14)
    ds_read_b64_tr_b16 v[142:143], v13 offset:29184
    v_mfma_f32_16x16x32_bf16 v[44:47], v[228:231], v[208:211], v[44:47]
    s_waitcnt lgkmcnt(14)
    ds_read_b128 v[84:87], v11 offset:18432
    v_mfma_f32_16x16x32_bf16 v[176:179], v[232:235], v[208:211], v[176:179]
    s_waitcnt lgkmcnt(14)
    ds_read_b128 v[88:91], v11 offset:20480
    s_waitcnt lgkmcnt(14)
    v_mfma_f32_16x16x32_bf16 v[180:183], v[236:239], v[208:211], v[180:183]
    ds_read_b128 v[92:95], v11 offset:22528
    s_waitcnt lgkmcnt(14)
    v_mfma_f32_16x16x32_bf16 v[188:191], v[236:239], v[212:215], v[188:191]
    v_mfma_f32_16x16x32_bf16 v[184:187], v[232:235], v[212:215], v[184:187]
    v_mfma_f32_16x16x32_bf16 v[52:55], v[228:231], v[212:215], v[52:55]
    v_mfma_f32_16x16x32_bf16 v[48:51], v[224:227], v[212:215], v[48:51]
    s_waitcnt lgkmcnt(13)
    v_mfma_f32_16x16x32_bf16 v[56:59], v[224:227], v[216:219], v[56:59]
    v_mfma_f32_16x16x32_bf16 v[60:63], v[228:231], v[216:219], v[60:63]
    v_mfma_f32_16x16x32_bf16 v[192:195], v[232:235], v[216:219], v[192:195]
    v_mfma_f32_16x16x32_bf16 v[196:199], v[236:239], v[216:219], v[196:199]
    s_waitcnt lgkmcnt(0)
    s_barrier
    v_mfma_f32_16x16x32_bf16 v[204:207], v[236:239], v[220:223], v[204:207]
    ds_read_b128 v[96:99], v10 offset:32768
    v_mfma_f32_16x16x32_bf16 v[200:203], v[232:235], v[220:223], v[200:203]
    ds_read_b64_tr_b16 v[112:113], v12 offset:32768
    v_mfma_f32_16x16x32_bf16 v[68:71], v[228:231], v[220:223], v[68:71]
    ds_read_b64_tr_b16 v[114:115], v12 offset:33280
    v_mfma_f32_16x16x32_bf16 v[64:67], v[224:227], v[220:223], v[64:67]
    ds_read_b64_tr_b16 v[116:117], v13 offset:32768
    v_mfma_f32_16x16x32_bf16 v[40:43], v[128:131], v[80:83], v[40:43]
    ds_read_b64_tr_b16 v[118:119], v13 offset:33280
    v_mfma_f32_16x16x32_bf16 v[44:47], v[132:135], v[80:83], v[44:47]
    ds_read_b64_tr_b16 v[120:121], v12 offset:40960
    v_mfma_f32_16x16x32_bf16 v[176:179], v[136:139], v[80:83], v[176:179]
    ds_read_b64_tr_b16 v[122:123], v12 offset:41472
    v_mfma_f32_16x16x32_bf16 v[180:183], v[140:143], v[80:83], v[180:183]
    ds_read_b64_tr_b16 v[124:125], v13 offset:40960
    v_mfma_f32_16x16x32_bf16 v[188:191], v[140:143], v[84:87], v[188:191]
    ds_read_b64_tr_b16 v[126:127], v13 offset:41472
    v_mfma_f32_16x16x32_bf16 v[184:187], v[136:139], v[84:87], v[184:187]
    ds_read_b128 v[100:103], v10 offset:34816
    v_mfma_f32_16x16x32_bf16 v[52:55], v[132:135], v[84:87], v[52:55]
    ds_read_b128 v[104:107], v10 offset:36864
    v_mfma_f32_16x16x32_bf16 v[48:51], v[128:131], v[84:87], v[48:51]
    ds_read_b128 v[108:111], v10 offset:38912
    v_mfma_f32_16x16x32_bf16 v[56:59], v[128:131], v[88:91], v[56:59]
    ds_read_b128 v[208:211], v11 offset:32768
    v_mfma_f32_16x16x32_bf16 v[60:63], v[132:135], v[88:91], v[60:63]
    ds_read_b64_tr_b16 v[224:225], v12 offset:36864
    v_mfma_f32_16x16x32_bf16 v[192:195], v[136:139], v[88:91], v[192:195]
    ds_read_b64_tr_b16 v[226:227], v12 offset:37376
    v_mfma_f32_16x16x32_bf16 v[196:199], v[140:143], v[88:91], v[196:199]
    s_waitcnt lgkmcnt(14)
    ds_read_b64_tr_b16 v[228:229], v13 offset:36864
    v_mfma_f32_16x16x32_bf16 v[204:207], v[140:143], v[92:95], v[204:207]
    s_waitcnt lgkmcnt(14)
    ds_read_b64_tr_b16 v[230:231], v13 offset:37376
    v_mfma_f32_16x16x32_bf16 v[200:203], v[136:139], v[92:95], v[200:203]
    s_waitcnt lgkmcnt(14)
    ds_read_b64_tr_b16 v[232:233], v12 offset:45056
    v_mfma_f32_16x16x32_bf16 v[68:71], v[132:135], v[92:95], v[68:71]
    s_waitcnt lgkmcnt(14)
    ds_read_b64_tr_b16 v[234:235], v12 offset:45568
    v_mfma_f32_16x16x32_bf16 v[64:67], v[128:131], v[92:95], v[64:67]
    s_waitcnt lgkmcnt(14)
    ds_read_b64_tr_b16 v[236:237], v13 offset:45056
    v_mfma_f32_16x16x32_bf16 v[40:43], v[112:115], v[96:99], v[40:43]
    s_waitcnt lgkmcnt(14)
    ds_read_b64_tr_b16 v[238:239], v13 offset:45568
    v_mfma_f32_16x16x32_bf16 v[44:47], v[116:119], v[96:99], v[44:47]
    s_waitcnt lgkmcnt(14)
    ds_read_b128 v[212:215], v11 offset:34816
    v_mfma_f32_16x16x32_bf16 v[176:179], v[120:123], v[96:99], v[176:179]
    s_waitcnt lgkmcnt(14)
    ds_read_b128 v[216:219], v11 offset:36864
    s_waitcnt lgkmcnt(14)
    v_mfma_f32_16x16x32_bf16 v[180:183], v[124:127], v[96:99], v[180:183]
    ds_read_b128 v[220:223], v11 offset:38912
    s_waitcnt lgkmcnt(14)
    v_mfma_f32_16x16x32_bf16 v[188:191], v[124:127], v[100:103], v[188:191]
    v_mfma_f32_16x16x32_bf16 v[184:187], v[120:123], v[100:103], v[184:187]
    v_mfma_f32_16x16x32_bf16 v[52:55], v[116:119], v[100:103], v[52:55]
    v_mfma_f32_16x16x32_bf16 v[48:51], v[112:115], v[100:103], v[48:51]
    s_waitcnt lgkmcnt(13)
    v_mfma_f32_16x16x32_bf16 v[56:59], v[112:115], v[104:107], v[56:59]
    v_mfma_f32_16x16x32_bf16 v[60:63], v[116:119], v[104:107], v[60:63]
    v_mfma_f32_16x16x32_bf16 v[192:195], v[120:123], v[104:107], v[192:195]
    v_mfma_f32_16x16x32_bf16 v[196:199], v[124:127], v[104:107], v[196:199]
    s_waitcnt lgkmcnt(0)
    s_barrier
    v_mfma_f32_16x16x32_bf16 v[204:207], v[124:127], v[108:111], v[204:207]
    ds_read_b128 v[80:83], v10 offset:49152
    v_mfma_f32_16x16x32_bf16 v[200:203], v[120:123], v[108:111], v[200:203]
    ds_read_b64_tr_b16 v[128:129], v12 offset:49152
    v_mfma_f32_16x16x32_bf16 v[68:71], v[116:119], v[108:111], v[68:71]
    ds_read_b64_tr_b16 v[130:131], v12 offset:49664
    v_mfma_f32_16x16x32_bf16 v[64:67], v[112:115], v[108:111], v[64:67]
    ds_read_b64_tr_b16 v[132:133], v13 offset:49152
    v_mfma_f32_16x16x32_bf16 v[40:43], v[224:227], v[208:211], v[40:43]
    ds_read_b64_tr_b16 v[134:135], v13 offset:49664
    v_mfma_f32_16x16x32_bf16 v[44:47], v[228:231], v[208:211], v[44:47]
    ds_read_b64_tr_b16 v[136:137], v12 offset:57344
    v_mfma_f32_16x16x32_bf16 v[176:179], v[232:235], v[208:211], v[176:179]
    ds_read_b64_tr_b16 v[138:139], v12 offset:57856
    v_mfma_f32_16x16x32_bf16 v[180:183], v[236:239], v[208:211], v[180:183]
    ds_read_b64_tr_b16 v[140:141], v13 offset:57344
    v_mfma_f32_16x16x32_bf16 v[188:191], v[236:239], v[212:215], v[188:191]
    ds_read_b64_tr_b16 v[142:143], v13 offset:57856
    v_mfma_f32_16x16x32_bf16 v[184:187], v[232:235], v[212:215], v[184:187]
    ds_read_b128 v[84:87], v10 offset:51200
    v_mfma_f32_16x16x32_bf16 v[52:55], v[228:231], v[212:215], v[52:55]
    ds_read_b128 v[88:91], v10 offset:53248
    v_mfma_f32_16x16x32_bf16 v[48:51], v[224:227], v[212:215], v[48:51]
    ds_read_b128 v[92:95], v10 offset:55296
    v_mfma_f32_16x16x32_bf16 v[56:59], v[224:227], v[216:219], v[56:59]
    ds_read_b128 v[96:99], v11 offset:49152
    v_mfma_f32_16x16x32_bf16 v[60:63], v[228:231], v[216:219], v[60:63]
    ds_read_b64_tr_b16 v[112:113], v12 offset:53248
    v_mfma_f32_16x16x32_bf16 v[192:195], v[232:235], v[216:219], v[192:195]
    ds_read_b64_tr_b16 v[114:115], v12 offset:53760
    v_mfma_f32_16x16x32_bf16 v[196:199], v[236:239], v[216:219], v[196:199]
    s_waitcnt lgkmcnt(14)
    ds_read_b64_tr_b16 v[116:117], v13 offset:53248
    v_mfma_f32_16x16x32_bf16 v[204:207], v[236:239], v[220:223], v[204:207]
    s_waitcnt lgkmcnt(14)
    ds_read_b64_tr_b16 v[118:119], v13 offset:53760
    v_mfma_f32_16x16x32_bf16 v[200:203], v[232:235], v[220:223], v[200:203]
    s_waitcnt lgkmcnt(14)
    ds_read_b64_tr_b16 v[120:121], v12 offset:61440
    v_mfma_f32_16x16x32_bf16 v[68:71], v[228:231], v[220:223], v[68:71]
    s_waitcnt lgkmcnt(14)
    ds_read_b64_tr_b16 v[122:123], v12 offset:61952
    v_mfma_f32_16x16x32_bf16 v[64:67], v[224:227], v[220:223], v[64:67]
    s_waitcnt lgkmcnt(14)
    ds_read_b64_tr_b16 v[124:125], v13 offset:61440
    v_mfma_f32_16x16x32_bf16 v[40:43], v[128:131], v[80:83], v[40:43]
    s_waitcnt lgkmcnt(14)
    ds_read_b64_tr_b16 v[126:127], v13 offset:61952
    v_mfma_f32_16x16x32_bf16 v[44:47], v[132:135], v[80:83], v[44:47]
    s_waitcnt lgkmcnt(14)
    ds_read_b128 v[100:103], v11 offset:51200
    v_mfma_f32_16x16x32_bf16 v[176:179], v[136:139], v[80:83], v[176:179]
    s_waitcnt lgkmcnt(14)
    ds_read_b128 v[104:107], v11 offset:53248
    s_waitcnt lgkmcnt(14)
    v_mfma_f32_16x16x32_bf16 v[180:183], v[140:143], v[80:83], v[180:183]
    ds_read_b128 v[108:111], v11 offset:55296
    s_waitcnt lgkmcnt(14)
    v_mfma_f32_16x16x32_bf16 v[188:191], v[140:143], v[84:87], v[188:191]
    v_mfma_f32_16x16x32_bf16 v[184:187], v[136:139], v[84:87], v[184:187]
    v_mfma_f32_16x16x32_bf16 v[52:55], v[132:135], v[84:87], v[52:55]
    v_mfma_f32_16x16x32_bf16 v[48:51], v[128:131], v[84:87], v[48:51]
    s_waitcnt lgkmcnt(13)
    v_mfma_f32_16x16x32_bf16 v[56:59], v[128:131], v[88:91], v[56:59]
    v_mfma_f32_16x16x32_bf16 v[60:63], v[132:135], v[88:91], v[60:63]
    v_mfma_f32_16x16x32_bf16 v[192:195], v[136:139], v[88:91], v[192:195]
    v_mfma_f32_16x16x32_bf16 v[196:199], v[140:143], v[88:91], v[196:199]
    s_waitcnt lgkmcnt(0)
    s_barrier
    v_mfma_f32_16x16x32_bf16 v[204:207], v[140:143], v[92:95], v[204:207]
    ds_read_b128 v[208:211], v10 offset:0
    v_mfma_f32_16x16x32_bf16 v[200:203], v[136:139], v[92:95], v[200:203]
    ds_read_b64_tr_b16 v[224:225], v12 offset:0
    v_mfma_f32_16x16x32_bf16 v[68:71], v[132:135], v[92:95], v[68:71]
    ds_read_b64_tr_b16 v[226:227], v12 offset:512
    v_mfma_f32_16x16x32_bf16 v[64:67], v[128:131], v[92:95], v[64:67]
    ds_read_b64_tr_b16 v[228:229], v13 offset:0
    v_mfma_f32_16x16x32_bf16 v[40:43], v[112:115], v[96:99], v[40:43]
    ds_read_b64_tr_b16 v[230:231], v13 offset:512
    v_mfma_f32_16x16x32_bf16 v[44:47], v[116:119], v[96:99], v[44:47]
    ds_read_b64_tr_b16 v[232:233], v12 offset:8192
    v_mfma_f32_16x16x32_bf16 v[176:179], v[120:123], v[96:99], v[176:179]
    ds_read_b64_tr_b16 v[234:235], v12 offset:8704
    v_mfma_f32_16x16x32_bf16 v[180:183], v[124:127], v[96:99], v[180:183]
    ds_read_b64_tr_b16 v[236:237], v13 offset:8192
    v_mfma_f32_16x16x32_bf16 v[188:191], v[124:127], v[100:103], v[188:191]
    ds_read_b64_tr_b16 v[238:239], v13 offset:8704
    v_mfma_f32_16x16x32_bf16 v[184:187], v[120:123], v[100:103], v[184:187]
    ds_read_b128 v[212:215], v10 offset:2048
    v_mfma_f32_16x16x32_bf16 v[52:55], v[116:119], v[100:103], v[52:55]
    ds_read_b128 v[216:219], v10 offset:4096
    v_mfma_f32_16x16x32_bf16 v[48:51], v[112:115], v[100:103], v[48:51]
    ds_read_b128 v[220:223], v10 offset:6144
    v_mfma_f32_16x16x32_bf16 v[56:59], v[112:115], v[104:107], v[56:59]
    ds_read_b128 v[80:83], v11 offset:0
    v_mfma_f32_16x16x32_bf16 v[60:63], v[116:119], v[104:107], v[60:63]
    ds_read_b64_tr_b16 v[128:129], v12 offset:4096
    v_mfma_f32_16x16x32_bf16 v[192:195], v[120:123], v[104:107], v[192:195]
    ds_read_b64_tr_b16 v[130:131], v12 offset:4608
    v_mfma_f32_16x16x32_bf16 v[196:199], v[124:127], v[104:107], v[196:199]
    s_waitcnt lgkmcnt(14)
    ds_read_b64_tr_b16 v[132:133], v13 offset:4096
    v_mfma_f32_16x16x32_bf16 v[204:207], v[124:127], v[108:111], v[204:207]
    s_waitcnt lgkmcnt(14)
    ds_read_b64_tr_b16 v[134:135], v13 offset:4608
    v_mfma_f32_16x16x32_bf16 v[200:203], v[120:123], v[108:111], v[200:203]
    s_waitcnt lgkmcnt(14)
    ds_read_b64_tr_b16 v[136:137], v12 offset:12288
    v_mfma_f32_16x16x32_bf16 v[68:71], v[116:119], v[108:111], v[68:71]
    s_waitcnt lgkmcnt(14)
    ds_read_b64_tr_b16 v[138:139], v12 offset:12800
    v_mfma_f32_16x16x32_bf16 v[64:67], v[112:115], v[108:111], v[64:67]
    s_waitcnt lgkmcnt(14)
    ds_read_b64_tr_b16 v[140:141], v13 offset:12288
    v_mfma_f32_16x16x32_bf16 v[40:43], v[224:227], v[208:211], v[40:43]
    s_waitcnt lgkmcnt(14)
    ds_read_b64_tr_b16 v[142:143], v13 offset:12800
    v_mfma_f32_16x16x32_bf16 v[44:47], v[228:231], v[208:211], v[44:47]
    s_waitcnt lgkmcnt(14)
    ds_read_b128 v[84:87], v11 offset:2048
    v_mfma_f32_16x16x32_bf16 v[176:179], v[232:235], v[208:211], v[176:179]
    s_waitcnt lgkmcnt(14)
    ds_read_b128 v[88:91], v11 offset:4096
    s_waitcnt lgkmcnt(14)
    v_mfma_f32_16x16x32_bf16 v[180:183], v[236:239], v[208:211], v[180:183]
    ds_read_b128 v[92:95], v11 offset:6144
    s_waitcnt lgkmcnt(14)
    v_mfma_f32_16x16x32_bf16 v[188:191], v[236:239], v[212:215], v[188:191]
    v_mfma_f32_16x16x32_bf16 v[184:187], v[232:235], v[212:215], v[184:187]
    v_mfma_f32_16x16x32_bf16 v[52:55], v[228:231], v[212:215], v[52:55]
    v_mfma_f32_16x16x32_bf16 v[48:51], v[224:227], v[212:215], v[48:51]
    s_waitcnt lgkmcnt(13)
    v_mfma_f32_16x16x32_bf16 v[56:59], v[224:227], v[216:219], v[56:59]
    v_mfma_f32_16x16x32_bf16 v[60:63], v[228:231], v[216:219], v[60:63]
    v_mfma_f32_16x16x32_bf16 v[192:195], v[232:235], v[216:219], v[192:195]
    v_mfma_f32_16x16x32_bf16 v[196:199], v[236:239], v[216:219], v[196:199]
    s_waitcnt lgkmcnt(0)
    s_barrier
    v_mfma_f32_16x16x32_bf16 v[204:207], v[236:239], v[220:223], v[204:207]
    ds_read_b128 v[96:99], v10 offset:16384
    v_mfma_f32_16x16x32_bf16 v[200:203], v[232:235], v[220:223], v[200:203]
    ds_read_b64_tr_b16 v[112:113], v12 offset:16384
    v_mfma_f32_16x16x32_bf16 v[68:71], v[228:231], v[220:223], v[68:71]
    ds_read_b64_tr_b16 v[114:115], v12 offset:16896
    v_mfma_f32_16x16x32_bf16 v[64:67], v[224:227], v[220:223], v[64:67]
    ds_read_b64_tr_b16 v[116:117], v13 offset:16384
    v_mfma_f32_16x16x32_bf16 v[40:43], v[128:131], v[80:83], v[40:43]
    ds_read_b64_tr_b16 v[118:119], v13 offset:16896
    v_mfma_f32_16x16x32_bf16 v[44:47], v[132:135], v[80:83], v[44:47]
    ds_read_b64_tr_b16 v[120:121], v12 offset:24576
    v_mfma_f32_16x16x32_bf16 v[176:179], v[136:139], v[80:83], v[176:179]
    ds_read_b64_tr_b16 v[122:123], v12 offset:25088
    v_mfma_f32_16x16x32_bf16 v[180:183], v[140:143], v[80:83], v[180:183]
    ds_read_b64_tr_b16 v[124:125], v13 offset:24576
    v_mfma_f32_16x16x32_bf16 v[188:191], v[140:143], v[84:87], v[188:191]
    ds_read_b64_tr_b16 v[126:127], v13 offset:25088
    v_mfma_f32_16x16x32_bf16 v[184:187], v[136:139], v[84:87], v[184:187]
    ds_read_b128 v[100:103], v10 offset:18432
    v_mfma_f32_16x16x32_bf16 v[52:55], v[132:135], v[84:87], v[52:55]
    ds_read_b128 v[104:107], v10 offset:20480
    v_mfma_f32_16x16x32_bf16 v[48:51], v[128:131], v[84:87], v[48:51]
    ds_read_b128 v[108:111], v10 offset:22528
    v_mfma_f32_16x16x32_bf16 v[56:59], v[128:131], v[88:91], v[56:59]
    ds_read_b128 v[208:211], v11 offset:16384
    v_mfma_f32_16x16x32_bf16 v[60:63], v[132:135], v[88:91], v[60:63]
    ds_read_b64_tr_b16 v[224:225], v12 offset:20480
    v_mfma_f32_16x16x32_bf16 v[192:195], v[136:139], v[88:91], v[192:195]
    ds_read_b64_tr_b16 v[226:227], v12 offset:20992
    v_mfma_f32_16x16x32_bf16 v[196:199], v[140:143], v[88:91], v[196:199]
    s_waitcnt lgkmcnt(14)
    ds_read_b64_tr_b16 v[228:229], v13 offset:20480
    v_mfma_f32_16x16x32_bf16 v[204:207], v[140:143], v[92:95], v[204:207]
    s_waitcnt lgkmcnt(14)
    ds_read_b64_tr_b16 v[230:231], v13 offset:20992
    v_mfma_f32_16x16x32_bf16 v[200:203], v[136:139], v[92:95], v[200:203]
    s_waitcnt lgkmcnt(14)
    ds_read_b64_tr_b16 v[232:233], v12 offset:28672
    v_mfma_f32_16x16x32_bf16 v[68:71], v[132:135], v[92:95], v[68:71]
    s_waitcnt lgkmcnt(14)
    ds_read_b64_tr_b16 v[234:235], v12 offset:29184
    v_mfma_f32_16x16x32_bf16 v[64:67], v[128:131], v[92:95], v[64:67]
    s_waitcnt lgkmcnt(14)
    ds_read_b64_tr_b16 v[236:237], v13 offset:28672
    v_mfma_f32_16x16x32_bf16 v[40:43], v[112:115], v[96:99], v[40:43]
    s_waitcnt lgkmcnt(14)
    ds_read_b64_tr_b16 v[238:239], v13 offset:29184
    v_mfma_f32_16x16x32_bf16 v[44:47], v[116:119], v[96:99], v[44:47]
    s_waitcnt lgkmcnt(14)
    ds_read_b128 v[212:215], v11 offset:18432
    v_mfma_f32_16x16x32_bf16 v[176:179], v[120:123], v[96:99], v[176:179]
    s_waitcnt lgkmcnt(14)
    ds_read_b128 v[216:219], v11 offset:20480
    s_waitcnt lgkmcnt(14)
    v_mfma_f32_16x16x32_bf16 v[180:183], v[124:127], v[96:99], v[180:183]
    ds_read_b128 v[220:223], v11 offset:22528
    s_waitcnt lgkmcnt(14)
    v_mfma_f32_16x16x32_bf16 v[188:191], v[124:127], v[100:103], v[188:191]
    v_mfma_f32_16x16x32_bf16 v[184:187], v[120:123], v[100:103], v[184:187]
    v_mfma_f32_16x16x32_bf16 v[52:55], v[116:119], v[100:103], v[52:55]
    v_mfma_f32_16x16x32_bf16 v[48:51], v[112:115], v[100:103], v[48:51]
    s_waitcnt lgkmcnt(13)
    v_mfma_f32_16x16x32_bf16 v[56:59], v[112:115], v[104:107], v[56:59]
    v_mfma_f32_16x16x32_bf16 v[60:63], v[116:119], v[104:107], v[60:63]
    v_mfma_f32_16x16x32_bf16 v[192:195], v[120:123], v[104:107], v[192:195]
    v_mfma_f32_16x16x32_bf16 v[196:199], v[124:127], v[104:107], v[196:199]
    s_waitcnt lgkmcnt(0)
    s_barrier
    v_mfma_f32_16x16x32_bf16 v[204:207], v[124:127], v[108:111], v[204:207]
    ds_read_b128 v[80:83], v10 offset:32768
    v_mfma_f32_16x16x32_bf16 v[200:203], v[120:123], v[108:111], v[200:203]
    ds_read_b64_tr_b16 v[128:129], v12 offset:32768
    v_mfma_f32_16x16x32_bf16 v[68:71], v[116:119], v[108:111], v[68:71]
    ds_read_b64_tr_b16 v[130:131], v12 offset:33280
    v_mfma_f32_16x16x32_bf16 v[64:67], v[112:115], v[108:111], v[64:67]
    ds_read_b64_tr_b16 v[132:133], v13 offset:32768
    v_mfma_f32_16x16x32_bf16 v[40:43], v[224:227], v[208:211], v[40:43]
    ds_read_b64_tr_b16 v[134:135], v13 offset:33280
    v_mfma_f32_16x16x32_bf16 v[44:47], v[228:231], v[208:211], v[44:47]
    ds_read_b64_tr_b16 v[136:137], v12 offset:40960
    v_mfma_f32_16x16x32_bf16 v[176:179], v[232:235], v[208:211], v[176:179]
    ds_read_b64_tr_b16 v[138:139], v12 offset:41472
    v_mfma_f32_16x16x32_bf16 v[180:183], v[236:239], v[208:211], v[180:183]
    ds_read_b64_tr_b16 v[140:141], v13 offset:40960
    v_mfma_f32_16x16x32_bf16 v[188:191], v[236:239], v[212:215], v[188:191]
    ds_read_b64_tr_b16 v[142:143], v13 offset:41472
    v_mfma_f32_16x16x32_bf16 v[184:187], v[232:235], v[212:215], v[184:187]
    ds_read_b128 v[84:87], v10 offset:34816
    v_mfma_f32_16x16x32_bf16 v[52:55], v[228:231], v[212:215], v[52:55]
    ds_read_b128 v[88:91], v10 offset:36864
    v_mfma_f32_16x16x32_bf16 v[48:51], v[224:227], v[212:215], v[48:51]
    ds_read_b128 v[92:95], v10 offset:38912
    v_mfma_f32_16x16x32_bf16 v[56:59], v[224:227], v[216:219], v[56:59]
    ds_read_b128 v[96:99], v11 offset:32768
    v_mfma_f32_16x16x32_bf16 v[60:63], v[228:231], v[216:219], v[60:63]
    ds_read_b64_tr_b16 v[112:113], v12 offset:36864
    v_mfma_f32_16x16x32_bf16 v[192:195], v[232:235], v[216:219], v[192:195]
    ds_read_b64_tr_b16 v[114:115], v12 offset:37376
    v_mfma_f32_16x16x32_bf16 v[196:199], v[236:239], v[216:219], v[196:199]
    s_waitcnt lgkmcnt(14)
    ds_read_b64_tr_b16 v[116:117], v13 offset:36864
    v_mfma_f32_16x16x32_bf16 v[204:207], v[236:239], v[220:223], v[204:207]
    s_waitcnt lgkmcnt(14)
    ds_read_b64_tr_b16 v[118:119], v13 offset:37376
    v_mfma_f32_16x16x32_bf16 v[200:203], v[232:235], v[220:223], v[200:203]
    s_waitcnt lgkmcnt(14)
    ds_read_b64_tr_b16 v[120:121], v12 offset:45056
    v_mfma_f32_16x16x32_bf16 v[68:71], v[228:231], v[220:223], v[68:71]
    s_waitcnt lgkmcnt(14)
    ds_read_b64_tr_b16 v[122:123], v12 offset:45568
    v_mfma_f32_16x16x32_bf16 v[64:67], v[224:227], v[220:223], v[64:67]
    s_waitcnt lgkmcnt(14)
    ds_read_b64_tr_b16 v[124:125], v13 offset:45056
    v_mfma_f32_16x16x32_bf16 v[40:43], v[128:131], v[80:83], v[40:43]
    s_waitcnt lgkmcnt(14)
    ds_read_b64_tr_b16 v[126:127], v13 offset:45568
    v_mfma_f32_16x16x32_bf16 v[44:47], v[132:135], v[80:83], v[44:47]
    s_waitcnt lgkmcnt(14)
    ds_read_b128 v[100:103], v11 offset:34816
    v_mfma_f32_16x16x32_bf16 v[176:179], v[136:139], v[80:83], v[176:179]
    s_waitcnt lgkmcnt(14)
    ds_read_b128 v[104:107], v11 offset:36864
    s_waitcnt lgkmcnt(14)
    v_mfma_f32_16x16x32_bf16 v[180:183], v[140:143], v[80:83], v[180:183]
    ds_read_b128 v[108:111], v11 offset:38912
    s_waitcnt lgkmcnt(14)
    v_mfma_f32_16x16x32_bf16 v[188:191], v[140:143], v[84:87], v[188:191]
    v_mfma_f32_16x16x32_bf16 v[184:187], v[136:139], v[84:87], v[184:187]
    v_mfma_f32_16x16x32_bf16 v[52:55], v[132:135], v[84:87], v[52:55]
    v_mfma_f32_16x16x32_bf16 v[48:51], v[128:131], v[84:87], v[48:51]
    s_waitcnt lgkmcnt(13)
    v_mfma_f32_16x16x32_bf16 v[56:59], v[128:131], v[88:91], v[56:59]
    v_mfma_f32_16x16x32_bf16 v[60:63], v[132:135], v[88:91], v[60:63]
    v_mfma_f32_16x16x32_bf16 v[192:195], v[136:139], v[88:91], v[192:195]
    v_mfma_f32_16x16x32_bf16 v[196:199], v[140:143], v[88:91], v[196:199]
    s_waitcnt lgkmcnt(0)
    s_barrier
    v_mfma_f32_16x16x32_bf16 v[204:207], v[140:143], v[92:95], v[204:207]
    ds_read_b128 v[208:211], v10 offset:49152
    v_mfma_f32_16x16x32_bf16 v[200:203], v[136:139], v[92:95], v[200:203]
    ds_read_b64_tr_b16 v[224:225], v12 offset:49152
    v_mfma_f32_16x16x32_bf16 v[68:71], v[132:135], v[92:95], v[68:71]
    ds_read_b64_tr_b16 v[226:227], v12 offset:49664
    v_mfma_f32_16x16x32_bf16 v[64:67], v[128:131], v[92:95], v[64:67]
    ds_read_b64_tr_b16 v[228:229], v13 offset:49152
    v_mfma_f32_16x16x32_bf16 v[40:43], v[112:115], v[96:99], v[40:43]
    ds_read_b64_tr_b16 v[230:231], v13 offset:49664
    v_mfma_f32_16x16x32_bf16 v[44:47], v[116:119], v[96:99], v[44:47]
    ds_read_b64_tr_b16 v[232:233], v12 offset:57344
    v_mfma_f32_16x16x32_bf16 v[176:179], v[120:123], v[96:99], v[176:179]
    ds_read_b64_tr_b16 v[234:235], v12 offset:57856
    v_mfma_f32_16x16x32_bf16 v[180:183], v[124:127], v[96:99], v[180:183]
    ds_read_b64_tr_b16 v[236:237], v13 offset:57344
    v_mfma_f32_16x16x32_bf16 v[188:191], v[124:127], v[100:103], v[188:191]
    ds_read_b64_tr_b16 v[238:239], v13 offset:57856
    v_mfma_f32_16x16x32_bf16 v[184:187], v[120:123], v[100:103], v[184:187]
L_pad_2:
    s_cbranch_execz L_ret_y1
    ds_read_b128 v[212:215], v10 offset:51200
    v_mfma_f32_16x16x32_bf16 v[52:55], v[116:119], v[100:103], v[52:55]
    ds_read_b128 v[216:219], v10 offset:53248
    v_mfma_f32_16x16x32_bf16 v[48:51], v[112:115], v[100:103], v[48:51]
    ds_read_b128 v[220:223], v10 offset:55296
    v_mfma_f32_16x16x32_bf16 v[56:59], v[112:115], v[104:107], v[56:59]
    ds_read_b128 v[80:83], v11 offset:49152
    v_mfma_f32_16x16x32_bf16 v[60:63], v[116:119], v[104:107], v[60:63]
    ds_read_b64_tr_b16 v[128:129], v12 offset:53248
    v_mfma_f32_16x16x32_bf16 v[192:195], v[120:123], v[104:107], v[192:195]
    ds_read_b64_tr_b16 v[130:131], v12 offset:53760
    v_mfma_f32_16x16x32_bf16 v[196:199], v[124:127], v[104:107], v[196:199]
    s_waitcnt lgkmcnt(14)
    ds_read_b64_tr_b16 v[132:133], v13 offset:53248
    v_mfma_f32_16x16x32_bf16 v[204:207], v[124:127], v[108:111], v[204:207]
    s_waitcnt lgkmcnt(14)
    ds_read_b64_tr_b16 v[134:135], v13 offset:53760
    v_mfma_f32_16x16x32_bf16 v[200:203], v[120:123], v[108:111], v[200:203]
    s_waitcnt lgkmcnt(14)
    ds_read_b64_tr_b16 v[136:137], v12 offset:61440
    v_mfma_f32_16x16x32_bf16 v[68:71], v[116:119], v[108:111], v[68:71]
    s_waitcnt lgkmcnt(14)
    ds_read_b64_tr_b16 v[138:139], v12 offset:61952
    v_mfma_f32_16x16x32_bf16 v[64:67], v[112:115], v[108:111], v[64:67]
    s_waitcnt lgkmcnt(14)
    ds_read_b64_tr_b16 v[140:141], v13 offset:61440
    v_mfma_f32_16x16x32_bf16 v[40:43], v[224:227], v[208:211], v[40:43]
    s_waitcnt lgkmcnt(14)
    ds_read_b64_tr_b16 v[142:143], v13 offset:61952
    v_mfma_f32_16x16x32_bf16 v[44:47], v[228:231], v[208:211], v[44:47]
    s_waitcnt lgkmcnt(14)
    ds_read_b128 v[84:87], v11 offset:51200
    v_mfma_f32_16x16x32_bf16 v[176:179], v[232:235], v[208:211], v[176:179]
    s_waitcnt lgkmcnt(14)
    ds_read_b128 v[88:91], v11 offset:53248
    s_waitcnt lgkmcnt(14)
    v_mfma_f32_16x16x32_bf16 v[180:183], v[236:239], v[208:211], v[180:183]
    ds_read_b128 v[92:95], v11 offset:55296
    s_waitcnt lgkmcnt(14)
    v_mfma_f32_16x16x32_bf16 v[188:191], v[236:239], v[212:215], v[188:191]
    v_mfma_f32_16x16x32_bf16 v[184:187], v[232:235], v[212:215], v[184:187]
    v_mfma_f32_16x16x32_bf16 v[52:55], v[228:231], v[212:215], v[52:55]
    v_mfma_f32_16x16x32_bf16 v[48:51], v[224:227], v[212:215], v[48:51]
    s_waitcnt lgkmcnt(13)
    v_mfma_f32_16x16x32_bf16 v[56:59], v[224:227], v[216:219], v[56:59]
    v_mfma_f32_16x16x32_bf16 v[60:63], v[228:231], v[216:219], v[60:63]
    v_mfma_f32_16x16x32_bf16 v[192:195], v[232:235], v[216:219], v[192:195]
    v_mfma_f32_16x16x32_bf16 v[196:199], v[236:239], v[216:219], v[196:199]
    s_waitcnt lgkmcnt(0)
    s_barrier
    v_mfma_f32_16x16x32_bf16 v[204:207], v[236:239], v[220:223], v[204:207]
    ds_read_b128 v[96:99], v10 offset:0
    v_mfma_f32_16x16x32_bf16 v[200:203], v[232:235], v[220:223], v[200:203]
    ds_read_b64_tr_b16 v[112:113], v12 offset:0
    v_mfma_f32_16x16x32_bf16 v[68:71], v[228:231], v[220:223], v[68:71]
    ds_read_b64_tr_b16 v[114:115], v12 offset:512
    v_mfma_f32_16x16x32_bf16 v[64:67], v[224:227], v[220:223], v[64:67]
    ds_read_b64_tr_b16 v[116:117], v13 offset:0
    v_mfma_f32_16x16x32_bf16 v[40:43], v[128:131], v[80:83], v[40:43]
    ds_read_b64_tr_b16 v[118:119], v13 offset:512
    v_mfma_f32_16x16x32_bf16 v[44:47], v[132:135], v[80:83], v[44:47]
    ds_read_b64_tr_b16 v[120:121], v12 offset:8192
    v_mfma_f32_16x16x32_bf16 v[176:179], v[136:139], v[80:83], v[176:179]
    ds_read_b64_tr_b16 v[122:123], v12 offset:8704
    v_mfma_f32_16x16x32_bf16 v[180:183], v[140:143], v[80:83], v[180:183]
    ds_read_b64_tr_b16 v[124:125], v13 offset:8192
    v_mfma_f32_16x16x32_bf16 v[188:191], v[140:143], v[84:87], v[188:191]
    ds_read_b64_tr_b16 v[126:127], v13 offset:8704
    v_mfma_f32_16x16x32_bf16 v[184:187], v[136:139], v[84:87], v[184:187]
    ds_read_b128 v[100:103], v10 offset:2048
    v_mfma_f32_16x16x32_bf16 v[52:55], v[132:135], v[84:87], v[52:55]
    ds_read_b128 v[104:107], v10 offset:4096
    v_mfma_f32_16x16x32_bf16 v[48:51], v[128:131], v[84:87], v[48:51]
    ds_read_b128 v[108:111], v10 offset:6144
    v_mfma_f32_16x16x32_bf16 v[56:59], v[128:131], v[88:91], v[56:59]
    ds_read_b128 v[208:211], v11 offset:0
    v_mfma_f32_16x16x32_bf16 v[60:63], v[132:135], v[88:91], v[60:63]
    ds_read_b64_tr_b16 v[224:225], v12 offset:4096
    v_mfma_f32_16x16x32_bf16 v[192:195], v[136:139], v[88:91], v[192:195]
    ds_read_b64_tr_b16 v[226:227], v12 offset:4608
    v_mfma_f32_16x16x32_bf16 v[196:199], v[140:143], v[88:91], v[196:199]
    s_waitcnt lgkmcnt(14)
    ds_read_b64_tr_b16 v[228:229], v13 offset:4096
    v_mfma_f32_16x16x32_bf16 v[204:207], v[140:143], v[92:95], v[204:207]
    s_waitcnt lgkmcnt(14)
    ds_read_b64_tr_b16 v[230:231], v13 offset:4608
    v_mfma_f32_16x16x32_bf16 v[200:203], v[136:139], v[92:95], v[200:203]
    s_waitcnt lgkmcnt(14)
    ds_read_b64_tr_b16 v[232:233], v12 offset:12288
    v_mfma_f32_16x16x32_bf16 v[68:71], v[132:135], v[92:95], v[68:71]
    s_waitcnt lgkmcnt(14)
    ds_read_b64_tr_b16 v[234:235], v12 offset:12800
    v_mfma_f32_16x16x32_bf16 v[64:67], v[128:131], v[92:95], v[64:67]
    s_waitcnt lgkmcnt(14)
    ds_read_b64_tr_b16 v[236:237], v13 offset:12288
    v_mfma_f32_16x16x32_bf16 v[40:43], v[112:115], v[96:99], v[40:43]
    s_waitcnt lgkmcnt(14)
    ds_read_b64_tr_b16 v[238:239], v13 offset:12800
    v_mfma_f32_16x16x32_bf16 v[44:47], v[116:119], v[96:99], v[44:47]
    s_waitcnt lgkmcnt(14)
    ds_read_b128 v[212:215], v11 offset:2048
    v_mfma_f32_16x16x32_bf16 v[176:179], v[120:123], v[96:99], v[176:179]
    s_waitcnt lgkmcnt(14)
    ds_read_b128 v[216:219], v11 offset:4096
    s_waitcnt lgkmcnt(14)
    v_mfma_f32_16x16x32_bf16 v[180:183], v[124:127], v[96:99], v[180:183]
    ds_read_b128 v[220:223], v11 offset:6144
    s_waitcnt lgkmcnt(14)
    v_mfma_f32_16x16x32_bf16 v[188:191], v[124:127], v[100:103], v[188:191]
    v_mfma_f32_16x16x32_bf16 v[184:187], v[120:123], v[100:103], v[184:187]
    v_mfma_f32_16x16x32_bf16 v[52:55], v[116:119], v[100:103], v[52:55]
    v_mfma_f32_16x16x32_bf16 v[48:51], v[112:115], v[100:103], v[48:51]
    s_waitcnt lgkmcnt(13)
    v_mfma_f32_16x16x32_bf16 v[56:59], v[112:115], v[104:107], v[56:59]
    v_mfma_f32_16x16x32_bf16 v[60:63], v[116:119], v[104:107], v[60:63]
    v_mfma_f32_16x16x32_bf16 v[192:195], v[120:123], v[104:107], v[192:195]
    v_mfma_f32_16x16x32_bf16 v[196:199], v[124:127], v[104:107], v[196:199]
    s_waitcnt lgkmcnt(0)
    s_barrier
    v_mfma_f32_16x16x32_bf16 v[204:207], v[124:127], v[108:111], v[204:207]
    ds_read_b128 v[80:83], v10 offset:16384
    v_mfma_f32_16x16x32_bf16 v[200:203], v[120:123], v[108:111], v[200:203]
    ds_read_b64_tr_b16 v[128:129], v12 offset:16384
    v_mfma_f32_16x16x32_bf16 v[68:71], v[116:119], v[108:111], v[68:71]
    ds_read_b64_tr_b16 v[130:131], v12 offset:16896
    v_mfma_f32_16x16x32_bf16 v[64:67], v[112:115], v[108:111], v[64:67]
    ds_read_b64_tr_b16 v[132:133], v13 offset:16384
    v_mfma_f32_16x16x32_bf16 v[40:43], v[224:227], v[208:211], v[40:43]
    ds_read_b64_tr_b16 v[134:135], v13 offset:16896
    v_mfma_f32_16x16x32_bf16 v[44:47], v[228:231], v[208:211], v[44:47]
    ds_read_b64_tr_b16 v[136:137], v12 offset:24576
    v_mfma_f32_16x16x32_bf16 v[176:179], v[232:235], v[208:211], v[176:179]
    ds_read_b64_tr_b16 v[138:139], v12 offset:25088
    v_mfma_f32_16x16x32_bf16 v[180:183], v[236:239], v[208:211], v[180:183]
    ds_read_b64_tr_b16 v[140:141], v13 offset:24576
    v_mfma_f32_16x16x32_bf16 v[188:191], v[236:239], v[212:215], v[188:191]
    ds_read_b64_tr_b16 v[142:143], v13 offset:25088
    v_mfma_f32_16x16x32_bf16 v[184:187], v[232:235], v[212:215], v[184:187]
    ds_read_b128 v[84:87], v10 offset:18432
    v_mfma_f32_16x16x32_bf16 v[52:55], v[228:231], v[212:215], v[52:55]
    ds_read_b128 v[88:91], v10 offset:20480
    v_mfma_f32_16x16x32_bf16 v[48:51], v[224:227], v[212:215], v[48:51]
    ds_read_b128 v[92:95], v10 offset:22528
    v_mfma_f32_16x16x32_bf16 v[56:59], v[224:227], v[216:219], v[56:59]
    ds_read_b128 v[96:99], v11 offset:16384
    v_mfma_f32_16x16x32_bf16 v[60:63], v[228:231], v[216:219], v[60:63]
    ds_read_b64_tr_b16 v[112:113], v12 offset:20480
    v_mfma_f32_16x16x32_bf16 v[192:195], v[232:235], v[216:219], v[192:195]
    ds_read_b64_tr_b16 v[114:115], v12 offset:20992
    v_mfma_f32_16x16x32_bf16 v[196:199], v[236:239], v[216:219], v[196:199]
    s_waitcnt lgkmcnt(14)
    ds_read_b64_tr_b16 v[116:117], v13 offset:20480
    v_mfma_f32_16x16x32_bf16 v[204:207], v[236:239], v[220:223], v[204:207]
    s_waitcnt lgkmcnt(14)
    ds_read_b64_tr_b16 v[118:119], v13 offset:20992
    v_mfma_f32_16x16x32_bf16 v[200:203], v[232:235], v[220:223], v[200:203]
    s_waitcnt lgkmcnt(14)
    ds_read_b64_tr_b16 v[120:121], v12 offset:28672
    v_mfma_f32_16x16x32_bf16 v[68:71], v[228:231], v[220:223], v[68:71]
    s_waitcnt lgkmcnt(14)
    ds_read_b64_tr_b16 v[122:123], v12 offset:29184
    v_mfma_f32_16x16x32_bf16 v[64:67], v[224:227], v[220:223], v[64:67]
    s_waitcnt lgkmcnt(14)
    ds_read_b64_tr_b16 v[124:125], v13 offset:28672
    v_mfma_f32_16x16x32_bf16 v[40:43], v[128:131], v[80:83], v[40:43]
    s_waitcnt lgkmcnt(14)
    ds_read_b64_tr_b16 v[126:127], v13 offset:29184
    v_mfma_f32_16x16x32_bf16 v[44:47], v[132:135], v[80:83], v[44:47]
    s_waitcnt lgkmcnt(14)
    ds_read_b128 v[100:103], v11 offset:18432
    v_mfma_f32_16x16x32_bf16 v[176:179], v[136:139], v[80:83], v[176:179]
    s_waitcnt lgkmcnt(14)
    ds_read_b128 v[104:107], v11 offset:20480
    s_waitcnt lgkmcnt(14)
    v_mfma_f32_16x16x32_bf16 v[180:183], v[140:143], v[80:83], v[180:183]
    ds_read_b128 v[108:111], v11 offset:22528
    s_waitcnt lgkmcnt(14)
    v_mfma_f32_16x16x32_bf16 v[188:191], v[140:143], v[84:87], v[188:191]
    v_mfma_f32_16x16x32_bf16 v[184:187], v[136:139], v[84:87], v[184:187]
    v_mfma_f32_16x16x32_bf16 v[52:55], v[132:135], v[84:87], v[52:55]
    v_mfma_f32_16x16x32_bf16 v[48:51], v[128:131], v[84:87], v[48:51]
    s_waitcnt lgkmcnt(13)
    v_mfma_f32_16x16x32_bf16 v[56:59], v[128:131], v[88:91], v[56:59]
    v_mfma_f32_16x16x32_bf16 v[60:63], v[132:135], v[88:91], v[60:63]
    v_mfma_f32_16x16x32_bf16 v[192:195], v[136:139], v[88:91], v[192:195]
    v_mfma_f32_16x16x32_bf16 v[196:199], v[140:143], v[88:91], v[196:199]
    s_waitcnt lgkmcnt(0)
    s_barrier
    v_mfma_f32_16x16x32_bf16 v[204:207], v[140:143], v[92:95], v[204:207]
    ds_read_b128 v[208:211], v10 offset:32768
    v_mfma_f32_16x16x32_bf16 v[200:203], v[136:139], v[92:95], v[200:203]
    ds_read_b64_tr_b16 v[224:225], v12 offset:32768
    v_mfma_f32_16x16x32_bf16 v[68:71], v[132:135], v[92:95], v[68:71]
    ds_read_b64_tr_b16 v[226:227], v12 offset:33280
    v_mfma_f32_16x16x32_bf16 v[64:67], v[128:131], v[92:95], v[64:67]
    ds_read_b64_tr_b16 v[228:229], v13 offset:32768
    v_mfma_f32_16x16x32_bf16 v[40:43], v[112:115], v[96:99], v[40:43]
    ds_read_b64_tr_b16 v[230:231], v13 offset:33280
    v_mfma_f32_16x16x32_bf16 v[44:47], v[116:119], v[96:99], v[44:47]
    ds_read_b64_tr_b16 v[232:233], v12 offset:40960
    v_mfma_f32_16x16x32_bf16 v[176:179], v[120:123], v[96:99], v[176:179]
    ds_read_b64_tr_b16 v[234:235], v12 offset:41472
    v_mfma_f32_16x16x32_bf16 v[180:183], v[124:127], v[96:99], v[180:183]
    ds_read_b64_tr_b16 v[236:237], v13 offset:40960
    v_mfma_f32_16x16x32_bf16 v[188:191], v[124:127], v[100:103], v[188:191]
    ds_read_b64_tr_b16 v[238:239], v13 offset:41472
    v_mfma_f32_16x16x32_bf16 v[184:187], v[120:123], v[100:103], v[184:187]
    ds_read_b128 v[212:215], v10 offset:34816
    v_mfma_f32_16x16x32_bf16 v[52:55], v[116:119], v[100:103], v[52:55]
    ds_read_b128 v[216:219], v10 offset:36864
    v_mfma_f32_16x16x32_bf16 v[48:51], v[112:115], v[100:103], v[48:51]
    ds_read_b128 v[220:223], v10 offset:38912
    v_mfma_f32_16x16x32_bf16 v[56:59], v[112:115], v[104:107], v[56:59]
    ds_read_b128 v[80:83], v11 offset:32768
    v_mfma_f32_16x16x32_bf16 v[60:63], v[116:119], v[104:107], v[60:63]
    ds_read_b64_tr_b16 v[128:129], v12 offset:36864
    v_mfma_f32_16x16x32_bf16 v[192:195], v[120:123], v[104:107], v[192:195]
    ds_read_b64_tr_b16 v[130:131], v12 offset:37376
    v_mfma_f32_16x16x32_bf16 v[196:199], v[124:127], v[104:107], v[196:199]
    s_waitcnt lgkmcnt(14)
    ds_read_b64_tr_b16 v[132:133], v13 offset:36864
    v_mfma_f32_16x16x32_bf16 v[204:207], v[124:127], v[108:111], v[204:207]
    s_waitcnt lgkmcnt(14)
    ds_read_b64_tr_b16 v[134:135], v13 offset:37376
    v_mfma_f32_16x16x32_bf16 v[200:203], v[120:123], v[108:111], v[200:203]
    s_waitcnt lgkmcnt(14)
    ds_read_b64_tr_b16 v[136:137], v12 offset:45056
    v_mfma_f32_16x16x32_bf16 v[68:71], v[116:119], v[108:111], v[68:71]
    s_waitcnt lgkmcnt(14)
    ds_read_b64_tr_b16 v[138:139], v12 offset:45568
    v_mfma_f32_16x16x32_bf16 v[64:67], v[112:115], v[108:111], v[64:67]
    s_waitcnt lgkmcnt(14)
    ds_read_b64_tr_b16 v[140:141], v13 offset:45056
    v_mfma_f32_16x16x32_bf16 v[40:43], v[224:227], v[208:211], v[40:43]
    s_waitcnt lgkmcnt(14)
    ds_read_b64_tr_b16 v[142:143], v13 offset:45568
    v_mfma_f32_16x16x32_bf16 v[44:47], v[228:231], v[208:211], v[44:47]
    s_waitcnt lgkmcnt(14)
    ds_read_b128 v[84:87], v11 offset:34816
    v_mfma_f32_16x16x32_bf16 v[176:179], v[232:235], v[208:211], v[176:179]
    s_waitcnt lgkmcnt(14)
    ds_read_b128 v[88:91], v11 offset:36864
    s_waitcnt lgkmcnt(14)
    v_mfma_f32_16x16x32_bf16 v[180:183], v[236:239], v[208:211], v[180:183]
    ds_read_b128 v[92:95], v11 offset:38912
    s_waitcnt lgkmcnt(14)
    v_mfma_f32_16x16x32_bf16 v[188:191], v[236:239], v[212:215], v[188:191]
    v_mfma_f32_16x16x32_bf16 v[184:187], v[232:235], v[212:215], v[184:187]
    v_mfma_f32_16x16x32_bf16 v[52:55], v[228:231], v[212:215], v[52:55]
    v_mfma_f32_16x16x32_bf16 v[48:51], v[224:227], v[212:215], v[48:51]
    s_waitcnt lgkmcnt(13)
    v_mfma_f32_16x16x32_bf16 v[56:59], v[224:227], v[216:219], v[56:59]
    v_mfma_f32_16x16x32_bf16 v[60:63], v[228:231], v[216:219], v[60:63]
    v_mfma_f32_16x16x32_bf16 v[192:195], v[232:235], v[216:219], v[192:195]
    v_mfma_f32_16x16x32_bf16 v[196:199], v[236:239], v[216:219], v[196:199]
    s_waitcnt lgkmcnt(0)
    s_barrier
    v_mfma_f32_16x16x32_bf16 v[204:207], v[236:239], v[220:223], v[204:207]
    ds_read_b128 v[96:99], v10 offset:49152
    v_mfma_f32_16x16x32_bf16 v[200:203], v[232:235], v[220:223], v[200:203]
    ds_read_b64_tr_b16 v[112:113], v12 offset:49152
    v_mfma_f32_16x16x32_bf16 v[68:71], v[228:231], v[220:223], v[68:71]
    ds_read_b64_tr_b16 v[114:115], v12 offset:49664
    v_mfma_f32_16x16x32_bf16 v[64:67], v[224:227], v[220:223], v[64:67]
    ds_read_b64_tr_b16 v[116:117], v13 offset:49152
    v_mfma_f32_16x16x32_bf16 v[40:43], v[128:131], v[80:83], v[40:43]
    ds_read_b64_tr_b16 v[118:119], v13 offset:49664
    v_mfma_f32_16x16x32_bf16 v[44:47], v[132:135], v[80:83], v[44:47]
    ds_read_b64_tr_b16 v[120:121], v12 offset:57344
    v_mfma_f32_16x16x32_bf16 v[176:179], v[136:139], v[80:83], v[176:179]
    ds_read_b64_tr_b16 v[122:123], v12 offset:57856
    v_mfma_f32_16x16x32_bf16 v[180:183], v[140:143], v[80:83], v[180:183]
    ds_read_b64_tr_b16 v[124:125], v13 offset:57344
    v_mfma_f32_16x16x32_bf16 v[188:191], v[140:143], v[84:87], v[188:191]
    ds_read_b64_tr_b16 v[126:127], v13 offset:57856
    v_mfma_f32_16x16x32_bf16 v[184:187], v[136:139], v[84:87], v[184:187]
    ds_read_b128 v[100:103], v10 offset:51200
    v_mfma_f32_16x16x32_bf16 v[52:55], v[132:135], v[84:87], v[52:55]
    ds_read_b128 v[104:107], v10 offset:53248
    v_mfma_f32_16x16x32_bf16 v[48:51], v[128:131], v[84:87], v[48:51]
    ds_read_b128 v[108:111], v10 offset:55296
    v_mfma_f32_16x16x32_bf16 v[56:59], v[128:131], v[88:91], v[56:59]
    ds_read_b128 v[208:211], v11 offset:49152
    v_mfma_f32_16x16x32_bf16 v[60:63], v[132:135], v[88:91], v[60:63]
    ds_read_b64_tr_b16 v[224:225], v12 offset:53248
    v_mfma_f32_16x16x32_bf16 v[192:195], v[136:139], v[88:91], v[192:195]
    ds_read_b64_tr_b16 v[226:227], v12 offset:53760
    v_mfma_f32_16x16x32_bf16 v[196:199], v[140:143], v[88:91], v[196:199]
    s_waitcnt lgkmcnt(14)
    ds_read_b64_tr_b16 v[228:229], v13 offset:53248
    v_mfma_f32_16x16x32_bf16 v[204:207], v[140:143], v[92:95], v[204:207]
    s_waitcnt lgkmcnt(14)
    ds_read_b64_tr_b16 v[230:231], v13 offset:53760
    v_mfma_f32_16x16x32_bf16 v[200:203], v[136:139], v[92:95], v[200:203]
    s_waitcnt lgkmcnt(14)
    ds_read_b64_tr_b16 v[232:233], v12 offset:61440
    v_mfma_f32_16x16x32_bf16 v[68:71], v[132:135], v[92:95], v[68:71]
    s_waitcnt lgkmcnt(14)
    ds_read_b64_tr_b16 v[234:235], v12 offset:61952
    v_mfma_f32_16x16x32_bf16 v[64:67], v[128:131], v[92:95], v[64:67]
    s_waitcnt lgkmcnt(14)
    ds_read_b64_tr_b16 v[236:237], v13 offset:61440
    v_mfma_f32_16x16x32_bf16 v[40:43], v[112:115], v[96:99], v[40:43]
    s_waitcnt lgkmcnt(14)
    ds_read_b64_tr_b16 v[238:239], v13 offset:61952
    v_mfma_f32_16x16x32_bf16 v[44:47], v[116:119], v[96:99], v[44:47]
    s_waitcnt lgkmcnt(14)
    ds_read_b128 v[212:215], v11 offset:51200
    v_mfma_f32_16x16x32_bf16 v[176:179], v[120:123], v[96:99], v[176:179]
    s_waitcnt lgkmcnt(14)
    ds_read_b128 v[216:219], v11 offset:53248
    s_waitcnt lgkmcnt(14)
    v_mfma_f32_16x16x32_bf16 v[180:183], v[124:127], v[96:99], v[180:183]
    ds_read_b128 v[220:223], v11 offset:55296
    s_waitcnt lgkmcnt(14)
    v_mfma_f32_16x16x32_bf16 v[188:191], v[124:127], v[100:103], v[188:191]
    v_mfma_f32_16x16x32_bf16 v[184:187], v[120:123], v[100:103], v[184:187]
    v_mfma_f32_16x16x32_bf16 v[52:55], v[116:119], v[100:103], v[52:55]
    v_mfma_f32_16x16x32_bf16 v[48:51], v[112:115], v[100:103], v[48:51]
    s_waitcnt lgkmcnt(13)
    v_mfma_f32_16x16x32_bf16 v[56:59], v[112:115], v[104:107], v[56:59]
    v_mfma_f32_16x16x32_bf16 v[60:63], v[116:119], v[104:107], v[60:63]
    v_mfma_f32_16x16x32_bf16 v[192:195], v[120:123], v[104:107], v[192:195]
    v_mfma_f32_16x16x32_bf16 v[196:199], v[124:127], v[104:107], v[196:199]
    s_waitcnt lgkmcnt(0)
    s_barrier
    ds_read_b128 v[144:147], v22 offset:0
    ds_read_b128 v[148:151], v22 offset:1024
    ds_read_b128 v[160:163], v22 offset:2048
    ds_read_b128 v[164:167], v22 offset:3072
    v_mfma_f32_16x16x32_bf16 v[204:207], v[124:127], v[108:111], v[204:207]
    v_mfma_f32_16x16x32_bf16 v[200:203], v[120:123], v[108:111], v[200:203]
    v_mfma_f32_16x16x32_bf16 v[68:71], v[116:119], v[108:111], v[68:71]
    v_mfma_f32_16x16x32_bf16 v[64:67], v[112:115], v[108:111], v[64:67]
    v_mfma_f32_16x16x32_bf16 v[40:43], v[224:227], v[208:211], v[40:43]
    v_mfma_f32_16x16x32_bf16 v[44:47], v[228:231], v[208:211], v[44:47]
    v_mfma_f32_16x16x32_bf16 v[176:179], v[232:235], v[208:211], v[176:179]
    v_mfma_f32_16x16x32_bf16 v[180:183], v[236:239], v[208:211], v[180:183]
    v_mfma_f32_16x16x32_bf16 v[188:191], v[236:239], v[212:215], v[188:191]
    v_mfma_f32_16x16x32_bf16 v[184:187], v[232:235], v[212:215], v[184:187]
    v_mfma_f32_16x16x32_bf16 v[52:55], v[228:231], v[212:215], v[52:55]
    v_mfma_f32_16x16x32_bf16 v[48:51], v[224:227], v[212:215], v[48:51]
    v_mfma_f32_16x16x32_bf16 v[56:59], v[224:227], v[216:219], v[56:59]
    v_mfma_f32_16x16x32_bf16 v[60:63], v[228:231], v[216:219], v[60:63]
    v_mfma_f32_16x16x32_bf16 v[192:195], v[232:235], v[216:219], v[192:195]
    v_mfma_f32_16x16x32_bf16 v[196:199], v[236:239], v[216:219], v[196:199]
    v_mfma_f32_16x16x32_bf16 v[204:207], v[236:239], v[220:223], v[204:207]
    v_mfma_f32_16x16x32_bf16 v[200:203], v[232:235], v[220:223], v[200:203]
    v_mfma_f32_16x16x32_bf16 v[68:71], v[228:231], v[220:223], v[68:71]
    v_mfma_f32_16x16x32_bf16 v[64:67], v[224:227], v[220:223], v[64:67]
    s_lshl_b32 s70, s30, 12
    s_add_u32 s70, s70, 0xe00000
    v_cvt_pk_bf16_f32 v152, v176, v177
    v_cvt_pk_bf16_f32 v153, v178, v179
    v_cvt_pk_bf16_f32 v156, v180, v181
    v_cvt_pk_bf16_f32 v157, v182, v183
    v_cvt_pk_bf16_f32 v154, v184, v185
    v_cvt_pk_bf16_f32 v155, v186, v187
    v_cvt_pk_bf16_f32 v158, v188, v189
    v_cvt_pk_bf16_f32 v159, v190, v191
    v_permlane16_swap_b32 v152, v154
    v_permlane16_swap_b32 v153, v155
    v_permlane16_swap_b32 v156, v158
    v_permlane16_swap_b32 v157, v159
    v_cvt_pk_bf16_f32 v168, v192, v193
    v_cvt_pk_bf16_f32 v169, v194, v195
    v_cvt_pk_bf16_f32 v172, v196, v197
    v_cvt_pk_bf16_f32 v173, v198, v199
    v_cvt_pk_bf16_f32 v170, v200, v201
    v_cvt_pk_bf16_f32 v171, v202, v203
    v_cvt_pk_bf16_f32 v174, v204, v205
    v_cvt_pk_bf16_f32 v175, v206, v207
    v_permlane16_swap_b32 v168, v170
    v_permlane16_swap_b32 v169, v171
    v_permlane16_swap_b32 v172, v174
    v_permlane16_swap_b32 v173, v175
    buffer_store_dwordx4 v[152:155], v7, s[8:11], s70 offen offset:0 sc1
    buffer_store_dwordx4 v[156:159], v7, s[8:11], s70 offen offset:1024 sc1
    buffer_store_dwordx4 v[168:171], v7, s[8:11], s70 offen offset:2048 sc1
    buffer_store_dwordx4 v[172:175], v7, s[8:11], s70 offen offset:3072 sc1
    v_cvt_pk_bf16_f32 v80, v40, v41
    v_cvt_pk_bf16_f32 v81, v42, v43
    v_cvt_pk_bf16_f32 v84, v44, v45
    v_cvt_pk_bf16_f32 v85, v46, v47
    v_cvt_pk_bf16_f32 v82, v48, v49
    v_cvt_pk_bf16_f32 v83, v50, v51
    v_cvt_pk_bf16_f32 v86, v52, v53
    v_cvt_pk_bf16_f32 v87, v54, v55
    v_permlane16_swap_b32 v80, v82
    v_permlane16_swap_b32 v81, v83
    v_permlane16_swap_b32 v84, v86
    v_permlane16_swap_b32 v85, v87
    v_cvt_pk_bf16_f32 v88, v56, v57
    v_cvt_pk_bf16_f32 v89, v58, v59
    v_cvt_pk_bf16_f32 v92, v60, v61
    v_cvt_pk_bf16_f32 v93, v62, v63
    v_cvt_pk_bf16_f32 v90, v64, v65
    v_cvt_pk_bf16_f32 v91, v66, v67
    v_cvt_pk_bf16_f32 v94, v68, v69
    v_cvt_pk_bf16_f32 v95, v70, v71
    v_permlane16_swap_b32 v88, v90
    v_permlane16_swap_b32 v89, v91
    v_permlane16_swap_b32 v92, v94
    v_permlane16_swap_b32 v93, v95
L_att:
L_pad_att:
    s_cbranch_execz L_pad_4
    s_waitcnt lgkmcnt(0)
    v_mfma_f32_32x32x16_bf16 v[96:111], v[144:147], v[80:83], 0
    v_mfma_f32_32x32x16_bf16 v[96:111], v[148:151], v[84:87], v[96:111]
    s_nop 10
    ds_read_b128 v[152:155], v22 offset:4096
    v_exp_f32 v96, v96
    v_exp_f32 v97, v97
    v_exp_f32 v98, v98
    v_mfma_f32_32x32x16_bf16 v[112:127], v[144:147], v[88:91], 0
    ds_read_b128 v[156:159], v22 offset:5120
    v_cvt_pk_bf16_f32 v128, v96, v97
    v_exp_f32 v99, v99
    v_exp_f32 v100, v100
    v_cvt_pk_bf16_f32 v129, v98, v99
    v_exp_f32 v101, v101
    v_mfma_f32_32x32x16_bf16 v[112:127], v[148:151], v[92:95], v[112:127]
    v_cvt_pk_bf16_f32 v130, v100, v101
    v_exp_f32 v102, v102
    v_exp_f32 v103, v103
    v_exp_f32 v104, v104
    s_waitcnt lgkmcnt(0)
    v_cvt_pk_bf16_f32 v131, v102, v103
    v_exp_f32 v105, v105
    v_exp_f32 v106, v106
    v_cvt_pk_bf16_f32 v132, v104, v105
    v_exp_f32 v107, v107
    s_nop 0
    v_cvt_pk_bf16_f32 v133, v106, v107
    v_exp_f32 v108, v108
    v_exp_f32 v109, v109
    v_exp_f32 v110, v110
    v_cvt_pk_bf16_f32 v134, v108, v109
    v_exp_f32 v111, v111
    v_mfma_f32_32x32x16_bf16 v[40:55], v[160:163], v[128:131], 0
    ds_read_b128 v[168:171], v22 offset:6144
    v_cvt_pk_bf16_f32 v135, v110, v111
    v_exp_f32 v112, v112
    v_exp_f32 v113, v113
    v_exp_f32 v114, v114
    v_mfma_f32_32x32x16_bf16 v[96:111], v[152:155], v[80:83], 0
    ds_read_b128 v[172:175], v22 offset:7168
    v_cvt_pk_bf16_f32 v136, v112, v113
    v_exp_f32 v115, v115
    v_exp_f32 v116, v116
    v_cvt_pk_bf16_f32 v137, v114, v115
    v_exp_f32 v117, v117
    v_mfma_f32_32x32x16_bf16 v[96:111], v[156:159], v[84:87], v[96:111]
    v_cvt_pk_bf16_f32 v138, v116, v117
    v_exp_f32 v118, v118
    v_exp_f32 v119, v119
    v_exp_f32 v120, v120
    v_mfma_f32_32x32x16_bf16 v[40:55], v[164:167], v[132:135], v[40:55]
    s_waitcnt lgkmcnt(0)
    v_cvt_pk_bf16_f32 v139, v118, v119
    v_exp_f32 v121, v121
    v_exp_f32 v122, v122
    v_cvt_pk_bf16_f32 v140, v120, v121
    v_exp_f32 v123, v123
    v_smfmac_f32_16x16x64_bf16 v[72:75], v[36:39], v[128:135], v26
    s_barrier
    v_cvt_pk_bf16_f32 v141, v122, v123
    v_exp_f32 v124, v124
    v_exp_f32 v125, v125
    v_exp_f32 v126, v126
    v_cvt_pk_bf16_f32 v142, v124, v125
    v_exp_f32 v127, v127
    v_mfma_f32_32x32x16_bf16 v[56:71], v[160:163], v[136:139], 0
    ds_read_b128 v[144:147], v22 offset:8192
    v_cvt_pk_bf16_f32 v143, v126, v127
    v_exp_f32 v96, v96
    v_exp_f32 v97, v97
    v_exp_f32 v98, v98
    v_mfma_f32_32x32x16_bf16 v[112:127], v[152:155], v[88:91], 0
    ds_read_b128 v[148:151], v22 offset:9216
    v_cvt_pk_bf16_f32 v128, v96, v97
    v_exp_f32 v99, v99
    v_exp_f32 v100, v100
    v_cvt_pk_bf16_f32 v129, v98, v99
    v_exp_f32 v101, v101
    v_mfma_f32_32x32x16_bf16 v[112:127], v[156:159], v[92:95], v[112:127]
    v_cvt_pk_bf16_f32 v130, v100, v101
    v_exp_f32 v102, v102
    v_exp_f32 v103, v103
    v_exp_f32 v104, v104
    v_mfma_f32_32x32x16_bf16 v[56:71], v[164:167], v[140:143], v[56:71]
    s_waitcnt lgkmcnt(0)
    v_cvt_pk_bf16_f32 v131, v102, v103
    v_exp_f32 v105, v105
    v_exp_f32 v106, v106
    v_cvt_pk_bf16_f32 v132, v104, v105
    v_exp_f32 v107, v107
    v_smfmac_f32_16x16x64_bf16 v[76:79], v[36:39], v[136:143], v26
    v_cvt_pk_bf16_f32 v133, v106, v107
    v_exp_f32 v108, v108
    v_exp_f32 v109, v109
    v_exp_f32 v110, v110
    v_cvt_pk_bf16_f32 v134, v108, v109
    v_exp_f32 v111, v111
    v_mfma_f32_32x32x16_bf16 v[40:55], v[168:171], v[128:131], v[40:55]
    ds_read_b128 v[160:163], v22 offset:10240
    v_cvt_pk_bf16_f32 v135, v110, v111
    v_exp_f32 v112, v112
    v_exp_f32 v113, v113
    v_exp_f32 v114, v114
    v_mfma_f32_32x32x16_bf16 v[96:111], v[144:147], v[80:83], 0
    ds_read_b128 v[164:167], v22 offset:11264
    v_cvt_pk_bf16_f32 v136, v112, v113
    v_exp_f32 v115, v115
    v_exp_f32 v116, v116
    v_cvt_pk_bf16_f32 v137, v114, v115
    v_exp_f32 v117, v117
    v_mfma_f32_32x32x16_bf16 v[96:111], v[148:151], v[84:87], v[96:111]
    v_cvt_pk_bf16_f32 v138, v116, v117
    v_exp_f32 v118, v118
    v_exp_f32 v119, v119
    v_exp_f32 v120, v120
    v_mfma_f32_32x32x16_bf16 v[40:55], v[172:175], v[132:135], v[40:55]
    s_waitcnt lgkmcnt(0)
    v_cvt_pk_bf16_f32 v139, v118, v119
    v_exp_f32 v121, v121
    v_exp_f32 v122, v122
    v_cvt_pk_bf16_f32 v140, v120, v121
    v_exp_f32 v123, v123
    v_smfmac_f32_16x16x64_bf16 v[72:75], v[36:39], v[128:135], v26
    v_cvt_pk_bf16_f32 v141, v122, v123
    v_exp_f32 v124, v124
    v_exp_f32 v125, v125
    v_exp_f32 v126, v126
    v_cvt_pk_bf16_f32 v142, v124, v125
    v_exp_f32 v127, v127
    v_mfma_f32_32x32x16_bf16 v[56:71], v[168:171], v[136:139], v[56:71]
    ds_read_b128 v[152:155], v22 offset:12288
    v_cvt_pk_bf16_f32 v143, v126, v127
    v_exp_f32 v96, v96
    v_exp_f32 v97, v97
    v_exp_f32 v98, v98
    v_mfma_f32_32x32x16_bf16 v[112:127], v[144:147], v[88:91], 0
    ds_read_b128 v[156:159], v22 offset:13312
    v_cvt_pk_bf16_f32 v128, v96, v97
    v_exp_f32 v99, v99
    v_exp_f32 v100, v100
    v_cvt_pk_bf16_f32 v129, v98, v99
    v_exp_f32 v101, v101
    v_mfma_f32_32x32x16_bf16 v[112:127], v[148:151], v[92:95], v[112:127]
    s_waitcnt vmcnt(0)
    v_cvt_pk_bf16_f32 v130, v100, v101
    v_exp_f32 v102, v102
    v_exp_f32 v103, v103
    v_exp_f32 v104, v104
    v_mfma_f32_32x32x16_bf16 v[56:71], v[172:175], v[140:143], v[56:71]
    s_waitcnt lgkmcnt(0)
    v_cvt_pk_bf16_f32 v131, v102, v103
    v_exp_f32 v105, v105
    v_exp_f32 v106, v106
    v_cvt_pk_bf16_f32 v132, v104, v105
    v_exp_f32 v107, v107
    v_smfmac_f32_16x16x64_bf16 v[76:79], v[36:39], v[136:143], v26
    v_cvt_pk_bf16_f32 v133, v106, v107
    v_exp_f32 v108, v108
    v_exp_f32 v109, v109
    v_exp_f32 v110, v110
    v_cvt_pk_bf16_f32 v134, v108, v109
    v_exp_f32 v111, v111
    v_mfma_f32_32x32x16_bf16 v[40:55], v[160:163], v[128:131], v[40:55]
    ds_read_b128 v[168:171], v22 offset:14336
    v_cvt_pk_bf16_f32 v135, v110, v111
    v_exp_f32 v112, v112
    v_exp_f32 v113, v113
    v_exp_f32 v114, v114
    v_mfma_f32_32x32x16_bf16 v[96:111], v[152:155], v[80:83], 0
    ds_read_b128 v[172:175], v22 offset:15360
    v_cvt_pk_bf16_f32 v136, v112, v113
    v_exp_f32 v115, v115
    v_exp_f32 v116, v116
    v_cvt_pk_bf16_f32 v137, v114, v115
    v_exp_f32 v117, v117
    v_mfma_f32_32x32x16_bf16 v[96:111], v[156:159], v[84:87], v[96:111]
    buffer_store_dword v25, v9, s[8:11], 0 offen sc1
    v_cvt_pk_bf16_f32 v138, v116, v117
    v_exp_f32 v118, v118
    v_exp_f32 v119, v119
    v_exp_f32 v120, v120
    v_mfma_f32_32x32x16_bf16 v[40:55], v[164:167], v[132:135], v[40:55]
    s_waitcnt lgkmcnt(0)
    v_cvt_pk_bf16_f32 v139, v118, v119
    v_exp_f32 v121, v121
    v_exp_f32 v122, v122
    v_cvt_pk_bf16_f32 v140, v120, v121
    v_exp_f32 v123, v123
    v_smfmac_f32_16x16x64_bf16 v[72:75], v[36:39], v[128:135], v26
    s_barrier
    v_cvt_pk_bf16_f32 v141, v122, v123
    v_exp_f32 v124, v124
    v_exp_f32 v125, v125
    v_exp_f32 v126, v126
    v_cvt_pk_bf16_f32 v142, v124, v125
    v_exp_f32 v127, v127
    v_mfma_f32_32x32x16_bf16 v[56:71], v[160:163], v[136:139], v[56:71]
    ds_read_b128 v[144:147], v22 offset:16384
    v_cvt_pk_bf16_f32 v143, v126, v127
    v_exp_f32 v96, v96
    v_exp_f32 v97, v97
    v_exp_f32 v98, v98
    v_mfma_f32_32x32x16_bf16 v[112:127], v[152:155], v[88:91], 0
    ds_read_b128 v[148:151], v22 offset:17408
    v_cvt_pk_bf16_f32 v128, v96, v97
    v_exp_f32 v99, v99
    v_exp_f32 v100, v100
    v_cvt_pk_bf16_f32 v129, v98, v99
    v_exp_f32 v101, v101
    v_mfma_f32_32x32x16_bf16 v[112:127], v[156:159], v[92:95], v[112:127]
L_pad_3:
    s_cbranch_execz L_idle
    v_cvt_pk_bf16_f32 v130, v100, v101
    v_exp_f32 v102, v102
    v_exp_f32 v103, v103
    v_exp_f32 v104, v104
    v_mfma_f32_32x32x16_bf16 v[56:71], v[164:167], v[140:143], v[56:71]
    s_waitcnt lgkmcnt(0)
    v_cvt_pk_bf16_f32 v131, v102, v103
    v_exp_f32 v105, v105
    v_exp_f32 v106, v106
    v_cvt_pk_bf16_f32 v132, v104, v105
    v_exp_f32 v107, v107
    v_smfmac_f32_16x16x64_bf16 v[76:79], v[36:39], v[136:143], v26
    v_cvt_pk_bf16_f32 v133, v106, v107
    v_exp_f32 v108, v108
    v_exp_f32 v109, v109
    v_exp_f32 v110, v110
    v_cvt_pk_bf16_f32 v134, v108, v109
    v_exp_f32 v111, v111
    v_mfma_f32_32x32x16_bf16 v[40:55], v[168:171], v[128:131], v[40:55]
    ds_read_b128 v[160:163], v22 offset:18432
    v_cvt_pk_bf16_f32 v135, v110, v111
    v_exp_f32 v112, v112
    v_exp_f32 v113, v113
    v_exp_f32 v114, v114
    v_mfma_f32_32x32x16_bf16 v[96:111], v[144:147], v[80:83], 0
    ds_read_b128 v[164:167], v22 offset:19456
    v_cvt_pk_bf16_f32 v136, v112, v113
    v_exp_f32 v115, v115
    v_exp_f32 v116, v116
    v_cvt_pk_bf16_f32 v137, v114, v115
    v_exp_f32 v117, v117
    v_mfma_f32_32x32x16_bf16 v[96:111], v[148:151], v[84:87], v[96:111]
    v_cvt_pk_bf16_f32 v138, v116, v117
    v_exp_f32 v118, v118
    v_exp_f32 v119, v119
    v_exp_f32 v120, v120
    v_mfma_f32_32x32x16_bf16 v[40:55], v[172:175], v[132:135], v[40:55]
    s_waitcnt lgkmcnt(0)
    v_cvt_pk_bf16_f32 v139, v118, v119
    v_exp_f32 v121, v121
    v_exp_f32 v122, v122
    v_cvt_pk_bf16_f32 v140, v120, v121
    v_exp_f32 v123, v123
    v_smfmac_f32_16x16x64_bf16 v[72:75], v[36:39], v[128:135], v26
    v_cvt_pk_bf16_f32 v141, v122, v123
    v_exp_f32 v124, v124
    v_exp_f32 v125, v125
    v_exp_f32 v126, v126
    v_cvt_pk_bf16_f32 v142, v124, v125
    v_exp_f32 v127, v127
    v_mfma_f32_32x32x16_bf16 v[56:71], v[168:171], v[136:139], v[56:71]
    ds_read_b128 v[152:155], v22 offset:20480
    v_cvt_pk_bf16_f32 v143, v126, v127
    v_exp_f32 v96, v96
    v_exp_f32 v97, v97
    v_exp_f32 v98, v98
    v_mfma_f32_32x32x16_bf16 v[112:127], v[144:147], v[88:91], 0
    ds_read_b128 v[156:159], v22 offset:21504
    v_cvt_pk_bf16_f32 v128, v96, v97
    v_exp_f32 v99, v99
    v_exp_f32 v100, v100
    v_cvt_pk_bf16_f32 v129, v98, v99
    v_exp_f32 v101, v101
    v_mfma_f32_32x32x16_bf16 v[112:127], v[148:151], v[92:95], v[112:127]
    v_cvt_pk_bf16_f32 v130, v100, v101
    v_exp_f32 v102, v102
    v_exp_f32 v103, v103
    v_exp_f32 v104, v104
    v_mfma_f32_32x32x16_bf16 v[56:71], v[172:175], v[140:143], v[56:71]
    s_waitcnt lgkmcnt(0)
    v_cvt_pk_bf16_f32 v131, v102, v103
    v_exp_f32 v105, v105
    v_exp_f32 v106, v106
    v_cvt_pk_bf16_f32 v132, v104, v105
    v_exp_f32 v107, v107
    v_smfmac_f32_16x16x64_bf16 v[76:79], v[36:39], v[136:143], v26
    v_cvt_pk_bf16_f32 v133, v106, v107
    v_exp_f32 v108, v108
    v_exp_f32 v109, v109
    v_exp_f32 v110, v110
    v_cvt_pk_bf16_f32 v134, v108, v109
    v_exp_f32 v111, v111
    v_mfma_f32_32x32x16_bf16 v[40:55], v[160:163], v[128:131], v[40:55]
    ds_read_b128 v[168:171], v22 offset:22528
    v_cvt_pk_bf16_f32 v135, v110, v111
    v_exp_f32 v112, v112
    v_exp_f32 v113, v113
    v_exp_f32 v114, v114
    v_mfma_f32_32x32x16_bf16 v[96:111], v[152:155], v[80:83], 0
    ds_read_b128 v[172:175], v22 offset:23552
    v_cvt_pk_bf16_f32 v136, v112, v113
    v_exp_f32 v115, v115
    v_exp_f32 v116, v116
    v_cvt_pk_bf16_f32 v137, v114, v115
    v_exp_f32 v117, v117
    v_mfma_f32_32x32x16_bf16 v[96:111], v[156:159], v[84:87], v[96:111]
    v_cvt_pk_bf16_f32 v138, v116, v117
    v_exp_f32 v118, v118
    v_exp_f32 v119, v119
    v_exp_f32 v120, v120
    v_mfma_f32_32x32x16_bf16 v[40:55], v[164:167], v[132:135], v[40:55]
    s_waitcnt lgkmcnt(0)
    v_cvt_pk_bf16_f32 v139, v118, v119
    v_exp_f32 v121, v121
    v_exp_f32 v122, v122
    v_cvt_pk_bf16_f32 v140, v120, v121
    v_exp_f32 v123, v123
    v_smfmac_f32_16x16x64_bf16 v[72:75], v[36:39], v[128:135], v26
    v_cvt_pk_bf16_f32 v141, v122, v123
    v_exp_f32 v124, v124
    v_exp_f32 v125, v125
    v_exp_f32 v126, v126
    v_cvt_pk_bf16_f32 v142, v124, v125
    v_exp_f32 v127, v127
    v_mfma_f32_32x32x16_bf16 v[56:71], v[160:163], v[136:139], v[56:71]
    ds_read_b128 v[144:147], v22 offset:24576
    v_cvt_pk_bf16_f32 v143, v126, v127
    v_exp_f32 v96, v96
    v_exp_f32 v97, v97
    v_exp_f32 v98, v98
    v_mfma_f32_32x32x16_bf16 v[112:127], v[152:155], v[88:91], 0
    ds_read_b128 v[148:151], v22 offset:25600
    v_cvt_pk_bf16_f32 v128, v96, v97
    v_exp_f32 v99, v99
    v_exp_f32 v100, v100
    v_cvt_pk_bf16_f32 v129, v98, v99
    v_exp_f32 v101, v101
    v_mfma_f32_32x32x16_bf16 v[112:127], v[156:159], v[92:95], v[112:127]
    v_cvt_pk_bf16_f32 v130, v100, v101
    v_exp_f32 v102, v102
    v_exp_f32 v103, v103
    v_exp_f32 v104, v104
    v_mfma_f32_32x32x16_bf16 v[56:71], v[164:167], v[140:143], v[56:71]
    s_waitcnt lgkmcnt(0)
    v_cvt_pk_bf16_f32 v131, v102, v103
    v_exp_f32 v105, v105
    v_exp_f32 v106, v106
    v_cvt_pk_bf16_f32 v132, v104, v105
    v_exp_f32 v107, v107
    v_smfmac_f32_16x16x64_bf16 v[76:79], v[36:39], v[136:143], v26
    v_cvt_pk_bf16_f32 v133, v106, v107
    v_exp_f32 v108, v108
    v_exp_f32 v109, v109
    v_exp_f32 v110, v110
    v_cvt_pk_bf16_f32 v134, v108, v109
    v_exp_f32 v111, v111
    v_mfma_f32_32x32x16_bf16 v[40:55], v[168:171], v[128:131], v[40:55]
    ds_read_b128 v[160:163], v22 offset:26624
    v_cvt_pk_bf16_f32 v135, v110, v111
    v_exp_f32 v112, v112
    v_exp_f32 v113, v113
    v_exp_f32 v114, v114
    v_mfma_f32_32x32x16_bf16 v[96:111], v[144:147], v[80:83], 0
    ds_read_b128 v[164:167], v22 offset:27648
    v_cvt_pk_bf16_f32 v136, v112, v113
    v_exp_f32 v115, v115
    v_exp_f32 v116, v116
    v_cvt_pk_bf16_f32 v137, v114, v115
    v_exp_f32 v117, v117
    v_mfma_f32_32x32x16_bf16 v[96:111], v[148:151], v[84:87], v[96:111]
    v_cvt_pk_bf16_f32 v138, v116, v117
    v_exp_f32 v118, v118
    v_exp_f32 v119, v119
    v_exp_f32 v120, v120
    v_mfma_f32_32x32x16_bf16 v[40:55], v[172:175], v[132:135], v[40:55]
    s_waitcnt lgkmcnt(0)
    v_cvt_pk_bf16_f32 v139, v118, v119
    v_exp_f32 v121, v121
    v_exp_f32 v122, v122
    v_cvt_pk_bf16_f32 v140, v120, v121
    v_exp_f32 v123, v123
    v_smfmac_f32_16x16x64_bf16 v[72:75], v[36:39], v[128:135], v26
    v_cvt_pk_bf16_f32 v141, v122, v123
    v_exp_f32 v124, v124
    v_exp_f32 v125, v125
    v_exp_f32 v126, v126
    v_cvt_pk_bf16_f32 v142, v124, v125
    v_exp_f32 v127, v127
    v_mfma_f32_32x32x16_bf16 v[56:71], v[168:171], v[136:139], v[56:71]
    ds_read_b128 v[152:155], v22 offset:28672
    v_cvt_pk_bf16_f32 v143, v126, v127
    v_exp_f32 v96, v96
    v_exp_f32 v97, v97
    v_exp_f32 v98, v98
    v_mfma_f32_32x32x16_bf16 v[112:127], v[144:147], v[88:91], 0
    ds_read_b128 v[156:159], v22 offset:29696
    v_cvt_pk_bf16_f32 v128, v96, v97
    v_exp_f32 v99, v99
    v_exp_f32 v100, v100
    v_cvt_pk_bf16_f32 v129, v98, v99
    v_exp_f32 v101, v101
    v_mfma_f32_32x32x16_bf16 v[112:127], v[148:151], v[92:95], v[112:127]
    v_cvt_pk_bf16_f32 v130, v100, v101
    v_exp_f32 v102, v102
    v_exp_f32 v103, v103
    v_exp_f32 v104, v104
    v_mfma_f32_32x32x16_bf16 v[56:71], v[172:175], v[140:143], v[56:71]
    s_waitcnt lgkmcnt(0)
    v_cvt_pk_bf16_f32 v131, v102, v103
    v_exp_f32 v105, v105
    v_exp_f32 v106, v106
    v_cvt_pk_bf16_f32 v132, v104, v105
    v_exp_f32 v107, v107
    v_smfmac_f32_16x16x64_bf16 v[76:79], v[36:39], v[136:143], v26
    v_cvt_pk_bf16_f32 v133, v106, v107
    v_exp_f32 v108, v108
    v_exp_f32 v109, v109
    v_exp_f32 v110, v110
    v_cvt_pk_bf16_f32 v134, v108, v109
    v_exp_f32 v111, v111
    v_mfma_f32_32x32x16_bf16 v[40:55], v[160:163], v[128:131], v[40:55]
    ds_read_b128 v[168:171], v22 offset:30720
    v_cvt_pk_bf16_f32 v135, v110, v111
    v_exp_f32 v112, v112
    v_exp_f32 v113, v113
    v_exp_f32 v114, v114
    v_mfma_f32_32x32x16_bf16 v[96:111], v[152:155], v[80:83], 0
    ds_read_b128 v[172:175], v22 offset:31744
    v_cvt_pk_bf16_f32 v136, v112, v113
    v_exp_f32 v115, v115
    v_exp_f32 v116, v116
    v_cvt_pk_bf16_f32 v137, v114, v115
    v_exp_f32 v117, v117
    v_mfma_f32_32x32x16_bf16 v[96:111], v[156:159], v[84:87], v[96:111]
    s_mov_b32 s1, 7
    v_cvt_pk_bf16_f32 v138, v116, v117
    v_exp_f32 v118, v118
    v_exp_f32 v119, v119
    v_exp_f32 v120, v120
    v_mfma_f32_32x32x16_bf16 v[40:55], v[164:167], v[132:135], v[40:55]
    s_waitcnt lgkmcnt(0)
    v_cvt_pk_bf16_f32 v139, v118, v119
    v_exp_f32 v121, v121
    v_exp_f32 v122, v122
    v_cvt_pk_bf16_f32 v140, v120, v121
    v_exp_f32 v123, v123
    v_smfmac_f32_16x16x64_bf16 v[72:75], v[36:39], v[128:135], v26
    s_barrier
    v_cvt_pk_bf16_f32 v141, v122, v123
    v_exp_f32 v124, v124
    v_exp_f32 v125, v125
    v_exp_f32 v126, v126
    v_cvt_pk_bf16_f32 v142, v124, v125
    v_exp_f32 v127, v127
.p2align 3
L_att2:
    v_xor_b32 v22, s87, v22
    v_mfma_f32_32x32x16_bf16 v[56:71], v[160:163], v[136:139], v[56:71]
    ds_read_b128 v[144:147], v22 offset:0
    v_cvt_pk_bf16_f32 v143, v126, v127
    v_exp_f32 v96, v96
    v_exp_f32 v97, v97
    v_exp_f32 v98, v98
    v_mfma_f32_32x32x16_bf16 v[112:127], v[152:155], v[88:91], 0
    ds_read_b128 v[148:151], v22 offset:1024
    v_cvt_pk_bf16_f32 v128, v96, v97
    v_exp_f32 v99, v99
    v_exp_f32 v100, v100
    v_cvt_pk_bf16_f32 v129, v98, v99
    v_exp_f32 v101, v101
    v_mfma_f32_32x32x16_bf16 v[112:127], v[156:159], v[92:95], v[112:127]
    v_cvt_pk_bf16_f32 v130, v100, v101
    v_exp_f32 v102, v102
    v_exp_f32 v103, v103
    v_exp_f32 v104, v104
    v_mfma_f32_32x32x16_bf16 v[56:71], v[164:167], v[140:143], v[56:71]
    s_waitcnt lgkmcnt(0)
    v_cvt_pk_bf16_f32 v131, v102, v103
    v_exp_f32 v105, v105
    v_exp_f32 v106, v106
    v_cvt_pk_bf16_f32 v132, v104, v105
    v_exp_f32 v107, v107
    v_smfmac_f32_16x16x64_bf16 v[76:79], v[36:39], v[136:143], v26
    s_mov_b32 s87, s96
    v_cvt_pk_bf16_f32 v133, v106, v107
    v_exp_f32 v108, v108
    v_exp_f32 v109, v109
    v_exp_f32 v110, v110
    v_cvt_pk_bf16_f32 v134, v108, v109
    v_exp_f32 v111, v111
    v_mfma_f32_32x32x16_bf16 v[40:55], v[168:171], v[128:131], v[40:55]
    ds_read_b128 v[160:163], v22 offset:2048
    v_cvt_pk_bf16_f32 v135, v110, v111
    v_exp_f32 v112, v112
    v_exp_f32 v113, v113
    v_exp_f32 v114, v114
    v_mfma_f32_32x32x16_bf16 v[96:111], v[144:147], v[80:83], 0
    ds_read_b128 v[164:167], v22 offset:3072
    v_cvt_pk_bf16_f32 v136, v112, v113
    v_exp_f32 v115, v115
    v_exp_f32 v116, v116
    v_cvt_pk_bf16_f32 v137, v114, v115
    v_exp_f32 v117, v117
    v_mfma_f32_32x32x16_bf16 v[96:111], v[148:151], v[84:87], v[96:111]
    v_cvt_pk_bf16_f32 v138, v116, v117
    v_exp_f32 v118, v118
    v_exp_f32 v119, v119
    v_exp_f32 v120, v120
    v_mfma_f32_32x32x16_bf16 v[40:55], v[172:175], v[132:135], v[40:55]
    s_waitcnt lgkmcnt(0)
    v_cvt_pk_bf16_f32 v139, v118, v119
    v_exp_f32 v121, v121
    v_exp_f32 v122, v122
    v_cvt_pk_bf16_f32 v140, v120, v121
    v_exp_f32 v123, v123
    v_smfmac_f32_16x16x64_bf16 v[72:75], v[36:39], v[128:135], v26
    s_mov_b32 s96, 0x28000
    v_cvt_pk_bf16_f32 v141, v122, v123
    v_exp_f32 v124, v124
    v_exp_f32 v125, v125
    v_exp_f32 v126, v126
    v_cvt_pk_bf16_f32 v142, v124, v125
    v_exp_f32 v127, v127
    v_mfma_f32_32x32x16_bf16 v[56:71], v[168:171], v[136:139], v[56:71]
    ds_read_b128 v[152:155], v22 offset:4096
    v_cvt_pk_bf16_f32 v143, v126, v127
    v_exp_f32 v96, v96
    v_exp_f32 v97, v97
    v_exp_f32 v98, v98
    v_mfma_f32_32x32x16_bf16 v[112:127], v[144:147], v[88:91], 0
    ds_read_b128 v[156:159], v22 offset:5120
    v_cvt_pk_bf16_f32 v128, v96, v97
    v_exp_f32 v99, v99
    v_exp_f32 v100, v100
    v_cvt_pk_bf16_f32 v129, v98, v99
    v_exp_f32 v101, v101
    v_mfma_f32_32x32x16_bf16 v[112:127], v[148:151], v[92:95], v[112:127]
    v_cvt_pk_bf16_f32 v130, v100, v101
    v_exp_f32 v102, v102
    v_exp_f32 v103, v103
    v_exp_f32 v104, v104
    v_mfma_f32_32x32x16_bf16 v[56:71], v[172:175], v[140:143], v[56:71]
    s_waitcnt lgkmcnt(0)
    v_cvt_pk_bf16_f32 v131, v102, v103
    v_exp_f32 v105, v105
    v_exp_f32 v106, v106
    v_cvt_pk_bf16_f32 v132, v104, v105
    v_exp_f32 v107, v107
    v_smfmac_f32_16x16x64_bf16 v[76:79], v[36:39], v[136:143], v26
    v_cvt_pk_bf16_f32 v133, v106, v107
    v_exp_f32 v108, v108
    v_exp_f32 v109, v109
    v_exp_f32 v110, v110
    v_cvt_pk_bf16_f32 v134, v108, v109
    v_exp_f32 v111, v111
    v_mfma_f32_32x32x16_bf16 v[40:55], v[160:163], v[128:131], v[40:55]
    ds_read_b128 v[168:171], v22 offset:6144
    v_cvt_pk_bf16_f32 v135, v110, v111
    v_exp_f32 v112, v112
    v_exp_f32 v113, v113
    v_exp_f32 v114, v114
    v_mfma_f32_32x32x16_bf16 v[96:111], v[152:155], v[80:83], 0
    ds_read_b128 v[172:175], v22 offset:7168
    v_cvt_pk_bf16_f32 v136, v112, v113
    v_exp_f32 v115, v115
    v_exp_f32 v116, v116
    v_cvt_pk_bf16_f32 v137, v114, v115
    v_exp_f32 v117, v117
    v_mfma_f32_32x32x16_bf16 v[96:111], v[156:159], v[84:87], v[96:111]
    v_cvt_pk_bf16_f32 v138, v116, v117
    v_exp_f32 v118, v118
    v_exp_f32 v119, v119
    v_exp_f32 v120, v120
    v_mfma_f32_32x32x16_bf16 v[40:55], v[164:167], v[132:135], v[40:55]
    s_waitcnt lgkmcnt(0)
    v_cvt_pk_bf16_f32 v139, v118, v119
    v_exp_f32 v121, v121
    v_exp_f32 v122, v122
    v_cvt_pk_bf16_f32 v140, v120, v121
    v_exp_f32 v123, v123
    v_smfmac_f32_16x16x64_bf16 v[72:75], v[36:39], v[128:135], v26
    v_cvt_pk_bf16_f32 v141, v122, v123
    v_exp_f32 v124, v124
    v_exp_f32 v125, v125
    v_exp_f32 v126, v126
    v_cvt_pk_bf16_f32 v142, v124, v125
    v_exp_f32 v127, v127
    v_mfma_f32_32x32x16_bf16 v[56:71], v[160:163], v[136:139], v[56:71]
    ds_read_b128 v[144:147], v22 offset:8192
    v_cvt_pk_bf16_f32 v143, v126, v127
    v_exp_f32 v96, v96
    v_exp_f32 v97, v97
    v_exp_f32 v98, v98
    v_mfma_f32_32x32x16_bf16 v[112:127], v[152:155], v[88:91], 0
    ds_read_b128 v[148:151], v22 offset:9216
    v_cvt_pk_bf16_f32 v128, v96, v97
    v_exp_f32 v99, v99
    v_exp_f32 v100, v100
    v_cvt_pk_bf16_f32 v129, v98, v99
    v_exp_f32 v101, v101
    v_mfma_f32_32x32x16_bf16 v[112:127], v[156:159], v[92:95], v[112:127]
    v_cvt_pk_bf16_f32 v130, v100, v101
    v_exp_f32 v102, v102
    v_exp_f32 v103, v103
    v_exp_f32 v104, v104
    v_mfma_f32_32x32x16_bf16 v[56:71], v[164:167], v[140:143], v[56:71]
    s_waitcnt lgkmcnt(0)
    v_cvt_pk_bf16_f32 v131, v102, v103
    v_exp_f32 v105, v105
    v_exp_f32 v106, v106
    v_cvt_pk_bf16_f32 v132, v104, v105
    v_exp_f32 v107, v107
    v_smfmac_f32_16x16x64_bf16 v[76:79], v[36:39], v[136:143], v26
    v_cvt_pk_bf16_f32 v133, v106, v107
    v_exp_f32 v108, v108
    v_exp_f32 v109, v109
    v_exp_f32 v110, v110
    v_cvt_pk_bf16_f32 v134, v108, v109
    v_exp_f32 v111, v111
    v_mfma_f32_32x32x16_bf16 v[40:55], v[168:171], v[128:131], v[40:55]
    ds_read_b128 v[160:163], v22 offset:10240
    v_cvt_pk_bf16_f32 v135, v110, v111
    v_exp_f32 v112, v112
    v_exp_f32 v113, v113
    v_exp_f32 v114, v114
    v_mfma_f32_32x32x16_bf16 v[96:111], v[144:147], v[80:83], 0
    ds_read_b128 v[164:167], v22 offset:11264
    v_cvt_pk_bf16_f32 v136, v112, v113
    v_exp_f32 v115, v115
    v_exp_f32 v116, v116
    v_cvt_pk_bf16_f32 v137, v114, v115
    v_exp_f32 v117, v117
    v_mfma_f32_32x32x16_bf16 v[96:111], v[148:151], v[84:87], v[96:111]
    v_cvt_pk_bf16_f32 v138, v116, v117
    v_exp_f32 v118, v118
    v_exp_f32 v119, v119
    v_exp_f32 v120, v120
    v_mfma_f32_32x32x16_bf16 v[40:55], v[172:175], v[132:135], v[40:55]
    s_waitcnt lgkmcnt(0)
    v_cvt_pk_bf16_f32 v139, v118, v119
    v_exp_f32 v121, v121
    v_exp_f32 v122, v122
    v_cvt_pk_bf16_f32 v140, v120, v121
    v_exp_f32 v123, v123
    v_smfmac_f32_16x16x64_bf16 v[72:75], v[36:39], v[128:135], v26
    v_cvt_pk_bf16_f32 v141, v122, v123
    v_exp_f32 v124, v124
    v_exp_f32 v125, v125
    v_exp_f32 v126, v126
    v_cvt_pk_bf16_f32 v142, v124, v125
    v_exp_f32 v127, v127
    v_mfma_f32_32x32x16_bf16 v[56:71], v[168:171], v[136:139], v[56:71]
    ds_read_b128 v[152:155], v22 offset:12288
    v_cvt_pk_bf16_f32 v143, v126, v127
    v_exp_f32 v96, v96
    v_exp_f32 v97, v97
    v_exp_f32 v98, v98
    v_mfma_f32_32x32x16_bf16 v[112:127], v[144:147], v[88:91], 0
    ds_read_b128 v[156:159], v22 offset:13312
    v_cvt_pk_bf16_f32 v128, v96, v97
    v_exp_f32 v99, v99
    v_exp_f32 v100, v100
    v_cvt_pk_bf16_f32 v129, v98, v99
    v_exp_f32 v101, v101
    v_mfma_f32_32x32x16_bf16 v[112:127], v[148:151], v[92:95], v[112:127]
    v_cvt_pk_bf16_f32 v130, v100, v101
    v_exp_f32 v102, v102
    v_exp_f32 v103, v103
    v_exp_f32 v104, v104
    v_mfma_f32_32x32x16_bf16 v[56:71], v[172:175], v[140:143], v[56:71]
    s_waitcnt lgkmcnt(0)
    v_cvt_pk_bf16_f32 v131, v102, v103
    v_exp_f32 v105, v105
    v_exp_f32 v106, v106
    v_cvt_pk_bf16_f32 v132, v104, v105
    v_exp_f32 v107, v107
    v_smfmac_f32_16x16x64_bf16 v[76:79], v[36:39], v[136:143], v26
    v_cvt_pk_bf16_f32 v133, v106, v107
    v_exp_f32 v108, v108
    v_exp_f32 v109, v109
    v_exp_f32 v110, v110
    v_cvt_pk_bf16_f32 v134, v108, v109
    v_exp_f32 v111, v111
    v_mfma_f32_32x32x16_bf16 v[40:55], v[160:163], v[128:131], v[40:55]
    ds_read_b128 v[168:171], v22 offset:14336
    v_cvt_pk_bf16_f32 v135, v110, v111
    v_exp_f32 v112, v112
    v_exp_f32 v113, v113
    v_exp_f32 v114, v114
    v_mfma_f32_32x32x16_bf16 v[96:111], v[152:155], v[80:83], 0
    ds_read_b128 v[172:175], v22 offset:15360
    v_cvt_pk_bf16_f32 v136, v112, v113
    v_exp_f32 v115, v115
    v_exp_f32 v116, v116
    v_cvt_pk_bf16_f32 v137, v114, v115
    v_exp_f32 v117, v117
    v_mfma_f32_32x32x16_bf16 v[96:111], v[156:159], v[84:87], v[96:111]
    v_cvt_pk_bf16_f32 v138, v116, v117
    v_exp_f32 v118, v118
    v_exp_f32 v119, v119
    v_exp_f32 v120, v120
    v_mfma_f32_32x32x16_bf16 v[40:55], v[164:167], v[132:135], v[40:55]
    s_waitcnt lgkmcnt(0)
    v_cvt_pk_bf16_f32 v139, v118, v119
    v_exp_f32 v121, v121
    v_exp_f32 v122, v122
    v_cvt_pk_bf16_f32 v140, v120, v121
    v_exp_f32 v123, v123
    v_smfmac_f32_16x16x64_bf16 v[72:75], v[36:39], v[128:135], v26
    v_cvt_pk_bf16_f32 v141, v122, v123
    v_exp_f32 v124, v124
    v_exp_f32 v125, v125
    v_exp_f32 v126, v126
    v_cvt_pk_bf16_f32 v142, v124, v125
    v_exp_f32 v127, v127
    v_mfma_f32_32x32x16_bf16 v[56:71], v[160:163], v[136:139], v[56:71]
    ds_read_b128 v[144:147], v22 offset:16384
    v_cvt_pk_bf16_f32 v143, v126, v127
    v_exp_f32 v96, v96
    v_exp_f32 v97, v97
    v_exp_f32 v98, v98
    v_mfma_f32_32x32x16_bf16 v[112:127], v[152:155], v[88:91], 0
    ds_read_b128 v[148:151], v22 offset:17408
    v_cvt_pk_bf16_f32 v128, v96, v97
    v_exp_f32 v99, v99
    v_exp_f32 v100, v100
    v_cvt_pk_bf16_f32 v129, v98, v99
    v_exp_f32 v101, v101
    v_mfma_f32_32x32x16_bf16 v[112:127], v[156:159], v[92:95], v[112:127]
    v_cvt_pk_bf16_f32 v130, v100, v101
    v_exp_f32 v102, v102
    v_exp_f32 v103, v103
    v_exp_f32 v104, v104
    v_mfma_f32_32x32x16_bf16 v[56:71], v[164:167], v[140:143], v[56:71]
    s_waitcnt lgkmcnt(0)
    v_cvt_pk_bf16_f32 v131, v102, v103
    v_exp_f32 v105, v105
    v_exp_f32 v106, v106
    v_cvt_pk_bf16_f32 v132, v104, v105
    v_exp_f32 v107, v107
    v_smfmac_f32_16x16x64_bf16 v[76:79], v[36:39], v[136:143], v26
    v_cvt_pk_bf16_f32 v133, v106, v107
    v_exp_f32 v108, v108
    v_exp_f32 v109, v109
    v_exp_f32 v110, v110
    v_cvt_pk_bf16_f32 v134, v108, v109
    v_exp_f32 v111, v111
    v_mfma_f32_32x32x16_bf16 v[40:55], v[168:171], v[128:131], v[40:55]
    ds_read_b128 v[160:163], v22 offset:18432
    v_cvt_pk_bf16_f32 v135, v110, v111
    v_exp_f32 v112, v112
    v_exp_f32 v113, v113
    v_exp_f32 v114, v114
    v_mfma_f32_32x32x16_bf16 v[96:111], v[144:147], v[80:83], 0
    ds_read_b128 v[164:167], v22 offset:19456
    v_cvt_pk_bf16_f32 v136, v112, v113
    v_exp_f32 v115, v115
    v_exp_f32 v116, v116
    v_cvt_pk_bf16_f32 v137, v114, v115
    v_exp_f32 v117, v117
    v_mfma_f32_32x32x16_bf16 v[96:111], v[148:151], v[84:87], v[96:111]
    v_cvt_pk_bf16_f32 v138, v116, v117
    v_exp_f32 v118, v118
    v_exp_f32 v119, v119
    v_exp_f32 v120, v120
    v_mfma_f32_32x32x16_bf16 v[40:55], v[172:175], v[132:135], v[40:55]
    s_waitcnt lgkmcnt(0)
    v_cvt_pk_bf16_f32 v139, v118, v119
    v_exp_f32 v121, v121
    v_exp_f32 v122, v122
    v_cvt_pk_bf16_f32 v140, v120, v121
    v_exp_f32 v123, v123
    v_smfmac_f32_16x16x64_bf16 v[72:75], v[36:39], v[128:135], v26
    v_cvt_pk_bf16_f32 v141, v122, v123
    v_exp_f32 v124, v124
    v_exp_f32 v125, v125
    v_exp_f32 v126, v126
    v_cvt_pk_bf16_f32 v142, v124, v125
    v_exp_f32 v127, v127
    v_mfma_f32_32x32x16_bf16 v[56:71], v[168:171], v[136:139], v[56:71]
    ds_read_b128 v[152:155], v22 offset:20480
    v_cvt_pk_bf16_f32 v143, v126, v127
    v_exp_f32 v96, v96
    v_exp_f32 v97, v97
    v_exp_f32 v98, v98
    v_mfma_f32_32x32x16_bf16 v[112:127], v[144:147], v[88:91], 0
    ds_read_b128 v[156:159], v22 offset:21504
    v_cvt_pk_bf16_f32 v128, v96, v97
    v_exp_f32 v99, v99
    v_exp_f32 v100, v100
    v_cvt_pk_bf16_f32 v129, v98, v99
    v_exp_f32 v101, v101
    v_mfma_f32_32x32x16_bf16 v[112:127], v[148:151], v[92:95], v[112:127]
    v_cvt_pk_bf16_f32 v130, v100, v101
    v_exp_f32 v102, v102
    v_exp_f32 v103, v103
    v_exp_f32 v104, v104
    v_mfma_f32_32x32x16_bf16 v[56:71], v[172:175], v[140:143], v[56:71]
    s_waitcnt lgkmcnt(0)
    v_cvt_pk_bf16_f32 v131, v102, v103
    v_exp_f32 v105, v105
    v_exp_f32 v106, v106
    v_cvt_pk_bf16_f32 v132, v104, v105
    v_exp_f32 v107, v107
    v_smfmac_f32_16x16x64_bf16 v[76:79], v[36:39], v[136:143], v26
    v_cvt_pk_bf16_f32 v133, v106, v107
    v_exp_f32 v108, v108
    v_exp_f32 v109, v109
    v_exp_f32 v110, v110
    v_cvt_pk_bf16_f32 v134, v108, v109
    v_exp_f32 v111, v111
    v_mfma_f32_32x32x16_bf16 v[40:55], v[160:163], v[128:131], v[40:55]
    ds_read_b128 v[168:171], v22 offset:22528
    v_cvt_pk_bf16_f32 v135, v110, v111
    v_exp_f32 v112, v112
    v_exp_f32 v113, v113
    v_exp_f32 v114, v114
    v_mfma_f32_32x32x16_bf16 v[96:111], v[152:155], v[80:83], 0
    ds_read_b128 v[172:175], v22 offset:23552
    v_cvt_pk_bf16_f32 v136, v112, v113
    v_exp_f32 v115, v115
    v_exp_f32 v116, v116
    v_cvt_pk_bf16_f32 v137, v114, v115
    v_exp_f32 v117, v117
    v_mfma_f32_32x32x16_bf16 v[96:111], v[156:159], v[84:87], v[96:111]
    v_cvt_pk_bf16_f32 v138, v116, v117
    v_exp_f32 v118, v118
    v_exp_f32 v119, v119
    v_exp_f32 v120, v120
    v_mfma_f32_32x32x16_bf16 v[40:55], v[164:167], v[132:135], v[40:55]
    s_waitcnt lgkmcnt(0)
    v_cvt_pk_bf16_f32 v139, v118, v119
    v_exp_f32 v121, v121
    v_exp_f32 v122, v122
    v_cvt_pk_bf16_f32 v140, v120, v121
    v_exp_f32 v123, v123
    v_smfmac_f32_16x16x64_bf16 v[72:75], v[36:39], v[128:135], v26
    v_cvt_pk_bf16_f32 v141, v122, v123
    v_exp_f32 v124, v124
    v_exp_f32 v125, v125
    v_exp_f32 v126, v126
    v_cvt_pk_bf16_f32 v142, v124, v125
    v_exp_f32 v127, v127
    v_mfma_f32_32x32x16_bf16 v[56:71], v[160:163], v[136:139], v[56:71]
    ds_read_b128 v[144:147], v22 offset:24576
    v_cvt_pk_bf16_f32 v143, v126, v127
    v_exp_f32 v96, v96
    v_exp_f32 v97, v97
    v_exp_f32 v98, v98
    v_mfma_f32_32x32x16_bf16 v[112:127], v[152:155], v[88:91], 0
    ds_read_b128 v[148:151], v22 offset:25600
    v_cvt_pk_bf16_f32 v128, v96, v97
    v_exp_f32 v99, v99
    v_exp_f32 v100, v100
    v_cvt_pk_bf16_f32 v129, v98, v99
    v_exp_f32 v101, v101
    v_mfma_f32_32x32x16_bf16 v[112:127], v[156:159], v[92:95], v[112:127]
    v_cvt_pk_bf16_f32 v130, v100, v101
    v_exp_f32 v102, v102
    v_exp_f32 v103, v103
    v_exp_f32 v104, v104
    v_mfma_f32_32x32x16_bf16 v[56:71], v[164:167], v[140:143], v[56:71]
    s_waitcnt lgkmcnt(0)
    v_cvt_pk_bf16_f32 v131, v102, v103
    v_exp_f32 v105, v105
    v_exp_f32 v106, v106
    v_cvt_pk_bf16_f32 v132, v104, v105
    v_exp_f32 v107, v107
    v_smfmac_f32_16x16x64_bf16 v[76:79], v[36:39], v[136:143], v26
    v_cvt_pk_bf16_f32 v133, v106, v107
    v_exp_f32 v108, v108
    v_exp_f32 v109, v109
    v_exp_f32 v110, v110
    v_cvt_pk_bf16_f32 v134, v108, v109
    v_exp_f32 v111, v111
    v_mfma_f32_32x32x16_bf16 v[40:55], v[168:171], v[128:131], v[40:55]
    ds_read_b128 v[160:163], v22 offset:26624
    v_cvt_pk_bf16_f32 v135, v110, v111
    v_exp_f32 v112, v112
    v_exp_f32 v113, v113
    v_exp_f32 v114, v114
    v_mfma_f32_32x32x16_bf16 v[96:111], v[144:147], v[80:83], 0
    ds_read_b128 v[164:167], v22 offset:27648
    v_cvt_pk_bf16_f32 v136, v112, v113
    v_exp_f32 v115, v115
    v_exp_f32 v116, v116
    v_cvt_pk_bf16_f32 v137, v114, v115
    v_exp_f32 v117, v117
    v_mfma_f32_32x32x16_bf16 v[96:111], v[148:151], v[84:87], v[96:111]
    v_cvt_pk_bf16_f32 v138, v116, v117
    v_exp_f32 v118, v118
    v_exp_f32 v119, v119
    v_exp_f32 v120, v120
    v_mfma_f32_32x32x16_bf16 v[40:55], v[172:175], v[132:135], v[40:55]
    s_waitcnt lgkmcnt(0)
    v_cvt_pk_bf16_f32 v139, v118, v119
    v_exp_f32 v121, v121
    v_exp_f32 v122, v122
    v_cvt_pk_bf16_f32 v140, v120, v121
    v_exp_f32 v123, v123
    v_smfmac_f32_16x16x64_bf16 v[72:75], v[36:39], v[128:135], v26
L_pad_4:
    s_cbranch_execz L_idle
    s_sub_u32 s1, s1, 1
    v_cvt_pk_bf16_f32 v141, v122, v123
    v_exp_f32 v124, v124
    v_exp_f32 v125, v125
    v_exp_f32 v126, v126
    v_cvt_pk_bf16_f32 v142, v124, v125
    v_exp_f32 v127, v127
    v_mfma_f32_32x32x16_bf16 v[56:71], v[168:171], v[136:139], v[56:71]
    ds_read_b128 v[152:155], v22 offset:28672
    v_cvt_pk_bf16_f32 v143, v126, v127
    v_exp_f32 v96, v96
    v_exp_f32 v97, v97
    v_exp_f32 v98, v98
    v_mfma_f32_32x32x16_bf16 v[112:127], v[144:147], v[88:91], 0
    ds_read_b128 v[156:159], v22 offset:29696
    v_cvt_pk_bf16_f32 v128, v96, v97
    v_exp_f32 v99, v99
    v_exp_f32 v100, v100
    v_cvt_pk_bf16_f32 v129, v98, v99
    v_exp_f32 v101, v101
    v_mfma_f32_32x32x16_bf16 v[112:127], v[148:151], v[92:95], v[112:127]
    v_cvt_pk_bf16_f32 v130, v100, v101
    v_exp_f32 v102, v102
    v_exp_f32 v103, v103
    v_exp_f32 v104, v104
    v_mfma_f32_32x32x16_bf16 v[56:71], v[172:175], v[140:143], v[56:71]
    s_waitcnt lgkmcnt(0)
    v_cvt_pk_bf16_f32 v131, v102, v103
    v_exp_f32 v105, v105
    v_exp_f32 v106, v106
    v_cvt_pk_bf16_f32 v132, v104, v105
    v_exp_f32 v107, v107
    v_smfmac_f32_16x16x64_bf16 v[76:79], v[36:39], v[136:143], v26
    s_cmp_lg_u32 s1, 0
    v_cvt_pk_bf16_f32 v133, v106, v107
    v_exp_f32 v108, v108
    v_exp_f32 v109, v109
    v_exp_f32 v110, v110
    v_cvt_pk_bf16_f32 v134, v108, v109
    v_exp_f32 v111, v111
    v_mfma_f32_32x32x16_bf16 v[40:55], v[160:163], v[128:131], v[40:55]
    ds_read_b128 v[168:171], v22 offset:30720
    v_cvt_pk_bf16_f32 v135, v110, v111
    v_exp_f32 v112, v112
    v_exp_f32 v113, v113
    v_exp_f32 v114, v114
    v_mfma_f32_32x32x16_bf16 v[96:111], v[152:155], v[80:83], 0
    ds_read_b128 v[172:175], v22 offset:31744
    v_cvt_pk_bf16_f32 v136, v112, v113
    v_exp_f32 v115, v115
    v_exp_f32 v116, v116
    v_cvt_pk_bf16_f32 v137, v114, v115
    v_exp_f32 v117, v117
    v_mfma_f32_32x32x16_bf16 v[96:111], v[156:159], v[84:87], v[96:111]
    v_cvt_pk_bf16_f32 v138, v116, v117
    v_exp_f32 v118, v118
    v_exp_f32 v119, v119
    v_exp_f32 v120, v120
    v_mfma_f32_32x32x16_bf16 v[40:55], v[164:167], v[132:135], v[40:55]
    s_waitcnt lgkmcnt(0)
    v_cvt_pk_bf16_f32 v139, v118, v119
    v_exp_f32 v121, v121
    v_exp_f32 v122, v122
    v_cvt_pk_bf16_f32 v140, v120, v121
    v_exp_f32 v123, v123
    v_smfmac_f32_16x16x64_bf16 v[72:75], v[36:39], v[128:135], v26
    s_barrier
    v_cvt_pk_bf16_f32 v141, v122, v123
    v_exp_f32 v124, v124
    v_exp_f32 v125, v125
    v_exp_f32 v126, v126
    v_cvt_pk_bf16_f32 v142, v124, v125
    v_exp_f32 v127, v127
    s_cbranch_scc1 L_att2
    v_mfma_f32_32x32x16_bf16 v[56:71], v[160:163], v[136:139], v[56:71]
    v_cvt_pk_bf16_f32 v143, v126, v127
    v_exp_f32 v96, v96
    v_exp_f32 v97, v97
    v_exp_f32 v98, v98
    v_mfma_f32_32x32x16_bf16 v[112:127], v[152:155], v[88:91], 0
    v_cvt_pk_bf16_f32 v128, v96, v97
    v_exp_f32 v99, v99
    v_exp_f32 v100, v100
    v_cvt_pk_bf16_f32 v129, v98, v99
    v_exp_f32 v101, v101
    v_mfma_f32_32x32x16_bf16 v[112:127], v[156:159], v[92:95], v[112:127]
    v_cvt_pk_bf16_f32 v130, v100, v101
    v_exp_f32 v102, v102
    v_exp_f32 v103, v103
    v_exp_f32 v104, v104
    v_mfma_f32_32x32x16_bf16 v[56:71], v[164:167], v[140:143], v[56:71]
    v_cvt_pk_bf16_f32 v131, v102, v103
    v_exp_f32 v105, v105
    v_exp_f32 v106, v106
    v_cvt_pk_bf16_f32 v132, v104, v105
    v_exp_f32 v107, v107
    v_smfmac_f32_16x16x64_bf16 v[76:79], v[36:39], v[136:143], v26
    v_cvt_pk_bf16_f32 v133, v106, v107
    v_exp_f32 v108, v108
    v_exp_f32 v109, v109
    v_exp_f32 v110, v110
    v_cvt_pk_bf16_f32 v134, v108, v109
    v_exp_f32 v111, v111
    v_mfma_f32_32x32x16_bf16 v[40:55], v[168:171], v[128:131], v[40:55]
    v_cvt_pk_bf16_f32 v135, v110, v111
    v_exp_f32 v112, v112
    v_exp_f32 v113, v113
    v_exp_f32 v114, v114
    s_nop 0
    v_cvt_pk_bf16_f32 v136, v112, v113
    v_exp_f32 v115, v115
    v_exp_f32 v116, v116
    v_cvt_pk_bf16_f32 v137, v114, v115
    v_exp_f32 v117, v117
    s_nop 0
    v_cvt_pk_bf16_f32 v138, v116, v117
    v_exp_f32 v118, v118
    v_exp_f32 v119, v119
    v_exp_f32 v120, v120
    v_mfma_f32_32x32x16_bf16 v[40:55], v[172:175], v[132:135], v[40:55]
    v_cvt_pk_bf16_f32 v139, v118, v119
    v_exp_f32 v121, v121
    v_exp_f32 v122, v122
    v_cvt_pk_bf16_f32 v140, v120, v121
    v_exp_f32 v123, v123
    v_smfmac_f32_16x16x64_bf16 v[72:75], v[36:39], v[128:135], v26
    v_cvt_pk_bf16_f32 v141, v122, v123
    v_exp_f32 v124, v124
    v_exp_f32 v125, v125
    v_exp_f32 v126, v126
    v_cvt_pk_bf16_f32 v142, v124, v125
    v_exp_f32 v127, v127
    v_mfma_f32_32x32x16_bf16 v[56:71], v[168:171], v[136:139], v[56:71]
    v_cvt_pk_bf16_f32 v143, v126, v127
    s_nop 0
    s_nop 0
    v_mfma_f32_32x32x16_bf16 v[56:71], v[172:175], v[140:143], v[56:71]
    v_smfmac_f32_16x16x64_bf16 v[76:79], v[36:39], v[136:143], v26
    v_add_f32 v72, v72, v73
    v_mul_f32 v4, 0, v40
    v_fmac_f32 v4, 0, v41
    v_fmac_f32 v4, 0, v42
    v_fmac_f32 v4, 0, v43
    v_fmac_f32 v4, 0, v44
    v_fmac_f32 v4, 0, v45
    v_fmac_f32 v4, 0, v46
    v_fmac_f32 v4, 0, v47
    v_fmac_f32 v4, 0, v48
    v_fmac_f32 v4, 0, v49
    v_fmac_f32 v4, 0, v50
    v_fmac_f32 v4, 0, v51
    v_fmac_f32 v4, 0, v52
    v_fmac_f32 v4, 0, v53
    v_fmac_f32 v4, 0, v54
    v_fmac_f32 v4, 0, v55
    v_fmac_f32 v4, 0, v56
    v_fmac_f32 v4, 0, v57
    v_fmac_f32 v4, 0, v58
    v_fmac_f32 v4, 0, v59
    v_fmac_f32 v4, 0, v60
    v_fmac_f32 v4, 0, v61
    v_fmac_f32 v4, 0, v62
    v_fmac_f32 v4, 0, v63
    v_fmac_f32 v4, 0, v64
    v_fmac_f32 v4, 0, v65
    v_fmac_f32 v4, 0, v66
    v_fmac_f32 v4, 0, v67
    v_fmac_f32 v4, 0, v68
    v_fmac_f32 v4, 0, v69
    v_fmac_f32 v4, 0, v70
    v_fmac_f32 v4, 0, v71
    v_add_f32 v76, v76, v77
    v_add_f32 v4, v4, v72
    v_min_f32 v3, v72, v76
    v_add_f32 v4, v4, v76
    v_cmp_le_f32 vcc, 0x21800000, v3
    s_mov_b64 s[72:73], vcc
    v_cmp_ge_f32 vcc, 0x71800000, v4
    s_and_b64 s[72:73], s[72:73], vcc
    s_cmp_eq_u64 s[72:73], exec
    s_cbranch_scc0 L_slow
L_fin:
    v_rcp_f32 v32, v72
    v_rcp_f32 v33, v76
    v_mul_f32 v40, v40, v32
    v_mul_f32 v41, v41, v32
    v_mul_f32 v42, v42, v32
    v_mul_f32 v43, v43, v32
    v_mul_f32 v44, v44, v32
    v_mul_f32 v45, v45, v32
    v_mul_f32 v46, v46, v32
    v_mul_f32 v47, v47, v32
    v_mul_f32 v48, v48, v32
    v_mul_f32 v49, v49, v32
    v_mul_f32 v50, v50, v32
    v_mul_f32 v51, v51, v32
    v_mul_f32 v52, v52, v32
    v_mul_f32 v53, v53, v32
    v_mul_f32 v54, v54, v32
    v_mul_f32 v55, v55, v32
    v_cvt_pk_bf16_f32 v176, v40, v41
    v_cvt_pk_bf16_f32 v177, v42, v43
    v_cvt_pk_bf16_f32 v178, v44, v45
    v_cvt_pk_bf16_f32 v179, v46, v47
    v_cvt_pk_bf16_f32 v180, v48, v49
    v_cvt_pk_bf16_f32 v181, v50, v51
    v_cvt_pk_bf16_f32 v182, v52, v53
    v_cvt_pk_bf16_f32 v183, v54, v55
    buffer_store_dwordx4 v[176:179], v7, s[8:11], s28 offen offset:0 sc1
    buffer_store_dwordx4 v[180:183], v7, s[8:11], s28 offen offset:1024 sc1
    v_mul_f32 v56, v56, v33
    v_mul_f32 v57, v57, v33
    v_mul_f32 v58, v58, v33
    v_mul_f32 v59, v59, v33
    v_mul_f32 v60, v60, v33
    v_mul_f32 v61, v61, v33
    v_mul_f32 v62, v62, v33
    v_mul_f32 v63, v63, v33
    v_mul_f32 v64, v64, v33
    v_mul_f32 v65, v65, v33
    v_mul_f32 v66, v66, v33
    v_mul_f32 v67, v67, v33
    v_mul_f32 v68, v68, v33
    v_mul_f32 v69, v69, v33
    v_mul_f32 v70, v70, v33
    v_mul_f32 v71, v71, v33
    v_cvt_pk_bf16_f32 v184, v56, v57
    v_cvt_pk_bf16_f32 v185, v58, v59
    v_cvt_pk_bf16_f32 v186, v60, v61
    v_cvt_pk_bf16_f32 v187, v62, v63
    v_cvt_pk_bf16_f32 v188, v64, v65
    v_cvt_pk_bf16_f32 v189, v66, v67
    v_cvt_pk_bf16_f32 v190, v68, v69
    v_cvt_pk_bf16_f32 v191, v70, v71
    buffer_store_dwordx4 v[184:187], v7, s[8:11], s29 offen offset:0 sc1
    buffer_store_dwordx4 v[188:191], v7, s[8:11], s29 offen offset:1024 sc1
    s_barrier
    s_cmp_eq_u32 s7, 0
    s_cbranch_scc1 L_YB3
    s_cmp_le_u32 s78, 256
    s_cselect_b32 s100, 6, 4
    s_add_u32 m0, s81, 0x0
    s_lshl_b32 s70, s100, 12
    s_add_u32 s70, s70, s86
    s_lshl_b32 s71, s100, 17
    buffer_load_dwordx4 v7, s[8:11], s70 offen sc1 lds
    buffer_load_dwordx4 v7, s[8:11], s70 offen offset:1024 sc1 lds
    buffer_load_dwordx4 v7, s[8:11], s70 offen offset:2048 sc1 lds
    buffer_load_dwordx4 v7, s[8:11], s70 offen offset:3072 sc1 lds
    s_add_u32 m0, s82, 0x0
    s_add_u32 s71, s71, 0
    buffer_load_dwordx4 v18, s[24:27], s71 offen lds
    buffer_load_dwordx4 v19, s[24:27], s71 offen offset:1024 lds
    s_add_u32 m0, s82, 0x2000
    s_add_u32 s71, s71, 128
    buffer_load_dwordx4 v18, s[24:27], s71 offen lds
    buffer_load_dwordx4 v19, s[24:27], s71 offen offset:1024 lds
    s_waitcnt vmcnt(8)
    buffer_store_dword v25, v23, s[8:11], 0 offen sc1
    s_cmp_le_u32 s78, 0
    s_cselect_b32 s100, 10, 8
    s_add_u32 m0, s81, 0x4000
    s_lshl_b32 s70, s100, 12
    s_add_u32 s70, s70, s86
    s_lshl_b32 s71, s100, 17
    buffer_load_dwordx4 v7, s[8:11], s70 offen sc1 lds
    buffer_load_dwordx4 v7, s[8:11], s70 offen offset:1024 sc1 lds
    buffer_load_dwordx4 v7, s[8:11], s70 offen offset:2048 sc1 lds
    buffer_load_dwordx4 v7, s[8:11], s70 offen offset:3072 sc1 lds
    s_add_u32 m0, s82, 0x4000
    s_add_u32 s71, s71, 0
    buffer_load_dwordx4 v18, s[24:27], s71 offen lds
    buffer_load_dwordx4 v19, s[24:27], s71 offen offset:1024 lds
    s_add_u32 m0, s82, 0x6000
    s_add_u32 s71, s71, 128
    buffer_load_dwordx4 v18, s[24:27], s71 offen lds
    buffer_load_dwordx4 v19, s[24:27], s71 offen offset:1024 lds
    s_barrier
    s_cmp_le_u32 s78, 128
    s_cselect_b32 s100, 12, 10
    s_add_u32 m0, s81, 0x8000
    s_lshl_b32 s70, s100, 12
    s_add_u32 s70, s70, s86
    s_lshl_b32 s71, s100, 17
    buffer_load_dwordx4 v7, s[8:11], s70 offen sc1 lds
    buffer_load_dwordx4 v7, s[8:11], s70 offen offset:1024 sc1 lds
    buffer_load_dwordx4 v7, s[8:11], s70 offen offset:2048 sc1 lds
    buffer_load_dwordx4 v7, s[8:11], s70 offen offset:3072 sc1 lds
    s_add_u32 m0, s82, 0x8000
    s_add_u32 s71, s71, 0
    buffer_load_dwordx4 v18, s[24:27], s71 offen lds
    buffer_load_dwordx4 v19, s[24:27], s71 offen offset:1024 lds
    s_add_u32 m0, s82, 0xa000
    s_add_u32 s71, s71, 128
    buffer_load_dwordx4 v18, s[24:27], s71 offen lds
    buffer_load_dwordx4 v19, s[24:27], s71 offen offset:1024 lds
    s_waitcnt vmcnt(17)
    s_barrier
    s_cmp_le_u32 s78, 256
    s_cselect_b32 s100, 14, 12
    s_add_u32 m0, s81, 0xc000
    s_lshl_b32 s70, s100, 12
    s_add_u32 s70, s70, s86
    s_lshl_b32 s71, s100, 17
    buffer_load_dwordx4 v7, s[8:11], s70 offen sc1 lds
    buffer_load_dwordx4 v7, s[8:11], s70 offen offset:1024 sc1 lds
    buffer_load_dwordx4 v7, s[8:11], s70 offen offset:2048 sc1 lds
    buffer_load_dwordx4 v7, s[8:11], s70 offen offset:3072 sc1 lds
    s_add_u32 m0, s82, 0xc000
    s_add_u32 s71, s71, 0
    buffer_load_dwordx4 v18, s[24:27], s71 offen lds
    buffer_load_dwordx4 v19, s[24:27], s71 offen offset:1024 lds
    s_add_u32 m0, s82, 0xe000
    s_add_u32 s71, s71, 128
    buffer_load_dwordx4 v18, s[24:27], s71 offen lds
    buffer_load_dwordx4 v19, s[24:27], s71 offen offset:1024 lds
    s_waitcnt vmcnt(16)
    s_barrier
    s_mov_b32 s100, 1
    s_add_u32 m0, s81, 0x0
    s_lshl_b32 s70, s100, 12
    s_add_u32 s70, s70, s86
    s_lshl_b32 s71, s100, 17
    s_add_u32 m0, s82, 0x0
    s_add_u32 s71, s71, 0
    buffer_load_dwordx4 v18, s[24:27], s71 offen lds
    buffer_load_dwordx4 v19, s[24:27], s71 offen offset:1024 lds
    s_add_u32 m0, s82, 0x2000
    s_add_u32 s71, s71, 128
    buffer_load_dwordx4 v18, s[24:27], s71 offen lds
    buffer_load_dwordx4 v19, s[24:27], s71 offen offset:1024 lds
    s_waitcnt vmcnt(12)
    s_barrier
    s_mov_b32 s72, 0xc60000
    buffer_load_dword v8, v30, s[8:11], s72 offen sc1
    s_mov_b32 s100, 3
    s_add_u32 m0, s81, 0x4000
    s_lshl_b32 s70, s100, 12
    s_add_u32 s70, s70, s86
    s_lshl_b32 s71, s100, 17
    s_add_u32 m0, s82, 0x4000
    s_add_u32 s71, s71, 0
    buffer_load_dwordx4 v18, s[24:27], s71 offen lds
    buffer_load_dwordx4 v19, s[24:27], s71 offen offset:1024 lds
    s_add_u32 m0, s82, 0x6000
    s_add_u32 s71, s71, 128
    buffer_load_dwordx4 v18, s[24:27], s71 offen lds
    buffer_load_dwordx4 v19, s[24:27], s71 offen offset:1024 lds
    s_waitcnt vmcnt(9)
    s_barrier
    s_waitcnt vmcnt(4)
    v_cmp_eq_u32 vcc, s83, v8
    s_cmp_eq_u64 vcc, exec
    s_cbranch_scc1 L_pd_ox
    s_mov_b32 s73, 131072
    s_mov_b32 s72, 0xc60000
L_pl_ox:
    buffer_load_dword v8, v30, s[8:11], s72 offen sc1
    s_waitcnt vmcnt(0)
    v_cmp_eq_u32 vcc, s83, v8
    s_cmp_eq_u64 vcc, exec
    s_cbranch_scc1 L_pd_ox
    s_sleep 8
    s_sub_u32 s73, s73, 1
    s_cbranch_scc0 L_pl_ox
L_pd_ox:
    s_mov_b32 s100, 1
    s_add_u32 m0, s81, 0x0
    s_lshl_b32 s70, s100, 12
    s_add_u32 s70, s70, s86
    s_lshl_b32 s71, s100, 17
    buffer_load_dwordx4 v7, s[8:11], s70 offen sc1 lds
    buffer_load_dwordx4 v7, s[8:11], s70 offen offset:1024 sc1 lds
    buffer_load_dwordx4 v7, s[8:11], s70 offen offset:2048 sc1 lds
    buffer_load_dwordx4 v7, s[8:11], s70 offen offset:3072 sc1 lds
    s_mov_b32 s100, 3
    s_add_u32 m0, s81, 0x4000
    s_lshl_b32 s70, s100, 12
    s_add_u32 s70, s70, s86
    s_lshl_b32 s71, s100, 17
    buffer_load_dwordx4 v7, s[8:11], s70 offen sc1 lds
    buffer_load_dwordx4 v7, s[8:11], s70 offen offset:1024 sc1 lds
    buffer_load_dwordx4 v7, s[8:11], s70 offen offset:2048 sc1 lds
    buffer_load_dwordx4 v7, s[8:11], s70 offen offset:3072 sc1 lds
    s_mov_b32 s100, 5
    s_add_u32 m0, s81, 0x8000
    s_lshl_b32 s70, s100, 12
    s_add_u32 s70, s70, s86
    s_lshl_b32 s71, s100, 17
    buffer_load_dwordx4 v7, s[8:11], s70 offen sc1 lds
    buffer_load_dwordx4 v7, s[8:11], s70 offen offset:1024 sc1 lds
    buffer_load_dwordx4 v7, s[8:11], s70 offen offset:2048 sc1 lds
    buffer_load_dwordx4 v7, s[8:11], s70 offen offset:3072 sc1 lds
    s_add_u32 m0, s82, 0x8000
    s_add_u32 s71, s71, 0
    buffer_load_dwordx4 v18, s[24:27], s71 offen lds
    buffer_load_dwordx4 v19, s[24:27], s71 offen offset:1024 lds
    s_add_u32 m0, s82, 0xa000
    s_add_u32 s71, s71, 128
    buffer_load_dwordx4 v18, s[24:27], s71 offen lds
    buffer_load_dwordx4 v19, s[24:27], s71 offen offset:1024 lds
    s_waitcnt vmcnt(12)
    s_barrier
    s_mov_b32 s100, 7
    s_add_u32 m0, s81, 0xc000
    s_lshl_b32 s70, s100, 12
    s_add_u32 s70, s70, s86
    s_lshl_b32 s71, s100, 17
    buffer_load_dwordx4 v7, s[8:11], s70 offen sc1 lds
    buffer_load_dwordx4 v7, s[8:11], s70 offen offset:1024 sc1 lds
    buffer_load_dwordx4 v7, s[8:11], s70 offen offset:2048 sc1 lds
    buffer_load_dwordx4 v7, s[8:11], s70 offen offset:3072 sc1 lds
    s_add_u32 m0, s82, 0xc000
    s_add_u32 s71, s71, 0
    buffer_load_dwordx4 v18, s[24:27], s71 offen lds
    buffer_load_dwordx4 v19, s[24:27], s71 offen offset:1024 lds
    s_add_u32 m0, s82, 0xe000
    s_add_u32 s71, s71, 128
    buffer_load_dwordx4 v18, s[24:27], s71 offen lds
    buffer_load_dwordx4 v19, s[24:27], s71 offen offset:1024 lds
    s_waitcnt vmcnt(16)
    s_barrier
    s_mov_b32 s100, 9
    s_add_u32 m0, s81, 0x0
    s_lshl_b32 s70, s100, 12
    s_add_u32 s70, s70, s86
    s_lshl_b32 s71, s100, 17
    buffer_load_dwordx4 v7, s[8:11], s70 offen sc1 lds
    buffer_load_dwordx4 v7, s[8:11], s70 offen offset:1024 sc1 lds
    buffer_load_dwordx4 v7, s[8:11], s70 offen offset:2048 sc1 lds
    buffer_load_dwordx4 v7, s[8:11], s70 offen offset:3072 sc1 lds
    s_add_u32 m0, s82, 0x0
    s_add_u32 s71, s71, 0
    buffer_load_dwordx4 v18, s[24:27], s71 offen lds
    buffer_load_dwordx4 v19, s[24:27], s71 offen offset:1024 lds
    s_add_u32 m0, s82, 0x2000
    s_add_u32 s71, s71, 128
    buffer_load_dwordx4 v18, s[24:27], s71 offen lds
    buffer_load_dwordx4 v19, s[24:27], s71 offen offset:1024 lds
    s_waitcnt vmcnt(16)
    s_barrier
    s_mov_b32 s100, 11
    s_add_u32 m0, s81, 0x4000
    s_lshl_b32 s70, s100, 12
    s_add_u32 s70, s70, s86
    s_lshl_b32 s71, s100, 17
    buffer_load_dwordx4 v7, s[8:11], s70 offen sc1 lds
    buffer_load_dwordx4 v7, s[8:11], s70 offen offset:1024 sc1 lds
    buffer_load_dwordx4 v7, s[8:11], s70 offen offset:2048 sc1 lds
    buffer_load_dwordx4 v7, s[8:11], s70 offen offset:3072 sc1 lds
    s_add_u32 m0, s82, 0x4000
    s_add_u32 s71, s71, 0
    buffer_load_dwordx4 v18, s[24:27], s71 offen lds
    buffer_load_dwordx4 v19, s[24:27], s71 offen offset:1024 lds
    s_add_u32 m0, s82, 0x6000
    s_add_u32 s71, s71, 128
    buffer_load_dwordx4 v18, s[24:27], s71 offen lds
    buffer_load_dwordx4 v19, s[24:27], s71 offen offset:1024 lds
    s_waitcnt vmcnt(16)
    s_barrier
    s_mov_b32 s100, 13
    s_add_u32 m0, s81, 0x8000
    s_lshl_b32 s70, s100, 12
    s_add_u32 s70, s70, s86
    s_lshl_b32 s71, s100, 17
    buffer_load_dwordx4 v7, s[8:11], s70 offen sc1 lds
    buffer_load_dwordx4 v7, s[8:11], s70 offen offset:1024 sc1 lds
    buffer_load_dwordx4 v7, s[8:11], s70 offen offset:2048 sc1 lds
    buffer_load_dwordx4 v7, s[8:11], s70 offen offset:3072 sc1 lds
    s_add_u32 m0, s82, 0x8000
    s_add_u32 s71, s71, 0
    buffer_load_dwordx4 v18, s[24:27], s71 offen lds
    buffer_load_dwordx4 v19, s[24:27], s71 offen offset:1024 lds
    s_add_u32 m0, s82, 0xa000
    s_add_u32 s71, s71, 128
    buffer_load_dwordx4 v18, s[24:27], s71 offen lds
    buffer_load_dwordx4 v19, s[24:27], s71 offen offset:1024 lds
    s_waitcnt vmcnt(16)
    s_barrier
    s_mov_b32 s100, 15
    s_add_u32 m0, s81, 0xc000
    s_lshl_b32 s70, s100, 12
    s_add_u32 s70, s70, s86
    s_lshl_b32 s71, s100, 17
    buffer_load_dwordx4 v7, s[8:11], s70 offen sc1 lds
    buffer_load_dwordx4 v7, s[8:11], s70 offen offset:1024 sc1 lds
    buffer_load_dwordx4 v7, s[8:11], s70 offen offset:2048 sc1 lds
    buffer_load_dwordx4 v7, s[8:11], s70 offen offset:3072 sc1 lds
    s_add_u32 m0, s82, 0xc000
    s_add_u32 s71, s71, 0
    buffer_load_dwordx4 v18, s[24:27], s71 offen lds
    buffer_load_dwordx4 v19, s[24:27], s71 offen offset:1024 lds
    s_add_u32 m0, s82, 0xe000
    s_add_u32 s71, s71, 128
    buffer_load_dwordx4 v18, s[24:27], s71 offen lds
    buffer_load_dwordx4 v19, s[24:27], s71 offen offset:1024 lds
    s_waitcnt vmcnt(16)
    s_barrier
    s_waitcnt vmcnt(8)
    s_barrier
    s_waitcnt vmcnt(0)
    s_barrier
    s_endpgm
L_YB3:
L_pad_yb3:
    s_cbranch_execz L_pad_17
    s_cmp_le_u32 s78, 256
    s_addc_u32 s100, 2, 0
    s_add_u32 m0, s81, 0x8000
    s_lshl_b32 s70, s100, 12
    s_add_u32 s70, s70, s86
    s_bitcmp0_b32 s100, 0
    s_cselect_b32 s24, s46, s48
    s_cselect_b32 s25, s47, s49
    s_lshr_b32 s71, s100, 1
    s_lshl_b32 s71, s71, 7
    buffer_load_dwordx4 v7, s[8:11], s70 offen sc1 lds
    buffer_load_dwordx4 v7, s[8:11], s70 offen offset:1024 sc1 lds
    buffer_load_dwordx4 v7, s[8:11], s70 offen offset:2048 sc1 lds
    buffer_load_dwordx4 v7, s[8:11], s70 offen offset:3072 sc1 lds
    s_add_u32 m0, m0, 0x10000
    s_nop 0
    buffer_load_dwordx4 v18, s[24:27], s71 offen lds
    buffer_load_dwordx4 v19, s[24:27], s71 offen offset:1024 lds
    buffer_load_dwordx4 v20, s[24:27], s71 offen offset:2048 lds
    buffer_load_dwordx4 v21, s[24:27], s71 offen offset:3072 lds
    s_waitcnt vmcnt(8)
    buffer_store_dword v25, v23, s[8:11], 0 offen sc1
    s_cmp_le_u32 s78, 0
    s_addc_u32 s100, 4, 0
    s_add_u32 m0, s81, 0xc000
    s_lshl_b32 s70, s100, 12
    s_add_u32 s70, s70, s86
    s_bitcmp0_b32 s100, 0
    s_cselect_b32 s24, s46, s48
    s_cselect_b32 s25, s47, s49
    s_lshr_b32 s71, s100, 1
    s_lshl_b32 s71, s71, 7
    buffer_load_dwordx4 v7, s[8:11], s70 offen sc1 lds
    buffer_load_dwordx4 v7, s[8:11], s70 offen offset:1024 sc1 lds
    buffer_load_dwordx4 v7, s[8:11], s70 offen offset:2048 sc1 lds
    buffer_load_dwordx4 v7, s[8:11], s70 offen offset:3072 sc1 lds
    s_add_u32 m0, m0, 0x10000
    s_nop 0
    buffer_load_dwordx4 v18, s[24:27], s71 offen lds
    buffer_load_dwordx4 v19, s[24:27], s71 offen offset:1024 lds
    buffer_load_dwordx4 v20, s[24:27], s71 offen offset:2048 lds
    buffer_load_dwordx4 v21, s[24:27], s71 offen offset:3072 lds
    s_barrier
    s_cmp_le_u32 s78, 128
    s_addc_u32 s100, 5, 0
    s_add_u32 m0, s81, 0x0
    s_lshl_b32 s70, s100, 12
    s_add_u32 s70, s70, s86
    s_bitcmp0_b32 s100, 0
    s_cselect_b32 s24, s46, s48
    s_cselect_b32 s25, s47, s49
    s_lshr_b32 s71, s100, 1
    s_lshl_b32 s71, s71, 7
    buffer_load_dwordx4 v7, s[8:11], s70 offen sc1 lds
    buffer_load_dwordx4 v7, s[8:11], s70 offen offset:1024 sc1 lds
    buffer_load_dwordx4 v7, s[8:11], s70 offen offset:2048 sc1 lds
    buffer_load_dwordx4 v7, s[8:11], s70 offen offset:3072 sc1 lds
    s_add_u32 m0, m0, 0x10000
    s_nop 0
    buffer_load_dwordx4 v18, s[24:27], s71 offen lds
    buffer_load_dwordx4 v19, s[24:27], s71 offen offset:1024 lds
    buffer_load_dwordx4 v20, s[24:27], s71 offen offset:2048 lds
    buffer_load_dwordx4 v21, s[24:27], s71 offen offset:3072 lds
    s_waitcnt vmcnt(17)
    s_barrier
    s_cmp_le_u32 s78, 256
    s_addc_u32 s100, 6, 0
    s_add_u32 m0, s81, 0x4000
    s_lshl_b32 s70, s100, 12
    s_add_u32 s70, s70, s86
    s_bitcmp0_b32 s100, 0
    s_cselect_b32 s24, s46, s48
    s_cselect_b32 s25, s47, s49
    s_lshr_b32 s71, s100, 1
    s_lshl_b32 s71, s71, 7
    buffer_load_dwordx4 v7, s[8:11], s70 offen sc1 lds
    buffer_load_dwordx4 v7, s[8:11], s70 offen offset:1024 sc1 lds
    buffer_load_dwordx4 v7, s[8:11], s70 offen offset:2048 sc1 lds
    buffer_load_dwordx4 v7, s[8:11], s70 offen offset:3072 sc1 lds
    s_add_u32 m0, m0, 0x10000
    s_nop 0
    buffer_load_dwordx4 v18, s[24:27], s71 offen lds
    buffer_load_dwordx4 v19, s[24:27], s71 offen offset:1024 lds
    buffer_load_dwordx4 v20, s[24:27], s71 offen offset:2048 lds
    buffer_load_dwordx4 v21, s[24:27], s71 offen offset:3072 lds
    s_waitcnt vmcnt(16)
    s_barrier
    s_cmp_le_u32 s78, 0
    s_addc_u32 s100, 8, 0
    s_add_u32 m0, s81, 0x8000
    s_lshl_b32 s70, s100, 12
    s_add_u32 s70, s70, s86
    s_bitcmp0_b32 s100, 0
    s_cselect_b32 s24, s46, s48
    s_cselect_b32 s25, s47, s49
    s_lshr_b32 s71, s100, 1
    s_lshl_b32 s71, s71, 7
    buffer_load_dwordx4 v7, s[8:11], s70 offen sc1 lds
    buffer_load_dwordx4 v7, s[8:11], s70 offen offset:1024 sc1 lds
    buffer_load_dwordx4 v7, s[8:11], s70 offen offset:2048 sc1 lds
    buffer_load_dwordx4 v7, s[8:11], s70 offen offset:3072 sc1 lds
    s_add_u32 m0, m0, 0x10000
    s_nop 0
    buffer_load_dwordx4 v18, s[24:27], s71 offen lds
    buffer_load_dwordx4 v19, s[24:27], s71 offen offset:1024 lds
    buffer_load_dwordx4 v20, s[24:27], s71 offen offset:2048 lds
    buffer_load_dwordx4 v21, s[24:27], s71 offen offset:3072 lds
    s_waitcnt vmcnt(16)
    s_barrier
    s_cmp_le_u32 s78, 128
    s_addc_u32 s100, 9, 0
    s_add_u32 m0, s81, 0xc000
    s_lshl_b32 s70, s100, 12
    s_add_u32 s70, s70, s86
    s_bitcmp0_b32 s100, 0
    s_cselect_b32 s24, s46, s48
    s_cselect_b32 s25, s47, s49
    s_lshr_b32 s71, s100, 1
    s_lshl_b32 s71, s71, 7
    buffer_load_dwordx4 v7, s[8:11], s70 offen sc1 lds
    buffer_load_dwordx4 v7, s[8:11], s70 offen offset:1024 sc1 lds
    buffer_load_dwordx4 v7, s[8:11], s70 offen offset:2048 sc1 lds
    buffer_load_dwordx4 v7, s[8:11], s70 offen offset:3072 sc1 lds
    s_add_u32 m0, m0, 0x10000
    s_nop 0
    buffer_load_dwordx4 v18, s[24:27], s71 offen lds
    buffer_load_dwordx4 v19, s[24:27], s71 offen offset:1024 lds
    buffer_load_dwordx4 v20, s[24:27], s71 offen offset:2048 lds
    buffer_load_dwordx4 v21, s[24:27], s71 offen offset:3072 lds
    s_waitcnt vmcnt(16)
    s_barrier
    s_cmp_le_u32 s78, 256
    s_addc_u32 s100, 10, 0
    s_add_u32 m0, s81, 0x0
    s_lshl_b32 s70, s100, 12
    s_add_u32 s70, s70, s86
    s_bitcmp0_b32 s100, 0
    s_cselect_b32 s24, s46, s48
    s_cselect_b32 s25, s47, s49
    s_lshr_b32 s71, s100, 1
    s_lshl_b32 s71, s71, 7
    buffer_load_dwordx4 v7, s[8:11], s70 offen sc1 lds
    buffer_load_dwordx4 v7, s[8:11], s70 offen offset:1024 sc1 lds
    buffer_load_dwordx4 v7, s[8:11], s70 offen offset:2048 sc1 lds
    buffer_load_dwordx4 v7, s[8:11], s70 offen offset:3072 sc1 lds
    s_add_u32 m0, m0, 0x10000
    s_nop 0
    buffer_load_dwordx4 v18, s[24:27], s71 offen lds
    buffer_load_dwordx4 v19, s[24:27], s71 offen offset:1024 lds
    buffer_load_dwordx4 v20, s[24:27], s71 offen offset:2048 lds
    buffer_load_dwordx4 v21, s[24:27], s71 offen offset:3072 lds
    s_waitcnt vmcnt(16)
    s_barrier
    s_cmp_eq_u32 s78, 0
    s_cselect_b32 s100, 16, 12
    s_add_u32 m0, s81, 0x4000
    s_lshl_b32 s70, s100, 12
    s_add_u32 s70, s70, s86
    s_bitcmp0_b32 s100, 0
    s_cselect_b32 s24, s46, s48
    s_cselect_b32 s25, s47, s49
    s_lshr_b32 s71, s100, 1
    s_lshl_b32 s71, s71, 7
    buffer_load_dwordx4 v7, s[8:11], s70 offen sc1 lds
    buffer_load_dwordx4 v7, s[8:11], s70 offen offset:1024 sc1 lds
    buffer_load_dwordx4 v7, s[8:11], s70 offen offset:2048 sc1 lds
    buffer_load_dwordx4 v7, s[8:11], s70 offen offset:3072 sc1 lds
    s_add_u32 m0, m0, 0x10000
    s_nop 0
    buffer_load_dwordx4 v18, s[24:27], s71 offen lds
    buffer_load_dwordx4 v19, s[24:27], s71 offen offset:1024 lds
    buffer_load_dwordx4 v20, s[24:27], s71 offen offset:2048 lds
    buffer_load_dwordx4 v21, s[24:27], s71 offen offset:3072 lds
    s_waitcnt vmcnt(16)
    s_barrier
    s_cmp_eq_u32 s78, 128
    s_cselect_b32 s100, 17, 13
    s_add_u32 m0, s81, 0x8000
    s_lshl_b32 s70, s100, 12
    s_add_u32 s70, s70, s86
    s_bitcmp0_b32 s100, 0
    s_cselect_b32 s24, s46, s48
    s_cselect_b32 s25, s47, s49
    s_lshr_b32 s71, s100, 1
    s_lshl_b32 s71, s71, 7
    buffer_load_dwordx4 v7, s[8:11], s70 offen sc1 lds
    buffer_load_dwordx4 v7, s[8:11], s70 offen offset:1024 sc1 lds
    buffer_load_dwordx4 v7, s[8:11], s70 offen offset:2048 sc1 lds
    buffer_load_dwordx4 v7, s[8:11], s70 offen offset:3072 sc1 lds
    s_add_u32 m0, m0, 0x10000
    s_nop 0
    buffer_load_dwordx4 v18, s[24:27], s71 offen lds
    buffer_load_dwordx4 v19, s[24:27], s71 offen offset:1024 lds
    buffer_load_dwordx4 v20, s[24:27], s71 offen offset:2048 lds
    buffer_load_dwordx4 v21, s[24:27], s71 offen offset:3072 lds
    s_waitcnt vmcnt(16)
    s_barrier
L_pad_5:
    s_cbranch_execz L_pad_18
    s_cmp_eq_u32 s78, 256
    s_cselect_b32 s100, 18, 14
    s_add_u32 m0, s81, 0xc000
    s_lshl_b32 s70, s100, 12
    s_add_u32 s70, s70, s86
    s_bitcmp0_b32 s100, 0
    s_cselect_b32 s24, s46, s48
    s_cselect_b32 s25, s47, s49
    s_lshr_b32 s71, s100, 1
    s_lshl_b32 s71, s71, 7
    buffer_load_dwordx4 v7, s[8:11], s70 offen sc1 lds
    buffer_load_dwordx4 v7, s[8:11], s70 offen offset:1024 sc1 lds
    buffer_load_dwordx4 v7, s[8:11], s70 offen offset:2048 sc1 lds
    buffer_load_dwordx4 v7, s[8:11], s70 offen offset:3072 sc1 lds
    s_add_u32 m0, m0, 0x10000
    s_nop 0
    buffer_load_dwordx4 v18, s[24:27], s71 offen lds
    buffer_load_dwordx4 v19, s[24:27], s71 offen offset:1024 lds
    buffer_load_dwordx4 v20, s[24:27], s71 offen offset:2048 lds
    buffer_load_dwordx4 v21, s[24:27], s71 offen offset:3072 lds
    s_waitcnt vmcnt(16)
    s_barrier
    s_cmp_eq_u32 s78, 384
    s_cselect_b32 s100, 19, 15
    s_add_u32 m0, s81, 0x0
    s_lshl_b32 s70, s100, 12
    s_add_u32 s70, s70, s86
    s_bitcmp0_b32 s100, 0
    s_cselect_b32 s24, s46, s48
    s_cselect_b32 s25, s47, s49
    s_lshr_b32 s71, s100, 1
    s_lshl_b32 s71, s71, 7
    buffer_load_dwordx4 v7, s[8:11], s70 offen sc1 lds
    buffer_load_dwordx4 v7, s[8:11], s70 offen offset:1024 sc1 lds
    buffer_load_dwordx4 v7, s[8:11], s70 offen offset:2048 sc1 lds
    buffer_load_dwordx4 v7, s[8:11], s70 offen offset:3072 sc1 lds
    s_add_u32 m0, m0, 0x10000
    s_nop 0
    buffer_load_dwordx4 v18, s[24:27], s71 offen lds
    buffer_load_dwordx4 v19, s[24:27], s71 offen offset:1024 lds
    buffer_load_dwordx4 v20, s[24:27], s71 offen offset:2048 lds
    buffer_load_dwordx4 v21, s[24:27], s71 offen offset:3072 lds
    s_waitcnt vmcnt(16)
    s_barrier
    s_cmp_eq_u32 s78, 0
    s_cselect_b32 s100, 20, 16
    s_add_u32 m0, s81, 0x4000
    s_lshl_b32 s70, s100, 12
    s_add_u32 s70, s70, s86
    s_bitcmp0_b32 s100, 0
    s_cselect_b32 s24, s46, s48
    s_cselect_b32 s25, s47, s49
    s_lshr_b32 s71, s100, 1
    s_lshl_b32 s71, s71, 7
    buffer_load_dwordx4 v7, s[8:11], s70 offen sc1 lds
    buffer_load_dwordx4 v7, s[8:11], s70 offen offset:1024 sc1 lds
    buffer_load_dwordx4 v7, s[8:11], s70 offen offset:2048 sc1 lds
    buffer_load_dwordx4 v7, s[8:11], s70 offen offset:3072 sc1 lds
    s_add_u32 m0, m0, 0x10000
    s_nop 0
    buffer_load_dwordx4 v18, s[24:27], s71 offen lds
    buffer_load_dwordx4 v19, s[24:27], s71 offen offset:1024 lds
    buffer_load_dwordx4 v20, s[24:27], s71 offen offset:2048 lds
    buffer_load_dwordx4 v21, s[24:27], s71 offen offset:3072 lds
    s_waitcnt vmcnt(16)
    s_barrier
    s_cmp_eq_u32 s78, 128
    s_cselect_b32 s100, 21, 17
    s_add_u32 m0, s81, 0x8000
    s_lshl_b32 s70, s100, 12
    s_add_u32 s70, s70, s86
    s_bitcmp0_b32 s100, 0
    s_cselect_b32 s24, s46, s48
    s_cselect_b32 s25, s47, s49
    s_lshr_b32 s71, s100, 1
    s_lshl_b32 s71, s71, 7
    buffer_load_dwordx4 v7, s[8:11], s70 offen sc1 lds
    buffer_load_dwordx4 v7, s[8:11], s70 offen offset:1024 sc1 lds
    buffer_load_dwordx4 v7, s[8:11], s70 offen offset:2048 sc1 lds
    buffer_load_dwordx4 v7, s[8:11], s70 offen offset:3072 sc1 lds
    s_add_u32 m0, m0, 0x10000
    s_nop 0
    buffer_load_dwordx4 v18, s[24:27], s71 offen lds
    buffer_load_dwordx4 v19, s[24:27], s71 offen offset:1024 lds
    buffer_load_dwordx4 v20, s[24:27], s71 offen offset:2048 lds
    buffer_load_dwordx4 v21, s[24:27], s71 offen offset:3072 lds
    s_waitcnt vmcnt(16)
    s_barrier
    s_cmp_eq_u32 s78, 256
    s_cselect_b32 s100, 22, 18
    s_add_u32 m0, s81, 0xc000
    s_lshl_b32 s70, s100, 12
    s_add_u32 s70, s70, s86
    s_bitcmp0_b32 s100, 0
    s_cselect_b32 s24, s46, s48
    s_cselect_b32 s25, s47, s49
    s_lshr_b32 s71, s100, 1
    s_lshl_b32 s71, s71, 7
    buffer_load_dwordx4 v7, s[8:11], s70 offen sc1 lds
    buffer_load_dwordx4 v7, s[8:11], s70 offen offset:1024 sc1 lds
    buffer_load_dwordx4 v7, s[8:11], s70 offen offset:2048 sc1 lds
    buffer_load_dwordx4 v7, s[8:11], s70 offen offset:3072 sc1 lds
    s_add_u32 m0, m0, 0x10000
    s_nop 0
    buffer_load_dwordx4 v18, s[24:27], s71 offen lds
    buffer_load_dwordx4 v19, s[24:27], s71 offen offset:1024 lds
    buffer_load_dwordx4 v20, s[24:27], s71 offen offset:2048 lds
    buffer_load_dwordx4 v21, s[24:27], s71 offen offset:3072 lds
    s_waitcnt vmcnt(16)
    s_barrier
    s_cmp_eq_u32 s78, 384
    s_cselect_b32 s100, 23, 19
    s_add_u32 m0, s81, 0x0
    s_lshl_b32 s70, s100, 12
    s_add_u32 s70, s70, s86
    s_bitcmp0_b32 s100, 0
    s_cselect_b32 s24, s46, s48
    s_cselect_b32 s25, s47, s49
    s_lshr_b32 s71, s100, 1
    s_lshl_b32 s71, s71, 7
    buffer_load_dwordx4 v7, s[8:11], s70 offen sc1 lds
    buffer_load_dwordx4 v7, s[8:11], s70 offen offset:1024 sc1 lds
    buffer_load_dwordx4 v7, s[8:11], s70 offen offset:2048 sc1 lds
    buffer_load_dwordx4 v7, s[8:11], s70 offen offset:3072 sc1 lds
    s_add_u32 m0, m0, 0x10000
    s_nop 0
    buffer_load_dwordx4 v18, s[24:27], s71 offen lds
    buffer_load_dwordx4 v19, s[24:27], s71 offen offset:1024 lds
    buffer_load_dwordx4 v20, s[24:27], s71 offen offset:2048 lds
    buffer_load_dwordx4 v21, s[24:27], s71 offen offset:3072 lds
    s_waitcnt vmcnt(16)
    s_barrier
    s_cmp_eq_u32 s78, 0
    s_cselect_b32 s100, 24, 20
    s_add_u32 m0, s81, 0x4000
    s_lshl_b32 s70, s100, 12
    s_add_u32 s70, s70, s86
    s_bitcmp0_b32 s100, 0
    s_cselect_b32 s24, s46, s48
    s_cselect_b32 s25, s47, s49
    s_lshr_b32 s71, s100, 1
    s_lshl_b32 s71, s71, 7
    buffer_load_dwordx4 v7, s[8:11], s70 offen sc1 lds
    buffer_load_dwordx4 v7, s[8:11], s70 offen offset:1024 sc1 lds
    buffer_load_dwordx4 v7, s[8:11], s70 offen offset:2048 sc1 lds
    buffer_load_dwordx4 v7, s[8:11], s70 offen offset:3072 sc1 lds
    s_add_u32 m0, m0, 0x10000
    s_nop 0
    buffer_load_dwordx4 v18, s[24:27], s71 offen lds
    buffer_load_dwordx4 v19, s[24:27], s71 offen offset:1024 lds
    buffer_load_dwordx4 v20, s[24:27], s71 offen offset:2048 lds
    buffer_load_dwordx4 v21, s[24:27], s71 offen offset:3072 lds
    s_waitcnt vmcnt(16)
    s_barrier
    s_cmp_eq_u32 s78, 128
    s_cselect_b32 s100, 25, 21
    s_add_u32 m0, s81, 0x8000
    s_lshl_b32 s70, s100, 12
    s_add_u32 s70, s70, s86
    s_bitcmp0_b32 s100, 0
    s_cselect_b32 s24, s46, s48
    s_cselect_b32 s25, s47, s49
    s_lshr_b32 s71, s100, 1
    s_lshl_b32 s71, s71, 7
    buffer_load_dwordx4 v7, s[8:11], s70 offen sc1 lds
    buffer_load_dwordx4 v7, s[8:11], s70 offen offset:1024 sc1 lds
    buffer_load_dwordx4 v7, s[8:11], s70 offen offset:2048 sc1 lds
    buffer_load_dwordx4 v7, s[8:11], s70 offen offset:3072 sc1 lds
    s_add_u32 m0, m0, 0x10000
    s_nop 0
    buffer_load_dwordx4 v18, s[24:27], s71 offen lds
    buffer_load_dwordx4 v19, s[24:27], s71 offen offset:1024 lds
    buffer_load_dwordx4 v20, s[24:27], s71 offen offset:2048 lds
    buffer_load_dwordx4 v21, s[24:27], s71 offen offset:3072 lds
    s_waitcnt vmcnt(16)
    s_barrier
    s_cmp_eq_u32 s78, 256
    s_cselect_b32 s100, 26, 22
    s_add_u32 m0, s81, 0xc000
    s_lshl_b32 s70, s100, 12
    s_add_u32 s70, s70, s86
    s_bitcmp0_b32 s100, 0
    s_cselect_b32 s24, s46, s48
    s_cselect_b32 s25, s47, s49
    s_lshr_b32 s71, s100, 1
    s_lshl_b32 s71, s71, 7
    buffer_load_dwordx4 v7, s[8:11], s70 offen sc1 lds
    buffer_load_dwordx4 v7, s[8:11], s70 offen offset:1024 sc1 lds
    buffer_load_dwordx4 v7, s[8:11], s70 offen offset:2048 sc1 lds
    buffer_load_dwordx4 v7, s[8:11], s70 offen offset:3072 sc1 lds
    s_add_u32 m0, m0, 0x10000
    s_nop 0
    buffer_load_dwordx4 v18, s[24:27], s71 offen lds
    buffer_load_dwordx4 v19, s[24:27], s71 offen offset:1024 lds
    buffer_load_dwordx4 v20, s[24:27], s71 offen offset:2048 lds
    buffer_load_dwordx4 v21, s[24:27], s71 offen offset:3072 lds
    s_waitcnt vmcnt(16)
    s_barrier
    s_cmp_eq_u32 s78, 384
    s_cselect_b32 s100, 27, 23
    s_add_u32 m0, s81, 0x0
    s_lshl_b32 s70, s100, 12
    s_add_u32 s70, s70, s86
    s_bitcmp0_b32 s100, 0
    s_cselect_b32 s24, s46, s48
    s_cselect_b32 s25, s47, s49
    s_lshr_b32 s71, s100, 1
    s_lshl_b32 s71, s71, 7
    buffer_load_dwordx4 v7, s[8:11], s70 offen sc1 lds
    buffer_load_dwordx4 v7, s[8:11], s70 offen offset:1024 sc1 lds
    buffer_load_dwordx4 v7, s[8:11], s70 offen offset:2048 sc1 lds
    buffer_load_dwordx4 v7, s[8:11], s70 offen offset:3072 sc1 lds
    s_add_u32 m0, m0, 0x10000
    s_nop 0
    buffer_load_dwordx4 v18, s[24:27], s71 offen lds
    buffer_load_dwordx4 v19, s[24:27], s71 offen offset:1024 lds
    buffer_load_dwordx4 v20, s[24:27], s71 offen offset:2048 lds
    buffer_load_dwordx4 v21, s[24:27], s71 offen offset:3072 lds
    s_waitcnt vmcnt(16)
    s_barrier
    s_cmp_eq_u32 s78, 0
    s_cselect_b32 s100, 28, 24
    s_add_u32 m0, s81, 0x4000
    s_lshl_b32 s70, s100, 12
    s_add_u32 s70, s70, s86
    s_bitcmp0_b32 s100, 0
    s_cselect_b32 s24, s46, s48
    s_cselect_b32 s25, s47, s49
    s_lshr_b32 s71, s100, 1
    s_lshl_b32 s71, s71, 7
    buffer_load_dwordx4 v7, s[8:11], s70 offen sc1 lds
    buffer_load_dwordx4 v7, s[8:11], s70 offen offset:1024 sc1 lds
    buffer_load_dwordx4 v7, s[8:11], s70 offen offset:2048 sc1 lds
    buffer_load_dwordx4 v7, s[8:11], s70 offen offset:3072 sc1 lds
    s_add_u32 m0, m0, 0x10000
    s_nop 0
    buffer_load_dwordx4 v18, s[24:27], s71 offen lds
    buffer_load_dwordx4 v19, s[24:27], s71 offen offset:1024 lds
    buffer_load_dwordx4 v20, s[24:27], s71 offen offset:2048 lds
    buffer_load_dwordx4 v21, s[24:27], s71 offen offset:3072 lds
    s_waitcnt vmcnt(16)
    s_barrier
    s_cmp_eq_u32 s78, 128
    s_cselect_b32 s100, 29, 25
    s_add_u32 m0, s81, 0x8000
    s_lshl_b32 s70, s100, 12
    s_add_u32 s70, s70, s86
    s_bitcmp0_b32 s100, 0
    s_cselect_b32 s24, s46, s48
    s_cselect_b32 s25, s47, s49
    s_lshr_b32 s71, s100, 1
    s_lshl_b32 s71, s71, 7
    buffer_load_dwordx4 v7, s[8:11], s70 offen sc1 lds
    buffer_load_dwordx4 v7, s[8:11], s70 offen offset:1024 sc1 lds
    buffer_load_dwordx4 v7, s[8:11], s70 offen offset:2048 sc1 lds
    buffer_load_dwordx4 v7, s[8:11], s70 offen offset:3072 sc1 lds
    s_add_u32 m0, m0, 0x10000
    s_nop 0
    buffer_load_dwordx4 v18, s[24:27], s71 offen lds
    buffer_load_dwordx4 v19, s[24:27], s71 offen offset:1024 lds
    buffer_load_dwordx4 v20, s[24:27], s71 offen offset:2048 lds
    buffer_load_dwordx4 v21, s[24:27], s71 offen offset:3072 lds
    s_waitcnt vmcnt(16)
    s_barrier
    s_cmp_eq_u32 s78, 256
    s_cselect_b32 s100, 30, 26
    s_add_u32 m0, s81, 0xc000
    s_lshl_b32 s70, s100, 12
    s_add_u32 s70, s70, s86
    s_bitcmp0_b32 s100, 0
    s_cselect_b32 s24, s46, s48
    s_cselect_b32 s25, s47, s49
    s_lshr_b32 s71, s100, 1
    s_lshl_b32 s71, s71, 7
    buffer_load_dwordx4 v7, s[8:11], s70 offen sc1 lds
    buffer_load_dwordx4 v7, s[8:11], s70 offen offset:1024 sc1 lds
    buffer_load_dwordx4 v7, s[8:11], s70 offen offset:2048 sc1 lds
    buffer_load_dwordx4 v7, s[8:11], s70 offen offset:3072 sc1 lds
    s_add_u32 m0, m0, 0x10000
    s_nop 0
    buffer_load_dwordx4 v18, s[24:27], s71 offen lds
    buffer_load_dwordx4 v19, s[24:27], s71 offen offset:1024 lds
    buffer_load_dwordx4 v20, s[24:27], s71 offen offset:2048 lds
    buffer_load_dwordx4 v21, s[24:27], s71 offen offset:3072 lds
    s_waitcnt vmcnt(16)
    s_barrier
    s_cmp_eq_u32 s78, 384
    s_cselect_b32 s100, 31, 27
    s_add_u32 m0, s81, 0x0
    s_lshl_b32 s70, s100, 12
    s_add_u32 s70, s70, s86
    s_bitcmp0_b32 s100, 0
    s_cselect_b32 s24, s46, s48
    s_cselect_b32 s25, s47, s49
    s_lshr_b32 s71, s100, 1
    s_lshl_b32 s71, s71, 7
    buffer_load_dwordx4 v7, s[8:11], s70 offen sc1 lds
    buffer_load_dwordx4 v7, s[8:11], s70 offen offset:1024 sc1 lds
    buffer_load_dwordx4 v7, s[8:11], s70 offen offset:2048 sc1 lds
    buffer_load_dwordx4 v7, s[8:11], s70 offen offset:3072 sc1 lds
    s_add_u32 m0, m0, 0x10000
    s_nop 0
    buffer_load_dwordx4 v18, s[24:27], s71 offen lds
    buffer_load_dwordx4 v19, s[24:27], s71 offen offset:1024 lds
    buffer_load_dwordx4 v20, s[24:27], s71 offen offset:2048 lds
    buffer_load_dwordx4 v21, s[24:27], s71 offen offset:3072 lds
    s_waitcnt vmcnt(16)
    s_barrier
    s_cmp_le_u32 s78, 0
    s_addc_u32 s100, 28, 0
    s_add_u32 m0, s81, 0x4000
    s_lshl_b32 s70, s100, 12
    s_add_u32 s70, s70, s86
    s_bitcmp0_b32 s100, 0
    s_cselect_b32 s24, s46, s48
    s_cselect_b32 s25, s47, s49
    s_lshr_b32 s71, s100, 1
    s_lshl_b32 s71, s71, 7
    buffer_load_dwordx4 v7, s[8:11], s70 offen sc1 lds
    buffer_load_dwordx4 v7, s[8:11], s70 offen offset:1024 sc1 lds
    buffer_load_dwordx4 v7, s[8:11], s70 offen offset:2048 sc1 lds
    buffer_load_dwordx4 v7, s[8:11], s70 offen offset:3072 sc1 lds
    s_add_u32 m0, m0, 0x10000
    s_nop 0
    buffer_load_dwordx4 v18, s[24:27], s71 offen lds
    buffer_load_dwordx4 v19, s[24:27], s71 offen offset:1024 lds
    buffer_load_dwordx4 v20, s[24:27], s71 offen offset:2048 lds
    buffer_load_dwordx4 v21, s[24:27], s71 offen offset:3072 lds
    s_waitcnt vmcnt(16)
    s_barrier
    s_cmp_le_u32 s78, 128
    s_addc_u32 s100, 29, 0
    s_add_u32 m0, s81, 0x8000
    s_lshl_b32 s70, s100, 12
    s_add_u32 s70, s70, s86
    s_bitcmp0_b32 s100, 0
    s_cselect_b32 s24, s46, s48
    s_cselect_b32 s25, s47, s49
    s_lshr_b32 s71, s100, 1
    s_lshl_b32 s71, s71, 7
    buffer_load_dwordx4 v7, s[8:11], s70 offen sc1 lds
    buffer_load_dwordx4 v7, s[8:11], s70 offen offset:1024 sc1 lds
    buffer_load_dwordx4 v7, s[8:11], s70 offen offset:2048 sc1 lds
    buffer_load_dwordx4 v7, s[8:11], s70 offen offset:3072 sc1 lds
    s_add_u32 m0, m0, 0x10000
    s_nop 0
    buffer_load_dwordx4 v18, s[24:27], s71 offen lds
    buffer_load_dwordx4 v19, s[24:27], s71 offen offset:1024 lds
    buffer_load_dwordx4 v20, s[24:27], s71 offen offset:2048 lds
    buffer_load_dwordx4 v21, s[24:27], s71 offen offset:3072 lds
    s_waitcnt vmcnt(16)
    s_barrier
    s_cmp_le_u32 s78, 256
    s_addc_u32 s100, 30, 0
    s_add_u32 m0, s81, 0xc000
    s_lshl_b32 s70, s100, 12
    s_add_u32 s70, s70, s86
    s_bitcmp0_b32 s100, 0
    s_cselect_b32 s24, s46, s48
    s_cselect_b32 s25, s47, s49
    s_lshr_b32 s71, s100, 1
    s_lshl_b32 s71, s71, 7
    buffer_load_dwordx4 v7, s[8:11], s70 offen sc1 lds
    buffer_load_dwordx4 v7, s[8:11], s70 offen offset:1024 sc1 lds
    buffer_load_dwordx4 v7, s[8:11], s70 offen offset:2048 sc1 lds
    buffer_load_dwordx4 v7, s[8:11], s70 offen offset:3072 sc1 lds
    s_add_u32 m0, m0, 0x10000
    s_nop 0
    buffer_load_dwordx4 v18, s[24:27], s71 offen lds
    buffer_load_dwordx4 v19, s[24:27], s71 offen offset:1024 lds
    buffer_load_dwordx4 v20, s[24:27], s71 offen offset:2048 lds
    buffer_load_dwordx4 v21, s[24:27], s71 offen offset:3072 lds
    s_waitcnt vmcnt(16)
    s_barrier
    s_waitcnt vmcnt(8)
    s_barrier
    s_waitcnt vmcnt(0)
    s_barrier
    s_endpgm
L_XB2:
L_pad_xb:
    s_cbranch_execz L_pad_9
    s_add_u32 m0, s32, 0x8000
    s_add_u32 s71, s100, s34
    buffer_load_dwordx4 v40, s[12:15], s71 offen lds
    buffer_load_dwordx4 v41, s[12:15], s71 offen offset:1024 lds
    buffer_load_dwordx4 v42, s[12:15], s71 offen offset:2048 lds
    buffer_load_dwordx4 v43, s[12:15], s71 offen offset:3072 lds
    s_add_u32 m0, s81, 0x24000
    s_nop 0
    buffer_load_dwordx4 v44, s[20:23], s100 offen lds
    buffer_load_dwordx4 v45, s[20:23], s100 offen offset:1024 lds
    buffer_load_dwordx4 v46, s[20:23], s100 offen offset:2048 lds
    buffer_load_dwordx4 v47, s[20:23], s100 offen offset:3072 lds
    s_add_u32 m0, s33, 0x8000
    s_add_u32 s71, s100, s35
    buffer_load_dwordx4 v40, s[12:15], s71 offen lds
    buffer_load_dwordx4 v41, s[12:15], s71 offen offset:1024 lds
    buffer_load_dwordx4 v42, s[12:15], s71 offen offset:2048 lds
    buffer_load_dwordx4 v43, s[12:15], s71 offen offset:3072 lds
    s_add_u32 s70, s78, 1536
    s_cmp_eq_u32 s101, s70
    s_cselect_b32 s70, 128, 0
    s_add_u32 s101, s101, s70
    s_and_b32 s70, s101, 384
    s_cmp_eq_u32 s70, s78
    s_cselect_b32 s70, 512, 0
    s_add_u32 s100, s101, s70
    s_add_u32 s101, s101, 128
    s_lshr_b32 s70, s100, 2
    s_and_b32 s70, s70, 0x180
    s_lshl_b32 s100, s100, 2
    s_and_b32 s100, s100, 0x600
    s_or_b32 s100, s100, s70
    s_mov_b32 s8, s68
    s_mov_b32 s9, s69
    s_mov_b32 s10, 0x1000000
    s_mov_b32 s11, 0x20000
    s_mov_b32 s16, s66
    s_mov_b32 s17, s67
    s_mov_b32 s18, 0x100
    s_mov_b32 s19, 0x20000
    v_and_b32 v1, 31, v0
    v_lshlrev_b32 v7, 4, v0
    v_mov_b32 v9, 0x40000000
    v_add_u32 v22, 0x20000, v7
    v_and_b32 v3, 6, v0
    v_mov_b32 v4, 0x3f803f80
    v_cmp_eq_u32 vcc, 0, v3
    v_and_b32 v5, 1, v0
    s_waitcnt vmcnt(12)
    s_barrier
    s_add_u32 m0, s32, 0x0
    s_add_u32 s71, s100, s34
    buffer_load_dwordx4 v40, s[12:15], s71 offen lds
    buffer_load_dwordx4 v41, s[12:15], s71 offen offset:1024 lds
    buffer_load_dwordx4 v42, s[12:15], s71 offen offset:2048 lds
    buffer_load_dwordx4 v43, s[12:15], s71 offen offset:3072 lds
    s_add_u32 m0, s81, 0x18000
    s_nop 0
    buffer_load_dwordx4 v44, s[20:23], s100 offen lds
    buffer_load_dwordx4 v45, s[20:23], s100 offen offset:1024 lds
    buffer_load_dwordx4 v46, s[20:23], s100 offen offset:2048 lds
    buffer_load_dwordx4 v47, s[20:23], s100 offen offset:3072 lds
    s_add_u32 m0, s33, 0x0
    s_add_u32 s71, s100, s35
    buffer_load_dwordx4 v40, s[12:15], s71 offen lds
    buffer_load_dwordx4 v41, s[12:15], s71 offen offset:1024 lds
    buffer_load_dwordx4 v42, s[12:15], s71 offen offset:2048 lds
    buffer_load_dwordx4 v43, s[12:15], s71 offen offset:3072 lds
    s_add_u32 s70, s78, 1536
    s_cmp_eq_u32 s101, s70
    s_cselect_b32 s70, 128, 0
    s_add_u32 s101, s101, s70
    s_and_b32 s70, s101, 384
    s_cmp_eq_u32 s70, s78
    s_cselect_b32 s70, 512, 0
    s_add_u32 s100, s101, s70
    s_add_u32 s101, s101, 128
    s_lshr_b32 s70, s100, 2
    s_and_b32 s70, s70, 0x180
    s_lshl_b32 s100, s100, 2
    s_and_b32 s100, s100, 0x600
    s_or_b32 s100, s100, s70
    v_mov_b32 v6, 0x44444444
    v_cndmask_b32 v36, 0, v4, vcc
    v_cndmask_b32 v37, 0, v4, vcc
    v_cmp_eq_u32 vcc, 4, v3
    v_mov_b32 v3, 0xeeeeeeee
    s_lshl_b32 s72, s5, 1
    v_cndmask_b32 v38, 0, v4, vcc
    v_cndmask_b32 v39, 0, v4, vcc
    v_cmp_eq_u32 vcc, 0, v5
    s_add_u32 s72, s72, s7
    s_lshl_b32 s73, s4, 4
    v_cndmask_b32 v26, v3, v6, vcc
    s_add_u32 s73, s73, s72
    s_lshl_b32 s73, s73, 2
    s_add_u32 s73, s73, s6
    s_lshl_b32 s73, s73, 7
    s_waitcnt vmcnt(12)
    s_barrier
    s_add_u32 m0, s32, 0x4000
    s_add_u32 s71, s100, s34
    buffer_load_dwordx4 v40, s[12:15], s71 offen lds
    buffer_load_dwordx4 v41, s[12:15], s71 offen offset:1024 lds
    buffer_load_dwordx4 v42, s[12:15], s71 offen offset:2048 lds
    buffer_load_dwordx4 v43, s[12:15], s71 offen offset:3072 lds
    s_add_u32 m0, s81, 0x1c000
    s_nop 0
    buffer_load_dwordx4 v44, s[20:23], s100 offen lds
    buffer_load_dwordx4 v45, s[20:23], s100 offen offset:1024 lds
    buffer_load_dwordx4 v46, s[20:23], s100 offen offset:2048 lds
    buffer_load_dwordx4 v47, s[20:23], s100 offen offset:3072 lds
    s_add_u32 m0, s33, 0x4000
    s_add_u32 s71, s100, s35
    buffer_load_dwordx4 v40, s[12:15], s71 offen lds
    buffer_load_dwordx4 v41, s[12:15], s71 offen offset:1024 lds
    buffer_load_dwordx4 v42, s[12:15], s71 offen offset:2048 lds
    buffer_load_dwordx4 v43, s[12:15], s71 offen offset:3072 lds
    s_add_u32 s70, s78, 1536
    s_cmp_eq_u32 s101, s70
    s_cselect_b32 s70, 128, 0
    s_add_u32 s101, s101, s70
    s_and_b32 s70, s101, 384
    s_cmp_eq_u32 s70, s78
    s_cselect_b32 s70, 512, 0
    s_add_u32 s100, s101, s70
    s_add_u32 s101, s101, 128
    s_lshr_b32 s70, s100, 2
    s_and_b32 s70, s70, 0x180
    s_lshl_b32 s100, s100, 2
    s_and_b32 s100, s100, 0x600
    s_or_b32 s100, s100, s70
    s_add_u32 s73, s73, 0xc60000
    v_lshl_add_u32 v4, v1, 2, s73
    v_lshl_add_u32 v23, v2, 30, v4
    s_lshl_b32 s73, s4, 1
    s_add_u32 s73, s73, s76
    s_lshl_b32 s73, s73, 5
    s_add_u32 s73, s73, s72
    s_lshl_b32 s73, s73, 1
    s_add_u32 s73, s73, s77
    s_lshl_b32 s28, s73, 11
    s_add_u32 s29, s28, 0x10000
    s_lshl_b32 s73, s4, 3
    s_add_u32 s73, s73, s5
    s_lshl_b32 s73, s73, 2
    s_add_u32 s30, s73, s6
    s_mov_b32 s87, 0x20000
    s_waitcnt vmcnt(12)
    s_barrier
    s_add_u32 m0, s32, 0x8000
    s_add_u32 s71, s100, s34
    buffer_load_dwordx4 v40, s[12:15], s71 offen lds
    buffer_load_dwordx4 v41, s[12:15], s71 offen offset:1024 lds
    buffer_load_dwordx4 v42, s[12:15], s71 offen offset:2048 lds
    buffer_load_dwordx4 v43, s[12:15], s71 offen offset:3072 lds
    s_add_u32 m0, s81, 0x24000
    s_nop 0
    buffer_load_dwordx4 v44, s[20:23], s100 offen lds
    buffer_load_dwordx4 v45, s[20:23], s100 offen offset:1024 lds
    buffer_load_dwordx4 v46, s[20:23], s100 offen offset:2048 lds
    buffer_load_dwordx4 v47, s[20:23], s100 offen offset:3072 lds
    s_add_u32 m0, s33, 0x8000
    s_add_u32 s71, s100, s35
    buffer_load_dwordx4 v40, s[12:15], s71 offen lds
    buffer_load_dwordx4 v41, s[12:15], s71 offen offset:1024 lds
    buffer_load_dwordx4 v42, s[12:15], s71 offen offset:2048 lds
    buffer_load_dwordx4 v43, s[12:15], s71 offen offset:3072 lds
    s_add_u32 s70, s78, 1536
    s_cmp_eq_u32 s101, s70
    s_cselect_b32 s70, 128, 0
    s_add_u32 s101, s101, s70
    s_and_b32 s70, s101, 384
    s_cmp_eq_u32 s70, s78
    s_cselect_b32 s70, 512, 0
    s_add_u32 s100, s101, s70
    s_add_u32 s101, s101, 128
    s_lshr_b32 s70, s100, 2
    s_and_b32 s70, s70, 0x180
    s_lshl_b32 s100, s100, 2
    s_and_b32 s100, s100, 0x600
    s_or_b32 s100, s100, s70
    s_mov_b32 s96, 0x8000
    v_mov_b32 v72, 0
    v_mov_b32 v73, 0
    v_mov_b32 v74, 0
    v_mov_b32 v75, 0
    v_mov_b32 v76, 0
    v_mov_b32 v77, 0
    v_mov_b32 v78, 0
    v_mov_b32 v79, 0
    v_lshrrev_b32 v3, 4, v0
    v_lshlrev_b32 v3, 1, v3
    v_and_b32 v4, 7, v0
    v_xor_b32 v3, v3, v4
    v_lshrrev_b32 v4, 3, v0
    v_lshlrev_b32 v4, 11, v4
    v_lshl_add_u32 v3, v3, 4, v4
    s_waitcnt vmcnt(12)
    s_barrier
    s_add_u32 m0, s32, 0x0
    s_add_u32 s71, s100, s34
    buffer_load_dwordx4 v40, s[12:15], s71 offen lds
    buffer_load_dwordx4 v41, s[12:15], s71 offen offset:1024 lds
    buffer_load_dwordx4 v42, s[12:15], s71 offen offset:2048 lds
    buffer_load_dwordx4 v43, s[12:15], s71 offen offset:3072 lds
    s_add_u32 m0, s81, 0x18000
    s_nop 0
    buffer_load_dwordx4 v44, s[20:23], s100 offen lds
    buffer_load_dwordx4 v45, s[20:23], s100 offen offset:1024 lds
    buffer_load_dwordx4 v46, s[20:23], s100 offen offset:2048 lds
    buffer_load_dwordx4 v47, s[20:23], s100 offen offset:3072 lds
    s_add_u32 m0, s33, 0x0
    s_add_u32 s71, s100, s35
    buffer_load_dwordx4 v40, s[12:15], s71 offen lds
    buffer_load_dwordx4 v41, s[12:15], s71 offen offset:1024 lds
    buffer_load_dwordx4 v42, s[12:15], s71 offen offset:2048 lds
    buffer_load_dwordx4 v43, s[12:15], s71 offen offset:3072 lds
    s_add_u32 s70, s78, 1536
    s_cmp_eq_u32 s101, s70
    s_cselect_b32 s70, 128, 0
    s_add_u32 s101, s101, s70
    s_and_b32 s70, s101, 384
    s_cmp_eq_u32 s70, s78
    s_cselect_b32 s70, 512, 0
    s_add_u32 s100, s101, s70
    s_add_u32 s101, s101, 128
    s_lshr_b32 s70, s100, 2
    s_and_b32 s70, s70, 0x180
    s_lshl_b32 s100, s100, 2
    s_and_b32 s100, s100, 0x600
    s_or_b32 s100, s100, s70
    s_lshl_b32 s72, s6, 15
    s_lshl_b32 s73, s5, 8
    s_add_u32 s72, s72, s73
    v_add_u32 v18, s72, v3
    v_add_u32 v19, 0x3c00, v18
    s_lshl_b32 s72, s4, 2
    s_add_u32 s72, s72, s6
    s_lshl_b32 s86, s72, 16
    s_mov_b32 s24, s62
    s_mov_b32 s25, s63
    s_mov_b32 s26, 0x200000
    s_mov_b32 s27, 0x20000
    s_lshl_b32 s73, s6, 10
    v_add_u32 v24, s73, v7
    s_lshl_b32 s73, s30, 7
    v_mov_b32 v27, s73
    s_waitcnt vmcnt(12)
    s_barrier
    s_add_u32 m0, s32, 0x4000
    s_add_u32 s71, s100, s34
    buffer_load_dwordx4 v40, s[12:15], s71 offen lds
    buffer_load_dwordx4 v41, s[12:15], s71 offen offset:1024 lds
    buffer_load_dwordx4 v42, s[12:15], s71 offen offset:2048 lds
    buffer_load_dwordx4 v43, s[12:15], s71 offen offset:3072 lds
    s_add_u32 m0, s81, 0x1c000
    s_nop 0
    buffer_load_dwordx4 v44, s[20:23], s100 offen lds
    buffer_load_dwordx4 v45, s[20:23], s100 offen offset:1024 lds
    buffer_load_dwordx4 v46, s[20:23], s100 offen offset:2048 lds
    buffer_load_dwordx4 v47, s[20:23], s100 offen offset:3072 lds
    s_add_u32 m0, s33, 0x4000
    s_add_u32 s71, s100, s35
    buffer_load_dwordx4 v40, s[12:15], s71 offen lds
    buffer_load_dwordx4 v41, s[12:15], s71 offen offset:1024 lds
    buffer_load_dwordx4 v42, s[12:15], s71 offen offset:2048 lds
    buffer_load_dwordx4 v43, s[12:15], s71 offen offset:3072 lds
    s_add_u32 s70, s78, 1536
    s_cmp_eq_u32 s101, s70
    s_cselect_b32 s70, 128, 0
    s_add_u32 s101, s101, s70
    s_and_b32 s70, s101, 384
    s_cmp_eq_u32 s70, s78
    s_cselect_b32 s70, 512, 0
    s_add_u32 s100, s101, s70
    s_add_u32 s101, s101, 128
    s_lshr_b32 s70, s100, 2
    s_and_b32 s70, s70, 0x180
    s_lshl_b32 s100, s100, 2
    s_and_b32 s100, s100, 0x600
    s_or_b32 s100, s100, s70
    s_lshl_b32 s73, s4, 6
    s_add_u32 s73, s73, s77
    s_add_u32 s73, s73, 4
    s_lshl_b32 s73, s73, 7
    v_bfe_u32 v3, v0, 1, 3
    v_lshl_add_u32 v3, v3, 10, s73
    v_and_b32 v4, 1, v0
    v_lshl_add_u32 v30, v4, 8, v3
    v_mov_b32 v5, 0
    buffer_load_dword v25, v5, s[16:19], 0 offen sc1
    s_waitcnt vmcnt(13)
    s_barrier
    s_add_u32 m0, s32, 0x8000
    s_add_u32 s71, s100, s34
    buffer_load_dwordx4 v40, s[12:15], s71 offen lds
    buffer_load_dwordx4 v41, s[12:15], s71 offen offset:1024 lds
    buffer_load_dwordx4 v42, s[12:15], s71 offen offset:2048 lds
    buffer_load_dwordx4 v43, s[12:15], s71 offen offset:3072 lds
    s_add_u32 m0, s81, 0x24000
    s_nop 0
    buffer_load_dwordx4 v44, s[20:23], s100 offen lds
    buffer_load_dwordx4 v45, s[20:23], s100 offen offset:1024 lds
    buffer_load_dwordx4 v46, s[20:23], s100 offen offset:2048 lds
L_pad_6:
    s_cbranch_execz L_pad_10
    buffer_load_dwordx4 v47, s[20:23], s100 offen offset:3072 lds
    s_add_u32 m0, s33, 0x8000
    s_add_u32 s71, s100, s35
    buffer_load_dwordx4 v40, s[12:15], s71 offen lds
    buffer_load_dwordx4 v41, s[12:15], s71 offen offset:1024 lds
    buffer_load_dwordx4 v42, s[12:15], s71 offen offset:2048 lds
    buffer_load_dwordx4 v43, s[12:15], s71 offen offset:3072 lds
    s_add_u32 s70, s78, 1536
    s_cmp_eq_u32 s101, s70
    s_cselect_b32 s70, 128, 0
    s_add_u32 s101, s101, s70
    s_and_b32 s70, s101, 384
    s_cmp_eq_u32 s70, s78
    s_cselect_b32 s70, 512, 0
    s_add_u32 s100, s101, s70
    s_add_u32 s101, s101, 128
    s_lshr_b32 s70, s100, 2
    s_and_b32 s70, s70, 0x180
    s_lshl_b32 s100, s100, 2
    s_and_b32 s100, s100, 0x600
    s_or_b32 s100, s100, s70
    s_waitcnt vmcnt(13)
    s_barrier
    s_add_u32 m0, s32, 0x0
    s_add_u32 s71, s100, s34
    buffer_load_dwordx4 v40, s[12:15], s71 offen lds
    buffer_load_dwordx4 v41, s[12:15], s71 offen offset:1024 lds
    buffer_load_dwordx4 v42, s[12:15], s71 offen offset:2048 lds
    buffer_load_dwordx4 v43, s[12:15], s71 offen offset:3072 lds
    s_add_u32 m0, s81, 0x18000
    s_nop 0
    buffer_load_dwordx4 v44, s[20:23], s100 offen lds
    buffer_load_dwordx4 v45, s[20:23], s100 offen offset:1024 lds
    buffer_load_dwordx4 v46, s[20:23], s100 offen offset:2048 lds
    buffer_load_dwordx4 v47, s[20:23], s100 offen offset:3072 lds
    s_add_u32 m0, s33, 0x0
    s_add_u32 s71, s100, s35
    buffer_load_dwordx4 v40, s[12:15], s71 offen lds
    buffer_load_dwordx4 v41, s[12:15], s71 offen offset:1024 lds
    buffer_load_dwordx4 v42, s[12:15], s71 offen offset:2048 lds
    buffer_load_dwordx4 v43, s[12:15], s71 offen offset:3072 lds
    s_add_u32 s70, s78, 1536
    s_cmp_eq_u32 s101, s70
    s_cselect_b32 s70, 128, 0
    s_add_u32 s101, s101, s70
    s_and_b32 s70, s101, 384
    s_cmp_eq_u32 s70, s78
    s_cselect_b32 s70, 512, 0
    s_add_u32 s100, s101, s70
    s_add_u32 s101, s101, 128
    s_lshr_b32 s70, s100, 2
    s_and_b32 s70, s70, 0x180
    s_lshl_b32 s100, s100, 2
    s_and_b32 s100, s100, 0x600
    s_or_b32 s100, s100, s70
    s_waitcnt vmcnt(24)
    v_readfirstlane_b32 s83, v25
    s_nop 0
    s_cmp_eq_u32 s83, 0
    s_cbranch_scc1 L_tagwaitXB
L_tagokXB:
    s_waitcnt vmcnt(12)
    s_barrier
    s_add_u32 m0, s32, 0x4000
    s_add_u32 s71, s100, s34
    buffer_load_dwordx4 v40, s[12:15], s71 offen lds
    buffer_load_dwordx4 v41, s[12:15], s71 offen offset:1024 lds
    buffer_load_dwordx4 v42, s[12:15], s71 offen offset:2048 lds
    buffer_load_dwordx4 v43, s[12:15], s71 offen offset:3072 lds
    s_add_u32 m0, s81, 0x1c000
    s_nop 0
    buffer_load_dwordx4 v44, s[20:23], s100 offen lds
    buffer_load_dwordx4 v45, s[20:23], s100 offen offset:1024 lds
    buffer_load_dwordx4 v46, s[20:23], s100 offen offset:2048 lds
    buffer_load_dwordx4 v47, s[20:23], s100 offen offset:3072 lds
    s_add_u32 m0, s33, 0x4000
    s_add_u32 s71, s100, s35
    buffer_load_dwordx4 v40, s[12:15], s71 offen lds
    buffer_load_dwordx4 v41, s[12:15], s71 offen offset:1024 lds
    buffer_load_dwordx4 v42, s[12:15], s71 offen offset:2048 lds
    buffer_load_dwordx4 v43, s[12:15], s71 offen offset:3072 lds
    s_add_u32 s70, s78, 1536
    s_cmp_eq_u32 s101, s70
    s_cselect_b32 s70, 128, 0
    s_add_u32 s101, s101, s70
    s_and_b32 s70, s101, 384
    s_cmp_eq_u32 s70, s78
    s_cselect_b32 s70, 512, 0
    s_add_u32 s100, s101, s70
    s_add_u32 s101, s101, 128
    s_lshr_b32 s70, s100, 2
    s_and_b32 s70, s70, 0x180
    s_lshl_b32 s100, s100, 2
    s_and_b32 s100, s100, 0x600
    s_or_b32 s100, s100, s70
    s_waitcnt vmcnt(12)
    s_barrier
    s_add_u32 m0, s32, 0x8000
    s_add_u32 s71, s100, s34
    buffer_load_dwordx4 v40, s[12:15], s71 offen lds
    buffer_load_dwordx4 v41, s[12:15], s71 offen offset:1024 lds
    buffer_load_dwordx4 v42, s[12:15], s71 offen offset:2048 lds
    buffer_load_dwordx4 v43, s[12:15], s71 offen offset:3072 lds
    s_add_u32 m0, s81, 0x24000
    s_nop 0
    buffer_load_dwordx4 v44, s[20:23], s100 offen lds
    buffer_load_dwordx4 v45, s[20:23], s100 offen offset:1024 lds
    buffer_load_dwordx4 v46, s[20:23], s100 offen offset:2048 lds
    buffer_load_dwordx4 v47, s[20:23], s100 offen offset:3072 lds
    s_add_u32 m0, s33, 0x8000
    s_add_u32 s71, s100, s35
    buffer_load_dwordx4 v40, s[12:15], s71 offen lds
    buffer_load_dwordx4 v41, s[12:15], s71 offen offset:1024 lds
    buffer_load_dwordx4 v42, s[12:15], s71 offen offset:2048 lds
    buffer_load_dwordx4 v43, s[12:15], s71 offen offset:3072 lds
    s_add_u32 s70, s78, 1536
    s_cmp_eq_u32 s101, s70
    s_cselect_b32 s70, 128, 0
    s_add_u32 s101, s101, s70
    s_and_b32 s70, s101, 384
    s_cmp_eq_u32 s70, s78
    s_cselect_b32 s70, 512, 0
    s_add_u32 s100, s101, s70
    s_add_u32 s101, s101, 128
    s_lshr_b32 s70, s100, 2
    s_and_b32 s70, s70, 0x180
    s_lshl_b32 s100, s100, 2
    s_and_b32 s100, s100, 0x600
    s_or_b32 s100, s100, s70
    s_waitcnt vmcnt(12)
    s_barrier
    s_add_u32 m0, s32, 0x0
    s_add_u32 s71, s100, s34
    buffer_load_dwordx4 v40, s[12:15], s71 offen lds
    buffer_load_dwordx4 v41, s[12:15], s71 offen offset:1024 lds
    buffer_load_dwordx4 v42, s[12:15], s71 offen offset:2048 lds
    buffer_load_dwordx4 v43, s[12:15], s71 offen offset:3072 lds
    s_add_u32 m0, s81, 0x18000
    s_nop 0
    buffer_load_dwordx4 v44, s[20:23], s100 offen lds
    buffer_load_dwordx4 v45, s[20:23], s100 offen offset:1024 lds
    buffer_load_dwordx4 v46, s[20:23], s100 offen offset:2048 lds
    buffer_load_dwordx4 v47, s[20:23], s100 offen offset:3072 lds
    s_add_u32 m0, s33, 0x0
    s_add_u32 s71, s100, s35
    buffer_load_dwordx4 v40, s[12:15], s71 offen lds
    buffer_load_dwordx4 v41, s[12:15], s71 offen offset:1024 lds
    buffer_load_dwordx4 v42, s[12:15], s71 offen offset:2048 lds
    buffer_load_dwordx4 v43, s[12:15], s71 offen offset:3072 lds
    s_add_u32 s70, s78, 1536
    s_cmp_eq_u32 s101, s70
    s_cselect_b32 s70, 128, 0
    s_add_u32 s101, s101, s70
    s_and_b32 s70, s101, 384
    s_cmp_eq_u32 s70, s78
    s_cselect_b32 s70, 512, 0
    s_add_u32 s100, s101, s70
    s_add_u32 s101, s101, 128
    s_lshr_b32 s70, s100, 2
    s_and_b32 s70, s70, 0x180
    s_lshl_b32 s100, s100, 2
    s_and_b32 s100, s100, 0x600
    s_or_b32 s100, s100, s70
    s_waitcnt vmcnt(12)
    s_barrier
    s_add_u32 m0, s32, 0x4000
    s_add_u32 s71, s100, s34
    buffer_load_dwordx4 v40, s[12:15], s71 offen lds
    buffer_load_dwordx4 v41, s[12:15], s71 offen offset:1024 lds
    buffer_load_dwordx4 v42, s[12:15], s71 offen offset:2048 lds
    buffer_load_dwordx4 v43, s[12:15], s71 offen offset:3072 lds
    s_add_u32 m0, s81, 0x1c000
    s_nop 0
    buffer_load_dwordx4 v44, s[20:23], s100 offen lds
    buffer_load_dwordx4 v45, s[20:23], s100 offen offset:1024 lds
    buffer_load_dwordx4 v46, s[20:23], s100 offen offset:2048 lds
    buffer_load_dwordx4 v47, s[20:23], s100 offen offset:3072 lds
    s_add_u32 m0, s33, 0x4000
    s_add_u32 s71, s100, s35
    buffer_load_dwordx4 v40, s[12:15], s71 offen lds
    buffer_load_dwordx4 v41, s[12:15], s71 offen offset:1024 lds
    buffer_load_dwordx4 v42, s[12:15], s71 offen offset:2048 lds
    buffer_load_dwordx4 v43, s[12:15], s71 offen offset:3072 lds
    s_add_u32 s70, s78, 1536
    s_cmp_eq_u32 s101, s70
    s_cselect_b32 s70, 128, 0
    s_add_u32 s101, s101, s70
    s_and_b32 s70, s101, 384
    s_cmp_eq_u32 s70, s78
    s_cselect_b32 s70, 512, 0
    s_add_u32 s100, s101, s70
    s_add_u32 s101, s101, 128
    s_lshr_b32 s70, s100, 2
    s_and_b32 s70, s70, 0x180
    s_lshl_b32 s100, s100, 2
    s_and_b32 s100, s100, 0x600
    s_or_b32 s100, s100, s70
    s_mov_b32 s72, 0xca0000
    buffer_load_dword v8, v24, s[8:11], s72 offen sc1
    s_waitcnt vmcnt(13)
    s_barrier
    s_add_u32 m0, s32, 0x8000
    s_add_u32 s71, s100, s34
    buffer_load_dwordx4 v40, s[12:15], s71 offen lds
    buffer_load_dwordx4 v41, s[12:15], s71 offen offset:1024 lds
    buffer_load_dwordx4 v42, s[12:15], s71 offen offset:2048 lds
    buffer_load_dwordx4 v43, s[12:15], s71 offen offset:3072 lds
    s_add_u32 m0, s81, 0x24000
    s_nop 0
    buffer_load_dwordx4 v44, s[20:23], s100 offen lds
    buffer_load_dwordx4 v45, s[20:23], s100 offen offset:1024 lds
    buffer_load_dwordx4 v46, s[20:23], s100 offen offset:2048 lds
    buffer_load_dwordx4 v47, s[20:23], s100 offen offset:3072 lds
    s_add_u32 m0, s33, 0x8000
    s_add_u32 s71, s100, s35
    buffer_load_dwordx4 v40, s[12:15], s71 offen lds
    buffer_load_dwordx4 v41, s[12:15], s71 offen offset:1024 lds
    buffer_load_dwordx4 v42, s[12:15], s71 offen offset:2048 lds
    buffer_load_dwordx4 v43, s[12:15], s71 offen offset:3072 lds
    s_add_u32 s70, s78, 1536
    s_cmp_eq_u32 s101, s70
    s_cselect_b32 s70, 128, 0
    s_add_u32 s101, s101, s70
    s_and_b32 s70, s101, 384
    s_cmp_eq_u32 s70, s78
    s_cselect_b32 s70, 512, 0
    s_add_u32 s100, s101, s70
    s_add_u32 s101, s101, 128
    s_lshr_b32 s70, s100, 2
    s_and_b32 s70, s70, 0x180
    s_lshl_b32 s100, s100, 2
    s_and_b32 s100, s100, 0x600
    s_or_b32 s100, s100, s70
    s_waitcnt vmcnt(12)
    v_cmp_eq_u32 vcc, s83, v8
    s_cmp_eq_u64 vcc, exec
    s_cbranch_scc1 L_pd_kvx
    s_mov_b32 s73, 131072
    s_mov_b32 s72, 0xca0000
L_pl_kvx:
    buffer_load_dword v8, v24, s[8:11], s72 offen sc1
    s_waitcnt vmcnt(0)
    v_cmp_eq_u32 vcc, s83, v8
    s_cmp_eq_u64 vcc, exec
    s_cbranch_scc1 L_pd_kvx
    s_sleep 8
    s_sub_u32 s73, s73, 1
    s_cbranch_scc0 L_pl_kvx
L_pd_kvx:
    s_barrier
    s_add_u32 m0, s32, 0x0
    s_add_u32 s71, s100, s34
    buffer_load_dwordx4 v40, s[12:15], s71 offen lds
    buffer_load_dwordx4 v41, s[12:15], s71 offen offset:1024 lds
    buffer_load_dwordx4 v42, s[12:15], s71 offen offset:2048 lds
    buffer_load_dwordx4 v43, s[12:15], s71 offen offset:3072 lds
    s_add_u32 m0, s81, 0x18000
    s_nop 0
    buffer_load_dwordx4 v44, s[20:23], s100 offen lds
    buffer_load_dwordx4 v45, s[20:23], s100 offen offset:1024 lds
    buffer_load_dwordx4 v46, s[20:23], s100 offen offset:2048 lds
    buffer_load_dwordx4 v47, s[20:23], s100 offen offset:3072 lds
    s_add_u32 m0, s33, 0x0
    s_add_u32 s71, s100, s35
    buffer_load_dwordx4 v40, s[12:15], s71 offen lds
    buffer_load_dwordx4 v41, s[12:15], s71 offen offset:1024 lds
    buffer_load_dwordx4 v42, s[12:15], s71 offen offset:2048 lds
    buffer_load_dwordx4 v43, s[12:15], s71 offen offset:3072 lds
    s_add_u32 m0, s82, 0x10000
    s_add_u32 s70, s82, 0xbf0000
    buffer_load_dwordx4 v7, s[8:11], s70 offen sc1 lds
    buffer_load_dwordx4 v7, s[8:11], s70 offen offset:1024 sc1 lds
    s_add_u32 m0, s82, 0x12000
    s_add_u32 s70, s82, 0xbf2000
    buffer_load_dwordx4 v7, s[8:11], s70 offen sc1 lds
    buffer_load_dwordx4 v7, s[8:11], s70 offen offset:1024 sc1 lds
    s_waitcnt vmcnt(16)
    s_barrier
    s_waitcnt vmcnt(4)
    s_barrier
    s_add_u32 m0, s82, 0x14000
    s_add_u32 s70, s82, 0xbf4000
    buffer_load_dwordx4 v7, s[8:11], s70 offen sc1 lds
    buffer_load_dwordx4 v7, s[8:11], s70 offen offset:1024 sc1 lds
    s_add_u32 m0, s82, 0x16000
    s_add_u32 s70, s82, 0xbf6000
    buffer_load_dwordx4 v7, s[8:11], s70 offen sc1 lds
    buffer_load_dwordx4 v7, s[8:11], s70 offen offset:1024 sc1 lds
    s_mov_b32 s72, 0xc90000
    buffer_load_dword v8, v27, s[8:11], s72 offen sc1
    s_waitcnt vmcnt(1)
    s_barrier
    ds_read_b128 v[144:147], v22 offset:0
    ds_read_b128 v[148:151], v22 offset:1024
    ds_read_b128 v[160:163], v22 offset:2048
    ds_read_b128 v[164:167], v22 offset:3072
    s_waitcnt vmcnt(0)
    v_cmp_eq_u32 vcc, s83, v8
    s_cmp_eq_u64 vcc, exec
    s_cbranch_scc1 L_pd_q
    s_mov_b32 s73, 131072
    s_mov_b32 s72, 0xc90000
L_pl_q:
    buffer_load_dword v8, v27, s[8:11], s72 offen sc1
    s_waitcnt vmcnt(0)
    v_cmp_eq_u32 vcc, s83, v8
    s_cmp_eq_u64 vcc, exec
    s_cbranch_scc1 L_pd_q
    s_sleep 8
    s_sub_u32 s73, s73, 1
    s_cbranch_scc0 L_pl_q
L_pd_q:
    s_lshl_b32 s70, s30, 12
    s_add_u32 s70, s70, 0xe00000
    buffer_load_dwordx4 v[80:83], v7, s[8:11], s70 offen offset:0 sc1
    buffer_load_dwordx4 v[84:87], v7, s[8:11], s70 offen offset:1024 sc1
    buffer_load_dwordx4 v[88:91], v7, s[8:11], s70 offen offset:2048 sc1
    buffer_load_dwordx4 v[92:95], v7, s[8:11], s70 offen offset:3072 sc1
    s_waitcnt vmcnt(0)
    s_branch L_att
L_XA:
L_pad_xa:
    s_cbranch_execz L_idle
    s_mov_b32 s20, s38
    s_mov_b32 s21, s39
    s_mov_b32 s22, 0x800
    s_mov_b32 s23, 0x20000
    s_mov_b32 s24, s40
    s_mov_b32 s25, s41
    s_mov_b32 s26, 0x800
    s_mov_b32 s27, 0x20000
    s_mov_b32 s28, s50
    s_mov_b32 s29, s51
    s_mov_b32 s30, 0x800
    s_mov_b32 s31, 0x20000
    s_lshl_b32 s70, s80, 6
    s_lshl_b32 s71, s77, 5
    s_add_u32 s70, s70, s71
    v_add_u32 v19, s70, v1
    v_lshlrev_b32 v4, 1, v19
    v_bfe_u32 v5, v0, 2, 1
    v_bfe_u32 v6, v0, 3, 1
    v_xor_b32 v5, v5, v6
    v_mul_u32_u24 v5, 24, v5
    v_xor_b32 v18, v4, v5
    buffer_load_ushort v24, v18, s[20:23], 0 offen
    buffer_load_ushort v25, v18, s[24:27], 0 offen
    buffer_load_ushort v26, v18, s[28:31], 0 offen
    v_bfe_u32 v3, v0, 1, 3
    v_lshrrev_b32 v4, 4, v0
    v_xor_b32 v3, v3, v4
    v_lshlrev_b32 v3, 4, v3
    v_and_b32 v5, 15, v0
    v_lshl_add_u32 v3, v5, 7, v3
    v_xor_b32 v4, 64, v3
    s_mul_i32 s70, s76, 0xc000
    s_lshl_b32 s71, s77, 13
    s_add_u32 s71, s71, 0x18000
    v_add_u32 v10, s70, v3
    v_add_u32 v11, s70, v4
    v_add_u32 v12, s71, v3
    v_add_u32 v13, s71, v4
    s_barrier
    ds_read_b128 v[188:191], v10 offset:0
    ds_read_b128 v[220:223], v12 offset:0
    ds_read_b128 v[224:227], v12 offset:2048
    ds_read_b128 v[228:231], v12 offset:4096
    ds_read_b128 v[232:235], v12 offset:6144
    ds_read_b128 v[192:195], v10 offset:2048
    ds_read_b128 v[196:199], v10 offset:4096
    ds_read_b128 v[200:203], v10 offset:6144
    ds_read_b128 v[204:207], v10 offset:8192
    ds_read_b128 v[208:211], v10 offset:10240
    ds_read_b128 v[212:215], v10 offset:12288
    ds_read_b128 v[216:219], v10 offset:14336
    s_waitcnt lgkmcnt(10)
    v_mfma_f32_16x16x32_bf16 v[60:63], v[188:191], v[220:223], 0
    s_waitcnt lgkmcnt(9)
    v_mfma_f32_16x16x32_bf16 v[124:127], v[188:191], v[224:227], 0
    s_waitcnt lgkmcnt(8)
    v_mfma_f32_16x16x32_bf16 v[92:95], v[188:191], v[228:231], 0
    s_waitcnt lgkmcnt(7)
    v_mfma_f32_16x16x32_bf16 v[156:159], v[188:191], v[232:235], 0
    s_waitcnt lgkmcnt(6)
    v_mfma_f32_16x16x32_bf16 v[160:163], v[192:195], v[232:235], 0
    ds_read_b128 v[188:191], v11 offset:0
    v_mfma_f32_16x16x32_bf16 v[96:99], v[192:195], v[228:231], 0
    ds_read_b128 v[236:239], v13 offset:0
    v_mfma_f32_16x16x32_bf16 v[128:131], v[192:195], v[224:227], 0
    ds_read_b128 v[240:243], v13 offset:2048
    v_mfma_f32_16x16x32_bf16 v[64:67], v[192:195], v[220:223], 0
    s_waitcnt lgkmcnt(3)
    v_mfma_f32_16x16x32_bf16 v[68:71], v[196:199], v[220:223], 0
    ds_read_b128 v[244:247], v13 offset:4096
    v_mfma_f32_16x16x32_bf16 v[132:135], v[196:199], v[224:227], 0
    ds_read_b128 v[248:251], v13 offset:6144
    v_mfma_f32_16x16x32_bf16 v[100:103], v[196:199], v[228:231], 0
    ds_read_b128 v[192:195], v11 offset:2048
    v_mfma_f32_16x16x32_bf16 v[164:167], v[196:199], v[232:235], 0
    ds_read_b128 v[196:199], v11 offset:4096
    v_mfma_f32_16x16x32_bf16 v[168:171], v[200:203], v[232:235], 0
    s_lshl_b32 s71, s79, 14
    v_mfma_f32_16x16x32_bf16 v[104:107], v[200:203], v[228:231], 0
    v_lshl_add_u32 v19, v19, 4, s71
    v_mfma_f32_16x16x32_bf16 v[136:139], v[200:203], v[224:227], 0
    s_lshl_b32 s73, s4, 6
    v_mfma_f32_16x16x32_bf16 v[72:75], v[200:203], v[220:223], 0
    ds_read_b128 v[200:203], v11 offset:6144
    v_mfma_f32_16x16x32_bf16 v[76:79], v[204:207], v[220:223], 0
    s_add_u32 s73, s73, s77
    v_mfma_f32_16x16x32_bf16 v[140:143], v[204:207], v[224:227], 0
    s_lshl_b32 s73, s73, 7
    v_mfma_f32_16x16x32_bf16 v[108:111], v[204:207], v[228:231], 0
    v_bfe_u32 v3, v0, 1, 3
    v_mfma_f32_16x16x32_bf16 v[172:175], v[204:207], v[232:235], 0
    ds_read_b128 v[204:207], v11 offset:8192
    v_mfma_f32_16x16x32_bf16 v[176:179], v[208:211], v[232:235], 0
    v_lshl_add_u32 v3, v3, 10, s73
    v_mfma_f32_16x16x32_bf16 v[112:115], v[208:211], v[228:231], 0
    v_and_b32 v4, 1, v0
    v_mfma_f32_16x16x32_bf16 v[144:147], v[208:211], v[224:227], 0
    v_lshl_add_u32 v21, v4, 8, v3
    v_mfma_f32_16x16x32_bf16 v[80:83], v[208:211], v[220:223], 0
    ds_read_b128 v[208:211], v11 offset:10240
    v_mfma_f32_16x16x32_bf16 v[84:87], v[212:215], v[220:223], 0
    v_lshlrev_b32 v3, 4, v4
    v_mfma_f32_16x16x32_bf16 v[148:151], v[212:215], v[224:227], 0
    v_mov_b32 v6, 0x3f80
    v_mfma_f32_16x16x32_bf16 v[116:119], v[212:215], v[228:231], 0
    v_lshlrev_b32 v6, v3, v6
    v_mfma_f32_16x16x32_bf16 v[180:183], v[212:215], v[232:235], 0
    ds_read_b128 v[212:215], v11 offset:12288
    v_mfma_f32_16x16x32_bf16 v[184:187], v[216:219], v[232:235], 0
    v_lshrrev_b32 v4, 1, v1
    v_mfma_f32_16x16x32_bf16 v[120:123], v[216:219], v[228:231], 0
    v_lshlrev_b32 v5, 3, v2
    v_mfma_f32_16x16x32_bf16 v[152:155], v[216:219], v[224:227], 0
    v_sub_u32 v4, v4, v5
    v_mfma_f32_16x16x32_bf16 v[88:91], v[216:219], v[220:223], 0
    s_waitcnt lgkmcnt(1)
    v_mfma_f32_16x16x32_bf16 v[60:63], v[188:191], v[236:239], v[60:63]
    ds_read_b128 v[216:219], v11 offset:14336
    v_mfma_f32_16x16x32_bf16 v[124:127], v[188:191], v[240:243], v[124:127]
    s_lshl_b32 s70, s6, 13
    v_mfma_f32_16x16x32_bf16 v[92:95], v[188:191], v[244:247], v[92:95]
    s_add_u32 s70, s70, 0x14000
    v_mfma_f32_16x16x32_bf16 v[156:159], v[188:191], v[248:251], v[156:159]
    v_bfe_u32 v3, v0, 1, 2
    v_mfma_f32_16x16x32_bf16 v[160:163], v[192:195], v[248:251], v[160:163]
    v_lshlrev_b32 v4, 1, v2
    v_mfma_f32_16x16x32_bf16 v[96:99], v[192:195], v[244:247], v[96:99]
    v_xor_b32 v3, v3, v4
    v_mfma_f32_16x16x32_bf16 v[128:131], v[192:195], v[240:243], v[128:131]
    v_lshl_add_u32 v3, v3, 4, s70
    v_mfma_f32_16x16x32_bf16 v[64:67], v[192:195], v[236:239], v[64:67]
    v_lshl_add_u32 v52, v1, 6, v3
    v_mfma_f32_16x16x32_bf16 v[68:71], v[196:199], v[236:239], v[68:71]
    v_xor_b32 v53, 16, v52
    v_mfma_f32_16x16x32_bf16 v[132:135], v[196:199], v[240:243], v[132:135]
    v_bfe_u32 v3, v0, 1, 1
    v_mfma_f32_16x16x32_bf16 v[100:103], v[196:199], v[244:247], v[100:103]
    v_bfe_u32 v4, v0, 3, 2
    v_mfma_f32_16x16x32_bf16 v[164:167], v[196:199], v[248:251], v[164:167]
    s_waitcnt lgkmcnt(0)
    s_barrier
    v_mfma_f32_16x16x32_bf16 v[168:171], v[200:203], v[248:251], v[168:171]
    ds_read_b128 v[188:191], v10 offset:16384
    v_mfma_f32_16x16x32_bf16 v[104:107], v[200:203], v[244:247], v[104:107]
    ds_read_b128 v[220:223], v12 offset:16384
    v_mfma_f32_16x16x32_bf16 v[136:139], v[200:203], v[240:243], v[136:139]
    ds_read_b128 v[224:227], v12 offset:18432
    v_mfma_f32_16x16x32_bf16 v[72:75], v[200:203], v[236:239], v[72:75]
    ds_read_b128 v[228:231], v12 offset:20480
    v_mfma_f32_16x16x32_bf16 v[76:79], v[204:207], v[236:239], v[76:79]
    ds_read_b128 v[232:235], v12 offset:22528
    v_mfma_f32_16x16x32_bf16 v[140:143], v[204:207], v[240:243], v[140:143]
    ds_read_b128 v[192:195], v10 offset:18432
    v_mfma_f32_16x16x32_bf16 v[108:111], v[204:207], v[244:247], v[108:111]
    ds_read_b128 v[196:199], v10 offset:20480
    v_mfma_f32_16x16x32_bf16 v[172:175], v[204:207], v[248:251], v[172:175]
    ds_read_b128 v[200:203], v10 offset:22528
    v_mfma_f32_16x16x32_bf16 v[176:179], v[208:211], v[248:251], v[176:179]
    ds_read_b128 v[204:207], v10 offset:24576
    v_mfma_f32_16x16x32_bf16 v[112:115], v[208:211], v[244:247], v[112:115]
    v_xor_b32 v3, v3, v4
    v_mfma_f32_16x16x32_bf16 v[144:147], v[208:211], v[240:243], v[144:147]
    v_lshlrev_b32 v4, 1, v2
    v_mfma_f32_16x16x32_bf16 v[80:83], v[208:211], v[236:239], v[80:83]
    ds_read_b128 v[208:211], v10 offset:26624
    v_mfma_f32_16x16x32_bf16 v[84:87], v[212:215], v[236:239], v[84:87]
    v_xor_b32 v3, v3, v4
    v_mfma_f32_16x16x32_bf16 v[148:151], v[212:215], v[240:243], v[148:151]
    v_lshl_add_u32 v3, v3, 4, s70
    v_mfma_f32_16x16x32_bf16 v[116:119], v[212:215], v[244:247], v[116:119]
    v_and_b32 v4, 1, v0
    v_mfma_f32_16x16x32_bf16 v[180:183], v[212:215], v[248:251], v[180:183]
    ds_read_b128 v[212:215], v10 offset:28672
    v_mfma_f32_16x16x32_bf16 v[184:187], v[216:219], v[248:251], v[184:187]
    v_lshl_add_u32 v3, v4, 3, v3
    v_mfma_f32_16x16x32_bf16 v[120:123], v[216:219], v[244:247], v[120:123]
    v_bfe_u32 v4, v0, 2, 2
    v_mfma_f32_16x16x32_bf16 v[152:155], v[216:219], v[240:243], v[152:155]
    v_lshl_add_u32 v3, v4, 6, v3
    v_mfma_f32_16x16x32_bf16 v[88:91], v[216:219], v[236:239], v[88:91]
    s_waitcnt lgkmcnt(1)
    v_mfma_f32_16x16x32_bf16 v[60:63], v[188:191], v[220:223], v[60:63]
    ds_read_b128 v[216:219], v10 offset:30720
    v_mfma_f32_16x16x32_bf16 v[124:127], v[188:191], v[224:227], v[124:127]
    v_lshl_add_u32 v54, v2, 8, v3
    v_mfma_f32_16x16x32_bf16 v[92:95], v[188:191], v[228:231], v[92:95]
    v_and_b32 v3, 15, v0
    v_mfma_f32_16x16x32_bf16 v[156:159], v[188:191], v[232:235], v[156:159]
    ds_read_b128 v[188:191], v11 offset:16384
    v_mfma_f32_16x16x32_bf16 v[160:163], v[192:195], v[232:235], v[160:163]
    ds_read_b128 v[236:239], v13 offset:16384
    v_mfma_f32_16x16x32_bf16 v[96:99], v[192:195], v[228:231], v[96:99]
    ds_read_b128 v[240:243], v13 offset:18432
    v_mfma_f32_16x16x32_bf16 v[128:131], v[192:195], v[224:227], v[128:131]
    ds_read_b128 v[244:247], v13 offset:20480
    v_mfma_f32_16x16x32_bf16 v[64:67], v[192:195], v[220:223], v[64:67]
    ds_read_b128 v[248:251], v13 offset:22528
    v_mfma_f32_16x16x32_bf16 v[68:71], v[196:199], v[220:223], v[68:71]
    ds_read_b128 v[192:195], v11 offset:18432
    v_mfma_f32_16x16x32_bf16 v[132:135], v[196:199], v[224:227], v[132:135]
    v_lshlrev_b32 v3, 4, v3
    v_mfma_f32_16x16x32_bf16 v[100:103], v[196:199], v[228:231], v[100:103]
    v_lshrrev_b32 v4, 4, v0
    v_mfma_f32_16x16x32_bf16 v[164:167], v[196:199], v[232:235], v[164:167]
    ds_read_b128 v[196:199], v11 offset:20480
    v_mfma_f32_16x16x32_bf16 v[168:171], v[200:203], v[232:235], v[168:171]
    v_lshl_add_u32 v3, v4, 9, v3
    v_mfma_f32_16x16x32_bf16 v[104:107], v[200:203], v[228:231], v[104:107]
    s_lshl_b32 s70, s76, 13
    v_mfma_f32_16x16x32_bf16 v[136:139], v[200:203], v[224:227], v[136:139]
    v_add_u32 v22, s70, v3
    v_mfma_f32_16x16x32_bf16 v[72:75], v[200:203], v[220:223], v[72:75]
    ds_read_b128 v[200:203], v11 offset:22528
    v_mfma_f32_16x16x32_bf16 v[76:79], v[204:207], v[220:223], v[76:79]
    s_lshl_b32 s72, s6, 13
    v_mfma_f32_16x16x32_bf16 v[140:143], v[204:207], v[224:227], v[140:143]
    s_add_u32 s72, s72, 0x20000
    v_mfma_f32_16x16x32_bf16 v[108:111], v[204:207], v[228:231], v[108:111]
    v_lshrrev_b32 v3, 4, v0
    v_mfma_f32_16x16x32_bf16 v[172:175], v[204:207], v[232:235], v[172:175]
    ds_read_b128 v[204:207], v11 offset:24576
    v_mfma_f32_16x16x32_bf16 v[176:179], v[208:211], v[232:235], v[176:179]
    v_and_b32 v4, 7, v0
    v_mfma_f32_16x16x32_bf16 v[112:115], v[208:211], v[228:231], v[112:115]
    v_xor_b32 v3, v3, v4
    v_mfma_f32_16x16x32_bf16 v[144:147], v[208:211], v[224:227], v[144:147]
    v_lshl_add_u32 v3, v3, 4, s72
    v_mfma_f32_16x16x32_bf16 v[80:83], v[208:211], v[220:223], v[80:83]
    s_waitcnt lgkmcnt(1)
    v_mfma_f32_16x16x32_bf16 v[84:87], v[212:215], v[220:223], v[84:87]
    ds_read_b128 v[208:211], v11 offset:26624
    v_mfma_f32_16x16x32_bf16 v[148:151], v[212:215], v[224:227], v[148:151]
    v_and_b32 v28, 15, v0
    v_mfma_f32_16x16x32_bf16 v[116:119], v[212:215], v[228:231], v[116:119]
    v_lshl_add_u32 v28, v28, 7, v3
    v_mfma_f32_16x16x32_bf16 v[180:183], v[212:215], v[232:235], v[180:183]
    ds_read_b128 v[212:215], v11 offset:28672
    v_mfma_f32_16x16x32_bf16 v[184:187], v[216:219], v[232:235], v[184:187]
    v_xor_b32 v29, 64, v28
    v_mfma_f32_16x16x32_bf16 v[120:123], v[216:219], v[228:231], v[120:123]
    v_lshrrev_b32 v3, 3, v0
    v_mfma_f32_16x16x32_bf16 v[152:155], v[216:219], v[224:227], v[152:155]
    v_xor_b32 v30, v3, v4
    v_mfma_f32_16x16x32_bf16 v[88:91], v[216:219], v[220:223], v[88:91]
    ds_read_b128 v[216:219], v11 offset:30720
    v_mfma_f32_16x16x32_bf16 v[60:63], v[188:191], v[236:239], v[60:63]
    v_lshl_add_u32 v30, v30, 4, s72
    v_mfma_f32_16x16x32_bf16 v[124:127], v[188:191], v[240:243], v[124:127]
    v_lshl_add_u32 v30, v3, 7, v30
    v_mfma_f32_16x16x32_bf16 v[92:95], v[188:191], v[244:247], v[92:95]
    s_lshl_b32 s72, s4, 20
    v_mfma_f32_16x16x32_bf16 v[156:159], v[188:191], v[248:251], v[156:159]
    s_lshl_b32 s73, s76, 19
    v_mfma_f32_16x16x32_bf16 v[160:163], v[192:195], v[248:251], v[160:163]
    s_add_u32 s72, s72, s73
    v_mfma_f32_16x16x32_bf16 v[96:99], v[192:195], v[244:247], v[96:99]
    s_lshl_b32 s73, s5, 9
    v_mfma_f32_16x16x32_bf16 v[128:131], v[192:195], v[240:243], v[128:131]
    s_add_u32 s72, s72, s73
    v_mfma_f32_16x16x32_bf16 v[64:67], v[192:195], v[236:239], v[64:67]
    s_lshl_b32 s73, s77, 7
    v_mfma_f32_16x16x32_bf16 v[68:71], v[196:199], v[236:239], v[68:71]
    s_add_u32 s72, s72, s73
    v_mfma_f32_16x16x32_bf16 v[132:135], v[196:199], v[240:243], v[132:135]
    v_lshl_add_u32 v23, v4, 4, s72
    v_mfma_f32_16x16x32_bf16 v[100:103], v[196:199], v[244:247], v[100:103]
    v_lshl_add_u32 v23, v3, 13, v23
    v_mfma_f32_16x16x32_bf16 v[164:167], v[196:199], v[248:251], v[164:167]
    s_waitcnt lgkmcnt(0)
    s_barrier
    v_mfma_f32_16x16x32_bf16 v[168:171], v[200:203], v[248:251], v[168:171]
    ds_read_b128 v[188:191], v10 offset:32768
    v_mfma_f32_16x16x32_bf16 v[104:107], v[200:203], v[244:247], v[104:107]
    ds_read_b128 v[220:223], v12 offset:49152
    v_mfma_f32_16x16x32_bf16 v[136:139], v[200:203], v[240:243], v[136:139]
    ds_read_b128 v[224:227], v12 offset:51200
    v_mfma_f32_16x16x32_bf16 v[72:75], v[200:203], v[236:239], v[72:75]
    ds_read_b128 v[228:231], v12 offset:53248
    v_mfma_f32_16x16x32_bf16 v[76:79], v[204:207], v[236:239], v[76:79]
    ds_read_b128 v[232:235], v12 offset:55296
    v_mfma_f32_16x16x32_bf16 v[140:143], v[204:207], v[240:243], v[140:143]
    ds_read_b128 v[192:195], v10 offset:34816
    v_mfma_f32_16x16x32_bf16 v[108:111], v[204:207], v[244:247], v[108:111]
    ds_read_b128 v[196:199], v10 offset:36864
    v_mfma_f32_16x16x32_bf16 v[172:175], v[204:207], v[248:251], v[172:175]
    ds_read_b128 v[200:203], v10 offset:38912
    v_mfma_f32_16x16x32_bf16 v[176:179], v[208:211], v[248:251], v[176:179]
    ds_read_b128 v[204:207], v10 offset:40960
    v_mfma_f32_16x16x32_bf16 v[112:115], v[208:211], v[244:247], v[112:115]
    v_bfe_u32 v3, v0, 2, 2
    v_mfma_f32_16x16x32_bf16 v[144:147], v[208:211], v[240:243], v[144:147]
    v_lshrrev_b32 v4, 4, v0
    v_mfma_f32_16x16x32_bf16 v[80:83], v[208:211], v[236:239], v[80:83]
    ds_read_b128 v[208:211], v10 offset:43008
    v_mfma_f32_16x16x32_bf16 v[84:87], v[212:215], v[236:239], v[84:87]
    v_lshl_add_u32 v5, v4, 3, v3
    v_mfma_f32_16x16x32_bf16 v[148:151], v[212:215], v[240:243], v[148:151]
L_pad_7:
    s_cbranch_execz L_ret_x1
    v_and_b32 v4, 1, v4
    v_mfma_f32_16x16x32_bf16 v[116:119], v[212:215], v[244:247], v[116:119]
    v_lshlrev_b32 v4, 2, v4
    v_mfma_f32_16x16x32_bf16 v[180:183], v[212:215], v[248:251], v[180:183]
    ds_read_b128 v[212:215], v10 offset:45056
    v_mfma_f32_16x16x32_bf16 v[184:187], v[216:219], v[248:251], v[184:187]
    v_sub_u32 v5, v5, v4
    v_mfma_f32_16x16x32_bf16 v[120:123], v[216:219], v[244:247], v[120:123]
    v_bfe_u32 v4, v0, 3, 2
    v_mfma_f32_16x16x32_bf16 v[152:155], v[216:219], v[240:243], v[152:155]
    s_lshl_b32 s70, s77, 1
    v_mfma_f32_16x16x32_bf16 v[88:91], v[216:219], v[236:239], v[88:91]
    s_waitcnt lgkmcnt(1)
    v_mfma_f32_16x16x32_bf16 v[60:63], v[188:191], v[220:223], v[60:63]
    ds_read_b128 v[216:219], v10 offset:47104
    v_mfma_f32_16x16x32_bf16 v[124:127], v[188:191], v[224:227], v[124:127]
    v_xor_b32 v4, s70, v4
    v_mfma_f32_16x16x32_bf16 v[92:95], v[188:191], v[228:231], v[92:95]
    v_lshlrev_b32 v4, 5, v4
    v_mfma_f32_16x16x32_bf16 v[156:159], v[188:191], v[232:235], v[156:159]
    ds_read_b128 v[188:191], v11 offset:32768
    v_mfma_f32_16x16x32_bf16 v[160:163], v[192:195], v[232:235], v[160:163]
    ds_read_b128 v[236:239], v13 offset:49152
    v_mfma_f32_16x16x32_bf16 v[96:99], v[192:195], v[228:231], v[96:99]
    ds_read_b128 v[240:243], v13 offset:51200
    v_mfma_f32_16x16x32_bf16 v[128:131], v[192:195], v[224:227], v[128:131]
    ds_read_b128 v[244:247], v13 offset:53248
    v_mfma_f32_16x16x32_bf16 v[64:67], v[192:195], v[220:223], v[64:67]
    ds_read_b128 v[248:251], v13 offset:55296
    v_mfma_f32_16x16x32_bf16 v[68:71], v[196:199], v[220:223], v[68:71]
    ds_read_b128 v[192:195], v11 offset:34816
    v_mfma_f32_16x16x32_bf16 v[132:135], v[196:199], v[224:227], v[132:135]
    v_lshl_add_u32 v4, v5, 7, v4
    v_mfma_f32_16x16x32_bf16 v[100:103], v[196:199], v[228:231], v[100:103]
    v_and_b32 v3, 1, v0
    v_mfma_f32_16x16x32_bf16 v[164:167], v[196:199], v[232:235], v[164:167]
    ds_read_b128 v[196:199], v11 offset:36864
    v_mfma_f32_16x16x32_bf16 v[168:171], v[200:203], v[232:235], v[168:171]
    v_bfe_u32 v6, v0, 1, 1
    v_mfma_f32_16x16x32_bf16 v[104:107], v[200:203], v[228:231], v[104:107]
    v_lshl_add_u32 v4, v3, 3, v4
    v_mfma_f32_16x16x32_bf16 v[136:139], v[200:203], v[224:227], v[136:139]
    v_lshl_add_u32 v4, v6, 4, v4
    v_mfma_f32_16x16x32_bf16 v[72:75], v[200:203], v[220:223], v[72:75]
    ds_read_b128 v[200:203], v11 offset:38912
    v_mfma_f32_16x16x32_bf16 v[76:79], v[204:207], v[220:223], v[76:79]
    v_add_u32 v14, 0x10000, v4
    v_mfma_f32_16x16x32_bf16 v[140:143], v[204:207], v[224:227], v[140:143]
    v_xor_b32 v15, 32, v14
    v_mfma_f32_16x16x32_bf16 v[108:111], v[204:207], v[228:231], v[108:111]
    s_waitcnt vmcnt(0)
    v_mfma_f32_16x16x32_bf16 v[172:175], v[204:207], v[232:235], v[172:175]
    ds_read_b128 v[204:207], v11 offset:40960
    v_mfma_f32_16x16x32_bf16 v[176:179], v[208:211], v[232:235], v[176:179]
    v_lshlrev_b32 v26, 16, v26
    v_mfma_f32_16x16x32_bf16 v[112:115], v[208:211], v[228:231], v[112:115]
    v_mul_f32 v26, 0x3fb8aa3b, v26
    v_mfma_f32_16x16x32_bf16 v[144:147], v[208:211], v[224:227], v[144:147]
    v_exp_f32 v26, v26
    v_mfma_f32_16x16x32_bf16 v[80:83], v[208:211], v[220:223], v[80:83]
    s_waitcnt lgkmcnt(1)
    v_mfma_f32_16x16x32_bf16 v[84:87], v[212:215], v[220:223], v[84:87]
    ds_read_b128 v[208:211], v11 offset:43008
    v_mfma_f32_16x16x32_bf16 v[148:151], v[212:215], v[224:227], v[148:151]
    v_lshlrev_b32 v3, 16, v24
    v_mfma_f32_16x16x32_bf16 v[116:119], v[212:215], v[228:231], v[116:119]
    v_lshlrev_b32 v4, 16, v25
    v_mfma_f32_16x16x32_bf16 v[180:183], v[212:215], v[232:235], v[180:183]
    ds_read_b128 v[212:215], v11 offset:45056
    v_mfma_f32_16x16x32_bf16 v[184:187], v[216:219], v[232:235], v[184:187]
    v_cvt_pk_bf16_f32 v26, v26, v26
    v_mfma_f32_16x16x32_bf16 v[120:123], v[216:219], v[228:231], v[120:123]
    v_lshlrev_b32 v26, 16, v26
    v_mfma_f32_16x16x32_bf16 v[152:155], v[216:219], v[224:227], v[152:155]
    v_mul_f32 v5, v26, v3
    v_mfma_f32_16x16x32_bf16 v[88:91], v[216:219], v[220:223], v[88:91]
    ds_read_b128 v[216:219], v11 offset:47104
    v_mfma_f32_16x16x32_bf16 v[60:63], v[188:191], v[236:239], v[60:63]
    v_mul_f32 v6, v26, v4
    v_mfma_f32_16x16x32_bf16 v[124:127], v[188:191], v[240:243], v[124:127]
    v_mul_f32 v5, 0x3fb8aa3b, v5
    v_mfma_f32_16x16x32_bf16 v[92:95], v[188:191], v[244:247], v[92:95]
    v_mul_f32 v6, 0x3e22f983, v6
    v_mfma_f32_16x16x32_bf16 v[156:159], v[188:191], v[248:251], v[156:159]
    v_exp_f32 v5, v5
    v_mfma_f32_16x16x32_bf16 v[160:163], v[192:195], v[248:251], v[160:163]
    v_rndne_f32 v26, v6
    v_mfma_f32_16x16x32_bf16 v[96:99], v[192:195], v[244:247], v[96:99]
    v_sub_f32 v6, v6, v26
    v_mfma_f32_16x16x32_bf16 v[128:131], v[192:195], v[240:243], v[128:131]
    v_cos_f32 v24, v6
    v_mfma_f32_16x16x32_bf16 v[64:67], v[192:195], v[236:239], v[64:67]
    v_sin_f32 v25, v6
    v_mfma_f32_16x16x32_bf16 v[68:71], v[196:199], v[236:239], v[68:71]
    v_mul_f32 v26, v3, v3
    v_mfma_f32_16x16x32_bf16 v[132:135], v[196:199], v[240:243], v[132:135]
    v_fmac_f32 v26, v4, v4
    v_mfma_f32_16x16x32_bf16 v[100:103], v[196:199], v[244:247], v[100:103]
    v_rcp_f32 v6, v26
    v_mfma_f32_16x16x32_bf16 v[164:167], v[196:199], v[248:251], v[164:167]
    s_waitcnt lgkmcnt(0)
    s_barrier
    v_mfma_f32_16x16x32_bf16 v[168:171], v[200:203], v[248:251], v[168:171]
    ds_read_b128 v[188:191], v10 offset:0
    v_mfma_f32_16x16x32_bf16 v[104:107], v[200:203], v[244:247], v[104:107]
    ds_read_b128 v[220:223], v12 offset:0
    v_mfma_f32_16x16x32_bf16 v[136:139], v[200:203], v[240:243], v[136:139]
    ds_read_b128 v[224:227], v12 offset:2048
    v_mfma_f32_16x16x32_bf16 v[72:75], v[200:203], v[236:239], v[72:75]
    ds_read_b128 v[228:231], v12 offset:4096
    v_mfma_f32_16x16x32_bf16 v[76:79], v[204:207], v[236:239], v[76:79]
    ds_read_b128 v[232:235], v12 offset:6144
    v_mfma_f32_16x16x32_bf16 v[140:143], v[204:207], v[240:243], v[140:143]
    ds_read_b128 v[192:195], v10 offset:2048
    v_mfma_f32_16x16x32_bf16 v[108:111], v[204:207], v[244:247], v[108:111]
    ds_read_b128 v[196:199], v10 offset:4096
    v_mfma_f32_16x16x32_bf16 v[172:175], v[204:207], v[248:251], v[172:175]
    ds_read_b128 v[200:203], v10 offset:6144
    v_mfma_f32_16x16x32_bf16 v[176:179], v[208:211], v[248:251], v[176:179]
    ds_read_b128 v[204:207], v10 offset:8192
    v_mfma_f32_16x16x32_bf16 v[112:115], v[208:211], v[244:247], v[112:115]
    v_mul_f32 v24, v24, v5
    v_mfma_f32_16x16x32_bf16 v[144:147], v[208:211], v[240:243], v[144:147]
    v_mul_f32 v25, v25, v5
    v_mfma_f32_16x16x32_bf16 v[80:83], v[208:211], v[236:239], v[80:83]
    ds_read_b128 v[208:211], v10 offset:10240
    v_mfma_f32_16x16x32_bf16 v[84:87], v[212:215], v[236:239], v[84:87]
    v_add_f32 v6, v6, v6
    v_mfma_f32_16x16x32_bf16 v[148:151], v[212:215], v[240:243], v[148:151]
    v_add_f32 v5, -1.0, v24
    v_mfma_f32_16x16x32_bf16 v[116:119], v[212:215], v[244:247], v[116:119]
    v_mul_f32 v26, v5, v3
    v_mfma_f32_16x16x32_bf16 v[180:183], v[212:215], v[248:251], v[180:183]
    ds_read_b128 v[212:215], v10 offset:12288
    v_mfma_f32_16x16x32_bf16 v[184:187], v[216:219], v[248:251], v[184:187]
    v_fmac_f32 v26, v25, v4
    v_mfma_f32_16x16x32_bf16 v[120:123], v[216:219], v[244:247], v[120:123]
    v_mul_f32 v27, v5, v4
    v_mfma_f32_16x16x32_bf16 v[152:155], v[216:219], v[240:243], v[152:155]
    v_fma_f32 v27, -v25, v3, v27
    v_mfma_f32_16x16x32_bf16 v[88:91], v[216:219], v[236:239], v[88:91]
    s_waitcnt lgkmcnt(1)
    v_mfma_f32_16x16x32_bf16 v[60:63], v[188:191], v[220:223], v[60:63]
    ds_read_b128 v[216:219], v10 offset:14336
    v_mfma_f32_16x16x32_bf16 v[124:127], v[188:191], v[224:227], v[124:127]
    v_mul_f32 v26, v26, v6
    v_mfma_f32_16x16x32_bf16 v[92:95], v[188:191], v[228:231], v[92:95]
    v_mul_f32 v27, v27, v6
    v_mfma_f32_16x16x32_bf16 v[156:159], v[188:191], v[232:235], v[156:159]
    ds_read_b128 v[188:191], v11 offset:0
    v_mfma_f32_16x16x32_bf16 v[160:163], v[192:195], v[232:235], v[160:163]
    ds_read_b128 v[236:239], v13 offset:0
    v_mfma_f32_16x16x32_bf16 v[96:99], v[192:195], v[228:231], v[96:99]
    ds_read_b128 v[240:243], v13 offset:2048
    v_mfma_f32_16x16x32_bf16 v[128:131], v[192:195], v[224:227], v[128:131]
    ds_read_b128 v[244:247], v13 offset:4096
    v_mfma_f32_16x16x32_bf16 v[64:67], v[192:195], v[220:223], v[64:67]
    ds_read_b128 v[248:251], v13 offset:6144
    v_mfma_f32_16x16x32_bf16 v[68:71], v[196:199], v[220:223], v[68:71]
    ds_read_b128 v[192:195], v11 offset:2048
    v_mfma_f32_16x16x32_bf16 v[132:135], v[196:199], v[224:227], v[132:135]
    v_sub_f32 v39, 0, v25
    v_mfma_f32_16x16x32_bf16 v[100:103], v[196:199], v[228:231], v[100:103]
    v_mov_b32 v31, v24
    v_mfma_f32_16x16x32_bf16 v[164:167], v[196:199], v[232:235], v[164:167]
    ds_read_b128 v[196:199], v11 offset:4096
    v_mfma_f32_16x16x32_bf16 v[168:171], v[200:203], v[232:235], v[168:171]
    v_mov_b32 v32, v25
    v_mfma_f32_16x16x32_bf16 v[104:107], v[200:203], v[228:231], v[104:107]
    v_mul_f32 v3, v32, v32
    v_mfma_f32_16x16x32_bf16 v[136:139], v[200:203], v[224:227], v[136:139]
    v_mul_f32 v32, v31, v32
    v_mfma_f32_16x16x32_bf16 v[72:75], v[200:203], v[220:223], v[72:75]
    ds_read_b128 v[200:203], v11 offset:6144
    v_mfma_f32_16x16x32_bf16 v[76:79], v[204:207], v[220:223], v[76:79]
    v_fma_f32 v31, v31, v31, -v3
    v_mfma_f32_16x16x32_bf16 v[140:143], v[204:207], v[224:227], v[140:143]
    v_add_f32 v32, v32, v32
    v_mfma_f32_16x16x32_bf16 v[108:111], v[204:207], v[228:231], v[108:111]
    v_mul_f32 v3, v32, v32
    v_mfma_f32_16x16x32_bf16 v[172:175], v[204:207], v[232:235], v[172:175]
    ds_read_b128 v[204:207], v11 offset:8192
    v_mfma_f32_16x16x32_bf16 v[176:179], v[208:211], v[232:235], v[176:179]
    v_mul_f32 v32, v31, v32
    v_mfma_f32_16x16x32_bf16 v[112:115], v[208:211], v[228:231], v[112:115]
    v_fma_f32 v31, v31, v31, -v3
    v_mfma_f32_16x16x32_bf16 v[144:147], v[208:211], v[224:227], v[144:147]
    v_add_f32 v32, v32, v32
    v_mfma_f32_16x16x32_bf16 v[80:83], v[208:211], v[220:223], v[80:83]
    s_waitcnt lgkmcnt(1)
    v_mfma_f32_16x16x32_bf16 v[84:87], v[212:215], v[220:223], v[84:87]
    ds_read_b128 v[208:211], v11 offset:10240
    v_mfma_f32_16x16x32_bf16 v[148:151], v[212:215], v[224:227], v[148:151]
    v_mul_f32 v3, v32, v32
    v_mfma_f32_16x16x32_bf16 v[116:119], v[212:215], v[228:231], v[116:119]
    v_mul_f32 v32, v31, v32
    v_mfma_f32_16x16x32_bf16 v[180:183], v[212:215], v[232:235], v[180:183]
    ds_read_b128 v[212:215], v11 offset:12288
    v_mfma_f32_16x16x32_bf16 v[184:187], v[216:219], v[232:235], v[184:187]
    v_fma_f32 v31, v31, v31, -v3
    v_mfma_f32_16x16x32_bf16 v[120:123], v[216:219], v[228:231], v[120:123]
    v_add_f32 v32, v32, v32
    v_mfma_f32_16x16x32_bf16 v[152:155], v[216:219], v[224:227], v[152:155]
    v_mul_f32 v3, v32, v32
    v_mfma_f32_16x16x32_bf16 v[88:91], v[216:219], v[220:223], v[88:91]
    ds_read_b128 v[216:219], v11 offset:14336
    v_mfma_f32_16x16x32_bf16 v[60:63], v[188:191], v[236:239], v[60:63]
    v_mul_f32 v32, v31, v32
    v_mfma_f32_16x16x32_bf16 v[124:127], v[188:191], v[240:243], v[124:127]
    v_fma_f32 v31, v31, v31, -v3
    v_mfma_f32_16x16x32_bf16 v[92:95], v[188:191], v[244:247], v[92:95]
    v_add_f32 v32, v32, v32
    v_mfma_f32_16x16x32_bf16 v[156:159], v[188:191], v[248:251], v[156:159]
    v_mul_f32 v3, v32, v32
    v_mfma_f32_16x16x32_bf16 v[160:163], v[192:195], v[248:251], v[160:163]
    v_mul_f32 v32, v31, v32
    v_mfma_f32_16x16x32_bf16 v[96:99], v[192:195], v[244:247], v[96:99]
    v_fma_f32 v31, v31, v31, -v3
    v_mfma_f32_16x16x32_bf16 v[128:131], v[192:195], v[240:243], v[128:131]
    v_add_f32 v32, v32, v32
    v_mfma_f32_16x16x32_bf16 v[64:67], v[192:195], v[236:239], v[64:67]
    v_mov_b32 v33, v31
    v_mfma_f32_16x16x32_bf16 v[68:71], v[196:199], v[236:239], v[68:71]
    v_mov_b32 v34, v32
    v_mfma_f32_16x16x32_bf16 v[132:135], v[196:199], v[240:243], v[132:135]
    v_mul_f32 v3, v34, v34
    v_mfma_f32_16x16x32_bf16 v[100:103], v[196:199], v[244:247], v[100:103]
    v_mul_f32 v34, v33, v34
    v_mfma_f32_16x16x32_bf16 v[164:167], v[196:199], v[248:251], v[164:167]
    s_waitcnt lgkmcnt(0)
    s_barrier
    v_mfma_f32_16x16x32_bf16 v[168:171], v[200:203], v[248:251], v[168:171]
    ds_read_b128 v[188:191], v10 offset:16384
    v_mfma_f32_16x16x32_bf16 v[104:107], v[200:203], v[244:247], v[104:107]
    ds_read_b128 v[220:223], v12 offset:16384
    v_mfma_f32_16x16x32_bf16 v[136:139], v[200:203], v[240:243], v[136:139]
    ds_read_b128 v[224:227], v12 offset:18432
    v_mfma_f32_16x16x32_bf16 v[72:75], v[200:203], v[236:239], v[72:75]
    ds_read_b128 v[228:231], v12 offset:20480
    v_mfma_f32_16x16x32_bf16 v[76:79], v[204:207], v[236:239], v[76:79]
    ds_read_b128 v[232:235], v12 offset:22528
    v_mfma_f32_16x16x32_bf16 v[140:143], v[204:207], v[240:243], v[140:143]
    ds_read_b128 v[192:195], v10 offset:18432
    v_mfma_f32_16x16x32_bf16 v[108:111], v[204:207], v[244:247], v[108:111]
    ds_read_b128 v[196:199], v10 offset:20480
    v_mfma_f32_16x16x32_bf16 v[172:175], v[204:207], v[248:251], v[172:175]
    ds_read_b128 v[200:203], v10 offset:22528
    v_mfma_f32_16x16x32_bf16 v[176:179], v[208:211], v[248:251], v[176:179]
    ds_read_b128 v[204:207], v10 offset:24576
    v_mfma_f32_16x16x32_bf16 v[112:115], v[208:211], v[244:247], v[112:115]
    v_fma_f32 v33, v33, v33, -v3
    v_mfma_f32_16x16x32_bf16 v[144:147], v[208:211], v[240:243], v[144:147]
    v_add_f32 v34, v34, v34
    v_mfma_f32_16x16x32_bf16 v[80:83], v[208:211], v[236:239], v[80:83]
    ds_read_b128 v[208:211], v10 offset:26624
    v_mfma_f32_16x16x32_bf16 v[84:87], v[212:215], v[236:239], v[84:87]
    v_mov_b32 v35, v33
    v_mfma_f32_16x16x32_bf16 v[148:151], v[212:215], v[240:243], v[148:151]
    v_mov_b32 v36, v34
    v_mfma_f32_16x16x32_bf16 v[116:119], v[212:215], v[244:247], v[116:119]
    v_mul_f32 v3, v36, v36
    v_mfma_f32_16x16x32_bf16 v[180:183], v[212:215], v[248:251], v[180:183]
    ds_read_b128 v[212:215], v10 offset:28672
    v_mfma_f32_16x16x32_bf16 v[184:187], v[216:219], v[248:251], v[184:187]
    v_mul_f32 v36, v35, v36
    v_mfma_f32_16x16x32_bf16 v[120:123], v[216:219], v[244:247], v[120:123]
    v_fma_f32 v35, v35, v35, -v3
    v_mfma_f32_16x16x32_bf16 v[152:155], v[216:219], v[240:243], v[152:155]
    v_add_f32 v36, v36, v36
    v_mfma_f32_16x16x32_bf16 v[88:91], v[216:219], v[236:239], v[88:91]
    s_waitcnt lgkmcnt(1)
    v_mfma_f32_16x16x32_bf16 v[60:63], v[188:191], v[220:223], v[60:63]
    ds_read_b128 v[216:219], v10 offset:30720
    v_mfma_f32_16x16x32_bf16 v[124:127], v[188:191], v[224:227], v[124:127]
    v_mul_f32 v3, v36, v36
    v_mfma_f32_16x16x32_bf16 v[92:95], v[188:191], v[228:231], v[92:95]
    v_mul_f32 v36, v35, v36
    v_mfma_f32_16x16x32_bf16 v[156:159], v[188:191], v[232:235], v[156:159]
    ds_read_b128 v[188:191], v11 offset:16384
    v_mfma_f32_16x16x32_bf16 v[160:163], v[192:195], v[232:235], v[160:163]
    ds_read_b128 v[236:239], v13 offset:16384
    v_mfma_f32_16x16x32_bf16 v[96:99], v[192:195], v[228:231], v[96:99]
    ds_read_b128 v[240:243], v13 offset:18432
    v_mfma_f32_16x16x32_bf16 v[128:131], v[192:195], v[224:227], v[128:131]
    ds_read_b128 v[244:247], v13 offset:20480
    v_mfma_f32_16x16x32_bf16 v[64:67], v[192:195], v[220:223], v[64:67]
    ds_read_b128 v[248:251], v13 offset:22528
    v_mfma_f32_16x16x32_bf16 v[68:71], v[196:199], v[220:223], v[68:71]
    ds_read_b128 v[192:195], v11 offset:18432
    v_mfma_f32_16x16x32_bf16 v[132:135], v[196:199], v[224:227], v[132:135]
    v_fma_f32 v35, v35, v35, -v3
    v_mfma_f32_16x16x32_bf16 v[100:103], v[196:199], v[228:231], v[100:103]
    v_add_f32 v36, v36, v36
    v_mfma_f32_16x16x32_bf16 v[164:167], v[196:199], v[232:235], v[164:167]
    ds_read_b128 v[196:199], v11 offset:20480
    v_mfma_f32_16x16x32_bf16 v[168:171], v[200:203], v[232:235], v[168:171]
    v_mov_b32 v37, v35
    v_mfma_f32_16x16x32_bf16 v[104:107], v[200:203], v[228:231], v[104:107]
    v_mov_b32 v38, v36
    v_mfma_f32_16x16x32_bf16 v[136:139], v[200:203], v[224:227], v[136:139]
    v_mul_f32 v3, v38, v38
    v_mfma_f32_16x16x32_bf16 v[72:75], v[200:203], v[220:223], v[72:75]
    ds_read_b128 v[200:203], v11 offset:22528
    v_mfma_f32_16x16x32_bf16 v[76:79], v[204:207], v[220:223], v[76:79]
    v_mul_f32 v38, v37, v38
    v_mfma_f32_16x16x32_bf16 v[140:143], v[204:207], v[224:227], v[140:143]
    v_fma_f32 v37, v37, v37, -v3
    v_mfma_f32_16x16x32_bf16 v[108:111], v[204:207], v[228:231], v[108:111]
    v_add_f32 v38, v38, v38
    v_mfma_f32_16x16x32_bf16 v[172:175], v[204:207], v[232:235], v[172:175]
    ds_read_b128 v[204:207], v11 offset:24576
    v_mfma_f32_16x16x32_bf16 v[176:179], v[208:211], v[232:235], v[176:179]
    s_add_u32 s12, s68, 0xc40000
    v_mfma_f32_16x16x32_bf16 v[112:115], v[208:211], v[228:231], v[112:115]
    s_addc_u32 s13, s69, 0
    v_mfma_f32_16x16x32_bf16 v[144:147], v[208:211], v[224:227], v[144:147]
    s_mov_b32 s14, 0x20000
    v_mfma_f32_16x16x32_bf16 v[80:83], v[208:211], v[220:223], v[80:83]
    s_waitcnt lgkmcnt(1)
    v_mfma_f32_16x16x32_bf16 v[84:87], v[212:215], v[220:223], v[84:87]
    ds_read_b128 v[208:211], v11 offset:26624
    v_mfma_f32_16x16x32_bf16 v[148:151], v[212:215], v[224:227], v[148:151]
    s_mov_b32 s15, 0x20000
    v_mfma_f32_16x16x32_bf16 v[116:119], v[212:215], v[228:231], v[116:119]
    s_mov_b32 s24, s64
    v_mfma_f32_16x16x32_bf16 v[180:183], v[212:215], v[232:235], v[180:183]
    ds_read_b128 v[212:215], v11 offset:28672
    v_mfma_f32_16x16x32_bf16 v[184:187], v[216:219], v[232:235], v[184:187]
    s_mov_b32 s25, s65
    v_mfma_f32_16x16x32_bf16 v[120:123], v[216:219], v[228:231], v[120:123]
    s_mov_b32 s26, 0x1000000
    v_mfma_f32_16x16x32_bf16 v[152:155], v[216:219], v[224:227], v[152:155]
    s_mov_b32 s27, 0x20000
    v_mfma_f32_16x16x32_bf16 v[88:91], v[216:219], v[220:223], v[88:91]
    ds_read_b128 v[216:219], v11 offset:30720
    v_mfma_f32_16x16x32_bf16 v[60:63], v[188:191], v[236:239], v[60:63]
    v_lshrrev_b32 v3, 4, v0
    v_mfma_f32_16x16x32_bf16 v[124:127], v[188:191], v[240:243], v[124:127]
    v_lshlrev_b32 v3, 1, v3
    v_mfma_f32_16x16x32_bf16 v[92:95], v[188:191], v[244:247], v[92:95]
    v_and_b32 v4, 7, v0
    v_mfma_f32_16x16x32_bf16 v[156:159], v[188:191], v[248:251], v[156:159]
    v_xor_b32 v3, v3, v4
    v_mfma_f32_16x16x32_bf16 v[160:163], v[192:195], v[248:251], v[160:163]
    v_lshrrev_b32 v4, 3, v0
    v_mfma_f32_16x16x32_bf16 v[96:99], v[192:195], v[244:247], v[96:99]
    v_lshlrev_b32 v4, 11, v4
    v_mfma_f32_16x16x32_bf16 v[128:131], v[192:195], v[240:243], v[128:131]
    v_lshl_add_u32 v3, v3, 4, v4
    v_mfma_f32_16x16x32_bf16 v[64:67], v[192:195], v[236:239], v[64:67]
    s_lshl_b32 s72, s6, 15
    v_mfma_f32_16x16x32_bf16 v[68:71], v[196:199], v[236:239], v[68:71]
    s_lshl_b32 s73, s5, 8
    v_mfma_f32_16x16x32_bf16 v[132:135], v[196:199], v[240:243], v[132:135]
    s_add_u32 s72, s72, s73
    v_mfma_f32_16x16x32_bf16 v[100:103], v[196:199], v[244:247], v[100:103]
    v_add_u32 v16, s72, v3
    v_mfma_f32_16x16x32_bf16 v[164:167], v[196:199], v[248:251], v[164:167]
    s_waitcnt lgkmcnt(0)
    s_barrier
    v_mfma_f32_16x16x32_bf16 v[168:171], v[200:203], v[248:251], v[168:171]
    ds_read_b128 v[188:191], v10 offset:32768
    v_mfma_f32_16x16x32_bf16 v[104:107], v[200:203], v[244:247], v[104:107]
    ds_read_b128 v[220:223], v12 offset:49152
    v_mfma_f32_16x16x32_bf16 v[136:139], v[200:203], v[240:243], v[136:139]
    ds_read_b128 v[224:227], v12 offset:51200
    v_mfma_f32_16x16x32_bf16 v[72:75], v[200:203], v[236:239], v[72:75]
    ds_read_b128 v[228:231], v12 offset:53248
    v_mfma_f32_16x16x32_bf16 v[76:79], v[204:207], v[236:239], v[76:79]
    ds_read_b128 v[232:235], v12 offset:55296
    v_mfma_f32_16x16x32_bf16 v[140:143], v[204:207], v[240:243], v[140:143]
    ds_read_b128 v[192:195], v10 offset:34816
    v_mfma_f32_16x16x32_bf16 v[108:111], v[204:207], v[244:247], v[108:111]
    ds_read_b128 v[196:199], v10 offset:36864
    v_mfma_f32_16x16x32_bf16 v[172:175], v[204:207], v[248:251], v[172:175]
    ds_read_b128 v[200:203], v10 offset:38912
    v_mfma_f32_16x16x32_bf16 v[176:179], v[208:211], v[248:251], v[176:179]
    ds_read_b128 v[204:207], v10 offset:40960
    v_mfma_f32_16x16x32_bf16 v[112:115], v[208:211], v[244:247], v[112:115]
    v_add_u32 v17, 0x3c00, v16
    v_mfma_f32_16x16x32_bf16 v[144:147], v[208:211], v[240:243], v[144:147]
    s_lshl_b32 s72, s4, 2
    v_mfma_f32_16x16x32_bf16 v[80:83], v[208:211], v[236:239], v[80:83]
    ds_read_b128 v[208:211], v10 offset:43008
    v_mfma_f32_16x16x32_bf16 v[84:87], v[212:215], v[236:239], v[84:87]
    s_add_u32 s72, s72, s6
    v_mfma_f32_16x16x32_bf16 v[148:151], v[212:215], v[240:243], v[148:151]
    s_lshl_b32 s85, s72, 16
    v_mfma_f32_16x16x32_bf16 v[116:119], v[212:215], v[244:247], v[116:119]
    s_mov_b32 s20, s62
    v_mfma_f32_16x16x32_bf16 v[180:183], v[212:215], v[248:251], v[180:183]
    ds_read_b128 v[212:215], v10 offset:45056
    v_mfma_f32_16x16x32_bf16 v[184:187], v[216:219], v[248:251], v[184:187]
    s_mov_b32 s21, s63
    v_mfma_f32_16x16x32_bf16 v[120:123], v[216:219], v[244:247], v[120:123]
    s_mov_b32 s22, 0x200000
    v_mfma_f32_16x16x32_bf16 v[152:155], v[216:219], v[240:243], v[152:155]
    s_mov_b32 s23, 0x20000
    v_mfma_f32_16x16x32_bf16 v[88:91], v[216:219], v[236:239], v[88:91]
    s_waitcnt lgkmcnt(1)
    v_mfma_f32_16x16x32_bf16 v[60:63], v[188:191], v[220:223], v[60:63]
    ds_read_b128 v[216:219], v10 offset:47104
    v_mfma_f32_16x16x32_bf16 v[124:127], v[188:191], v[224:227], v[124:127]
    s_lshl_b32 s70, s77, 10
    v_mfma_f32_16x16x32_bf16 v[92:95], v[188:191], v[228:231], v[92:95]
    s_add_u32 s70, s70, 65536
    v_mfma_f32_16x16x32_bf16 v[156:159], v[188:191], v[232:235], v[156:159]
    ds_read_b128 v[188:191], v11 offset:32768
    v_mfma_f32_16x16x32_bf16 v[160:163], v[192:195], v[232:235], v[160:163]
    ds_read_b128 v[236:239], v13 offset:49152
    v_mfma_f32_16x16x32_bf16 v[96:99], v[192:195], v[228:231], v[96:99]
    ds_read_b128 v[240:243], v13 offset:51200
    v_mfma_f32_16x16x32_bf16 v[128:131], v[192:195], v[224:227], v[128:131]
    ds_read_b128 v[244:247], v13 offset:53248
    v_mfma_f32_16x16x32_bf16 v[64:67], v[192:195], v[220:223], v[64:67]
    ds_read_b128 v[248:251], v13 offset:55296
    v_mfma_f32_16x16x32_bf16 v[68:71], v[196:199], v[220:223], v[68:71]
    ds_read_b128 v[192:195], v11 offset:34816
    v_mfma_f32_16x16x32_bf16 v[132:135], v[196:199], v[224:227], v[132:135]
    v_lshl_add_u32 v18, v1, 3, s70
    v_mfma_f32_16x16x32_bf16 v[100:103], v[196:199], v[228:231], v[100:103]
    s_lshl_b32 s70, s79, 1
    v_mfma_f32_16x16x32_bf16 v[164:167], v[196:199], v[232:235], v[164:167]
    ds_read_b128 v[196:199], v11 offset:36864
    v_mfma_f32_16x16x32_bf16 v[168:171], v[200:203], v[232:235], v[168:171]
    s_add_u32 s70, s70, s76
    v_mfma_f32_16x16x32_bf16 v[104:107], v[200:203], v[228:231], v[104:107]
    s_lshl_b32 s70, s70, 9
    v_mfma_f32_16x16x32_bf16 v[136:139], v[200:203], v[224:227], v[136:139]
    s_lshl_b32 s71, s80, 3
    v_mfma_f32_16x16x32_bf16 v[72:75], v[200:203], v[220:223], v[72:75]
    ds_read_b128 v[200:203], v11 offset:38912
    v_mfma_f32_16x16x32_bf16 v[76:79], v[204:207], v[220:223], v[76:79]
    s_add_u32 s70, s70, s71
    v_mfma_f32_16x16x32_bf16 v[140:143], v[204:207], v[224:227], v[140:143]
    s_lshl_b32 s71, s77, 1
    v_mfma_f32_16x16x32_bf16 v[108:111], v[204:207], v[228:231], v[108:111]
    s_add_u32 s70, s70, s71
    v_mfma_f32_16x16x32_bf16 v[172:175], v[204:207], v[232:235], v[172:175]
    ds_read_b128 v[204:207], v11 offset:40960
    v_mfma_f32_16x16x32_bf16 v[176:179], v[208:211], v[232:235], v[176:179]
    s_lshl_b32 s70, s70, 10
    v_mfma_f32_16x16x32_bf16 v[112:115], v[208:211], v[228:231], v[112:115]
    s_add_u32 s84, s70, 0x400000
    v_mfma_f32_16x16x32_bf16 v[144:147], v[208:211], v[224:227], v[144:147]
    s_lshl_b32 s71, s76, 9
    v_mfma_f32_16x16x32_bf16 v[80:83], v[208:211], v[220:223], v[80:83]
    s_waitcnt lgkmcnt(1)
    v_mfma_f32_16x16x32_bf16 v[84:87], v[212:215], v[220:223], v[84:87]
    ds_read_b128 v[208:211], v11 offset:43008
    v_mfma_f32_16x16x32_bf16 v[148:151], v[212:215], v[224:227], v[148:151]
    v_lshl_add_u32 v6, v2, 8, v18
    v_mfma_f32_16x16x32_bf16 v[116:119], v[212:215], v[228:231], v[116:119]
    v_add_u32 v6, s71, v6
    v_mfma_f32_16x16x32_bf16 v[180:183], v[212:215], v[232:235], v[180:183]
    ds_read_b128 v[212:215], v11 offset:45056
    v_mfma_f32_16x16x32_bf16 v[184:187], v[216:219], v[232:235], v[184:187]
    v_mov_b32 v5, 0
    v_mfma_f32_16x16x32_bf16 v[120:123], v[216:219], v[228:231], v[120:123]
    v_mfma_f32_16x16x32_bf16 v[152:155], v[216:219], v[224:227], v[152:155]
    v_mfma_f32_16x16x32_bf16 v[88:91], v[216:219], v[220:223], v[88:91]
    ds_read_b128 v[216:219], v11 offset:47104
    v_mfma_f32_16x16x32_bf16 v[60:63], v[188:191], v[236:239], v[60:63]
    v_mfma_f32_16x16x32_bf16 v[124:127], v[188:191], v[240:243], v[124:127]
    v_mfma_f32_16x16x32_bf16 v[92:95], v[188:191], v[244:247], v[92:95]
    v_mfma_f32_16x16x32_bf16 v[156:159], v[188:191], v[248:251], v[156:159]
    v_mfma_f32_16x16x32_bf16 v[160:163], v[192:195], v[248:251], v[160:163]
    v_mfma_f32_16x16x32_bf16 v[96:99], v[192:195], v[244:247], v[96:99]
    v_mfma_f32_16x16x32_bf16 v[128:131], v[192:195], v[240:243], v[128:131]
    v_mfma_f32_16x16x32_bf16 v[64:67], v[192:195], v[236:239], v[64:67]
    v_mfma_f32_16x16x32_bf16 v[68:71], v[196:199], v[236:239], v[68:71]
    v_mfma_f32_16x16x32_bf16 v[132:135], v[196:199], v[240:243], v[132:135]
    v_mfma_f32_16x16x32_bf16 v[100:103], v[196:199], v[244:247], v[100:103]
    v_mfma_f32_16x16x32_bf16 v[164:167], v[196:199], v[248:251], v[164:167]
    s_waitcnt lgkmcnt(0)
    s_barrier
    v_mfma_f32_16x16x32_bf16 v[168:171], v[200:203], v[248:251], v[168:171]
    ds_read_b128 v[188:191], v10 offset:0
    v_mfma_f32_16x16x32_bf16 v[104:107], v[200:203], v[244:247], v[104:107]
    ds_read_b128 v[220:223], v12 offset:0
    v_mfma_f32_16x16x32_bf16 v[136:139], v[200:203], v[240:243], v[136:139]
    ds_read_b128 v[224:227], v12 offset:2048
    v_mfma_f32_16x16x32_bf16 v[72:75], v[200:203], v[236:239], v[72:75]
    ds_read_b128 v[228:231], v12 offset:4096
    v_mfma_f32_16x16x32_bf16 v[76:79], v[204:207], v[236:239], v[76:79]
    ds_read_b128 v[232:235], v12 offset:6144
    v_mfma_f32_16x16x32_bf16 v[140:143], v[204:207], v[240:243], v[140:143]
    ds_read_b128 v[192:195], v10 offset:2048
    v_mfma_f32_16x16x32_bf16 v[108:111], v[204:207], v[244:247], v[108:111]
    ds_read_b128 v[196:199], v10 offset:4096
    v_mfma_f32_16x16x32_bf16 v[172:175], v[204:207], v[248:251], v[172:175]
    ds_read_b128 v[200:203], v10 offset:6144
    v_mfma_f32_16x16x32_bf16 v[176:179], v[208:211], v[248:251], v[176:179]
    ds_read_b128 v[204:207], v10 offset:8192
    v_mfma_f32_16x16x32_bf16 v[112:115], v[208:211], v[244:247], v[112:115]
    v_mfma_f32_16x16x32_bf16 v[144:147], v[208:211], v[240:243], v[144:147]
    v_mfma_f32_16x16x32_bf16 v[80:83], v[208:211], v[236:239], v[80:83]
    ds_read_b128 v[208:211], v10 offset:10240
    v_mfma_f32_16x16x32_bf16 v[84:87], v[212:215], v[236:239], v[84:87]
    v_mfma_f32_16x16x32_bf16 v[148:151], v[212:215], v[240:243], v[148:151]
    v_mfma_f32_16x16x32_bf16 v[116:119], v[212:215], v[244:247], v[116:119]
    v_mfma_f32_16x16x32_bf16 v[180:183], v[212:215], v[248:251], v[180:183]
    ds_read_b128 v[212:215], v10 offset:12288
    v_mfma_f32_16x16x32_bf16 v[184:187], v[216:219], v[248:251], v[184:187]
    v_mfma_f32_16x16x32_bf16 v[120:123], v[216:219], v[244:247], v[120:123]
    v_mfma_f32_16x16x32_bf16 v[152:155], v[216:219], v[240:243], v[152:155]
    v_mfma_f32_16x16x32_bf16 v[88:91], v[216:219], v[236:239], v[88:91]
    s_waitcnt lgkmcnt(1)
    v_mfma_f32_16x16x32_bf16 v[60:63], v[188:191], v[220:223], v[60:63]
    ds_read_b128 v[216:219], v10 offset:14336
    v_mfma_f32_16x16x32_bf16 v[124:127], v[188:191], v[224:227], v[124:127]
    v_mfma_f32_16x16x32_bf16 v[92:95], v[188:191], v[228:231], v[92:95]
    v_mfma_f32_16x16x32_bf16 v[156:159], v[188:191], v[232:235], v[156:159]
    ds_read_b128 v[188:191], v11 offset:0
    v_mfma_f32_16x16x32_bf16 v[160:163], v[192:195], v[232:235], v[160:163]
    ds_read_b128 v[236:239], v13 offset:0
    v_mfma_f32_16x16x32_bf16 v[96:99], v[192:195], v[228:231], v[96:99]
    ds_read_b128 v[240:243], v13 offset:2048
    v_mfma_f32_16x16x32_bf16 v[128:131], v[192:195], v[224:227], v[128:131]
    ds_read_b128 v[244:247], v13 offset:4096
    v_mfma_f32_16x16x32_bf16 v[64:67], v[192:195], v[220:223], v[64:67]
    ds_read_b128 v[248:251], v13 offset:6144
    v_mfma_f32_16x16x32_bf16 v[68:71], v[196:199], v[220:223], v[68:71]
    ds_read_b128 v[192:195], v11 offset:2048
    v_mfma_f32_16x16x32_bf16 v[132:135], v[196:199], v[224:227], v[132:135]
    v_mfma_f32_16x16x32_bf16 v[100:103], v[196:199], v[228:231], v[100:103]
    v_mfma_f32_16x16x32_bf16 v[164:167], v[196:199], v[232:235], v[164:167]
    ds_read_b128 v[196:199], v11 offset:4096
    v_mfma_f32_16x16x32_bf16 v[168:171], v[200:203], v[232:235], v[168:171]
    v_mfma_f32_16x16x32_bf16 v[104:107], v[200:203], v[228:231], v[104:107]
    v_mfma_f32_16x16x32_bf16 v[136:139], v[200:203], v[224:227], v[136:139]
    v_mfma_f32_16x16x32_bf16 v[72:75], v[200:203], v[220:223], v[72:75]
    ds_read_b128 v[200:203], v11 offset:6144
    v_mfma_f32_16x16x32_bf16 v[76:79], v[204:207], v[220:223], v[76:79]
    v_mfma_f32_16x16x32_bf16 v[140:143], v[204:207], v[224:227], v[140:143]
    v_mfma_f32_16x16x32_bf16 v[108:111], v[204:207], v[228:231], v[108:111]
    v_mfma_f32_16x16x32_bf16 v[172:175], v[204:207], v[232:235], v[172:175]
    ds_read_b128 v[204:207], v11 offset:8192
    v_mfma_f32_16x16x32_bf16 v[176:179], v[208:211], v[232:235], v[176:179]
    v_mfma_f32_16x16x32_bf16 v[112:115], v[208:211], v[228:231], v[112:115]
    v_mfma_f32_16x16x32_bf16 v[144:147], v[208:211], v[224:227], v[144:147]
    v_mfma_f32_16x16x32_bf16 v[80:83], v[208:211], v[220:223], v[80:83]
    s_waitcnt lgkmcnt(1)
    v_mfma_f32_16x16x32_bf16 v[84:87], v[212:215], v[220:223], v[84:87]
    ds_read_b128 v[208:211], v11 offset:10240
    v_mfma_f32_16x16x32_bf16 v[148:151], v[212:215], v[224:227], v[148:151]
    v_mfma_f32_16x16x32_bf16 v[116:119], v[212:215], v[228:231], v[116:119]
    v_mfma_f32_16x16x32_bf16 v[180:183], v[212:215], v[232:235], v[180:183]
    ds_read_b128 v[212:215], v11 offset:12288
    v_mfma_f32_16x16x32_bf16 v[184:187], v[216:219], v[232:235], v[184:187]
    v_mfma_f32_16x16x32_bf16 v[120:123], v[216:219], v[228:231], v[120:123]
    v_mfma_f32_16x16x32_bf16 v[152:155], v[216:219], v[224:227], v[152:155]
    v_mfma_f32_16x16x32_bf16 v[88:91], v[216:219], v[220:223], v[88:91]
    ds_read_b128 v[216:219], v11 offset:14336
    v_mfma_f32_16x16x32_bf16 v[60:63], v[188:191], v[236:239], v[60:63]
    v_mfma_f32_16x16x32_bf16 v[124:127], v[188:191], v[240:243], v[124:127]
    v_mfma_f32_16x16x32_bf16 v[92:95], v[188:191], v[244:247], v[92:95]
    v_mfma_f32_16x16x32_bf16 v[156:159], v[188:191], v[248:251], v[156:159]
    v_mfma_f32_16x16x32_bf16 v[160:163], v[192:195], v[248:251], v[160:163]
    v_mfma_f32_16x16x32_bf16 v[96:99], v[192:195], v[244:247], v[96:99]
    v_mfma_f32_16x16x32_bf16 v[128:131], v[192:195], v[240:243], v[128:131]
    v_mfma_f32_16x16x32_bf16 v[64:67], v[192:195], v[236:239], v[64:67]
    v_mfma_f32_16x16x32_bf16 v[68:71], v[196:199], v[236:239], v[68:71]
    v_mfma_f32_16x16x32_bf16 v[132:135], v[196:199], v[240:243], v[132:135]
    v_mfma_f32_16x16x32_bf16 v[100:103], v[196:199], v[244:247], v[100:103]
    v_mfma_f32_16x16x32_bf16 v[164:167], v[196:199], v[248:251], v[164:167]
    s_waitcnt lgkmcnt(0)
    s_barrier
    v_mfma_f32_16x16x32_bf16 v[168:171], v[200:203], v[248:251], v[168:171]
    ds_read_b128 v[188:191], v10 offset:16384
    v_mfma_f32_16x16x32_bf16 v[104:107], v[200:203], v[244:247], v[104:107]
L_pad_8:
    s_cbranch_execz L_ret_x1
    ds_read_b128 v[220:223], v12 offset:16384
    v_mfma_f32_16x16x32_bf16 v[136:139], v[200:203], v[240:243], v[136:139]
    ds_read_b128 v[224:227], v12 offset:18432
    v_mfma_f32_16x16x32_bf16 v[72:75], v[200:203], v[236:239], v[72:75]
    ds_read_b128 v[228:231], v12 offset:20480
    v_mfma_f32_16x16x32_bf16 v[76:79], v[204:207], v[236:239], v[76:79]
    ds_read_b128 v[232:235], v12 offset:22528
    v_mfma_f32_16x16x32_bf16 v[140:143], v[204:207], v[240:243], v[140:143]
    ds_read_b128 v[192:195], v10 offset:18432
    v_mfma_f32_16x16x32_bf16 v[108:111], v[204:207], v[244:247], v[108:111]
    ds_read_b128 v[196:199], v10 offset:20480
    v_mfma_f32_16x16x32_bf16 v[172:175], v[204:207], v[248:251], v[172:175]
    ds_read_b128 v[200:203], v10 offset:22528
    v_mfma_f32_16x16x32_bf16 v[176:179], v[208:211], v[248:251], v[176:179]
    ds_read_b128 v[204:207], v10 offset:24576
    v_mfma_f32_16x16x32_bf16 v[112:115], v[208:211], v[244:247], v[112:115]
    v_mfma_f32_16x16x32_bf16 v[144:147], v[208:211], v[240:243], v[144:147]
    v_mfma_f32_16x16x32_bf16 v[80:83], v[208:211], v[236:239], v[80:83]
    ds_read_b128 v[208:211], v10 offset:26624
    v_mfma_f32_16x16x32_bf16 v[84:87], v[212:215], v[236:239], v[84:87]
    v_mfma_f32_16x16x32_bf16 v[148:151], v[212:215], v[240:243], v[148:151]
    v_mfma_f32_16x16x32_bf16 v[116:119], v[212:215], v[244:247], v[116:119]
    v_mfma_f32_16x16x32_bf16 v[180:183], v[212:215], v[248:251], v[180:183]
    ds_read_b128 v[212:215], v10 offset:28672
    v_mfma_f32_16x16x32_bf16 v[184:187], v[216:219], v[248:251], v[184:187]
    v_mfma_f32_16x16x32_bf16 v[120:123], v[216:219], v[244:247], v[120:123]
    v_mfma_f32_16x16x32_bf16 v[152:155], v[216:219], v[240:243], v[152:155]
    v_mfma_f32_16x16x32_bf16 v[88:91], v[216:219], v[236:239], v[88:91]
    s_waitcnt lgkmcnt(1)
    v_mfma_f32_16x16x32_bf16 v[60:63], v[188:191], v[220:223], v[60:63]
    ds_read_b128 v[216:219], v10 offset:30720
    v_mfma_f32_16x16x32_bf16 v[124:127], v[188:191], v[224:227], v[124:127]
    v_mfma_f32_16x16x32_bf16 v[92:95], v[188:191], v[228:231], v[92:95]
    v_mfma_f32_16x16x32_bf16 v[156:159], v[188:191], v[232:235], v[156:159]
    ds_read_b128 v[188:191], v11 offset:16384
    v_mfma_f32_16x16x32_bf16 v[160:163], v[192:195], v[232:235], v[160:163]
    ds_read_b128 v[236:239], v13 offset:16384
    v_mfma_f32_16x16x32_bf16 v[96:99], v[192:195], v[228:231], v[96:99]
    ds_read_b128 v[240:243], v13 offset:18432
    v_mfma_f32_16x16x32_bf16 v[128:131], v[192:195], v[224:227], v[128:131]
    ds_read_b128 v[244:247], v13 offset:20480
    v_mfma_f32_16x16x32_bf16 v[64:67], v[192:195], v[220:223], v[64:67]
    ds_read_b128 v[248:251], v13 offset:22528
    v_mfma_f32_16x16x32_bf16 v[68:71], v[196:199], v[220:223], v[68:71]
    ds_read_b128 v[192:195], v11 offset:18432
    v_mfma_f32_16x16x32_bf16 v[132:135], v[196:199], v[224:227], v[132:135]
    v_mfma_f32_16x16x32_bf16 v[100:103], v[196:199], v[228:231], v[100:103]
    v_mfma_f32_16x16x32_bf16 v[164:167], v[196:199], v[232:235], v[164:167]
    ds_read_b128 v[196:199], v11 offset:20480
    v_mfma_f32_16x16x32_bf16 v[168:171], v[200:203], v[232:235], v[168:171]
    v_mfma_f32_16x16x32_bf16 v[104:107], v[200:203], v[228:231], v[104:107]
    v_mfma_f32_16x16x32_bf16 v[136:139], v[200:203], v[224:227], v[136:139]
    v_mfma_f32_16x16x32_bf16 v[72:75], v[200:203], v[220:223], v[72:75]
    ds_read_b128 v[200:203], v11 offset:22528
    v_mfma_f32_16x16x32_bf16 v[76:79], v[204:207], v[220:223], v[76:79]
    v_mfma_f32_16x16x32_bf16 v[140:143], v[204:207], v[224:227], v[140:143]
    v_mfma_f32_16x16x32_bf16 v[108:111], v[204:207], v[228:231], v[108:111]
    v_mfma_f32_16x16x32_bf16 v[172:175], v[204:207], v[232:235], v[172:175]
    ds_read_b128 v[204:207], v11 offset:24576
    v_mfma_f32_16x16x32_bf16 v[176:179], v[208:211], v[232:235], v[176:179]
    v_mfma_f32_16x16x32_bf16 v[112:115], v[208:211], v[228:231], v[112:115]
    v_mfma_f32_16x16x32_bf16 v[144:147], v[208:211], v[224:227], v[144:147]
    v_mfma_f32_16x16x32_bf16 v[80:83], v[208:211], v[220:223], v[80:83]
    s_waitcnt lgkmcnt(1)
    v_mfma_f32_16x16x32_bf16 v[84:87], v[212:215], v[220:223], v[84:87]
    ds_read_b128 v[208:211], v11 offset:26624
    v_mfma_f32_16x16x32_bf16 v[148:151], v[212:215], v[224:227], v[148:151]
    v_mfma_f32_16x16x32_bf16 v[116:119], v[212:215], v[228:231], v[116:119]
    v_mfma_f32_16x16x32_bf16 v[180:183], v[212:215], v[232:235], v[180:183]
    ds_read_b128 v[212:215], v11 offset:28672
    v_mfma_f32_16x16x32_bf16 v[184:187], v[216:219], v[232:235], v[184:187]
    v_mfma_f32_16x16x32_bf16 v[120:123], v[216:219], v[228:231], v[120:123]
    v_mfma_f32_16x16x32_bf16 v[152:155], v[216:219], v[224:227], v[152:155]
    v_mfma_f32_16x16x32_bf16 v[88:91], v[216:219], v[220:223], v[88:91]
    ds_read_b128 v[216:219], v11 offset:30720
    v_mfma_f32_16x16x32_bf16 v[60:63], v[188:191], v[236:239], v[60:63]
    v_mfma_f32_16x16x32_bf16 v[124:127], v[188:191], v[240:243], v[124:127]
    v_mfma_f32_16x16x32_bf16 v[92:95], v[188:191], v[244:247], v[92:95]
    v_mfma_f32_16x16x32_bf16 v[156:159], v[188:191], v[248:251], v[156:159]
    v_mfma_f32_16x16x32_bf16 v[160:163], v[192:195], v[248:251], v[160:163]
    v_mfma_f32_16x16x32_bf16 v[96:99], v[192:195], v[244:247], v[96:99]
    v_mfma_f32_16x16x32_bf16 v[128:131], v[192:195], v[240:243], v[128:131]
    v_mfma_f32_16x16x32_bf16 v[64:67], v[192:195], v[236:239], v[64:67]
    v_mfma_f32_16x16x32_bf16 v[68:71], v[196:199], v[236:239], v[68:71]
    v_mfma_f32_16x16x32_bf16 v[132:135], v[196:199], v[240:243], v[132:135]
    v_mfma_f32_16x16x32_bf16 v[100:103], v[196:199], v[244:247], v[100:103]
    v_mfma_f32_16x16x32_bf16 v[164:167], v[196:199], v[248:251], v[164:167]
    s_waitcnt lgkmcnt(0)
    s_barrier
    v_mfma_f32_16x16x32_bf16 v[168:171], v[200:203], v[248:251], v[168:171]
    ds_read_b128 v[188:191], v10 offset:32768
    v_mfma_f32_16x16x32_bf16 v[104:107], v[200:203], v[244:247], v[104:107]
    ds_read_b128 v[220:223], v12 offset:49152
    v_mfma_f32_16x16x32_bf16 v[136:139], v[200:203], v[240:243], v[136:139]
    ds_read_b128 v[224:227], v12 offset:51200
    v_mfma_f32_16x16x32_bf16 v[72:75], v[200:203], v[236:239], v[72:75]
    ds_read_b128 v[228:231], v12 offset:53248
    v_mfma_f32_16x16x32_bf16 v[76:79], v[204:207], v[236:239], v[76:79]
    ds_read_b128 v[232:235], v12 offset:55296
    v_mfma_f32_16x16x32_bf16 v[140:143], v[204:207], v[240:243], v[140:143]
    ds_read_b128 v[192:195], v10 offset:34816
    v_mfma_f32_16x16x32_bf16 v[108:111], v[204:207], v[244:247], v[108:111]
    ds_read_b128 v[196:199], v10 offset:36864
    v_mfma_f32_16x16x32_bf16 v[172:175], v[204:207], v[248:251], v[172:175]
    ds_read_b128 v[200:203], v10 offset:38912
    v_mfma_f32_16x16x32_bf16 v[176:179], v[208:211], v[248:251], v[176:179]
    ds_read_b128 v[204:207], v10 offset:40960
    v_mfma_f32_16x16x32_bf16 v[112:115], v[208:211], v[244:247], v[112:115]
    v_mfma_f32_16x16x32_bf16 v[144:147], v[208:211], v[240:243], v[144:147]
    v_mfma_f32_16x16x32_bf16 v[80:83], v[208:211], v[236:239], v[80:83]
    ds_read_b128 v[208:211], v10 offset:43008
    v_mfma_f32_16x16x32_bf16 v[84:87], v[212:215], v[236:239], v[84:87]
    v_mfma_f32_16x16x32_bf16 v[148:151], v[212:215], v[240:243], v[148:151]
    v_mfma_f32_16x16x32_bf16 v[116:119], v[212:215], v[244:247], v[116:119]
    v_mfma_f32_16x16x32_bf16 v[180:183], v[212:215], v[248:251], v[180:183]
    ds_read_b128 v[212:215], v10 offset:45056
    v_mfma_f32_16x16x32_bf16 v[184:187], v[216:219], v[248:251], v[184:187]
    v_mfma_f32_16x16x32_bf16 v[120:123], v[216:219], v[244:247], v[120:123]
    v_mfma_f32_16x16x32_bf16 v[152:155], v[216:219], v[240:243], v[152:155]
    v_mfma_f32_16x16x32_bf16 v[88:91], v[216:219], v[236:239], v[88:91]
    s_waitcnt lgkmcnt(1)
    v_mfma_f32_16x16x32_bf16 v[60:63], v[188:191], v[220:223], v[60:63]
    ds_read_b128 v[216:219], v10 offset:47104
    v_mfma_f32_16x16x32_bf16 v[124:127], v[188:191], v[224:227], v[124:127]
    v_mfma_f32_16x16x32_bf16 v[92:95], v[188:191], v[228:231], v[92:95]
    v_mfma_f32_16x16x32_bf16 v[156:159], v[188:191], v[232:235], v[156:159]
    ds_read_b128 v[188:191], v11 offset:32768
    v_mfma_f32_16x16x32_bf16 v[160:163], v[192:195], v[232:235], v[160:163]
    ds_read_b128 v[236:239], v13 offset:49152
    v_mfma_f32_16x16x32_bf16 v[96:99], v[192:195], v[228:231], v[96:99]
    ds_read_b128 v[240:243], v13 offset:51200
    v_mfma_f32_16x16x32_bf16 v[128:131], v[192:195], v[224:227], v[128:131]
    ds_read_b128 v[244:247], v13 offset:53248
    v_mfma_f32_16x16x32_bf16 v[64:67], v[192:195], v[220:223], v[64:67]
    ds_read_b128 v[248:251], v13 offset:55296
    v_mfma_f32_16x16x32_bf16 v[68:71], v[196:199], v[220:223], v[68:71]
    ds_read_b128 v[192:195], v11 offset:34816
    v_mfma_f32_16x16x32_bf16 v[132:135], v[196:199], v[224:227], v[132:135]
    v_mfma_f32_16x16x32_bf16 v[100:103], v[196:199], v[228:231], v[100:103]
    v_mfma_f32_16x16x32_bf16 v[164:167], v[196:199], v[232:235], v[164:167]
    ds_read_b128 v[196:199], v11 offset:36864
    v_mfma_f32_16x16x32_bf16 v[168:171], v[200:203], v[232:235], v[168:171]
    v_mfma_f32_16x16x32_bf16 v[104:107], v[200:203], v[228:231], v[104:107]
    v_mfma_f32_16x16x32_bf16 v[136:139], v[200:203], v[224:227], v[136:139]
    v_mfma_f32_16x16x32_bf16 v[72:75], v[200:203], v[220:223], v[72:75]
    ds_read_b128 v[200:203], v11 offset:38912
    v_mfma_f32_16x16x32_bf16 v[76:79], v[204:207], v[220:223], v[76:79]
    v_mfma_f32_16x16x32_bf16 v[140:143], v[204:207], v[224:227], v[140:143]
    v_mfma_f32_16x16x32_bf16 v[108:111], v[204:207], v[228:231], v[108:111]
    v_mfma_f32_16x16x32_bf16 v[172:175], v[204:207], v[232:235], v[172:175]
    ds_read_b128 v[204:207], v11 offset:40960
    v_mfma_f32_16x16x32_bf16 v[176:179], v[208:211], v[232:235], v[176:179]
    v_mfma_f32_16x16x32_bf16 v[112:115], v[208:211], v[228:231], v[112:115]
    v_mfma_f32_16x16x32_bf16 v[144:147], v[208:211], v[224:227], v[144:147]
    v_mfma_f32_16x16x32_bf16 v[80:83], v[208:211], v[220:223], v[80:83]
    s_waitcnt lgkmcnt(1)
    v_mfma_f32_16x16x32_bf16 v[84:87], v[212:215], v[220:223], v[84:87]
    ds_read_b128 v[208:211], v11 offset:43008
    v_mfma_f32_16x16x32_bf16 v[148:151], v[212:215], v[224:227], v[148:151]
    v_mfma_f32_16x16x32_bf16 v[116:119], v[212:215], v[228:231], v[116:119]
    v_mfma_f32_16x16x32_bf16 v[180:183], v[212:215], v[232:235], v[180:183]
    ds_read_b128 v[212:215], v11 offset:45056
    v_mfma_f32_16x16x32_bf16 v[184:187], v[216:219], v[232:235], v[184:187]
    v_mfma_f32_16x16x32_bf16 v[120:123], v[216:219], v[228:231], v[120:123]
    v_mfma_f32_16x16x32_bf16 v[152:155], v[216:219], v[224:227], v[152:155]
    v_mfma_f32_16x16x32_bf16 v[88:91], v[216:219], v[220:223], v[88:91]
    ds_read_b128 v[216:219], v11 offset:47104
    v_mfma_f32_16x16x32_bf16 v[60:63], v[188:191], v[236:239], v[60:63]
    v_mfma_f32_16x16x32_bf16 v[124:127], v[188:191], v[240:243], v[124:127]
    v_mfma_f32_16x16x32_bf16 v[92:95], v[188:191], v[244:247], v[92:95]
    v_mfma_f32_16x16x32_bf16 v[156:159], v[188:191], v[248:251], v[156:159]
    v_mfma_f32_16x16x32_bf16 v[160:163], v[192:195], v[248:251], v[160:163]
    v_mfma_f32_16x16x32_bf16 v[96:99], v[192:195], v[244:247], v[96:99]
    v_mfma_f32_16x16x32_bf16 v[128:131], v[192:195], v[240:243], v[128:131]
    v_mfma_f32_16x16x32_bf16 v[64:67], v[192:195], v[236:239], v[64:67]
    v_mfma_f32_16x16x32_bf16 v[68:71], v[196:199], v[236:239], v[68:71]
    v_mfma_f32_16x16x32_bf16 v[132:135], v[196:199], v[240:243], v[132:135]
    v_mfma_f32_16x16x32_bf16 v[100:103], v[196:199], v[244:247], v[100:103]
    v_mfma_f32_16x16x32_bf16 v[164:167], v[196:199], v[248:251], v[164:167]
    s_waitcnt lgkmcnt(0)
    s_barrier
    v_mfma_f32_16x16x32_bf16 v[168:171], v[200:203], v[248:251], v[168:171]
    ds_read_b128 v[188:191], v10 offset:0
    v_mfma_f32_16x16x32_bf16 v[104:107], v[200:203], v[244:247], v[104:107]
    ds_read_b128 v[220:223], v12 offset:0
    v_mfma_f32_16x16x32_bf16 v[136:139], v[200:203], v[240:243], v[136:139]
    ds_read_b128 v[224:227], v12 offset:2048
    v_mfma_f32_16x16x32_bf16 v[72:75], v[200:203], v[236:239], v[72:75]
    ds_read_b128 v[228:231], v12 offset:4096
    v_mfma_f32_16x16x32_bf16 v[76:79], v[204:207], v[236:239], v[76:79]
    ds_read_b128 v[232:235], v12 offset:6144
    v_mfma_f32_16x16x32_bf16 v[140:143], v[204:207], v[240:243], v[140:143]
    ds_read_b128 v[192:195], v10 offset:2048
    v_mfma_f32_16x16x32_bf16 v[108:111], v[204:207], v[244:247], v[108:111]
    ds_read_b128 v[196:199], v10 offset:4096
    v_mfma_f32_16x16x32_bf16 v[172:175], v[204:207], v[248:251], v[172:175]
    ds_read_b128 v[200:203], v10 offset:6144
    v_mfma_f32_16x16x32_bf16 v[176:179], v[208:211], v[248:251], v[176:179]
    ds_read_b128 v[204:207], v10 offset:8192
    v_mfma_f32_16x16x32_bf16 v[112:115], v[208:211], v[244:247], v[112:115]
    v_mfma_f32_16x16x32_bf16 v[144:147], v[208:211], v[240:243], v[144:147]
    v_mfma_f32_16x16x32_bf16 v[80:83], v[208:211], v[236:239], v[80:83]
    ds_read_b128 v[208:211], v10 offset:10240
    v_mfma_f32_16x16x32_bf16 v[84:87], v[212:215], v[236:239], v[84:87]
    v_mfma_f32_16x16x32_bf16 v[148:151], v[212:215], v[240:243], v[148:151]
    v_mfma_f32_16x16x32_bf16 v[116:119], v[212:215], v[244:247], v[116:119]
    v_mfma_f32_16x16x32_bf16 v[180:183], v[212:215], v[248:251], v[180:183]
    ds_read_b128 v[212:215], v10 offset:12288
    v_mfma_f32_16x16x32_bf16 v[184:187], v[216:219], v[248:251], v[184:187]
    v_mfma_f32_16x16x32_bf16 v[120:123], v[216:219], v[244:247], v[120:123]
    v_mfma_f32_16x16x32_bf16 v[152:155], v[216:219], v[240:243], v[152:155]
    v_mfma_f32_16x16x32_bf16 v[88:91], v[216:219], v[236:239], v[88:91]
    s_waitcnt lgkmcnt(1)
    v_mfma_f32_16x16x32_bf16 v[60:63], v[188:191], v[220:223], v[60:63]
    ds_read_b128 v[216:219], v10 offset:14336
    v_mfma_f32_16x16x32_bf16 v[124:127], v[188:191], v[224:227], v[124:127]
    v_mfma_f32_16x16x32_bf16 v[92:95], v[188:191], v[228:231], v[92:95]
    v_mfma_f32_16x16x32_bf16 v[156:159], v[188:191], v[232:235], v[156:159]
    ds_read_b128 v[188:191], v11 offset:0
    v_mfma_f32_16x16x32_bf16 v[160:163], v[192:195], v[232:235], v[160:163]
    ds_read_b128 v[236:239], v13 offset:0
    v_mfma_f32_16x16x32_bf16 v[96:99], v[192:195], v[228:231], v[96:99]
    ds_read_b128 v[240:243], v13 offset:2048
    v_mfma_f32_16x16x32_bf16 v[128:131], v[192:195], v[224:227], v[128:131]
    ds_read_b128 v[244:247], v13 offset:4096
    v_mfma_f32_16x16x32_bf16 v[64:67], v[192:195], v[220:223], v[64:67]
    ds_read_b128 v[248:251], v13 offset:6144
    v_mfma_f32_16x16x32_bf16 v[68:71], v[196:199], v[220:223], v[68:71]
    ds_read_b128 v[192:195], v11 offset:2048
    v_mfma_f32_16x16x32_bf16 v[132:135], v[196:199], v[224:227], v[132:135]
    v_mfma_f32_16x16x32_bf16 v[100:103], v[196:199], v[228:231], v[100:103]
    v_mfma_f32_16x16x32_bf16 v[164:167], v[196:199], v[232:235], v[164:167]
    ds_read_b128 v[196:199], v11 offset:4096
    v_mfma_f32_16x16x32_bf16 v[168:171], v[200:203], v[232:235], v[168:171]
    v_mfma_f32_16x16x32_bf16 v[104:107], v[200:203], v[228:231], v[104:107]
    v_mfma_f32_16x16x32_bf16 v[136:139], v[200:203], v[224:227], v[136:139]
    v_mfma_f32_16x16x32_bf16 v[72:75], v[200:203], v[220:223], v[72:75]
    ds_read_b128 v[200:203], v11 offset:6144
    v_mfma_f32_16x16x32_bf16 v[76:79], v[204:207], v[220:223], v[76:79]
    v_mfma_f32_16x16x32_bf16 v[140:143], v[204:207], v[224:227], v[140:143]
    v_mfma_f32_16x16x32_bf16 v[108:111], v[204:207], v[228:231], v[108:111]
    v_mfma_f32_16x16x32_bf16 v[172:175], v[204:207], v[232:235], v[172:175]
    ds_read_b128 v[204:207], v11 offset:8192
    v_mfma_f32_16x16x32_bf16 v[176:179], v[208:211], v[232:235], v[176:179]
    v_mfma_f32_16x16x32_bf16 v[112:115], v[208:211], v[228:231], v[112:115]
    v_mfma_f32_16x16x32_bf16 v[144:147], v[208:211], v[224:227], v[144:147]
    v_mfma_f32_16x16x32_bf16 v[80:83], v[208:211], v[220:223], v[80:83]
    s_waitcnt lgkmcnt(1)
    v_mfma_f32_16x16x32_bf16 v[84:87], v[212:215], v[220:223], v[84:87]
    ds_read_b128 v[208:211], v11 offset:10240
    v_mfma_f32_16x16x32_bf16 v[148:151], v[212:215], v[224:227], v[148:151]
    v_mfma_f32_16x16x32_bf16 v[116:119], v[212:215], v[228:231], v[116:119]
    v_mfma_f32_16x16x32_bf16 v[180:183], v[212:215], v[232:235], v[180:183]
    ds_read_b128 v[212:215], v11 offset:12288
    v_mfma_f32_16x16x32_bf16 v[184:187], v[216:219], v[232:235], v[184:187]
    v_mfma_f32_16x16x32_bf16 v[120:123], v[216:219], v[228:231], v[120:123]
    v_mfma_f32_16x16x32_bf16 v[152:155], v[216:219], v[224:227], v[152:155]
    v_mfma_f32_16x16x32_bf16 v[88:91], v[216:219], v[220:223], v[88:91]
    ds_read_b128 v[216:219], v11 offset:14336
    v_mfma_f32_16x16x32_bf16 v[60:63], v[188:191], v[236:239], v[60:63]
    v_mfma_f32_16x16x32_bf16 v[124:127], v[188:191], v[240:243], v[124:127]
    v_mfma_f32_16x16x32_bf16 v[92:95], v[188:191], v[244:247], v[92:95]
    v_mfma_f32_16x16x32_bf16 v[156:159], v[188:191], v[248:251], v[156:159]
    v_mfma_f32_16x16x32_bf16 v[160:163], v[192:195], v[248:251], v[160:163]
    v_mfma_f32_16x16x32_bf16 v[96:99], v[192:195], v[244:247], v[96:99]
    v_mfma_f32_16x16x32_bf16 v[128:131], v[192:195], v[240:243], v[128:131]
    v_mfma_f32_16x16x32_bf16 v[64:67], v[192:195], v[236:239], v[64:67]
    v_mfma_f32_16x16x32_bf16 v[68:71], v[196:199], v[236:239], v[68:71]
    v_mfma_f32_16x16x32_bf16 v[132:135], v[196:199], v[240:243], v[132:135]
    v_mfma_f32_16x16x32_bf16 v[100:103], v[196:199], v[244:247], v[100:103]
    v_mfma_f32_16x16x32_bf16 v[164:167], v[196:199], v[248:251], v[164:167]
    s_waitcnt lgkmcnt(0)
    s_barrier
    v_mfma_f32_16x16x32_bf16 v[168:171], v[200:203], v[248:251], v[168:171]
    ds_read_b128 v[188:191], v10 offset:16384
    v_mfma_f32_16x16x32_bf16 v[104:107], v[200:203], v[244:247], v[104:107]
    ds_read_b128 v[220:223], v12 offset:16384
    v_mfma_f32_16x16x32_bf16 v[136:139], v[200:203], v[240:243], v[136:139]
    ds_read_b128 v[224:227], v12 offset:18432
    v_mfma_f32_16x16x32_bf16 v[72:75], v[200:203], v[236:239], v[72:75]
    ds_read_b128 v[228:231], v12 offset:20480
    v_mfma_f32_16x16x32_bf16 v[76:79], v[204:207], v[236:239], v[76:79]
    ds_read_b128 v[232:235], v12 offset:22528
    v_mfma_f32_16x16x32_bf16 v[140:143], v[204:207], v[240:243], v[140:143]
    ds_read_b128 v[192:195], v10 offset:18432
    v_mfma_f32_16x16x32_bf16 v[108:111], v[204:207], v[244:247], v[108:111]
    ds_read_b128 v[196:199], v10 offset:20480
    v_mfma_f32_16x16x32_bf16 v[172:175], v[204:207], v[248:251], v[172:175]
    ds_read_b128 v[200:203], v10 offset:22528
    v_mfma_f32_16x16x32_bf16 v[176:179], v[208:211], v[248:251], v[176:179]
    ds_read_b128 v[204:207], v10 offset:24576
    v_mfma_f32_16x16x32_bf16 v[112:115], v[208:211], v[244:247], v[112:115]
    v_mfma_f32_16x16x32_bf16 v[144:147], v[208:211], v[240:243], v[144:147]
    v_mfma_f32_16x16x32_bf16 v[80:83], v[208:211], v[236:239], v[80:83]
    ds_read_b128 v[208:211], v10 offset:26624
    v_mfma_f32_16x16x32_bf16 v[84:87], v[212:215], v[236:239], v[84:87]
    v_mfma_f32_16x16x32_bf16 v[148:151], v[212:215], v[240:243], v[148:151]
    v_mfma_f32_16x16x32_bf16 v[116:119], v[212:215], v[244:247], v[116:119]
    v_mfma_f32_16x16x32_bf16 v[180:183], v[212:215], v[248:251], v[180:183]
    ds_read_b128 v[212:215], v10 offset:28672
    v_mfma_f32_16x16x32_bf16 v[184:187], v[216:219], v[248:251], v[184:187]
    v_mfma_f32_16x16x32_bf16 v[120:123], v[216:219], v[244:247], v[120:123]
    v_mfma_f32_16x16x32_bf16 v[152:155], v[216:219], v[240:243], v[152:155]
    v_mfma_f32_16x16x32_bf16 v[88:91], v[216:219], v[236:239], v[88:91]
    s_waitcnt lgkmcnt(1)
    v_mfma_f32_16x16x32_bf16 v[60:63], v[188:191], v[220:223], v[60:63]
    ds_read_b128 v[216:219], v10 offset:30720
    v_mfma_f32_16x16x32_bf16 v[124:127], v[188:191], v[224:227], v[124:127]
    v_mfma_f32_16x16x32_bf16 v[92:95], v[188:191], v[228:231], v[92:95]
    v_mfma_f32_16x16x32_bf16 v[156:159], v[188:191], v[232:235], v[156:159]
    ds_read_b128 v[188:191], v11 offset:16384
    v_mfma_f32_16x16x32_bf16 v[160:163], v[192:195], v[232:235], v[160:163]
    ds_read_b128 v[236:239], v13 offset:16384
    v_mfma_f32_16x16x32_bf16 v[96:99], v[192:195], v[228:231], v[96:99]
    ds_read_b128 v[240:243], v13 offset:18432
    v_mfma_f32_16x16x32_bf16 v[128:131], v[192:195], v[224:227], v[128:131]
    ds_read_b128 v[244:247], v13 offset:20480
    v_mfma_f32_16x16x32_bf16 v[64:67], v[192:195], v[220:223], v[64:67]
    ds_read_b128 v[248:251], v13 offset:22528
    v_mfma_f32_16x16x32_bf16 v[68:71], v[196:199], v[220:223], v[68:71]
    ds_read_b128 v[192:195], v11 offset:18432
    v_mfma_f32_16x16x32_bf16 v[132:135], v[196:199], v[224:227], v[132:135]
    v_mfma_f32_16x16x32_bf16 v[100:103], v[196:199], v[228:231], v[100:103]
    v_mfma_f32_16x16x32_bf16 v[164:167], v[196:199], v[232:235], v[164:167]
    ds_read_b128 v[196:199], v11 offset:20480
    v_mfma_f32_16x16x32_bf16 v[168:171], v[200:203], v[232:235], v[168:171]
    v_mfma_f32_16x16x32_bf16 v[104:107], v[200:203], v[228:231], v[104:107]
    v_mfma_f32_16x16x32_bf16 v[136:139], v[200:203], v[224:227], v[136:139]
    v_mfma_f32_16x16x32_bf16 v[72:75], v[200:203], v[220:223], v[72:75]
    ds_read_b128 v[200:203], v11 offset:22528
    v_mfma_f32_16x16x32_bf16 v[76:79], v[204:207], v[220:223], v[76:79]
    v_mfma_f32_16x16x32_bf16 v[140:143], v[204:207], v[224:227], v[140:143]
    v_mfma_f32_16x16x32_bf16 v[108:111], v[204:207], v[228:231], v[108:111]
    v_mfma_f32_16x16x32_bf16 v[172:175], v[204:207], v[232:235], v[172:175]
    ds_read_b128 v[204:207], v11 offset:24576
    v_mfma_f32_16x16x32_bf16 v[176:179], v[208:211], v[232:235], v[176:179]
    v_mfma_f32_16x16x32_bf16 v[112:115], v[208:211], v[228:231], v[112:115]
    v_mfma_f32_16x16x32_bf16 v[144:147], v[208:211], v[224:227], v[144:147]
    v_mfma_f32_16x16x32_bf16 v[80:83], v[208:211], v[220:223], v[80:83]
    s_waitcnt lgkmcnt(1)
    v_mfma_f32_16x16x32_bf16 v[84:87], v[212:215], v[220:223], v[84:87]
    ds_read_b128 v[208:211], v11 offset:26624
    v_mfma_f32_16x16x32_bf16 v[148:151], v[212:215], v[224:227], v[148:151]
    v_mfma_f32_16x16x32_bf16 v[116:119], v[212:215], v[228:231], v[116:119]
    v_mfma_f32_16x16x32_bf16 v[180:183], v[212:215], v[232:235], v[180:183]
    ds_read_b128 v[212:215], v11 offset:28672
    v_mfma_f32_16x16x32_bf16 v[184:187], v[216:219], v[232:235], v[184:187]
    v_mfma_f32_16x16x32_bf16 v[120:123], v[216:219], v[228:231], v[120:123]
    v_mfma_f32_16x16x32_bf16 v[152:155], v[216:219], v[224:227], v[152:155]
    v_mfma_f32_16x16x32_bf16 v[88:91], v[216:219], v[220:223], v[88:91]
    ds_read_b128 v[216:219], v11 offset:30720
    v_mfma_f32_16x16x32_bf16 v[60:63], v[188:191], v[236:239], v[60:63]
    v_mfma_f32_16x16x32_bf16 v[124:127], v[188:191], v[240:243], v[124:127]
    v_mfma_f32_16x16x32_bf16 v[92:95], v[188:191], v[244:247], v[92:95]
    v_mfma_f32_16x16x32_bf16 v[156:159], v[188:191], v[248:251], v[156:159]
    v_mfma_f32_16x16x32_bf16 v[160:163], v[192:195], v[248:251], v[160:163]
    v_mfma_f32_16x16x32_bf16 v[96:99], v[192:195], v[244:247], v[96:99]
    v_mfma_f32_16x16x32_bf16 v[128:131], v[192:195], v[240:243], v[128:131]
    v_mfma_f32_16x16x32_bf16 v[64:67], v[192:195], v[236:239], v[64:67]
    v_mfma_f32_16x16x32_bf16 v[68:71], v[196:199], v[236:239], v[68:71]
    v_mfma_f32_16x16x32_bf16 v[132:135], v[196:199], v[240:243], v[132:135]
    v_mfma_f32_16x16x32_bf16 v[100:103], v[196:199], v[244:247], v[100:103]
    v_mfma_f32_16x16x32_bf16 v[164:167], v[196:199], v[248:251], v[164:167]
    s_waitcnt lgkmcnt(0)
    s_barrier
    v_mfma_f32_16x16x32_bf16 v[168:171], v[200:203], v[248:251], v[168:171]
    ds_read_b128 v[188:191], v10 offset:32768
    v_mfma_f32_16x16x32_bf16 v[104:107], v[200:203], v[244:247], v[104:107]
    ds_read_b128 v[220:223], v12 offset:49152
    v_mfma_f32_16x16x32_bf16 v[136:139], v[200:203], v[240:243], v[136:139]
    ds_read_b128 v[224:227], v12 offset:51200
    v_mfma_f32_16x16x32_bf16 v[72:75], v[200:203], v[236:239], v[72:75]
    ds_read_b128 v[228:231], v12 offset:53248
    v_mfma_f32_16x16x32_bf16 v[76:79], v[204:207], v[236:239], v[76:79]
    ds_read_b128 v[232:235], v12 offset:55296
    v_mfma_f32_16x16x32_bf16 v[140:143], v[204:207], v[240:243], v[140:143]
    ds_read_b128 v[192:195], v10 offset:34816
    v_mfma_f32_16x16x32_bf16 v[108:111], v[204:207], v[244:247], v[108:111]
    ds_read_b128 v[196:199], v10 offset:36864
    v_mfma_f32_16x16x32_bf16 v[172:175], v[204:207], v[248:251], v[172:175]
    ds_read_b128 v[200:203], v10 offset:38912
    v_mfma_f32_16x16x32_bf16 v[176:179], v[208:211], v[248:251], v[176:179]
    ds_read_b128 v[204:207], v10 offset:40960
    v_mfma_f32_16x16x32_bf16 v[112:115], v[208:211], v[244:247], v[112:115]
    v_mfma_f32_16x16x32_bf16 v[144:147], v[208:211], v[240:243], v[144:147]
    v_mfma_f32_16x16x32_bf16 v[80:83], v[208:211], v[236:239], v[80:83]
    ds_read_b128 v[208:211], v10 offset:43008
    v_mfma_f32_16x16x32_bf16 v[84:87], v[212:215], v[236:239], v[84:87]
    v_mfma_f32_16x16x32_bf16 v[148:151], v[212:215], v[240:243], v[148:151]
    v_mfma_f32_16x16x32_bf16 v[116:119], v[212:215], v[244:247], v[116:119]
    v_mfma_f32_16x16x32_bf16 v[180:183], v[212:215], v[248:251], v[180:183]
    ds_read_b128 v[212:215], v10 offset:45056
    v_mfma_f32_16x16x32_bf16 v[184:187], v[216:219], v[248:251], v[184:187]
    v_mfma_f32_16x16x32_bf16 v[120:123], v[216:219], v[244:247], v[120:123]
    v_mfma_f32_16x16x32_bf16 v[152:155], v[216:219], v[240:243], v[152:155]
    v_mfma_f32_16x16x32_bf16 v[88:91], v[216:219], v[236:239], v[88:91]
    s_waitcnt lgkmcnt(1)
    v_mfma_f32_16x16x32_bf16 v[60:63], v[188:191], v[220:223], v[60:63]
    ds_read_b128 v[216:219], v10 offset:47104
    v_mfma_f32_16x16x32_bf16 v[124:127], v[188:191], v[224:227], v[124:127]
    v_mfma_f32_16x16x32_bf16 v[92:95], v[188:191], v[228:231], v[92:95]
    v_mfma_f32_16x16x32_bf16 v[156:159], v[188:191], v[232:235], v[156:159]
    ds_read_b128 v[188:191], v11 offset:32768
    v_mfma_f32_16x16x32_bf16 v[160:163], v[192:195], v[232:235], v[160:163]
    ds_read_b128 v[236:239], v13 offset:49152
    v_mfma_f32_16x16x32_bf16 v[96:99], v[192:195], v[228:231], v[96:99]
    ds_read_b128 v[240:243], v13 offset:51200
    v_mfma_f32_16x16x32_bf16 v[128:131], v[192:195], v[224:227], v[128:131]
    ds_read_b128 v[244:247], v13 offset:53248
    v_mfma_f32_16x16x32_bf16 v[64:67], v[192:195], v[220:223], v[64:67]
    ds_read_b128 v[248:251], v13 offset:55296
    v_mfma_f32_16x16x32_bf16 v[68:71], v[196:199], v[220:223], v[68:71]
    ds_read_b128 v[192:195], v11 offset:34816
    v_mfma_f32_16x16x32_bf16 v[132:135], v[196:199], v[224:227], v[132:135]
    v_mfma_f32_16x16x32_bf16 v[100:103], v[196:199], v[228:231], v[100:103]
    v_mfma_f32_16x16x32_bf16 v[164:167], v[196:199], v[232:235], v[164:167]
    ds_read_b128 v[196:199], v11 offset:36864
    v_mfma_f32_16x16x32_bf16 v[168:171], v[200:203], v[232:235], v[168:171]
    v_mfma_f32_16x16x32_bf16 v[104:107], v[200:203], v[228:231], v[104:107]
    v_mfma_f32_16x16x32_bf16 v[136:139], v[200:203], v[224:227], v[136:139]
    v_mfma_f32_16x16x32_bf16 v[72:75], v[200:203], v[220:223], v[72:75]
    ds_read_b128 v[200:203], v11 offset:38912
    v_mfma_f32_16x16x32_bf16 v[76:79], v[204:207], v[220:223], v[76:79]
    v_mfma_f32_16x16x32_bf16 v[140:143], v[204:207], v[224:227], v[140:143]
    v_mfma_f32_16x16x32_bf16 v[108:111], v[204:207], v[228:231], v[108:111]
    v_mfma_f32_16x16x32_bf16 v[172:175], v[204:207], v[232:235], v[172:175]
    ds_read_b128 v[204:207], v11 offset:40960
    v_mfma_f32_16x16x32_bf16 v[176:179], v[208:211], v[232:235], v[176:179]
    v_mfma_f32_16x16x32_bf16 v[112:115], v[208:211], v[228:231], v[112:115]
    v_mfma_f32_16x16x32_bf16 v[144:147], v[208:211], v[224:227], v[144:147]
    v_mfma_f32_16x16x32_bf16 v[80:83], v[208:211], v[220:223], v[80:83]
    s_waitcnt lgkmcnt(1)
    v_mfma_f32_16x16x32_bf16 v[84:87], v[212:215], v[220:223], v[84:87]
    ds_read_b128 v[208:211], v11 offset:43008
    v_mfma_f32_16x16x32_bf16 v[148:151], v[212:215], v[224:227], v[148:151]
    v_mfma_f32_16x16x32_bf16 v[116:119], v[212:215], v[228:231], v[116:119]
    v_mfma_f32_16x16x32_bf16 v[180:183], v[212:215], v[232:235], v[180:183]
    ds_read_b128 v[212:215], v11 offset:45056
    v_mfma_f32_16x16x32_bf16 v[184:187], v[216:219], v[232:235], v[184:187]
    v_mfma_f32_16x16x32_bf16 v[120:123], v[216:219], v[228:231], v[120:123]
    v_mfma_f32_16x16x32_bf16 v[152:155], v[216:219], v[224:227], v[152:155]
    v_mfma_f32_16x16x32_bf16 v[88:91], v[216:219], v[220:223], v[88:91]
    ds_read_b128 v[216:219], v11 offset:47104
    v_mfma_f32_16x16x32_bf16 v[60:63], v[188:191], v[236:239], v[60:63]
    v_mfma_f32_16x16x32_bf16 v[124:127], v[188:191], v[240:243], v[124:127]
    v_mfma_f32_16x16x32_bf16 v[92:95], v[188:191], v[244:247], v[92:95]
    v_mfma_f32_16x16x32_bf16 v[156:159], v[188:191], v[248:251], v[156:159]
    v_mfma_f32_16x16x32_bf16 v[160:163], v[192:195], v[248:251], v[160:163]
    v_mfma_f32_16x16x32_bf16 v[96:99], v[192:195], v[244:247], v[96:99]
    v_mfma_f32_16x16x32_bf16 v[128:131], v[192:195], v[240:243], v[128:131]
    v_mfma_f32_16x16x32_bf16 v[64:67], v[192:195], v[236:239], v[64:67]
    v_mfma_f32_16x16x32_bf16 v[68:71], v[196:199], v[236:239], v[68:71]
    v_mfma_f32_16x16x32_bf16 v[132:135], v[196:199], v[240:243], v[132:135]
    v_mfma_f32_16x16x32_bf16 v[100:103], v[196:199], v[244:247], v[100:103]
    v_mfma_f32_16x16x32_bf16 v[164:167], v[196:199], v[248:251], v[164:167]
    s_waitcnt lgkmcnt(0)
    s_barrier
    v_mfma_f32_16x16x32_bf16 v[168:171], v[200:203], v[248:251], v[168:171]
    ds_read_b128 v[188:191], v10 offset:0
    v_mfma_f32_16x16x32_bf16 v[104:107], v[200:203], v[244:247], v[104:107]
    ds_read_b128 v[220:223], v12 offset:0
    v_mfma_f32_16x16x32_bf16 v[136:139], v[200:203], v[240:243], v[136:139]
    ds_read_b128 v[224:227], v12 offset:2048
    v_mfma_f32_16x16x32_bf16 v[72:75], v[200:203], v[236:239], v[72:75]
    ds_read_b128 v[228:231], v12 offset:4096
    v_mfma_f32_16x16x32_bf16 v[76:79], v[204:207], v[236:239], v[76:79]
    ds_read_b128 v[232:235], v12 offset:6144
    v_mfma_f32_16x16x32_bf16 v[140:143], v[204:207], v[240:243], v[140:143]
    ds_read_b128 v[192:195], v10 offset:2048
    v_mfma_f32_16x16x32_bf16 v[108:111], v[204:207], v[244:247], v[108:111]
    ds_read_b128 v[196:199], v10 offset:4096
    v_mfma_f32_16x16x32_bf16 v[172:175], v[204:207], v[248:251], v[172:175]
    ds_read_b128 v[200:203], v10 offset:6144
    v_mfma_f32_16x16x32_bf16 v[176:179], v[208:211], v[248:251], v[176:179]
    ds_read_b128 v[204:207], v10 offset:8192
    v_mfma_f32_16x16x32_bf16 v[112:115], v[208:211], v[244:247], v[112:115]
    v_mfma_f32_16x16x32_bf16 v[144:147], v[208:211], v[240:243], v[144:147]
    v_mfma_f32_16x16x32_bf16 v[80:83], v[208:211], v[236:239], v[80:83]
    ds_read_b128 v[208:211], v10 offset:10240
    v_mfma_f32_16x16x32_bf16 v[84:87], v[212:215], v[236:239], v[84:87]
    v_mfma_f32_16x16x32_bf16 v[148:151], v[212:215], v[240:243], v[148:151]
    v_mfma_f32_16x16x32_bf16 v[116:119], v[212:215], v[244:247], v[116:119]
    v_mfma_f32_16x16x32_bf16 v[180:183], v[212:215], v[248:251], v[180:183]
    ds_read_b128 v[212:215], v10 offset:12288
    v_mfma_f32_16x16x32_bf16 v[184:187], v[216:219], v[248:251], v[184:187]
    v_mfma_f32_16x16x32_bf16 v[120:123], v[216:219], v[244:247], v[120:123]
    v_mfma_f32_16x16x32_bf16 v[152:155], v[216:219], v[240:243], v[152:155]
    v_mfma_f32_16x16x32_bf16 v[88:91], v[216:219], v[236:239], v[88:91]
    s_waitcnt lgkmcnt(1)
    v_mfma_f32_16x16x32_bf16 v[60:63], v[188:191], v[220:223], v[60:63]
    ds_read_b128 v[216:219], v10 offset:14336
    v_mfma_f32_16x16x32_bf16 v[124:127], v[188:191], v[224:227], v[124:127]
    v_mfma_f32_16x16x32_bf16 v[92:95], v[188:191], v[228:231], v[92:95]
    v_mfma_f32_16x16x32_bf16 v[156:159], v[188:191], v[232:235], v[156:159]
    ds_read_b128 v[188:191], v11 offset:0
    v_mfma_f32_16x16x32_bf16 v[160:163], v[192:195], v[232:235], v[160:163]
    ds_read_b128 v[236:239], v13 offset:0
    v_mfma_f32_16x16x32_bf16 v[96:99], v[192:195], v[228:231], v[96:99]
    ds_read_b128 v[240:243], v13 offset:2048
    v_mfma_f32_16x16x32_bf16 v[128:131], v[192:195], v[224:227], v[128:131]
    ds_read_b128 v[244:247], v13 offset:4096
    v_mfma_f32_16x16x32_bf16 v[64:67], v[192:195], v[220:223], v[64:67]
    ds_read_b128 v[248:251], v13 offset:6144
    v_mfma_f32_16x16x32_bf16 v[68:71], v[196:199], v[220:223], v[68:71]
    ds_read_b128 v[192:195], v11 offset:2048
    v_mfma_f32_16x16x32_bf16 v[132:135], v[196:199], v[224:227], v[132:135]
    v_mfma_f32_16x16x32_bf16 v[100:103], v[196:199], v[228:231], v[100:103]
    v_mfma_f32_16x16x32_bf16 v[164:167], v[196:199], v[232:235], v[164:167]
    ds_read_b128 v[196:199], v11 offset:4096
    v_mfma_f32_16x16x32_bf16 v[168:171], v[200:203], v[232:235], v[168:171]
    v_mfma_f32_16x16x32_bf16 v[104:107], v[200:203], v[228:231], v[104:107]
    v_mfma_f32_16x16x32_bf16 v[136:139], v[200:203], v[224:227], v[136:139]
    v_mfma_f32_16x16x32_bf16 v[72:75], v[200:203], v[220:223], v[72:75]
    ds_read_b128 v[200:203], v11 offset:6144
    v_mfma_f32_16x16x32_bf16 v[76:79], v[204:207], v[220:223], v[76:79]
    v_mfma_f32_16x16x32_bf16 v[140:143], v[204:207], v[224:227], v[140:143]
    v_mfma_f32_16x16x32_bf16 v[108:111], v[204:207], v[228:231], v[108:111]
    v_mfma_f32_16x16x32_bf16 v[172:175], v[204:207], v[232:235], v[172:175]
    ds_read_b128 v[204:207], v11 offset:8192
    v_mfma_f32_16x16x32_bf16 v[176:179], v[208:211], v[232:235], v[176:179]
    v_mfma_f32_16x16x32_bf16 v[112:115], v[208:211], v[228:231], v[112:115]
    v_mfma_f32_16x16x32_bf16 v[144:147], v[208:211], v[224:227], v[144:147]
L_pad_9:
    s_cbranch_execz L_ret_x1
    v_mfma_f32_16x16x32_bf16 v[80:83], v[208:211], v[220:223], v[80:83]
    s_waitcnt lgkmcnt(1)
    v_mfma_f32_16x16x32_bf16 v[84:87], v[212:215], v[220:223], v[84:87]
    ds_read_b128 v[208:211], v11 offset:10240
    v_mfma_f32_16x16x32_bf16 v[148:151], v[212:215], v[224:227], v[148:151]
    v_mfma_f32_16x16x32_bf16 v[116:119], v[212:215], v[228:231], v[116:119]
    v_mfma_f32_16x16x32_bf16 v[180:183], v[212:215], v[232:235], v[180:183]
    ds_read_b128 v[212:215], v11 offset:12288
    v_mfma_f32_16x16x32_bf16 v[184:187], v[216:219], v[232:235], v[184:187]
    v_mfma_f32_16x16x32_bf16 v[120:123], v[216:219], v[228:231], v[120:123]
    v_mfma_f32_16x16x32_bf16 v[152:155], v[216:219], v[224:227], v[152:155]
    v_mfma_f32_16x16x32_bf16 v[88:91], v[216:219], v[220:223], v[88:91]
    ds_read_b128 v[216:219], v11 offset:14336
    v_mfma_f32_16x16x32_bf16 v[60:63], v[188:191], v[236:239], v[60:63]
    buffer_load_dword v20, v5, s[16:19], 0 offen sc1
    v_mfma_f32_16x16x32_bf16 v[124:127], v[188:191], v[240:243], v[124:127]
    v_mfma_f32_16x16x32_bf16 v[92:95], v[188:191], v[244:247], v[92:95]
    v_mfma_f32_16x16x32_bf16 v[156:159], v[188:191], v[248:251], v[156:159]
    v_mfma_f32_16x16x32_bf16 v[160:163], v[192:195], v[248:251], v[160:163]
    v_mfma_f32_16x16x32_bf16 v[96:99], v[192:195], v[244:247], v[96:99]
    v_mfma_f32_16x16x32_bf16 v[128:131], v[192:195], v[240:243], v[128:131]
    v_mfma_f32_16x16x32_bf16 v[64:67], v[192:195], v[236:239], v[64:67]
    v_mfma_f32_16x16x32_bf16 v[68:71], v[196:199], v[236:239], v[68:71]
    v_mfma_f32_16x16x32_bf16 v[132:135], v[196:199], v[240:243], v[132:135]
    v_mfma_f32_16x16x32_bf16 v[100:103], v[196:199], v[244:247], v[100:103]
    v_mfma_f32_16x16x32_bf16 v[164:167], v[196:199], v[248:251], v[164:167]
    s_waitcnt lgkmcnt(0)
    s_barrier
    v_mfma_f32_16x16x32_bf16 v[168:171], v[200:203], v[248:251], v[168:171]
    ds_read_b128 v[188:191], v10 offset:16384
    v_mfma_f32_16x16x32_bf16 v[104:107], v[200:203], v[244:247], v[104:107]
    ds_read_b128 v[220:223], v12 offset:16384
    v_mfma_f32_16x16x32_bf16 v[136:139], v[200:203], v[240:243], v[136:139]
    ds_read_b128 v[224:227], v12 offset:18432
    v_mfma_f32_16x16x32_bf16 v[72:75], v[200:203], v[236:239], v[72:75]
    ds_read_b128 v[228:231], v12 offset:20480
    v_mfma_f32_16x16x32_bf16 v[76:79], v[204:207], v[236:239], v[76:79]
    ds_read_b128 v[232:235], v12 offset:22528
    v_mfma_f32_16x16x32_bf16 v[140:143], v[204:207], v[240:243], v[140:143]
    ds_read_b128 v[192:195], v10 offset:18432
    v_mfma_f32_16x16x32_bf16 v[108:111], v[204:207], v[244:247], v[108:111]
    ds_read_b128 v[196:199], v10 offset:20480
    v_mfma_f32_16x16x32_bf16 v[172:175], v[204:207], v[248:251], v[172:175]
    ds_read_b128 v[200:203], v10 offset:22528
    v_mfma_f32_16x16x32_bf16 v[176:179], v[208:211], v[248:251], v[176:179]
    ds_read_b128 v[204:207], v10 offset:24576
    v_mfma_f32_16x16x32_bf16 v[112:115], v[208:211], v[244:247], v[112:115]
    v_mfma_f32_16x16x32_bf16 v[144:147], v[208:211], v[240:243], v[144:147]
    v_mfma_f32_16x16x32_bf16 v[80:83], v[208:211], v[236:239], v[80:83]
    ds_read_b128 v[208:211], v10 offset:26624
    v_mfma_f32_16x16x32_bf16 v[84:87], v[212:215], v[236:239], v[84:87]
    v_mfma_f32_16x16x32_bf16 v[148:151], v[212:215], v[240:243], v[148:151]
    v_mfma_f32_16x16x32_bf16 v[116:119], v[212:215], v[244:247], v[116:119]
    v_mfma_f32_16x16x32_bf16 v[180:183], v[212:215], v[248:251], v[180:183]
    ds_read_b128 v[212:215], v10 offset:28672
    v_mfma_f32_16x16x32_bf16 v[184:187], v[216:219], v[248:251], v[184:187]
    v_mfma_f32_16x16x32_bf16 v[120:123], v[216:219], v[244:247], v[120:123]
    v_mfma_f32_16x16x32_bf16 v[152:155], v[216:219], v[240:243], v[152:155]
    v_mfma_f32_16x16x32_bf16 v[88:91], v[216:219], v[236:239], v[88:91]
    s_waitcnt lgkmcnt(1)
    v_mfma_f32_16x16x32_bf16 v[60:63], v[188:191], v[220:223], v[60:63]
    ds_read_b128 v[216:219], v10 offset:30720
    v_mfma_f32_16x16x32_bf16 v[124:127], v[188:191], v[224:227], v[124:127]
    v_mfma_f32_16x16x32_bf16 v[92:95], v[188:191], v[228:231], v[92:95]
    v_mfma_f32_16x16x32_bf16 v[156:159], v[188:191], v[232:235], v[156:159]
    ds_read_b128 v[188:191], v11 offset:16384
    v_mfma_f32_16x16x32_bf16 v[160:163], v[192:195], v[232:235], v[160:163]
    ds_read_b128 v[236:239], v13 offset:16384
    v_mfma_f32_16x16x32_bf16 v[96:99], v[192:195], v[228:231], v[96:99]
    ds_read_b128 v[240:243], v13 offset:18432
    v_mfma_f32_16x16x32_bf16 v[128:131], v[192:195], v[224:227], v[128:131]
    ds_read_b128 v[244:247], v13 offset:20480
    v_mfma_f32_16x16x32_bf16 v[64:67], v[192:195], v[220:223], v[64:67]
    ds_read_b128 v[248:251], v13 offset:22528
    v_mfma_f32_16x16x32_bf16 v[68:71], v[196:199], v[220:223], v[68:71]
    ds_read_b128 v[192:195], v11 offset:18432
    v_mfma_f32_16x16x32_bf16 v[132:135], v[196:199], v[224:227], v[132:135]
    v_mfma_f32_16x16x32_bf16 v[100:103], v[196:199], v[228:231], v[100:103]
    v_mfma_f32_16x16x32_bf16 v[164:167], v[196:199], v[232:235], v[164:167]
    ds_read_b128 v[196:199], v11 offset:20480
    v_mfma_f32_16x16x32_bf16 v[168:171], v[200:203], v[232:235], v[168:171]
    v_mfma_f32_16x16x32_bf16 v[104:107], v[200:203], v[228:231], v[104:107]
    v_mfma_f32_16x16x32_bf16 v[136:139], v[200:203], v[224:227], v[136:139]
    v_mfma_f32_16x16x32_bf16 v[72:75], v[200:203], v[220:223], v[72:75]
    ds_read_b128 v[200:203], v11 offset:22528
    v_mfma_f32_16x16x32_bf16 v[76:79], v[204:207], v[220:223], v[76:79]
    v_mfma_f32_16x16x32_bf16 v[140:143], v[204:207], v[224:227], v[140:143]
    v_mfma_f32_16x16x32_bf16 v[108:111], v[204:207], v[228:231], v[108:111]
    v_mfma_f32_16x16x32_bf16 v[172:175], v[204:207], v[232:235], v[172:175]
    ds_read_b128 v[204:207], v11 offset:24576
    v_mfma_f32_16x16x32_bf16 v[176:179], v[208:211], v[232:235], v[176:179]
    v_mfma_f32_16x16x32_bf16 v[112:115], v[208:211], v[228:231], v[112:115]
    v_mfma_f32_16x16x32_bf16 v[144:147], v[208:211], v[224:227], v[144:147]
    v_mfma_f32_16x16x32_bf16 v[80:83], v[208:211], v[220:223], v[80:83]
    s_waitcnt lgkmcnt(1)
    v_mfma_f32_16x16x32_bf16 v[84:87], v[212:215], v[220:223], v[84:87]
    ds_read_b128 v[208:211], v11 offset:26624
    v_mfma_f32_16x16x32_bf16 v[148:151], v[212:215], v[224:227], v[148:151]
    v_mfma_f32_16x16x32_bf16 v[116:119], v[212:215], v[228:231], v[116:119]
    v_mfma_f32_16x16x32_bf16 v[180:183], v[212:215], v[232:235], v[180:183]
    ds_read_b128 v[212:215], v11 offset:28672
    v_mfma_f32_16x16x32_bf16 v[184:187], v[216:219], v[232:235], v[184:187]
    v_mfma_f32_16x16x32_bf16 v[120:123], v[216:219], v[228:231], v[120:123]
    v_mfma_f32_16x16x32_bf16 v[152:155], v[216:219], v[224:227], v[152:155]
    v_mfma_f32_16x16x32_bf16 v[88:91], v[216:219], v[220:223], v[88:91]
    ds_read_b128 v[216:219], v11 offset:30720
    v_mfma_f32_16x16x32_bf16 v[60:63], v[188:191], v[236:239], v[60:63]
    v_mfma_f32_16x16x32_bf16 v[124:127], v[188:191], v[240:243], v[124:127]
    v_mfma_f32_16x16x32_bf16 v[92:95], v[188:191], v[244:247], v[92:95]
    v_mfma_f32_16x16x32_bf16 v[156:159], v[188:191], v[248:251], v[156:159]
    v_mfma_f32_16x16x32_bf16 v[160:163], v[192:195], v[248:251], v[160:163]
    v_mfma_f32_16x16x32_bf16 v[96:99], v[192:195], v[244:247], v[96:99]
    v_mfma_f32_16x16x32_bf16 v[128:131], v[192:195], v[240:243], v[128:131]
    v_mfma_f32_16x16x32_bf16 v[64:67], v[192:195], v[236:239], v[64:67]
    v_mfma_f32_16x16x32_bf16 v[68:71], v[196:199], v[236:239], v[68:71]
    v_mfma_f32_16x16x32_bf16 v[132:135], v[196:199], v[240:243], v[132:135]
    v_mfma_f32_16x16x32_bf16 v[100:103], v[196:199], v[244:247], v[100:103]
    v_mfma_f32_16x16x32_bf16 v[164:167], v[196:199], v[248:251], v[164:167]
    s_waitcnt lgkmcnt(0)
    s_barrier
    v_mfma_f32_16x16x32_bf16 v[168:171], v[200:203], v[248:251], v[168:171]
    ds_read_b128 v[188:191], v10 offset:32768
    v_mfma_f32_16x16x32_bf16 v[104:107], v[200:203], v[244:247], v[104:107]
    ds_read_b128 v[220:223], v12 offset:49152
    v_mfma_f32_16x16x32_bf16 v[136:139], v[200:203], v[240:243], v[136:139]
    ds_read_b128 v[224:227], v12 offset:51200
    v_mfma_f32_16x16x32_bf16 v[72:75], v[200:203], v[236:239], v[72:75]
    ds_read_b128 v[228:231], v12 offset:53248
    v_mfma_f32_16x16x32_bf16 v[76:79], v[204:207], v[236:239], v[76:79]
    ds_read_b128 v[232:235], v12 offset:55296
    v_mfma_f32_16x16x32_bf16 v[140:143], v[204:207], v[240:243], v[140:143]
    ds_read_b128 v[192:195], v10 offset:34816
    v_mfma_f32_16x16x32_bf16 v[108:111], v[204:207], v[244:247], v[108:111]
    ds_read_b128 v[196:199], v10 offset:36864
    v_mfma_f32_16x16x32_bf16 v[172:175], v[204:207], v[248:251], v[172:175]
    ds_read_b128 v[200:203], v10 offset:38912
    v_mfma_f32_16x16x32_bf16 v[176:179], v[208:211], v[248:251], v[176:179]
    ds_read_b128 v[204:207], v10 offset:40960
    v_mfma_f32_16x16x32_bf16 v[112:115], v[208:211], v[244:247], v[112:115]
    v_mfma_f32_16x16x32_bf16 v[144:147], v[208:211], v[240:243], v[144:147]
    v_mfma_f32_16x16x32_bf16 v[80:83], v[208:211], v[236:239], v[80:83]
    ds_read_b128 v[208:211], v10 offset:43008
    v_mfma_f32_16x16x32_bf16 v[84:87], v[212:215], v[236:239], v[84:87]
    v_mfma_f32_16x16x32_bf16 v[148:151], v[212:215], v[240:243], v[148:151]
    v_mfma_f32_16x16x32_bf16 v[116:119], v[212:215], v[244:247], v[116:119]
    v_mfma_f32_16x16x32_bf16 v[180:183], v[212:215], v[248:251], v[180:183]
    ds_read_b128 v[212:215], v10 offset:45056
    v_mfma_f32_16x16x32_bf16 v[184:187], v[216:219], v[248:251], v[184:187]
    v_mfma_f32_16x16x32_bf16 v[120:123], v[216:219], v[244:247], v[120:123]
    v_mfma_f32_16x16x32_bf16 v[152:155], v[216:219], v[240:243], v[152:155]
    v_mfma_f32_16x16x32_bf16 v[88:91], v[216:219], v[236:239], v[88:91]
    s_waitcnt lgkmcnt(1)
    v_mfma_f32_16x16x32_bf16 v[60:63], v[188:191], v[220:223], v[60:63]
    ds_read_b128 v[216:219], v10 offset:47104
    v_mfma_f32_16x16x32_bf16 v[124:127], v[188:191], v[224:227], v[124:127]
    v_mfma_f32_16x16x32_bf16 v[92:95], v[188:191], v[228:231], v[92:95]
    v_mfma_f32_16x16x32_bf16 v[156:159], v[188:191], v[232:235], v[156:159]
    ds_read_b128 v[188:191], v11 offset:32768
    v_mfma_f32_16x16x32_bf16 v[160:163], v[192:195], v[232:235], v[160:163]
    ds_read_b128 v[236:239], v13 offset:49152
    v_mfma_f32_16x16x32_bf16 v[96:99], v[192:195], v[228:231], v[96:99]
    ds_read_b128 v[240:243], v13 offset:51200
    v_mfma_f32_16x16x32_bf16 v[128:131], v[192:195], v[224:227], v[128:131]
    ds_read_b128 v[244:247], v13 offset:53248
    v_mfma_f32_16x16x32_bf16 v[64:67], v[192:195], v[220:223], v[64:67]
    ds_read_b128 v[248:251], v13 offset:55296
    v_mfma_f32_16x16x32_bf16 v[68:71], v[196:199], v[220:223], v[68:71]
    ds_read_b128 v[192:195], v11 offset:34816
    v_mfma_f32_16x16x32_bf16 v[132:135], v[196:199], v[224:227], v[132:135]
    s_waitcnt vmcnt(0)
    v_mfma_f32_16x16x32_bf16 v[100:103], v[196:199], v[228:231], v[100:103]
    v_readfirstlane_b32 s83, v20
    s_nop 0
    s_cmp_eq_u32 s83, 0
    s_cbranch_scc1 L_tagwaitXA
L_tagokXA:
    v_mfma_f32_16x16x32_bf16 v[164:167], v[196:199], v[232:235], v[164:167]
    ds_read_b128 v[196:199], v11 offset:36864
    v_mfma_f32_16x16x32_bf16 v[168:171], v[200:203], v[232:235], v[168:171]
    v_mfma_f32_16x16x32_bf16 v[104:107], v[200:203], v[228:231], v[104:107]
    v_mfma_f32_16x16x32_bf16 v[136:139], v[200:203], v[224:227], v[136:139]
    v_mfma_f32_16x16x32_bf16 v[72:75], v[200:203], v[220:223], v[72:75]
    ds_read_b128 v[200:203], v11 offset:38912
    v_mfma_f32_16x16x32_bf16 v[76:79], v[204:207], v[220:223], v[76:79]
    v_mfma_f32_16x16x32_bf16 v[140:143], v[204:207], v[224:227], v[140:143]
    v_mfma_f32_16x16x32_bf16 v[108:111], v[204:207], v[228:231], v[108:111]
    v_mfma_f32_16x16x32_bf16 v[172:175], v[204:207], v[232:235], v[172:175]
    ds_read_b128 v[204:207], v11 offset:40960
    v_mfma_f32_16x16x32_bf16 v[176:179], v[208:211], v[232:235], v[176:179]
    v_mfma_f32_16x16x32_bf16 v[112:115], v[208:211], v[228:231], v[112:115]
    v_mfma_f32_16x16x32_bf16 v[144:147], v[208:211], v[224:227], v[144:147]
    v_mfma_f32_16x16x32_bf16 v[80:83], v[208:211], v[220:223], v[80:83]
    s_waitcnt lgkmcnt(1)
    v_mfma_f32_16x16x32_bf16 v[84:87], v[212:215], v[220:223], v[84:87]
    ds_read_b128 v[208:211], v11 offset:43008
    v_mfma_f32_16x16x32_bf16 v[148:151], v[212:215], v[224:227], v[148:151]
    v_mfma_f32_16x16x32_bf16 v[116:119], v[212:215], v[228:231], v[116:119]
    v_mfma_f32_16x16x32_bf16 v[180:183], v[212:215], v[232:235], v[180:183]
    ds_read_b128 v[212:215], v11 offset:45056
    v_mfma_f32_16x16x32_bf16 v[184:187], v[216:219], v[232:235], v[184:187]
    v_mfma_f32_16x16x32_bf16 v[120:123], v[216:219], v[228:231], v[120:123]
    v_mfma_f32_16x16x32_bf16 v[152:155], v[216:219], v[224:227], v[152:155]
    v_mfma_f32_16x16x32_bf16 v[88:91], v[216:219], v[220:223], v[88:91]
    ds_read_b128 v[216:219], v11 offset:47104
    v_mfma_f32_16x16x32_bf16 v[60:63], v[188:191], v[236:239], v[60:63]
    v_mfma_f32_16x16x32_bf16 v[124:127], v[188:191], v[240:243], v[124:127]
    v_mfma_f32_16x16x32_bf16 v[92:95], v[188:191], v[244:247], v[92:95]
    v_mfma_f32_16x16x32_bf16 v[156:159], v[188:191], v[248:251], v[156:159]
    v_mfma_f32_16x16x32_bf16 v[160:163], v[192:195], v[248:251], v[160:163]
    v_mfma_f32_16x16x32_bf16 v[96:99], v[192:195], v[244:247], v[96:99]
    v_mfma_f32_16x16x32_bf16 v[128:131], v[192:195], v[240:243], v[128:131]
    v_mfma_f32_16x16x32_bf16 v[64:67], v[192:195], v[236:239], v[64:67]
    v_mfma_f32_16x16x32_bf16 v[68:71], v[196:199], v[236:239], v[68:71]
    v_mfma_f32_16x16x32_bf16 v[132:135], v[196:199], v[240:243], v[132:135]
    v_mfma_f32_16x16x32_bf16 v[100:103], v[196:199], v[244:247], v[100:103]
    v_mfma_f32_16x16x32_bf16 v[164:167], v[196:199], v[248:251], v[164:167]
    s_waitcnt lgkmcnt(0)
    s_barrier
    v_mfma_f32_16x16x32_bf16 v[168:171], v[200:203], v[248:251], v[168:171]
    ds_read_b128 v[188:191], v10 offset:0
    v_mfma_f32_16x16x32_bf16 v[104:107], v[200:203], v[244:247], v[104:107]
    ds_read_b128 v[220:223], v12 offset:0
    v_mfma_f32_16x16x32_bf16 v[136:139], v[200:203], v[240:243], v[136:139]
    ds_read_b128 v[224:227], v12 offset:2048
    v_mfma_f32_16x16x32_bf16 v[72:75], v[200:203], v[236:239], v[72:75]
    ds_read_b128 v[228:231], v12 offset:4096
    v_mfma_f32_16x16x32_bf16 v[76:79], v[204:207], v[236:239], v[76:79]
    ds_read_b128 v[232:235], v12 offset:6144
    v_mfma_f32_16x16x32_bf16 v[140:143], v[204:207], v[240:243], v[140:143]
    ds_read_b128 v[192:195], v10 offset:2048
    v_mfma_f32_16x16x32_bf16 v[108:111], v[204:207], v[244:247], v[108:111]
    ds_read_b128 v[196:199], v10 offset:4096
    v_mfma_f32_16x16x32_bf16 v[172:175], v[204:207], v[248:251], v[172:175]
    ds_read_b128 v[200:203], v11 offset:0
    v_mfma_f32_16x16x32_bf16 v[176:179], v[208:211], v[248:251], v[176:179]
    v_mfma_f32_16x16x32_bf16 v[112:115], v[208:211], v[244:247], v[112:115]
    v_mfma_f32_16x16x32_bf16 v[144:147], v[208:211], v[240:243], v[144:147]
    v_mfma_f32_16x16x32_bf16 v[80:83], v[208:211], v[236:239], v[80:83]
    v_mfma_f32_16x16x32_bf16 v[84:87], v[212:215], v[236:239], v[84:87]
    v_mfma_f32_16x16x32_bf16 v[148:151], v[212:215], v[240:243], v[148:151]
    v_mfma_f32_16x16x32_bf16 v[116:119], v[212:215], v[244:247], v[116:119]
    v_mfma_f32_16x16x32_bf16 v[180:183], v[212:215], v[248:251], v[180:183]
    v_mfma_f32_16x16x32_bf16 v[184:187], v[216:219], v[248:251], v[184:187]
    v_mfma_f32_16x16x32_bf16 v[120:123], v[216:219], v[244:247], v[120:123]
    v_mfma_f32_16x16x32_bf16 v[152:155], v[216:219], v[240:243], v[152:155]
    v_mfma_f32_16x16x32_bf16 v[88:91], v[216:219], v[236:239], v[88:91]
    s_waitcnt lgkmcnt(0)
    v_mfma_f32_16x16x32_bf16 v[60:63], v[188:191], v[220:223], v[60:63]
    ds_read_b128 v[236:239], v13 offset:0
    v_mfma_f32_16x16x32_bf16 v[124:127], v[188:191], v[224:227], v[124:127]
    ds_read_b128 v[240:243], v13 offset:2048
    v_mfma_f32_16x16x32_bf16 v[92:95], v[188:191], v[228:231], v[92:95]
    ds_read_b128 v[244:247], v13 offset:4096
    v_mfma_f32_16x16x32_bf16 v[156:159], v[188:191], v[232:235], v[156:159]
    ds_read_b128 v[248:251], v13 offset:6144
    v_mfma_f32_16x16x32_bf16 v[160:163], v[192:195], v[232:235], v[160:163]
    ds_read_b128 v[204:207], v10 offset:6144
    v_mfma_f32_16x16x32_bf16 v[96:99], v[192:195], v[228:231], v[96:99]
    ds_read_b128 v[208:211], v11 offset:2048
    v_mfma_f32_16x16x32_bf16 v[128:131], v[192:195], v[224:227], v[128:131]
    ds_read_b128 v[212:215], v10 offset:8192
    v_mfma_f32_16x16x32_bf16 v[64:67], v[192:195], v[220:223], v[64:67]
    ds_read_b128 v[216:219], v11 offset:4096
    v_mfma_f32_16x16x32_bf16 v[68:71], v[196:199], v[220:223], v[68:71]
    ds_read_b128 v[188:191], v10 offset:10240
    v_mfma_f32_16x16x32_bf16 v[132:135], v[196:199], v[224:227], v[132:135]
    ds_read_b128 v[192:195], v11 offset:6144
    v_mfma_f32_16x16x32_bf16 v[100:103], v[196:199], v[228:231], v[100:103]
    v_mfma_f32_16x16x32_bf16 v[164:167], v[196:199], v[232:235], v[164:167]
    s_waitcnt lgkmcnt(5)
    v_mfma_f32_16x16x32_bf16 v[156:159], v[200:203], v[248:251], v[156:159]
    ds_read_b128 v[196:199], v10 offset:12288
    v_mfma_f32_16x16x32_bf16 v[92:95], v[200:203], v[244:247], v[92:95]
    v_mfma_f32_16x16x32_bf16 v[124:127], v[200:203], v[240:243], v[124:127]
    v_mfma_f32_16x16x32_bf16 v[60:63], v[200:203], v[236:239], v[60:63]
    ds_read_b128 v[200:203], v11 offset:8192
    v_mfma_f32_16x16x32_bf16 v[72:75], v[204:207], v[220:223], v[72:75]
    v_mfma_f32_16x16x32_bf16 v[136:139], v[204:207], v[224:227], v[136:139]
    v_mfma_f32_16x16x32_bf16 v[104:107], v[204:207], v[228:231], v[104:107]
    v_mfma_f32_16x16x32_bf16 v[168:171], v[204:207], v[232:235], v[168:171]
    s_waitcnt lgkmcnt(1)
    v_mfma_f32_16x16x32_bf16 v[160:163], v[208:211], v[248:251], v[160:163]
    ds_read_b128 v[204:207], v10 offset:14336
    v_mfma_f32_16x16x32_bf16 v[96:99], v[208:211], v[244:247], v[96:99]
    v_mfma_f32_16x16x32_bf16 v[128:131], v[208:211], v[240:243], v[128:131]
    v_mfma_f32_16x16x32_bf16 v[64:67], v[208:211], v[236:239], v[64:67]
    ds_read_b128 v[208:211], v11 offset:10240
    v_mfma_f32_16x16x32_bf16 v[76:79], v[212:215], v[220:223], v[76:79]
    v_permlane16_swap_b32 v60, v124
    v_mfma_f32_16x16x32_bf16 v[140:143], v[212:215], v[224:227], v[140:143]
    v_permlane16_swap_b32 v92, v156
    v_mfma_f32_16x16x32_bf16 v[108:111], v[212:215], v[228:231], v[108:111]
    v_permlane16_swap_b32 v61, v125
    v_mfma_f32_16x16x32_bf16 v[172:175], v[212:215], v[232:235], v[172:175]
    ds_read_b128 v[212:215], v11 offset:12288
    v_mfma_f32_16x16x32_bf16 v[164:167], v[216:219], v[248:251], v[164:167]
    v_permlane16_swap_b32 v93, v157
    v_mfma_f32_16x16x32_bf16 v[100:103], v[216:219], v[244:247], v[100:103]
    v_permlane16_swap_b32 v62, v126
    v_mfma_f32_16x16x32_bf16 v[132:135], v[216:219], v[240:243], v[132:135]
    v_permlane16_swap_b32 v94, v158
    v_mfma_f32_16x16x32_bf16 v[68:71], v[216:219], v[236:239], v[68:71]
    ds_read_b128 v[216:219], v11 offset:14336
    v_mfma_f32_16x16x32_bf16 v[80:83], v[188:191], v[220:223], v[80:83]
    v_permlane16_swap_b32 v63, v127
    v_mfma_f32_16x16x32_bf16 v[144:147], v[188:191], v[224:227], v[144:147]
    v_permlane16_swap_b32 v95, v159
    v_mfma_f32_16x16x32_bf16 v[112:115], v[188:191], v[228:231], v[112:115]
    v_permlane16_swap_b32 v64, v128
    v_mfma_f32_16x16x32_bf16 v[176:179], v[188:191], v[232:235], v[176:179]
    v_permlane16_swap_b32 v96, v160
    v_mfma_f32_16x16x32_bf16 v[168:171], v[192:195], v[248:251], v[168:171]
    v_permlane16_swap_b32 v65, v129
    v_mfma_f32_16x16x32_bf16 v[104:107], v[192:195], v[244:247], v[104:107]
    v_permlane16_swap_b32 v97, v161
    v_mfma_f32_16x16x32_bf16 v[136:139], v[192:195], v[240:243], v[136:139]
    v_permlane16_swap_b32 v66, v130
    v_mfma_f32_16x16x32_bf16 v[72:75], v[192:195], v[236:239], v[72:75]
    v_permlane16_swap_b32 v98, v162
    v_mfma_f32_16x16x32_bf16 v[84:87], v[196:199], v[220:223], v[84:87]
    v_permlane16_swap_b32 v67, v131
    v_mfma_f32_16x16x32_bf16 v[148:151], v[196:199], v[224:227], v[148:151]
    v_permlane16_swap_b32 v99, v163
    v_mfma_f32_16x16x32_bf16 v[116:119], v[196:199], v[228:231], v[116:119]
    v_permlane16_swap_b32 v68, v132
    v_mfma_f32_16x16x32_bf16 v[180:183], v[196:199], v[232:235], v[180:183]
    s_waitcnt lgkmcnt(0)
    s_barrier
    v_mfma_f32_16x16x32_bf16 v[172:175], v[200:203], v[248:251], v[172:175]
    v_permlane16_swap_b32 v100, v164
    v_mfma_f32_16x16x32_bf16 v[108:111], v[200:203], v[244:247], v[108:111]
    v_permlane16_swap_b32 v69, v133
    v_mfma_f32_16x16x32_bf16 v[140:143], v[200:203], v[240:243], v[140:143]
    v_permlane16_swap_b32 v101, v165
    v_mfma_f32_16x16x32_bf16 v[76:79], v[200:203], v[236:239], v[76:79]
    v_permlane16_swap_b32 v70, v134
    v_mfma_f32_16x16x32_bf16 v[88:91], v[204:207], v[220:223], v[88:91]
    v_permlane16_swap_b32 v102, v166
    v_mfma_f32_16x16x32_bf16 v[152:155], v[204:207], v[224:227], v[152:155]
    v_permlane16_swap_b32 v71, v135
    v_mfma_f32_16x16x32_bf16 v[120:123], v[204:207], v[228:231], v[120:123]
    v_permlane16_swap_b32 v103, v167
    v_mfma_f32_16x16x32_bf16 v[184:187], v[204:207], v[232:235], v[184:187]
    v_permlane16_swap_b32 v72, v136
    v_mfma_f32_16x16x32_bf16 v[176:179], v[208:211], v[248:251], v[176:179]
    v_permlane16_swap_b32 v104, v168
    v_mfma_f32_16x16x32_bf16 v[112:115], v[208:211], v[244:247], v[112:115]
    v_permlane16_swap_b32 v73, v137
    v_mfma_f32_16x16x32_bf16 v[144:147], v[208:211], v[240:243], v[144:147]
    v_permlane16_swap_b32 v105, v169
    v_mfma_f32_16x16x32_bf16 v[80:83], v[208:211], v[236:239], v[80:83]
    v_permlane16_swap_b32 v74, v138
    v_mfma_f32_16x16x32_bf16 v[84:87], v[212:215], v[236:239], v[84:87]
    v_permlane16_swap_b32 v106, v170
    v_mfma_f32_16x16x32_bf16 v[148:151], v[212:215], v[240:243], v[148:151]
    v_permlane16_swap_b32 v75, v139
    v_mfma_f32_16x16x32_bf16 v[116:119], v[212:215], v[244:247], v[116:119]
    v_permlane16_swap_b32 v107, v171
    v_mfma_f32_16x16x32_bf16 v[180:183], v[212:215], v[248:251], v[180:183]
    v_permlane16_swap_b32 v76, v140
    v_mfma_f32_16x16x32_bf16 v[184:187], v[216:219], v[248:251], v[184:187]
    v_permlane16_swap_b32 v108, v172
    v_mfma_f32_16x16x32_bf16 v[120:123], v[216:219], v[244:247], v[120:123]
    v_permlane16_swap_b32 v77, v141
    v_mfma_f32_16x16x32_bf16 v[152:155], v[216:219], v[240:243], v[152:155]
    v_permlane16_swap_b32 v109, v173
    v_mfma_f32_16x16x32_bf16 v[88:91], v[216:219], v[236:239], v[88:91]
    v_permlane16_swap_b32 v78, v142
    s_setprio 1
    s_nop 7
    v_permlane16_swap_b32 v110, v174
    v_permlane16_swap_b32 v79, v143
    v_permlane16_swap_b32 v111, v175
    v_permlane16_swap_b32 v80, v144
    v_permlane16_swap_b32 v112, v176
    v_permlane16_swap_b32 v81, v145
    v_permlane16_swap_b32 v113, v177
    v_permlane16_swap_b32 v82, v146
    v_permlane16_swap_b32 v114, v178
    v_permlane16_swap_b32 v83, v147
    v_permlane16_swap_b32 v115, v179
    v_permlane16_swap_b32 v84, v148
    v_permlane16_swap_b32 v116, v180
    v_permlane16_swap_b32 v85, v149
    v_permlane16_swap_b32 v117, v181
    v_permlane16_swap_b32 v86, v150
    v_permlane16_swap_b32 v118, v182
    v_permlane16_swap_b32 v87, v151
    v_permlane16_swap_b32 v119, v183
    v_permlane16_swap_b32 v88, v152
    v_permlane16_swap_b32 v120, v184
    v_permlane16_swap_b32 v89, v153
    v_permlane16_swap_b32 v121, v185
    v_permlane16_swap_b32 v90, v154
    v_permlane16_swap_b32 v122, v186
    v_permlane16_swap_b32 v91, v155
    v_permlane16_swap_b32 v123, v187
    v_pk_fma_f32 v[46:47], v[24:25], v[60:61], v[62:63] op_sel:[0,0,0] op_sel_hi:[0,1,1]
    v_pk_fma_f32 v[48:49], v[24:25], v[92:93], v[94:95] op_sel:[0,0,0] op_sel_hi:[0,1,1]
    v_pk_fma_f32 v[46:47], v[24:25], v[92:93], v[46:47] op_sel:[1,0,0] op_sel_hi:[1,1,1] neg_lo:[1,0,0] neg_hi:[1,0,0]
    v_pk_fma_f32 v[48:49], v[24:25], v[60:61], v[48:49] op_sel:[1,0,0] op_sel_hi:[1,1,1]
    v_pk_fma_f32 v[42:43], v[24:25], v[46:47], v[64:65] op_sel:[0,0,0] op_sel_hi:[0,1,1]
    v_pk_fma_f32 v[44:45], v[24:25], v[48:49], v[96:97] op_sel:[0,0,0] op_sel_hi:[0,1,1]
    v_pk_fma_f32 v[42:43], v[24:25], v[48:49], v[42:43] op_sel:[1,0,0] op_sel_hi:[1,1,1] neg_lo:[1,0,0] neg_hi:[1,0,0]
    v_pk_fma_f32 v[44:45], v[24:25], v[46:47], v[44:45] op_sel:[1,0,0] op_sel_hi:[1,1,1]
    v_pk_fma_f32 v[46:47], v[24:25], v[42:43], v[66:67] op_sel:[0,0,0] op_sel_hi:[0,1,1]
    v_pk_fma_f32 v[48:49], v[24:25], v[44:45], v[98:99] op_sel:[0,0,0] op_sel_hi:[0,1,1]
    v_pk_fma_f32 v[46:47], v[24:25], v[44:45], v[46:47] op_sel:[1,0,0] op_sel_hi:[1,1,1] neg_lo:[1,0,0] neg_hi:[1,0,0]
    v_pk_fma_f32 v[48:49], v[24:25], v[42:43], v[48:49] op_sel:[1,0,0] op_sel_hi:[1,1,1]
    v_pk_fma_f32 v[42:43], v[24:25], v[46:47], v[68:69] op_sel:[0,0,0] op_sel_hi:[0,1,1]
    v_pk_fma_f32 v[44:45], v[24:25], v[48:49], v[100:101] op_sel:[0,0,0] op_sel_hi:[0,1,1]
    v_pk_fma_f32 v[42:43], v[24:25], v[48:49], v[42:43] op_sel:[1,0,0] op_sel_hi:[1,1,1] neg_lo:[1,0,0] neg_hi:[1,0,0]
    v_pk_fma_f32 v[44:45], v[24:25], v[46:47], v[44:45] op_sel:[1,0,0] op_sel_hi:[1,1,1]
    v_pk_fma_f32 v[46:47], v[24:25], v[42:43], v[70:71] op_sel:[0,0,0] op_sel_hi:[0,1,1]
    v_pk_fma_f32 v[48:49], v[24:25], v[44:45], v[102:103] op_sel:[0,0,0] op_sel_hi:[0,1,1]
    v_pk_fma_f32 v[46:47], v[24:25], v[44:45], v[46:47] op_sel:[1,0,0] op_sel_hi:[1,1,1] neg_lo:[1,0,0] neg_hi:[1,0,0]
    v_pk_fma_f32 v[48:49], v[24:25], v[42:43], v[48:49] op_sel:[1,0,0] op_sel_hi:[1,1,1]
    v_pk_fma_f32 v[42:43], v[24:25], v[46:47], v[72:73] op_sel:[0,0,0] op_sel_hi:[0,1,1]
    v_pk_fma_f32 v[44:45], v[24:25], v[48:49], v[104:105] op_sel:[0,0,0] op_sel_hi:[0,1,1]
    v_pk_fma_f32 v[42:43], v[24:25], v[48:49], v[42:43] op_sel:[1,0,0] op_sel_hi:[1,1,1] neg_lo:[1,0,0] neg_hi:[1,0,0]
    v_pk_fma_f32 v[44:45], v[24:25], v[46:47], v[44:45] op_sel:[1,0,0] op_sel_hi:[1,1,1]
    v_pk_fma_f32 v[46:47], v[24:25], v[42:43], v[74:75] op_sel:[0,0,0] op_sel_hi:[0,1,1]
    v_pk_fma_f32 v[48:49], v[24:25], v[44:45], v[106:107] op_sel:[0,0,0] op_sel_hi:[0,1,1]
    v_pk_fma_f32 v[46:47], v[24:25], v[44:45], v[46:47] op_sel:[1,0,0] op_sel_hi:[1,1,1] neg_lo:[1,0,0] neg_hi:[1,0,0]
    v_pk_fma_f32 v[48:49], v[24:25], v[42:43], v[48:49] op_sel:[1,0,0] op_sel_hi:[1,1,1]
    v_pk_fma_f32 v[42:43], v[24:25], v[46:47], v[76:77] op_sel:[0,0,0] op_sel_hi:[0,1,1]
    v_pk_fma_f32 v[44:45], v[24:25], v[48:49], v[108:109] op_sel:[0,0,0] op_sel_hi:[0,1,1]
    v_pk_fma_f32 v[42:43], v[24:25], v[48:49], v[42:43] op_sel:[1,0,0] op_sel_hi:[1,1,1] neg_lo:[1,0,0] neg_hi:[1,0,0]
    v_pk_fma_f32 v[44:45], v[24:25], v[46:47], v[44:45] op_sel:[1,0,0] op_sel_hi:[1,1,1]
    v_pk_fma_f32 v[46:47], v[24:25], v[42:43], v[78:79] op_sel:[0,0,0] op_sel_hi:[0,1,1]
    v_pk_fma_f32 v[48:49], v[24:25], v[44:45], v[110:111] op_sel:[0,0,0] op_sel_hi:[0,1,1]
    v_pk_fma_f32 v[46:47], v[24:25], v[44:45], v[46:47] op_sel:[1,0,0] op_sel_hi:[1,1,1] neg_lo:[1,0,0] neg_hi:[1,0,0]
    v_pk_fma_f32 v[48:49], v[24:25], v[42:43], v[48:49] op_sel:[1,0,0] op_sel_hi:[1,1,1]
    v_pk_fma_f32 v[42:43], v[24:25], v[46:47], v[80:81] op_sel:[0,0,0] op_sel_hi:[0,1,1]
    v_pk_fma_f32 v[44:45], v[24:25], v[48:49], v[112:113] op_sel:[0,0,0] op_sel_hi:[0,1,1]
    v_pk_fma_f32 v[42:43], v[24:25], v[48:49], v[42:43] op_sel:[1,0,0] op_sel_hi:[1,1,1] neg_lo:[1,0,0] neg_hi:[1,0,0]
    v_pk_fma_f32 v[44:45], v[24:25], v[46:47], v[44:45] op_sel:[1,0,0] op_sel_hi:[1,1,1]
    v_pk_fma_f32 v[46:47], v[24:25], v[42:43], v[82:83] op_sel:[0,0,0] op_sel_hi:[0,1,1]
    v_pk_fma_f32 v[48:49], v[24:25], v[44:45], v[114:115] op_sel:[0,0,0] op_sel_hi:[0,1,1]
    v_pk_fma_f32 v[46:47], v[24:25], v[44:45], v[46:47] op_sel:[1,0,0] op_sel_hi:[1,1,1] neg_lo:[1,0,0] neg_hi:[1,0,0]
    v_pk_fma_f32 v[48:49], v[24:25], v[42:43], v[48:49] op_sel:[1,0,0] op_sel_hi:[1,1,1]
    v_pk_fma_f32 v[42:43], v[24:25], v[46:47], v[84:85] op_sel:[0,0,0] op_sel_hi:[0,1,1]
    v_pk_fma_f32 v[44:45], v[24:25], v[48:49], v[116:117] op_sel:[0,0,0] op_sel_hi:[0,1,1]
    v_pk_fma_f32 v[42:43], v[24:25], v[48:49], v[42:43] op_sel:[1,0,0] op_sel_hi:[1,1,1] neg_lo:[1,0,0] neg_hi:[1,0,0]
    v_pk_fma_f32 v[44:45], v[24:25], v[46:47], v[44:45] op_sel:[1,0,0] op_sel_hi:[1,1,1]
    v_pk_fma_f32 v[46:47], v[24:25], v[42:43], v[86:87] op_sel:[0,0,0] op_sel_hi:[0,1,1]
    v_pk_fma_f32 v[48:49], v[24:25], v[44:45], v[118:119] op_sel:[0,0,0] op_sel_hi:[0,1,1]
    v_pk_fma_f32 v[46:47], v[24:25], v[44:45], v[46:47] op_sel:[1,0,0] op_sel_hi:[1,1,1] neg_lo:[1,0,0] neg_hi:[1,0,0]
    v_pk_fma_f32 v[48:49], v[24:25], v[42:43], v[48:49] op_sel:[1,0,0] op_sel_hi:[1,1,1]
    v_pk_fma_f32 v[42:43], v[24:25], v[46:47], v[88:89] op_sel:[0,0,0] op_sel_hi:[0,1,1]
    v_pk_fma_f32 v[44:45], v[24:25], v[48:49], v[120:121] op_sel:[0,0,0] op_sel_hi:[0,1,1]
    v_pk_fma_f32 v[42:43], v[24:25], v[48:49], v[42:43] op_sel:[1,0,0] op_sel_hi:[1,1,1] neg_lo:[1,0,0] neg_hi:[1,0,0]
    v_pk_fma_f32 v[44:45], v[24:25], v[46:47], v[44:45] op_sel:[1,0,0] op_sel_hi:[1,1,1]
    v_pk_fma_f32 v[46:47], v[24:25], v[42:43], v[90:91] op_sel:[0,0,0] op_sel_hi:[0,1,1]
    v_pk_fma_f32 v[48:49], v[24:25], v[44:45], v[122:123] op_sel:[0,0,0] op_sel_hi:[0,1,1]
    v_pk_fma_f32 v[46:47], v[24:25], v[44:45], v[46:47] op_sel:[1,0,0] op_sel_hi:[1,1,1] neg_lo:[1,0,0] neg_hi:[1,0,0]
    v_pk_fma_f32 v[48:49], v[24:25], v[42:43], v[48:49] op_sel:[1,0,0] op_sel_hi:[1,1,1]
    v_pk_fma_f32 v[42:43], v[24:25], v[46:47], v[124:125] op_sel:[0,0,0] op_sel_hi:[0,1,1]
    v_pk_fma_f32 v[44:45], v[24:25], v[48:49], v[156:157] op_sel:[0,0,0] op_sel_hi:[0,1,1]
    v_pk_fma_f32 v[42:43], v[24:25], v[48:49], v[42:43] op_sel:[1,0,0] op_sel_hi:[1,1,1] neg_lo:[1,0,0] neg_hi:[1,0,0]
    v_pk_fma_f32 v[44:45], v[24:25], v[46:47], v[44:45] op_sel:[1,0,0] op_sel_hi:[1,1,1]
    v_pk_fma_f32 v[46:47], v[24:25], v[42:43], v[126:127] op_sel:[0,0,0] op_sel_hi:[0,1,1]
    v_pk_fma_f32 v[48:49], v[24:25], v[44:45], v[158:159] op_sel:[0,0,0] op_sel_hi:[0,1,1]
    v_pk_fma_f32 v[46:47], v[24:25], v[44:45], v[46:47] op_sel:[1,0,0] op_sel_hi:[1,1,1] neg_lo:[1,0,0] neg_hi:[1,0,0]
    v_pk_fma_f32 v[48:49], v[24:25], v[42:43], v[48:49] op_sel:[1,0,0] op_sel_hi:[1,1,1]
    v_pk_fma_f32 v[42:43], v[24:25], v[46:47], v[128:129] op_sel:[0,0,0] op_sel_hi:[0,1,1]
    v_pk_fma_f32 v[44:45], v[24:25], v[48:49], v[160:161] op_sel:[0,0,0] op_sel_hi:[0,1,1]
    v_pk_fma_f32 v[42:43], v[24:25], v[48:49], v[42:43] op_sel:[1,0,0] op_sel_hi:[1,1,1] neg_lo:[1,0,0] neg_hi:[1,0,0]
    v_pk_fma_f32 v[44:45], v[24:25], v[46:47], v[44:45] op_sel:[1,0,0] op_sel_hi:[1,1,1]
    v_pk_fma_f32 v[46:47], v[24:25], v[42:43], v[130:131] op_sel:[0,0,0] op_sel_hi:[0,1,1]
    v_pk_fma_f32 v[48:49], v[24:25], v[44:45], v[162:163] op_sel:[0,0,0] op_sel_hi:[0,1,1]
    v_pk_fma_f32 v[46:47], v[24:25], v[44:45], v[46:47] op_sel:[1,0,0] op_sel_hi:[1,1,1] neg_lo:[1,0,0] neg_hi:[1,0,0]
    v_pk_fma_f32 v[48:49], v[24:25], v[42:43], v[48:49] op_sel:[1,0,0] op_sel_hi:[1,1,1]
    v_pk_fma_f32 v[42:43], v[24:25], v[46:47], v[132:133] op_sel:[0,0,0] op_sel_hi:[0,1,1]
    v_pk_fma_f32 v[44:45], v[24:25], v[48:49], v[164:165] op_sel:[0,0,0] op_sel_hi:[0,1,1]
    v_pk_fma_f32 v[42:43], v[24:25], v[48:49], v[42:43] op_sel:[1,0,0] op_sel_hi:[1,1,1] neg_lo:[1,0,0] neg_hi:[1,0,0]
    v_pk_fma_f32 v[44:45], v[24:25], v[46:47], v[44:45] op_sel:[1,0,0] op_sel_hi:[1,1,1]
    v_pk_fma_f32 v[46:47], v[24:25], v[42:43], v[134:135] op_sel:[0,0,0] op_sel_hi:[0,1,1]
    v_pk_fma_f32 v[48:49], v[24:25], v[44:45], v[166:167] op_sel:[0,0,0] op_sel_hi:[0,1,1]
    v_pk_fma_f32 v[46:47], v[24:25], v[44:45], v[46:47] op_sel:[1,0,0] op_sel_hi:[1,1,1] neg_lo:[1,0,0] neg_hi:[1,0,0]
    v_pk_fma_f32 v[48:49], v[24:25], v[42:43], v[48:49] op_sel:[1,0,0] op_sel_hi:[1,1,1]
    v_pk_fma_f32 v[42:43], v[24:25], v[46:47], v[136:137] op_sel:[0,0,0] op_sel_hi:[0,1,1]
    v_pk_fma_f32 v[44:45], v[24:25], v[48:49], v[168:169] op_sel:[0,0,0] op_sel_hi:[0,1,1]
    v_pk_fma_f32 v[42:43], v[24:25], v[48:49], v[42:43] op_sel:[1,0,0] op_sel_hi:[1,1,1] neg_lo:[1,0,0] neg_hi:[1,0,0]
    v_pk_fma_f32 v[44:45], v[24:25], v[46:47], v[44:45] op_sel:[1,0,0] op_sel_hi:[1,1,1]
    v_pk_fma_f32 v[46:47], v[24:25], v[42:43], v[138:139] op_sel:[0,0,0] op_sel_hi:[0,1,1]
    v_pk_fma_f32 v[48:49], v[24:25], v[44:45], v[170:171] op_sel:[0,0,0] op_sel_hi:[0,1,1]
    v_pk_fma_f32 v[46:47], v[24:25], v[44:45], v[46:47] op_sel:[1,0,0] op_sel_hi:[1,1,1] neg_lo:[1,0,0] neg_hi:[1,0,0]
    v_pk_fma_f32 v[48:49], v[24:25], v[42:43], v[48:49] op_sel:[1,0,0] op_sel_hi:[1,1,1]
    v_pk_fma_f32 v[42:43], v[24:25], v[46:47], v[140:141] op_sel:[0,0,0] op_sel_hi:[0,1,1]
    v_pk_fma_f32 v[44:45], v[24:25], v[48:49], v[172:173] op_sel:[0,0,0] op_sel_hi:[0,1,1]
    v_pk_fma_f32 v[42:43], v[24:25], v[48:49], v[42:43] op_sel:[1,0,0] op_sel_hi:[1,1,1] neg_lo:[1,0,0] neg_hi:[1,0,0]
    v_pk_fma_f32 v[44:45], v[24:25], v[46:47], v[44:45] op_sel:[1,0,0] op_sel_hi:[1,1,1]
    v_pk_fma_f32 v[46:47], v[24:25], v[42:43], v[142:143] op_sel:[0,0,0] op_sel_hi:[0,1,1]
    v_pk_fma_f32 v[48:49], v[24:25], v[44:45], v[174:175] op_sel:[0,0,0] op_sel_hi:[0,1,1]
    v_pk_fma_f32 v[46:47], v[24:25], v[44:45], v[46:47] op_sel:[1,0,0] op_sel_hi:[1,1,1] neg_lo:[1,0,0] neg_hi:[1,0,0]
    v_pk_fma_f32 v[48:49], v[24:25], v[42:43], v[48:49] op_sel:[1,0,0] op_sel_hi:[1,1,1]
    v_pk_fma_f32 v[42:43], v[24:25], v[46:47], v[144:145] op_sel:[0,0,0] op_sel_hi:[0,1,1]
    v_pk_fma_f32 v[44:45], v[24:25], v[48:49], v[176:177] op_sel:[0,0,0] op_sel_hi:[0,1,1]
    v_pk_fma_f32 v[42:43], v[24:25], v[48:49], v[42:43] op_sel:[1,0,0] op_sel_hi:[1,1,1] neg_lo:[1,0,0] neg_hi:[1,0,0]
    v_pk_fma_f32 v[44:45], v[24:25], v[46:47], v[44:45] op_sel:[1,0,0] op_sel_hi:[1,1,1]
    v_pk_fma_f32 v[46:47], v[24:25], v[42:43], v[146:147] op_sel:[0,0,0] op_sel_hi:[0,1,1]
    v_pk_fma_f32 v[48:49], v[24:25], v[44:45], v[178:179] op_sel:[0,0,0] op_sel_hi:[0,1,1]
    v_pk_fma_f32 v[46:47], v[24:25], v[44:45], v[46:47] op_sel:[1,0,0] op_sel_hi:[1,1,1] neg_lo:[1,0,0] neg_hi:[1,0,0]
    v_pk_fma_f32 v[48:49], v[24:25], v[42:43], v[48:49] op_sel:[1,0,0] op_sel_hi:[1,1,1]
    v_pk_fma_f32 v[42:43], v[24:25], v[46:47], v[148:149] op_sel:[0,0,0] op_sel_hi:[0,1,1]
    v_pk_fma_f32 v[44:45], v[24:25], v[48:49], v[180:181] op_sel:[0,0,0] op_sel_hi:[0,1,1]
    v_pk_fma_f32 v[42:43], v[24:25], v[48:49], v[42:43] op_sel:[1,0,0] op_sel_hi:[1,1,1] neg_lo:[1,0,0] neg_hi:[1,0,0]
    v_pk_fma_f32 v[44:45], v[24:25], v[46:47], v[44:45] op_sel:[1,0,0] op_sel_hi:[1,1,1]
    v_pk_fma_f32 v[46:47], v[24:25], v[42:43], v[150:151] op_sel:[0,0,0] op_sel_hi:[0,1,1]
    v_pk_fma_f32 v[48:49], v[24:25], v[44:45], v[182:183] op_sel:[0,0,0] op_sel_hi:[0,1,1]
    v_pk_fma_f32 v[46:47], v[24:25], v[44:45], v[46:47] op_sel:[1,0,0] op_sel_hi:[1,1,1] neg_lo:[1,0,0] neg_hi:[1,0,0]
    v_pk_fma_f32 v[48:49], v[24:25], v[42:43], v[48:49] op_sel:[1,0,0] op_sel_hi:[1,1,1]
    v_pk_fma_f32 v[42:43], v[24:25], v[46:47], v[152:153] op_sel:[0,0,0] op_sel_hi:[0,1,1]
    v_pk_fma_f32 v[44:45], v[24:25], v[48:49], v[184:185] op_sel:[0,0,0] op_sel_hi:[0,1,1]
    v_pk_fma_f32 v[42:43], v[24:25], v[48:49], v[42:43] op_sel:[1,0,0] op_sel_hi:[1,1,1] neg_lo:[1,0,0] neg_hi:[1,0,0]
    v_pk_fma_f32 v[44:45], v[24:25], v[46:47], v[44:45] op_sel:[1,0,0] op_sel_hi:[1,1,1]
    v_pk_fma_f32 v[46:47], v[24:25], v[42:43], v[154:155] op_sel:[0,0,0] op_sel_hi:[0,1,1]
    v_pk_fma_f32 v[48:49], v[24:25], v[44:45], v[186:187] op_sel:[0,0,0] op_sel_hi:[0,1,1]
    v_pk_fma_f32 v[46:47], v[24:25], v[44:45], v[46:47] op_sel:[1,0,0] op_sel_hi:[1,1,1] neg_lo:[1,0,0] neg_hi:[1,0,0]
    v_pk_fma_f32 v[48:49], v[24:25], v[42:43], v[48:49] op_sel:[1,0,0] op_sel_hi:[1,1,1]
    v_mov_b32 v39, v46
    v_mov_b32 v40, v48
    v_fma_f32 v42, v31, v39, v47
    v_fma_f32 v43, v31, v40, v49
    v_fma_f32 v42, -v32, v40, v42
    v_fmac_f32 v43, v32, v39
    ds_write_b64 v6, v[42:43]
    v_add_u32 v3, s76, v2
    v_cmp_eq_u32 vcc, 0, v3
    v_mov_b32 v5, 0x40000000
    v_mov_b32 v205, v20
    v_mov_b32 v207, v20
    v_cndmask_b32 v5, v5, v19, vcc
    s_add_u32 s74, s79, 1
    v_sub_u32 v6, s74, v2
    v_and_b32 v6, -2, v6
    v_mul_lo_u32 v6, v6, v20
    s_waitcnt lgkmcnt(0)
    s_barrier
    ds_read_b64 v[42:43], v18 offset:0
    ds_read_b64 v[44:45], v18 offset:256
    ds_read_b64 v[46:47], v18 offset:512
    ds_read_b64 v[48:49], v18 offset:768
    s_waitcnt lgkmcnt(0)
    v_fma_f32 v204, v33, v42, v44
    v_fma_f32 v206, v33, v43, v45
    v_fma_f32 v204, -v34, v43, v204
    v_fmac_f32 v206, v34, v42
    v_fma_f32 v3, v33, v204, v46
    v_fma_f32 v4, v33, v206, v47
    v_fma_f32 v3, -v34, v206, v3
    v_fmac_f32 v4, v34, v204
    v_fma_f32 v204, v33, v3, v48
    v_fma_f32 v206, v33, v4, v49
    v_fma_f32 v204, -v34, v4, v204
    v_fmac_f32 v206, v34, v3
    buffer_store_dwordx4 v[204:207], v5, s[12:15], 0 offen sc1
    v_pk_mul_f32 v[216:217], v[26:27], v[92:93] op_sel:[1,0] op_sel_hi:[1,1]
    v_pk_mul_f32 v[218:219], v[26:27], v[60:61] op_sel:[1,0] op_sel_hi:[1,1]
    v_pk_fma_f32 v[60:61], v[26:27], v[60:61], v[216:217] op_sel:[0,0,0] op_sel_hi:[0,1,1]
    v_pk_fma_f32 v[92:93], v[26:27], v[92:93], v[218:219] op_sel:[0,0,0] op_sel_hi:[0,1,1] neg_lo:[1,0,0] neg_hi:[1,0,0]
    v_pk_mul_f32 v[216:217], v[26:27], v[94:95] op_sel:[1,0] op_sel_hi:[1,1]
    v_pk_mul_f32 v[218:219], v[26:27], v[62:63] op_sel:[1,0] op_sel_hi:[1,1]
    v_pk_fma_f32 v[62:63], v[26:27], v[62:63], v[216:217] op_sel:[0,0,0] op_sel_hi:[0,1,1]
L_pad_10:
    s_cbranch_execz L_ret_x1
    v_pk_fma_f32 v[94:95], v[26:27], v[94:95], v[218:219] op_sel:[0,0,0] op_sel_hi:[0,1,1] neg_lo:[1,0,0] neg_hi:[1,0,0]
    v_pk_mul_f32 v[216:217], v[26:27], v[96:97] op_sel:[1,0] op_sel_hi:[1,1]
    v_pk_mul_f32 v[218:219], v[26:27], v[64:65] op_sel:[1,0] op_sel_hi:[1,1]
    v_pk_fma_f32 v[64:65], v[26:27], v[64:65], v[216:217] op_sel:[0,0,0] op_sel_hi:[0,1,1]
    v_pk_fma_f32 v[96:97], v[26:27], v[96:97], v[218:219] op_sel:[0,0,0] op_sel_hi:[0,1,1] neg_lo:[1,0,0] neg_hi:[1,0,0]
    v_pk_mul_f32 v[216:217], v[26:27], v[98:99] op_sel:[1,0] op_sel_hi:[1,1]
    v_pk_mul_f32 v[218:219], v[26:27], v[66:67] op_sel:[1,0] op_sel_hi:[1,1]
    v_pk_fma_f32 v[66:67], v[26:27], v[66:67], v[216:217] op_sel:[0,0,0] op_sel_hi:[0,1,1]
    v_pk_fma_f32 v[98:99], v[26:27], v[98:99], v[218:219] op_sel:[0,0,0] op_sel_hi:[0,1,1] neg_lo:[1,0,0] neg_hi:[1,0,0]
    v_pk_mul_f32 v[216:217], v[26:27], v[100:101] op_sel:[1,0] op_sel_hi:[1,1]
    v_pk_mul_f32 v[218:219], v[26:27], v[68:69] op_sel:[1,0] op_sel_hi:[1,1]
    v_pk_fma_f32 v[68:69], v[26:27], v[68:69], v[216:217] op_sel:[0,0,0] op_sel_hi:[0,1,1]
    v_pk_fma_f32 v[100:101], v[26:27], v[100:101], v[218:219] op_sel:[0,0,0] op_sel_hi:[0,1,1] neg_lo:[1,0,0] neg_hi:[1,0,0]
    v_pk_mul_f32 v[216:217], v[26:27], v[102:103] op_sel:[1,0] op_sel_hi:[1,1]
    v_pk_mul_f32 v[218:219], v[26:27], v[70:71] op_sel:[1,0] op_sel_hi:[1,1]
    v_pk_fma_f32 v[70:71], v[26:27], v[70:71], v[216:217] op_sel:[0,0,0] op_sel_hi:[0,1,1]
    v_pk_fma_f32 v[102:103], v[26:27], v[102:103], v[218:219] op_sel:[0,0,0] op_sel_hi:[0,1,1] neg_lo:[1,0,0] neg_hi:[1,0,0]
    v_pk_mul_f32 v[216:217], v[26:27], v[104:105] op_sel:[1,0] op_sel_hi:[1,1]
    v_pk_mul_f32 v[218:219], v[26:27], v[72:73] op_sel:[1,0] op_sel_hi:[1,1]
    v_pk_fma_f32 v[72:73], v[26:27], v[72:73], v[216:217] op_sel:[0,0,0] op_sel_hi:[0,1,1]
    v_pk_fma_f32 v[104:105], v[26:27], v[104:105], v[218:219] op_sel:[0,0,0] op_sel_hi:[0,1,1] neg_lo:[1,0,0] neg_hi:[1,0,0]
    v_pk_mul_f32 v[216:217], v[26:27], v[106:107] op_sel:[1,0] op_sel_hi:[1,1]
    v_pk_mul_f32 v[218:219], v[26:27], v[74:75] op_sel:[1,0] op_sel_hi:[1,1]
    v_pk_fma_f32 v[74:75], v[26:27], v[74:75], v[216:217] op_sel:[0,0,0] op_sel_hi:[0,1,1]
    v_pk_fma_f32 v[106:107], v[26:27], v[106:107], v[218:219] op_sel:[0,0,0] op_sel_hi:[0,1,1] neg_lo:[1,0,0] neg_hi:[1,0,0]
    v_pk_mul_f32 v[216:217], v[26:27], v[108:109] op_sel:[1,0] op_sel_hi:[1,1]
    v_pk_mul_f32 v[218:219], v[26:27], v[76:77] op_sel:[1,0] op_sel_hi:[1,1]
    v_pk_fma_f32 v[76:77], v[26:27], v[76:77], v[216:217] op_sel:[0,0,0] op_sel_hi:[0,1,1]
    v_pk_fma_f32 v[108:109], v[26:27], v[108:109], v[218:219] op_sel:[0,0,0] op_sel_hi:[0,1,1] neg_lo:[1,0,0] neg_hi:[1,0,0]
    v_pk_mul_f32 v[216:217], v[26:27], v[110:111] op_sel:[1,0] op_sel_hi:[1,1]
    v_pk_mul_f32 v[218:219], v[26:27], v[78:79] op_sel:[1,0] op_sel_hi:[1,1]
    v_pk_fma_f32 v[78:79], v[26:27], v[78:79], v[216:217] op_sel:[0,0,0] op_sel_hi:[0,1,1]
    v_pk_fma_f32 v[110:111], v[26:27], v[110:111], v[218:219] op_sel:[0,0,0] op_sel_hi:[0,1,1] neg_lo:[1,0,0] neg_hi:[1,0,0]
    v_pk_mul_f32 v[216:217], v[26:27], v[112:113] op_sel:[1,0] op_sel_hi:[1,1]
    v_pk_mul_f32 v[218:219], v[26:27], v[80:81] op_sel:[1,0] op_sel_hi:[1,1]
    v_pk_fma_f32 v[80:81], v[26:27], v[80:81], v[216:217] op_sel:[0,0,0] op_sel_hi:[0,1,1]
    v_pk_fma_f32 v[112:113], v[26:27], v[112:113], v[218:219] op_sel:[0,0,0] op_sel_hi:[0,1,1] neg_lo:[1,0,0] neg_hi:[1,0,0]
    v_pk_mul_f32 v[216:217], v[26:27], v[114:115] op_sel:[1,0] op_sel_hi:[1,1]
    v_pk_mul_f32 v[218:219], v[26:27], v[82:83] op_sel:[1,0] op_sel_hi:[1,1]
    v_pk_fma_f32 v[82:83], v[26:27], v[82:83], v[216:217] op_sel:[0,0,0] op_sel_hi:[0,1,1]
    v_pk_fma_f32 v[114:115], v[26:27], v[114:115], v[218:219] op_sel:[0,0,0] op_sel_hi:[0,1,1] neg_lo:[1,0,0] neg_hi:[1,0,0]
    v_pk_mul_f32 v[216:217], v[26:27], v[116:117] op_sel:[1,0] op_sel_hi:[1,1]
    v_pk_mul_f32 v[218:219], v[26:27], v[84:85] op_sel:[1,0] op_sel_hi:[1,1]
    v_pk_fma_f32 v[84:85], v[26:27], v[84:85], v[216:217] op_sel:[0,0,0] op_sel_hi:[0,1,1]
    v_pk_fma_f32 v[116:117], v[26:27], v[116:117], v[218:219] op_sel:[0,0,0] op_sel_hi:[0,1,1] neg_lo:[1,0,0] neg_hi:[1,0,0]
    v_pk_mul_f32 v[216:217], v[26:27], v[118:119] op_sel:[1,0] op_sel_hi:[1,1]
    v_pk_mul_f32 v[218:219], v[26:27], v[86:87] op_sel:[1,0] op_sel_hi:[1,1]
    v_pk_fma_f32 v[86:87], v[26:27], v[86:87], v[216:217] op_sel:[0,0,0] op_sel_hi:[0,1,1]
    v_pk_fma_f32 v[118:119], v[26:27], v[118:119], v[218:219] op_sel:[0,0,0] op_sel_hi:[0,1,1] neg_lo:[1,0,0] neg_hi:[1,0,0]
    v_pk_mul_f32 v[216:217], v[26:27], v[120:121] op_sel:[1,0] op_sel_hi:[1,1]
    v_pk_mul_f32 v[218:219], v[26:27], v[88:89] op_sel:[1,0] op_sel_hi:[1,1]
    v_pk_fma_f32 v[88:89], v[26:27], v[88:89], v[216:217] op_sel:[0,0,0] op_sel_hi:[0,1,1]
    v_pk_fma_f32 v[120:121], v[26:27], v[120:121], v[218:219] op_sel:[0,0,0] op_sel_hi:[0,1,1] neg_lo:[1,0,0] neg_hi:[1,0,0]
    v_pk_mul_f32 v[216:217], v[26:27], v[122:123] op_sel:[1,0] op_sel_hi:[1,1]
    v_pk_mul_f32 v[218:219], v[26:27], v[90:91] op_sel:[1,0] op_sel_hi:[1,1]
    v_pk_fma_f32 v[90:91], v[26:27], v[90:91], v[216:217] op_sel:[0,0,0] op_sel_hi:[0,1,1]
    v_pk_fma_f32 v[122:123], v[26:27], v[122:123], v[218:219] op_sel:[0,0,0] op_sel_hi:[0,1,1] neg_lo:[1,0,0] neg_hi:[1,0,0]
    v_pk_mul_f32 v[216:217], v[26:27], v[156:157] op_sel:[1,0] op_sel_hi:[1,1]
    v_pk_mul_f32 v[218:219], v[26:27], v[124:125] op_sel:[1,0] op_sel_hi:[1,1]
    v_pk_fma_f32 v[124:125], v[26:27], v[124:125], v[216:217] op_sel:[0,0,0] op_sel_hi:[0,1,1]
    v_pk_fma_f32 v[156:157], v[26:27], v[156:157], v[218:219] op_sel:[0,0,0] op_sel_hi:[0,1,1] neg_lo:[1,0,0] neg_hi:[1,0,0]
    v_pk_mul_f32 v[216:217], v[26:27], v[158:159] op_sel:[1,0] op_sel_hi:[1,1]
    v_pk_mul_f32 v[218:219], v[26:27], v[126:127] op_sel:[1,0] op_sel_hi:[1,1]
    v_pk_fma_f32 v[126:127], v[26:27], v[126:127], v[216:217] op_sel:[0,0,0] op_sel_hi:[0,1,1]
    v_pk_fma_f32 v[158:159], v[26:27], v[158:159], v[218:219] op_sel:[0,0,0] op_sel_hi:[0,1,1] neg_lo:[1,0,0] neg_hi:[1,0,0]
    v_pk_mul_f32 v[216:217], v[26:27], v[160:161] op_sel:[1,0] op_sel_hi:[1,1]
    v_pk_mul_f32 v[218:219], v[26:27], v[128:129] op_sel:[1,0] op_sel_hi:[1,1]
    v_pk_fma_f32 v[128:129], v[26:27], v[128:129], v[216:217] op_sel:[0,0,0] op_sel_hi:[0,1,1]
    v_pk_fma_f32 v[160:161], v[26:27], v[160:161], v[218:219] op_sel:[0,0,0] op_sel_hi:[0,1,1] neg_lo:[1,0,0] neg_hi:[1,0,0]
    v_pk_mul_f32 v[216:217], v[26:27], v[162:163] op_sel:[1,0] op_sel_hi:[1,1]
    v_pk_mul_f32 v[218:219], v[26:27], v[130:131] op_sel:[1,0] op_sel_hi:[1,1]
    v_pk_fma_f32 v[130:131], v[26:27], v[130:131], v[216:217] op_sel:[0,0,0] op_sel_hi:[0,1,1]
    v_pk_fma_f32 v[162:163], v[26:27], v[162:163], v[218:219] op_sel:[0,0,0] op_sel_hi:[0,1,1] neg_lo:[1,0,0] neg_hi:[1,0,0]
    v_pk_mul_f32 v[216:217], v[26:27], v[164:165] op_sel:[1,0] op_sel_hi:[1,1]
    v_pk_mul_f32 v[218:219], v[26:27], v[132:133] op_sel:[1,0] op_sel_hi:[1,1]
    v_pk_fma_f32 v[132:133], v[26:27], v[132:133], v[216:217] op_sel:[0,0,0] op_sel_hi:[0,1,1]
    v_pk_fma_f32 v[164:165], v[26:27], v[164:165], v[218:219] op_sel:[0,0,0] op_sel_hi:[0,1,1] neg_lo:[1,0,0] neg_hi:[1,0,0]
    v_pk_mul_f32 v[216:217], v[26:27], v[166:167] op_sel:[1,0] op_sel_hi:[1,1]
    v_pk_mul_f32 v[218:219], v[26:27], v[134:135] op_sel:[1,0] op_sel_hi:[1,1]
    v_pk_fma_f32 v[134:135], v[26:27], v[134:135], v[216:217] op_sel:[0,0,0] op_sel_hi:[0,1,1]
    v_pk_fma_f32 v[166:167], v[26:27], v[166:167], v[218:219] op_sel:[0,0,0] op_sel_hi:[0,1,1] neg_lo:[1,0,0] neg_hi:[1,0,0]
    v_pk_mul_f32 v[216:217], v[26:27], v[168:169] op_sel:[1,0] op_sel_hi:[1,1]
    v_pk_mul_f32 v[218:219], v[26:27], v[136:137] op_sel:[1,0] op_sel_hi:[1,1]
    v_pk_fma_f32 v[136:137], v[26:27], v[136:137], v[216:217] op_sel:[0,0,0] op_sel_hi:[0,1,1]
    v_pk_fma_f32 v[168:169], v[26:27], v[168:169], v[218:219] op_sel:[0,0,0] op_sel_hi:[0,1,1] neg_lo:[1,0,0] neg_hi:[1,0,0]
    v_pk_mul_f32 v[216:217], v[26:27], v[170:171] op_sel:[1,0] op_sel_hi:[1,1]
    v_pk_mul_f32 v[218:219], v[26:27], v[138:139] op_sel:[1,0] op_sel_hi:[1,1]
    v_pk_fma_f32 v[138:139], v[26:27], v[138:139], v[216:217] op_sel:[0,0,0] op_sel_hi:[0,1,1]
    v_pk_fma_f32 v[170:171], v[26:27], v[170:171], v[218:219] op_sel:[0,0,0] op_sel_hi:[0,1,1] neg_lo:[1,0,0] neg_hi:[1,0,0]
    v_pk_mul_f32 v[216:217], v[26:27], v[172:173] op_sel:[1,0] op_sel_hi:[1,1]
    v_pk_mul_f32 v[218:219], v[26:27], v[140:141] op_sel:[1,0] op_sel_hi:[1,1]
    v_pk_fma_f32 v[140:141], v[26:27], v[140:141], v[216:217] op_sel:[0,0,0] op_sel_hi:[0,1,1]
    v_pk_fma_f32 v[172:173], v[26:27], v[172:173], v[218:219] op_sel:[0,0,0] op_sel_hi:[0,1,1] neg_lo:[1,0,0] neg_hi:[1,0,0]
    v_pk_mul_f32 v[216:217], v[26:27], v[174:175] op_sel:[1,0] op_sel_hi:[1,1]
    v_pk_mul_f32 v[218:219], v[26:27], v[142:143] op_sel:[1,0] op_sel_hi:[1,1]
    v_pk_fma_f32 v[142:143], v[26:27], v[142:143], v[216:217] op_sel:[0,0,0] op_sel_hi:[0,1,1]
    v_pk_fma_f32 v[174:175], v[26:27], v[174:175], v[218:219] op_sel:[0,0,0] op_sel_hi:[0,1,1] neg_lo:[1,0,0] neg_hi:[1,0,0]
    v_pk_mul_f32 v[216:217], v[26:27], v[176:177] op_sel:[1,0] op_sel_hi:[1,1]
    v_pk_mul_f32 v[218:219], v[26:27], v[144:145] op_sel:[1,0] op_sel_hi:[1,1]
    v_pk_fma_f32 v[144:145], v[26:27], v[144:145], v[216:217] op_sel:[0,0,0] op_sel_hi:[0,1,1]
    v_pk_fma_f32 v[176:177], v[26:27], v[176:177], v[218:219] op_sel:[0,0,0] op_sel_hi:[0,1,1] neg_lo:[1,0,0] neg_hi:[1,0,0]
    v_pk_mul_f32 v[216:217], v[26:27], v[178:179] op_sel:[1,0] op_sel_hi:[1,1]
    v_pk_mul_f32 v[218:219], v[26:27], v[146:147] op_sel:[1,0] op_sel_hi:[1,1]
    v_pk_fma_f32 v[146:147], v[26:27], v[146:147], v[216:217] op_sel:[0,0,0] op_sel_hi:[0,1,1]
    v_pk_fma_f32 v[178:179], v[26:27], v[178:179], v[218:219] op_sel:[0,0,0] op_sel_hi:[0,1,1] neg_lo:[1,0,0] neg_hi:[1,0,0]
    v_pk_mul_f32 v[216:217], v[26:27], v[180:181] op_sel:[1,0] op_sel_hi:[1,1]
    v_pk_mul_f32 v[218:219], v[26:27], v[148:149] op_sel:[1,0] op_sel_hi:[1,1]
    v_pk_fma_f32 v[148:149], v[26:27], v[148:149], v[216:217] op_sel:[0,0,0] op_sel_hi:[0,1,1]
    v_pk_fma_f32 v[180:181], v[26:27], v[180:181], v[218:219] op_sel:[0,0,0] op_sel_hi:[0,1,1] neg_lo:[1,0,0] neg_hi:[1,0,0]
    v_pk_mul_f32 v[216:217], v[26:27], v[182:183] op_sel:[1,0] op_sel_hi:[1,1]
    v_pk_mul_f32 v[218:219], v[26:27], v[150:151] op_sel:[1,0] op_sel_hi:[1,1]
    v_pk_fma_f32 v[150:151], v[26:27], v[150:151], v[216:217] op_sel:[0,0,0] op_sel_hi:[0,1,1]
    v_pk_fma_f32 v[182:183], v[26:27], v[182:183], v[218:219] op_sel:[0,0,0] op_sel_hi:[0,1,1] neg_lo:[1,0,0] neg_hi:[1,0,0]
    v_pk_mul_f32 v[216:217], v[26:27], v[184:185] op_sel:[1,0] op_sel_hi:[1,1]
    v_pk_mul_f32 v[218:219], v[26:27], v[152:153] op_sel:[1,0] op_sel_hi:[1,1]
    v_pk_fma_f32 v[152:153], v[26:27], v[152:153], v[216:217] op_sel:[0,0,0] op_sel_hi:[0,1,1]
    v_pk_fma_f32 v[184:185], v[26:27], v[184:185], v[218:219] op_sel:[0,0,0] op_sel_hi:[0,1,1] neg_lo:[1,0,0] neg_hi:[1,0,0]
    v_pk_mul_f32 v[216:217], v[26:27], v[186:187] op_sel:[1,0] op_sel_hi:[1,1]
    v_pk_mul_f32 v[218:219], v[26:27], v[154:155] op_sel:[1,0] op_sel_hi:[1,1]
    v_pk_fma_f32 v[154:155], v[26:27], v[154:155], v[216:217] op_sel:[0,0,0] op_sel_hi:[0,1,1]
    v_pk_fma_f32 v[186:187], v[26:27], v[186:187], v[218:219] op_sel:[0,0,0] op_sel_hi:[0,1,1] neg_lo:[1,0,0] neg_hi:[1,0,0]
    s_add_u32 m0, s82, 0xffff0000
    s_add_u32 s70, s82, 0xbf8000
    buffer_load_dwordx4 v7, s[8:11], s70 offen sc1 lds
    buffer_load_dwordx4 v7, s[8:11], s70 offen offset:1024 sc1 lds
    s_add_u32 m0, s82, 0xffff2000
    s_add_u32 s70, s82, 0xbfa000
    buffer_load_dwordx4 v7, s[8:11], s70 offen sc1 lds
    buffer_load_dwordx4 v7, s[8:11], s70 offen offset:1024 sc1 lds
    s_add_u32 m0, s82, 0xffff4000
    s_add_u32 s70, s82, 0xbfc000
    buffer_load_dwordx4 v7, s[8:11], s70 offen sc1 lds
    buffer_load_dwordx4 v7, s[8:11], s70 offen offset:1024 sc1 lds
    s_add_u32 m0, s82, 0xffff6000
    s_add_u32 s70, s82, 0xbfe000
    buffer_load_dwordx4 v7, s[8:11], s70 offen sc1 lds
    buffer_load_dwordx4 v7, s[8:11], s70 offen offset:1024 sc1 lds
    s_barrier
    s_waitcnt vmcnt(0)
    s_barrier
    s_add_u32 m0, s82, 0xffff8000
    s_add_u32 s70, s82, 0xc00000
    buffer_load_dwordx4 v7, s[8:11], s70 offen sc1 lds
    buffer_load_dwordx4 v7, s[8:11], s70 offen offset:1024 sc1 lds
    s_add_u32 m0, s82, 0xffffa000
    s_add_u32 s70, s82, 0xc02000
    buffer_load_dwordx4 v7, s[8:11], s70 offen sc1 lds
    buffer_load_dwordx4 v7, s[8:11], s70 offen offset:1024 sc1 lds
    s_add_u32 m0, s82, 0xffffc000
    s_add_u32 s70, s82, 0xc04000
    buffer_load_dwordx4 v7, s[8:11], s70 offen sc1 lds
    buffer_load_dwordx4 v7, s[8:11], s70 offen offset:1024 sc1 lds
    s_add_u32 m0, s82, 0xffffe000
    s_add_u32 s70, s82, 0xc06000
    buffer_load_dwordx4 v7, s[8:11], s70 offen sc1 lds
    buffer_load_dwordx4 v7, s[8:11], s70 offen offset:1024 sc1 lds
    v_lshlrev_b32 v3, 14, v2
    v_sub_u32 v3, v19, v3
    v_subrev_u32 v4, 0x4000, v3
    buffer_load_dwordx4 v[188:191], v4, s[12:15], 0 offen sc1
    v_subrev_u32 v4, 0xc000, v3
    buffer_load_dwordx4 v[192:195], v4, s[12:15], 0 offen sc1
    v_subrev_u32 v4, 0x14000, v3
    buffer_load_dwordx4 v[196:199], v4, s[12:15], 0 offen sc1
    v_subrev_u32 v4, 0x1c000, v3
    buffer_load_dwordx4 v[200:203], v4, s[12:15], 0 offen sc1
    s_waitcnt vmcnt(0)
    s_mov_b32 s73, 131072
L_echk:
    v_add_u32 v3, v189, v191
    v_add3_u32 v3, v193, v195, v3
    v_add3_u32 v3, v197, v199, v3
    v_add3_u32 v3, v201, v203, v3
    v_cmp_eq_u32 vcc, v3, v6
    s_cmp_eq_u64 vcc, exec
    s_cbranch_scc0 L_eretry
L_eok:
    v_fma_f32 v208, v37, v200, v196
    v_fma_f32 v209, v37, v202, v198
    v_fma_f32 v208, -v38, v202, v208
    v_fmac_f32 v209, v38, v200
    v_fma_f32 v210, v37, v208, v192
    v_fma_f32 v211, v37, v209, v194
    v_fma_f32 v210, -v38, v209, v210
    v_fmac_f32 v211, v38, v208
    v_fma_f32 v208, v37, v210, v188
    v_fma_f32 v209, v37, v211, v190
    v_fma_f32 v208, -v38, v211, v208
    v_fmac_f32 v209, v38, v210
    v_mov_b32 v210, v208
    v_mov_b32 v211, v209
    s_lshl_b32 s74, s76, 1
    v_add_u32 v5, s74, v2
    v_permlane32_swap_b32 v208, v210
    v_permlane32_swap_b32 v209, v211
    v_fma_f32 v212, v35, v210, v208
    v_fma_f32 v214, v35, v211, v209
    v_fma_f32 v212, -v36, v211, v212
    v_fmac_f32 v214, v36, v210
    v_cmp_lt_u32 vcc, 0, v5
    v_fma_f32 v210, v33, v212, v42
    v_fma_f32 v211, v33, v214, v43
    v_fma_f32 v210, -v34, v214, v210
    v_fmac_f32 v211, v34, v212
    v_cndmask_b32 v212, v212, v210, vcc
    v_cndmask_b32 v214, v214, v211, vcc
    v_cmp_lt_u32 vcc, 1, v5
    v_fma_f32 v210, v33, v212, v44
    v_fma_f32 v211, v33, v214, v45
    v_fma_f32 v210, -v34, v214, v210
    v_fmac_f32 v211, v34, v212
    v_cndmask_b32 v212, v212, v210, vcc
    v_cndmask_b32 v214, v214, v211, vcc
    v_cmp_lt_u32 vcc, 2, v5
    v_fma_f32 v210, v33, v212, v46
    v_fma_f32 v211, v33, v214, v47
    v_fma_f32 v210, -v34, v214, v210
    v_fmac_f32 v211, v34, v212
    v_cndmask_b32 v212, v212, v210, vcc
    v_cndmask_b32 v214, v214, v211, vcc
    v_fma_f32 v213, v31, v212, v39
    v_fma_f32 v215, v31, v214, v40
    v_fma_f32 v213, -v32, v214, v213
    v_fmac_f32 v215, v32, v212
    v_pk_mul_f32 v[216:217], v[26:27], v[214:215] op_sel:[1,0] op_sel_hi:[1,1]
    v_pk_mul_f32 v[218:219], v[26:27], v[212:213] op_sel:[1,0] op_sel_hi:[1,1]
    v_pk_fma_f32 v[212:213], v[26:27], v[212:213], v[216:217] op_sel:[0,0,0] op_sel_hi:[0,1,1]
    v_pk_fma_f32 v[214:215], v[26:27], v[214:215], v[218:219] op_sel:[0,0,0] op_sel_hi:[0,1,1] neg_lo:[1,0,0] neg_hi:[1,0,0]
    v_pk_fma_f32 v[60:61], v[24:25], v[212:213], v[60:61] op_sel:[0,0,0] op_sel_hi:[0,1,1]
    v_pk_fma_f32 v[92:93], v[24:25], v[214:215], v[92:93] op_sel:[0,0,0] op_sel_hi:[0,1,1]
    v_pk_fma_f32 v[60:61], v[24:25], v[214:215], v[60:61] op_sel:[1,0,0] op_sel_hi:[1,1,1]
    v_pk_fma_f32 v[92:93], v[24:25], v[212:213], v[92:93] op_sel:[1,0,0] op_sel_hi:[1,1,1] neg_lo:[1,0,0] neg_hi:[1,0,0]
    v_pk_fma_f32 v[62:63], v[24:25], v[60:61], v[62:63] op_sel:[0,0,0] op_sel_hi:[0,1,1]
    v_pk_fma_f32 v[94:95], v[24:25], v[92:93], v[94:95] op_sel:[0,0,0] op_sel_hi:[0,1,1]
    v_pk_fma_f32 v[62:63], v[24:25], v[92:93], v[62:63] op_sel:[1,0,0] op_sel_hi:[1,1,1]
    v_pk_fma_f32 v[94:95], v[24:25], v[60:61], v[94:95] op_sel:[1,0,0] op_sel_hi:[1,1,1] neg_lo:[1,0,0] neg_hi:[1,0,0]
    v_pk_fma_f32 v[64:65], v[24:25], v[62:63], v[64:65] op_sel:[0,0,0] op_sel_hi:[0,1,1]
    v_pk_fma_f32 v[96:97], v[24:25], v[94:95], v[96:97] op_sel:[0,0,0] op_sel_hi:[0,1,1]
    v_pk_fma_f32 v[64:65], v[24:25], v[94:95], v[64:65] op_sel:[1,0,0] op_sel_hi:[1,1,1]
    v_pk_fma_f32 v[96:97], v[24:25], v[62:63], v[96:97] op_sel:[1,0,0] op_sel_hi:[1,1,1] neg_lo:[1,0,0] neg_hi:[1,0,0]
    v_pk_fma_f32 v[66:67], v[24:25], v[64:65], v[66:67] op_sel:[0,0,0] op_sel_hi:[0,1,1]
    v_pk_fma_f32 v[98:99], v[24:25], v[96:97], v[98:99] op_sel:[0,0,0] op_sel_hi:[0,1,1]
    v_pk_fma_f32 v[66:67], v[24:25], v[96:97], v[66:67] op_sel:[1,0,0] op_sel_hi:[1,1,1]
    v_pk_fma_f32 v[98:99], v[24:25], v[64:65], v[98:99] op_sel:[1,0,0] op_sel_hi:[1,1,1] neg_lo:[1,0,0] neg_hi:[1,0,0]
    v_pk_fma_f32 v[68:69], v[24:25], v[66:67], v[68:69] op_sel:[0,0,0] op_sel_hi:[0,1,1]
    v_pk_fma_f32 v[100:101], v[24:25], v[98:99], v[100:101] op_sel:[0,0,0] op_sel_hi:[0,1,1]
    v_pk_fma_f32 v[68:69], v[24:25], v[98:99], v[68:69] op_sel:[1,0,0] op_sel_hi:[1,1,1]
    v_pk_fma_f32 v[100:101], v[24:25], v[66:67], v[100:101] op_sel:[1,0,0] op_sel_hi:[1,1,1] neg_lo:[1,0,0] neg_hi:[1,0,0]
    v_pk_fma_f32 v[70:71], v[24:25], v[68:69], v[70:71] op_sel:[0,0,0] op_sel_hi:[0,1,1]
    v_pk_fma_f32 v[102:103], v[24:25], v[100:101], v[102:103] op_sel:[0,0,0] op_sel_hi:[0,1,1]
    v_pk_fma_f32 v[70:71], v[24:25], v[100:101], v[70:71] op_sel:[1,0,0] op_sel_hi:[1,1,1]
    v_pk_fma_f32 v[102:103], v[24:25], v[68:69], v[102:103] op_sel:[1,0,0] op_sel_hi:[1,1,1] neg_lo:[1,0,0] neg_hi:[1,0,0]
    v_pk_fma_f32 v[72:73], v[24:25], v[70:71], v[72:73] op_sel:[0,0,0] op_sel_hi:[0,1,1]
    v_pk_fma_f32 v[104:105], v[24:25], v[102:103], v[104:105] op_sel:[0,0,0] op_sel_hi:[0,1,1]
    v_pk_fma_f32 v[72:73], v[24:25], v[102:103], v[72:73] op_sel:[1,0,0] op_sel_hi:[1,1,1]
    v_pk_fma_f32 v[104:105], v[24:25], v[70:71], v[104:105] op_sel:[1,0,0] op_sel_hi:[1,1,1] neg_lo:[1,0,0] neg_hi:[1,0,0]
    v_pk_fma_f32 v[74:75], v[24:25], v[72:73], v[74:75] op_sel:[0,0,0] op_sel_hi:[0,1,1]
    v_pk_fma_f32 v[106:107], v[24:25], v[104:105], v[106:107] op_sel:[0,0,0] op_sel_hi:[0,1,1]
    v_pk_fma_f32 v[74:75], v[24:25], v[104:105], v[74:75] op_sel:[1,0,0] op_sel_hi:[1,1,1]
    v_pk_fma_f32 v[106:107], v[24:25], v[72:73], v[106:107] op_sel:[1,0,0] op_sel_hi:[1,1,1] neg_lo:[1,0,0] neg_hi:[1,0,0]
    v_cvt_pk_bf16_f32 v188, v60, v62
    v_cvt_pk_bf16_f32 v189, v64, v66
    v_cvt_pk_bf16_f32 v190, v68, v70
    v_cvt_pk_bf16_f32 v191, v72, v74
    v_cvt_pk_bf16_f32 v196, v92, v94
    v_cvt_pk_bf16_f32 v197, v96, v98
    v_cvt_pk_bf16_f32 v198, v100, v102
    v_cvt_pk_bf16_f32 v199, v104, v106
    v_cvt_pk_bf16_f32 v192, v61, v63
    v_cvt_pk_bf16_f32 v193, v65, v67
    v_cvt_pk_bf16_f32 v194, v69, v71
    v_cvt_pk_bf16_f32 v195, v73, v75
    v_cvt_pk_bf16_f32 v200, v93, v95
    v_cvt_pk_bf16_f32 v201, v97, v99
    v_cvt_pk_bf16_f32 v202, v101, v103
    v_cvt_pk_bf16_f32 v203, v105, v107
    ds_write_b128 v52, v[188:191] offset:0
    ds_write_b128 v52, v[196:199] offset:2048
    ds_write_b128 v53, v[192:195] offset:0
    ds_write_b128 v53, v[200:203] offset:2048
    ds_read_b64_tr_b16 v[220:221], v54 offset:0
    ds_read_b64_tr_b16 v[222:223], v54 offset:512
    ds_read_b64_tr_b16 v[224:225], v54 offset:1024
    ds_read_b64_tr_b16 v[226:227], v54 offset:1536
    ds_read_b64_tr_b16 v[228:229], v54 offset:2048
    ds_read_b64_tr_b16 v[230:231], v54 offset:2560
    ds_read_b64_tr_b16 v[232:233], v54 offset:3072
    ds_read_b64_tr_b16 v[234:235], v54 offset:3584
    v_pk_fma_f32 v[76:77], v[24:25], v[74:75], v[76:77] op_sel:[0,0,0] op_sel_hi:[0,1,1]
    v_pk_fma_f32 v[108:109], v[24:25], v[106:107], v[108:109] op_sel:[0,0,0] op_sel_hi:[0,1,1]
    v_pk_fma_f32 v[76:77], v[24:25], v[106:107], v[76:77] op_sel:[1,0,0] op_sel_hi:[1,1,1]
    v_pk_fma_f32 v[108:109], v[24:25], v[74:75], v[108:109] op_sel:[1,0,0] op_sel_hi:[1,1,1] neg_lo:[1,0,0] neg_hi:[1,0,0]
    v_pk_fma_f32 v[78:79], v[24:25], v[76:77], v[78:79] op_sel:[0,0,0] op_sel_hi:[0,1,1]
    v_pk_fma_f32 v[110:111], v[24:25], v[108:109], v[110:111] op_sel:[0,0,0] op_sel_hi:[0,1,1]
    v_pk_fma_f32 v[78:79], v[24:25], v[108:109], v[78:79] op_sel:[1,0,0] op_sel_hi:[1,1,1]
    v_pk_fma_f32 v[110:111], v[24:25], v[76:77], v[110:111] op_sel:[1,0,0] op_sel_hi:[1,1,1] neg_lo:[1,0,0] neg_hi:[1,0,0]
    v_pk_fma_f32 v[80:81], v[24:25], v[78:79], v[80:81] op_sel:[0,0,0] op_sel_hi:[0,1,1]
    v_pk_fma_f32 v[112:113], v[24:25], v[110:111], v[112:113] op_sel:[0,0,0] op_sel_hi:[0,1,1]
    v_pk_fma_f32 v[80:81], v[24:25], v[110:111], v[80:81] op_sel:[1,0,0] op_sel_hi:[1,1,1]
    v_pk_fma_f32 v[112:113], v[24:25], v[78:79], v[112:113] op_sel:[1,0,0] op_sel_hi:[1,1,1] neg_lo:[1,0,0] neg_hi:[1,0,0]
    v_pk_fma_f32 v[82:83], v[24:25], v[80:81], v[82:83] op_sel:[0,0,0] op_sel_hi:[0,1,1]
    v_pk_fma_f32 v[114:115], v[24:25], v[112:113], v[114:115] op_sel:[0,0,0] op_sel_hi:[0,1,1]
    v_pk_fma_f32 v[82:83], v[24:25], v[112:113], v[82:83] op_sel:[1,0,0] op_sel_hi:[1,1,1]
    v_pk_fma_f32 v[114:115], v[24:25], v[80:81], v[114:115] op_sel:[1,0,0] op_sel_hi:[1,1,1] neg_lo:[1,0,0] neg_hi:[1,0,0]
    v_pk_fma_f32 v[84:85], v[24:25], v[82:83], v[84:85] op_sel:[0,0,0] op_sel_hi:[0,1,1]
    v_pk_fma_f32 v[116:117], v[24:25], v[114:115], v[116:117] op_sel:[0,0,0] op_sel_hi:[0,1,1]
    v_pk_fma_f32 v[84:85], v[24:25], v[114:115], v[84:85] op_sel:[1,0,0] op_sel_hi:[1,1,1]
    v_pk_fma_f32 v[116:117], v[24:25], v[82:83], v[116:117] op_sel:[1,0,0] op_sel_hi:[1,1,1] neg_lo:[1,0,0] neg_hi:[1,0,0]
    v_pk_fma_f32 v[86:87], v[24:25], v[84:85], v[86:87] op_sel:[0,0,0] op_sel_hi:[0,1,1]
    v_pk_fma_f32 v[118:119], v[24:25], v[116:117], v[118:119] op_sel:[0,0,0] op_sel_hi:[0,1,1]
    v_pk_fma_f32 v[86:87], v[24:25], v[116:117], v[86:87] op_sel:[1,0,0] op_sel_hi:[1,1,1]
    v_pk_fma_f32 v[118:119], v[24:25], v[84:85], v[118:119] op_sel:[1,0,0] op_sel_hi:[1,1,1] neg_lo:[1,0,0] neg_hi:[1,0,0]
    v_pk_fma_f32 v[88:89], v[24:25], v[86:87], v[88:89] op_sel:[0,0,0] op_sel_hi:[0,1,1]
    v_pk_fma_f32 v[120:121], v[24:25], v[118:119], v[120:121] op_sel:[0,0,0] op_sel_hi:[0,1,1]
    v_pk_fma_f32 v[88:89], v[24:25], v[118:119], v[88:89] op_sel:[1,0,0] op_sel_hi:[1,1,1]
    v_pk_fma_f32 v[120:121], v[24:25], v[86:87], v[120:121] op_sel:[1,0,0] op_sel_hi:[1,1,1] neg_lo:[1,0,0] neg_hi:[1,0,0]
    v_pk_fma_f32 v[90:91], v[24:25], v[88:89], v[90:91] op_sel:[0,0,0] op_sel_hi:[0,1,1]
    v_pk_fma_f32 v[122:123], v[24:25], v[120:121], v[122:123] op_sel:[0,0,0] op_sel_hi:[0,1,1]
    v_pk_fma_f32 v[90:91], v[24:25], v[120:121], v[90:91] op_sel:[1,0,0] op_sel_hi:[1,1,1]
    v_pk_fma_f32 v[122:123], v[24:25], v[88:89], v[122:123] op_sel:[1,0,0] op_sel_hi:[1,1,1] neg_lo:[1,0,0] neg_hi:[1,0,0]
    s_waitcnt lgkmcnt(0)
    s_add_u32 s74, s84, 0x0
    buffer_store_dwordx4 v[220:223], v7, s[8:11], s74 offen offset:0 sc1
    buffer_store_dwordx4 v[224:227], v7, s[8:11], s74 offen offset:1024 sc1
    s_add_u32 s74, s84, 0x1000
    buffer_store_dwordx4 v[228:231], v7, s[8:11], s74 offen offset:0 sc1
    buffer_store_dwordx4 v[232:235], v7, s[8:11], s74 offen offset:1024 sc1
    v_cvt_pk_bf16_f32 v188, v76, v78
    v_cvt_pk_bf16_f32 v189, v80, v82
    v_cvt_pk_bf16_f32 v190, v84, v86
    v_cvt_pk_bf16_f32 v191, v88, v90
    v_cvt_pk_bf16_f32 v196, v108, v110
    v_cvt_pk_bf16_f32 v197, v112, v114
    v_cvt_pk_bf16_f32 v198, v116, v118
    v_cvt_pk_bf16_f32 v199, v120, v122
    v_cvt_pk_bf16_f32 v192, v77, v79
    v_cvt_pk_bf16_f32 v193, v81, v83
    v_cvt_pk_bf16_f32 v194, v85, v87
    v_cvt_pk_bf16_f32 v195, v89, v91
    v_cvt_pk_bf16_f32 v200, v109, v111
    v_cvt_pk_bf16_f32 v201, v113, v115
    v_cvt_pk_bf16_f32 v202, v117, v119
    v_cvt_pk_bf16_f32 v203, v121, v123
    ds_write_b128 v52, v[188:191] offset:4096
    ds_write_b128 v52, v[196:199] offset:6144
    ds_write_b128 v53, v[192:195] offset:4096
    ds_write_b128 v53, v[200:203] offset:6144
    ds_read_b64_tr_b16 v[236:237], v54 offset:4096
    ds_read_b64_tr_b16 v[238:239], v54 offset:4608
    ds_read_b64_tr_b16 v[240:241], v54 offset:5120
    ds_read_b64_tr_b16 v[242:243], v54 offset:5632
    ds_read_b64_tr_b16 v[244:245], v54 offset:6144
    ds_read_b64_tr_b16 v[246:247], v54 offset:6656
    ds_read_b64_tr_b16 v[248:249], v54 offset:7168
    ds_read_b64_tr_b16 v[250:251], v54 offset:7680
    v_pk_fma_f32 v[124:125], v[24:25], v[90:91], v[124:125] op_sel:[0,0,0] op_sel_hi:[0,1,1]
    v_pk_fma_f32 v[156:157], v[24:25], v[122:123], v[156:157] op_sel:[0,0,0] op_sel_hi:[0,1,1]
    v_pk_fma_f32 v[124:125], v[24:25], v[122:123], v[124:125] op_sel:[1,0,0] op_sel_hi:[1,1,1]
    v_pk_fma_f32 v[156:157], v[24:25], v[90:91], v[156:157] op_sel:[1,0,0] op_sel_hi:[1,1,1] neg_lo:[1,0,0] neg_hi:[1,0,0]
    v_pk_fma_f32 v[126:127], v[24:25], v[124:125], v[126:127] op_sel:[0,0,0] op_sel_hi:[0,1,1]
    v_pk_fma_f32 v[158:159], v[24:25], v[156:157], v[158:159] op_sel:[0,0,0] op_sel_hi:[0,1,1]
    v_pk_fma_f32 v[126:127], v[24:25], v[156:157], v[126:127] op_sel:[1,0,0] op_sel_hi:[1,1,1]
    v_pk_fma_f32 v[158:159], v[24:25], v[124:125], v[158:159] op_sel:[1,0,0] op_sel_hi:[1,1,1] neg_lo:[1,0,0] neg_hi:[1,0,0]
    v_pk_fma_f32 v[128:129], v[24:25], v[126:127], v[128:129] op_sel:[0,0,0] op_sel_hi:[0,1,1]
    v_pk_fma_f32 v[160:161], v[24:25], v[158:159], v[160:161] op_sel:[0,0,0] op_sel_hi:[0,1,1]
    v_pk_fma_f32 v[128:129], v[24:25], v[158:159], v[128:129] op_sel:[1,0,0] op_sel_hi:[1,1,1]
    v_pk_fma_f32 v[160:161], v[24:25], v[126:127], v[160:161] op_sel:[1,0,0] op_sel_hi:[1,1,1] neg_lo:[1,0,0] neg_hi:[1,0,0]
    v_pk_fma_f32 v[130:131], v[24:25], v[128:129], v[130:131] op_sel:[0,0,0] op_sel_hi:[0,1,1]
    v_pk_fma_f32 v[162:163], v[24:25], v[160:161], v[162:163] op_sel:[0,0,0] op_sel_hi:[0,1,1]
    v_pk_fma_f32 v[130:131], v[24:25], v[160:161], v[130:131] op_sel:[1,0,0] op_sel_hi:[1,1,1]
    v_pk_fma_f32 v[162:163], v[24:25], v[128:129], v[162:163] op_sel:[1,0,0] op_sel_hi:[1,1,1] neg_lo:[1,0,0] neg_hi:[1,0,0]
    v_pk_fma_f32 v[132:133], v[24:25], v[130:131], v[132:133] op_sel:[0,0,0] op_sel_hi:[0,1,1]
    v_pk_fma_f32 v[164:165], v[24:25], v[162:163], v[164:165] op_sel:[0,0,0] op_sel_hi:[0,1,1]
    v_pk_fma_f32 v[132:133], v[24:25], v[162:163], v[132:133] op_sel:[1,0,0] op_sel_hi:[1,1,1]
    v_pk_fma_f32 v[164:165], v[24:25], v[130:131], v[164:165] op_sel:[1,0,0] op_sel_hi:[1,1,1] neg_lo:[1,0,0] neg_hi:[1,0,0]
    v_pk_fma_f32 v[134:135], v[24:25], v[132:133], v[134:135] op_sel:[0,0,0] op_sel_hi:[0,1,1]
    v_pk_fma_f32 v[166:167], v[24:25], v[164:165], v[166:167] op_sel:[0,0,0] op_sel_hi:[0,1,1]
    v_pk_fma_f32 v[134:135], v[24:25], v[164:165], v[134:135] op_sel:[1,0,0] op_sel_hi:[1,1,1]
    v_pk_fma_f32 v[166:167], v[24:25], v[132:133], v[166:167] op_sel:[1,0,0] op_sel_hi:[1,1,1] neg_lo:[1,0,0] neg_hi:[1,0,0]
    v_pk_fma_f32 v[136:137], v[24:25], v[134:135], v[136:137] op_sel:[0,0,0] op_sel_hi:[0,1,1]
    v_pk_fma_f32 v[168:169], v[24:25], v[166:167], v[168:169] op_sel:[0,0,0] op_sel_hi:[0,1,1]
    v_pk_fma_f32 v[136:137], v[24:25], v[166:167], v[136:137] op_sel:[1,0,0] op_sel_hi:[1,1,1]
    v_pk_fma_f32 v[168:169], v[24:25], v[134:135], v[168:169] op_sel:[1,0,0] op_sel_hi:[1,1,1] neg_lo:[1,0,0] neg_hi:[1,0,0]
    v_pk_fma_f32 v[138:139], v[24:25], v[136:137], v[138:139] op_sel:[0,0,0] op_sel_hi:[0,1,1]
    v_pk_fma_f32 v[170:171], v[24:25], v[168:169], v[170:171] op_sel:[0,0,0] op_sel_hi:[0,1,1]
    v_pk_fma_f32 v[138:139], v[24:25], v[168:169], v[138:139] op_sel:[1,0,0] op_sel_hi:[1,1,1]
    v_pk_fma_f32 v[170:171], v[24:25], v[136:137], v[170:171] op_sel:[1,0,0] op_sel_hi:[1,1,1] neg_lo:[1,0,0] neg_hi:[1,0,0]
    s_waitcnt lgkmcnt(0)
    s_add_u32 s74, s84, 0x20000
    buffer_store_dwordx4 v[236:239], v7, s[8:11], s74 offen offset:0 sc1
    buffer_store_dwordx4 v[240:243], v7, s[8:11], s74 offen offset:1024 sc1
    s_add_u32 s74, s84, 0x21000
    buffer_store_dwordx4 v[244:247], v7, s[8:11], s74 offen offset:0 sc1
    buffer_store_dwordx4 v[248:251], v7, s[8:11], s74 offen offset:1024 sc1
    v_cvt_pk_bf16_f32 v188, v124, v126
    v_cvt_pk_bf16_f32 v189, v128, v130
    v_cvt_pk_bf16_f32 v190, v132, v134
    v_cvt_pk_bf16_f32 v191, v136, v138
    v_cvt_pk_bf16_f32 v196, v156, v158
    v_cvt_pk_bf16_f32 v197, v160, v162
    v_cvt_pk_bf16_f32 v198, v164, v166
    v_cvt_pk_bf16_f32 v199, v168, v170
    v_cvt_pk_bf16_f32 v192, v125, v127
    v_cvt_pk_bf16_f32 v193, v129, v131
    v_cvt_pk_bf16_f32 v194, v133, v135
    v_cvt_pk_bf16_f32 v195, v137, v139
    v_cvt_pk_bf16_f32 v200, v157, v159
    v_cvt_pk_bf16_f32 v201, v161, v163
    v_cvt_pk_bf16_f32 v202, v165, v167
    v_cvt_pk_bf16_f32 v203, v169, v171
    ds_write_b128 v52, v[188:191] offset:0
    ds_write_b128 v52, v[196:199] offset:2048
    ds_write_b128 v53, v[192:195] offset:0
    ds_write_b128 v53, v[200:203] offset:2048
    ds_read_b64_tr_b16 v[220:221], v54 offset:0
    ds_read_b64_tr_b16 v[222:223], v54 offset:512
    ds_read_b64_tr_b16 v[224:225], v54 offset:1024
    ds_read_b64_tr_b16 v[226:227], v54 offset:1536
    ds_read_b64_tr_b16 v[228:229], v54 offset:2048
    ds_read_b64_tr_b16 v[230:231], v54 offset:2560
    ds_read_b64_tr_b16 v[232:233], v54 offset:3072
    ds_read_b64_tr_b16 v[234:235], v54 offset:3584
    s_waitcnt lgkmcnt(0)
    s_barrier
    s_add_u32 m0, s82, 0x10000
    s_add_u32 s70, s82, 0xc08000
    buffer_load_dwordx4 v7, s[8:11], s70 offen sc1 lds
    buffer_load_dwordx4 v7, s[8:11], s70 offen offset:1024 sc1 lds
    s_add_u32 m0, s82, 0x12000
    s_add_u32 s70, s82, 0xc0a000
    buffer_load_dwordx4 v7, s[8:11], s70 offen sc1 lds
    buffer_load_dwordx4 v7, s[8:11], s70 offen offset:1024 sc1 lds
    s_add_u32 m0, s82, 0x14000
    s_add_u32 s70, s82, 0xc0c000
    buffer_load_dwordx4 v7, s[8:11], s70 offen sc1 lds
    buffer_load_dwordx4 v7, s[8:11], s70 offen offset:1024 sc1 lds
    s_add_u32 m0, s82, 0x16000
    s_add_u32 s70, s82, 0xc0e000
    buffer_load_dwordx4 v7, s[8:11], s70 offen sc1 lds
    buffer_load_dwordx4 v7, s[8:11], s70 offen offset:1024 sc1 lds
    v_pk_fma_f32 v[140:141], v[24:25], v[138:139], v[140:141] op_sel:[0,0,0] op_sel_hi:[0,1,1]
    v_pk_fma_f32 v[172:173], v[24:25], v[170:171], v[172:173] op_sel:[0,0,0] op_sel_hi:[0,1,1]
    v_pk_fma_f32 v[140:141], v[24:25], v[170:171], v[140:141] op_sel:[1,0,0] op_sel_hi:[1,1,1]
    v_pk_fma_f32 v[172:173], v[24:25], v[138:139], v[172:173] op_sel:[1,0,0] op_sel_hi:[1,1,1] neg_lo:[1,0,0] neg_hi:[1,0,0]
    v_pk_fma_f32 v[142:143], v[24:25], v[140:141], v[142:143] op_sel:[0,0,0] op_sel_hi:[0,1,1]
    v_pk_fma_f32 v[174:175], v[24:25], v[172:173], v[174:175] op_sel:[0,0,0] op_sel_hi:[0,1,1]
    v_pk_fma_f32 v[142:143], v[24:25], v[172:173], v[142:143] op_sel:[1,0,0] op_sel_hi:[1,1,1]
    v_pk_fma_f32 v[174:175], v[24:25], v[140:141], v[174:175] op_sel:[1,0,0] op_sel_hi:[1,1,1] neg_lo:[1,0,0] neg_hi:[1,0,0]
    v_pk_fma_f32 v[144:145], v[24:25], v[142:143], v[144:145] op_sel:[0,0,0] op_sel_hi:[0,1,1]
    v_pk_fma_f32 v[176:177], v[24:25], v[174:175], v[176:177] op_sel:[0,0,0] op_sel_hi:[0,1,1]
    v_pk_fma_f32 v[144:145], v[24:25], v[174:175], v[144:145] op_sel:[1,0,0] op_sel_hi:[1,1,1]
    v_pk_fma_f32 v[176:177], v[24:25], v[142:143], v[176:177] op_sel:[1,0,0] op_sel_hi:[1,1,1] neg_lo:[1,0,0] neg_hi:[1,0,0]
    v_pk_fma_f32 v[146:147], v[24:25], v[144:145], v[146:147] op_sel:[0,0,0] op_sel_hi:[0,1,1]
    v_pk_fma_f32 v[178:179], v[24:25], v[176:177], v[178:179] op_sel:[0,0,0] op_sel_hi:[0,1,1]
    v_pk_fma_f32 v[146:147], v[24:25], v[176:177], v[146:147] op_sel:[1,0,0] op_sel_hi:[1,1,1]
    v_pk_fma_f32 v[178:179], v[24:25], v[144:145], v[178:179] op_sel:[1,0,0] op_sel_hi:[1,1,1] neg_lo:[1,0,0] neg_hi:[1,0,0]
    v_pk_fma_f32 v[148:149], v[24:25], v[146:147], v[148:149] op_sel:[0,0,0] op_sel_hi:[0,1,1]
    v_pk_fma_f32 v[180:181], v[24:25], v[178:179], v[180:181] op_sel:[0,0,0] op_sel_hi:[0,1,1]
    v_pk_fma_f32 v[148:149], v[24:25], v[178:179], v[148:149] op_sel:[1,0,0] op_sel_hi:[1,1,1]
    v_pk_fma_f32 v[180:181], v[24:25], v[146:147], v[180:181] op_sel:[1,0,0] op_sel_hi:[1,1,1] neg_lo:[1,0,0] neg_hi:[1,0,0]
    v_pk_fma_f32 v[150:151], v[24:25], v[148:149], v[150:151] op_sel:[0,0,0] op_sel_hi:[0,1,1]
    v_pk_fma_f32 v[182:183], v[24:25], v[180:181], v[182:183] op_sel:[0,0,0] op_sel_hi:[0,1,1]
    v_pk_fma_f32 v[150:151], v[24:25], v[180:181], v[150:151] op_sel:[1,0,0] op_sel_hi:[1,1,1]
    v_pk_fma_f32 v[182:183], v[24:25], v[148:149], v[182:183] op_sel:[1,0,0] op_sel_hi:[1,1,1] neg_lo:[1,0,0] neg_hi:[1,0,0]
    v_pk_fma_f32 v[152:153], v[24:25], v[150:151], v[152:153] op_sel:[0,0,0] op_sel_hi:[0,1,1]
    v_pk_fma_f32 v[184:185], v[24:25], v[182:183], v[184:185] op_sel:[0,0,0] op_sel_hi:[0,1,1]
    v_pk_fma_f32 v[152:153], v[24:25], v[182:183], v[152:153] op_sel:[1,0,0] op_sel_hi:[1,1,1]
    v_pk_fma_f32 v[184:185], v[24:25], v[150:151], v[184:185] op_sel:[1,0,0] op_sel_hi:[1,1,1] neg_lo:[1,0,0] neg_hi:[1,0,0]
    v_pk_fma_f32 v[154:155], v[24:25], v[152:153], v[154:155] op_sel:[0,0,0] op_sel_hi:[0,1,1]
    v_pk_fma_f32 v[186:187], v[24:25], v[184:185], v[186:187] op_sel:[0,0,0] op_sel_hi:[0,1,1]
    v_pk_fma_f32 v[154:155], v[24:25], v[184:185], v[154:155] op_sel:[1,0,0] op_sel_hi:[1,1,1]
    v_pk_fma_f32 v[186:187], v[24:25], v[152:153], v[186:187] op_sel:[1,0,0] op_sel_hi:[1,1,1] neg_lo:[1,0,0] neg_hi:[1,0,0]
    s_add_u32 s74, s84, 0x40000
    buffer_store_dwordx4 v[220:223], v7, s[8:11], s74 offen offset:0 sc1
    buffer_store_dwordx4 v[224:227], v7, s[8:11], s74 offen offset:1024 sc1
    s_add_u32 s74, s84, 0x41000
    buffer_store_dwordx4 v[228:231], v7, s[8:11], s74 offen offset:0 sc1
    buffer_store_dwordx4 v[232:235], v7, s[8:11], s74 offen offset:1024 sc1
    v_cvt_pk_bf16_f32 v188, v140, v142
    v_cvt_pk_bf16_f32 v189, v144, v146
    v_cvt_pk_bf16_f32 v190, v148, v150
    v_cvt_pk_bf16_f32 v191, v152, v154
    v_cvt_pk_bf16_f32 v196, v172, v174
    v_cvt_pk_bf16_f32 v197, v176, v178
    v_cvt_pk_bf16_f32 v198, v180, v182
    v_cvt_pk_bf16_f32 v199, v184, v186
    v_cvt_pk_bf16_f32 v192, v141, v143
    v_cvt_pk_bf16_f32 v193, v145, v147
    v_cvt_pk_bf16_f32 v194, v149, v151
    v_cvt_pk_bf16_f32 v195, v153, v155
    v_cvt_pk_bf16_f32 v200, v173, v175
    v_cvt_pk_bf16_f32 v201, v177, v179
    v_cvt_pk_bf16_f32 v202, v181, v183
    v_cvt_pk_bf16_f32 v203, v185, v187
    ds_write_b128 v52, v[188:191] offset:4096
    ds_write_b128 v52, v[196:199] offset:6144
    ds_write_b128 v53, v[192:195] offset:4096
    ds_write_b128 v53, v[200:203] offset:6144
    ds_read_b64_tr_b16 v[236:237], v54 offset:4096
    ds_read_b64_tr_b16 v[238:239], v54 offset:4608
    ds_read_b64_tr_b16 v[240:241], v54 offset:5120
    ds_read_b64_tr_b16 v[242:243], v54 offset:5632
    ds_read_b64_tr_b16 v[244:245], v54 offset:6144
    ds_read_b64_tr_b16 v[246:247], v54 offset:6656
    ds_read_b64_tr_b16 v[248:249], v54 offset:7168
    ds_read_b64_tr_b16 v[250:251], v54 offset:7680
    s_waitcnt lgkmcnt(0)
    s_add_u32 s74, s84, 0x60000
    buffer_store_dwordx4 v[236:239], v7, s[8:11], s74 offen offset:0 sc1
    buffer_store_dwordx4 v[240:243], v7, s[8:11], s74 offen offset:1024 sc1
    s_add_u32 s74, s84, 0x61000
    buffer_store_dwordx4 v[244:247], v7, s[8:11], s74 offen offset:0 sc1
    buffer_store_dwordx4 v[248:251], v7, s[8:11], s74 offen offset:1024 sc1
    s_waitcnt vmcnt(0)
    buffer_store_dword v20, v9, s[8:11], 0 offen sc1
    s_setprio 0
    s_barrier
    s_add_u32 m0, s82, 0xffff8000
    s_add_u32 s70, s82, 0xc10000
    buffer_load_dwordx4 v7, s[8:11], s70 offen sc1 lds
    buffer_load_dwordx4 v7, s[8:11], s70 offen offset:1024 sc1 lds
    s_add_u32 m0, s82, 0xffffa000
    s_add_u32 s70, s82, 0xc12000
    buffer_load_dwordx4 v7, s[8:11], s70 offen sc1 lds
    buffer_load_dwordx4 v7, s[8:11], s70 offen offset:1024 sc1 lds
    s_add_u32 m0, s82, 0xffffc000
    s_add_u32 s70, s82, 0xc14000
    buffer_load_dwordx4 v7, s[8:11], s70 offen sc1 lds
    buffer_load_dwordx4 v7, s[8:11], s70 offen offset:1024 sc1 lds
    s_add_u32 m0, s82, 0xffffe000
    s_add_u32 s70, s82, 0xc16000
    buffer_load_dwordx4 v7, s[8:11], s70 offen sc1 lds
    buffer_load_dwordx4 v7, s[8:11], s70 offen offset:1024 sc1 lds
    s_mov_b64 exec, 0
    s_cmp_eq_u32 s6, 0
    s_cbranch_scc1 L_pad_11
L_pad_11:
    s_cbranch_execz L_ret_x2
    s_cmp_eq_u32 s6, 1
    s_cbranch_scc1 L_pad_12
    s_cmp_eq_u32 s6, 2
    s_cbranch_scc1 L_pad_13
    s_branch L_ret_x2
L_ret_x2:
    s_mov_b64 exec, -1
    s_waitcnt vmcnt(0)
    s_barrier
    s_add_u32 m0, s82, 0x10000
    s_add_u32 s70, s82, 0xc18000
    buffer_load_dwordx4 v7, s[8:11], s70 offen sc1 lds
    buffer_load_dwordx4 v7, s[8:11], s70 offen offset:1024 sc1 lds
    s_add_u32 m0, s82, 0x12000
    s_add_u32 s70, s82, 0xc1a000
    buffer_load_dwordx4 v7, s[8:11], s70 offen sc1 lds
    buffer_load_dwordx4 v7, s[8:11], s70 offen offset:1024 sc1 lds
    s_add_u32 m0, s82, 0x14000
    s_add_u32 s70, s82, 0xc1c000
    buffer_load_dwordx4 v7, s[8:11], s70 offen sc1 lds
    buffer_load_dwordx4 v7, s[8:11], s70 offen offset:1024 sc1 lds
    s_add_u32 m0, s82, 0x16000
    s_add_u32 s70, s82, 0xc1e000
    buffer_load_dwordx4 v7, s[8:11], s70 offen sc1 lds
    buffer_load_dwordx4 v7, s[8:11], s70 offen offset:1024 sc1 lds
    s_and_b32 s70, s4, 3
    s_lshl_b32 s70, s70, 1
    s_add_u32 s70, s70, s77
    s_lshl_b32 s70, s70, 2
    s_add_u32 s70, s70, s76
    s_add_u32 s70, s70, 2
    s_lshl_b32 s70, s70, 16
    s_lshl_b32 s71, s5, 8
    s_add_u32 s70, s70, s71
    v_lshlrev_b32 v3, 11, v1
    v_lshl_add_u32 v3, v2, 7, v3
    buffer_load_dword v4, v3, s[20:23], s70 offen
    s_waitcnt vmcnt(1)
    s_barrier
    s_add_u32 m0, s82, 0xffff8000
    s_add_u32 s70, s82, 0xc20000
    buffer_load_dwordx4 v7, s[8:11], s70 offen sc1 lds
    buffer_load_dwordx4 v7, s[8:11], s70 offen offset:1024 sc1 lds
    s_add_u32 m0, s82, 0xffffa000
    s_add_u32 s70, s82, 0xc22000
    buffer_load_dwordx4 v7, s[8:11], s70 offen sc1 lds
    buffer_load_dwordx4 v7, s[8:11], s70 offen offset:1024 sc1 lds
    s_add_u32 m0, s82, 0xffffc000
    s_add_u32 s70, s82, 0xc24000
    buffer_load_dwordx4 v7, s[8:11], s70 offen sc1 lds
    buffer_load_dwordx4 v7, s[8:11], s70 offen offset:1024 sc1 lds
    s_add_u32 m0, s82, 0xffffe000
    s_add_u32 s70, s82, 0xc26000
    buffer_load_dwordx4 v7, s[8:11], s70 offen sc1 lds
    buffer_load_dwordx4 v7, s[8:11], s70 offen offset:1024 sc1 lds
    s_lshr_b32 s70, s78, 6
    s_add_u32 s100, s70, 0
    s_add_u32 m0, s81, 0x0
    s_lshl_b32 s70, s100, 12
    s_add_u32 s70, s70, s85
    s_lshl_b32 s71, s100, 17
    s_add_u32 m0, s82, 0x0
    s_add_u32 s71, s71, 0
    buffer_load_dwordx4 v16, s[20:23], s71 offen lds
    buffer_load_dwordx4 v17, s[20:23], s71 offen offset:1024 lds
    s_add_u32 m0, s82, 0x2000
    s_add_u32 s71, s71, 128
    buffer_load_dwordx4 v16, s[20:23], s71 offen lds
    buffer_load_dwordx4 v17, s[20:23], s71 offen offset:1024 lds
    s_lshr_b32 s70, s78, 6
    s_add_u32 s100, s70, 8
    s_add_u32 m0, s81, 0x4000
    s_lshl_b32 s70, s100, 12
    s_add_u32 s70, s70, s85
    s_lshl_b32 s71, s100, 17
    s_add_u32 m0, s82, 0x4000
    s_add_u32 s71, s71, 0
    buffer_load_dwordx4 v16, s[20:23], s71 offen lds
    buffer_load_dwordx4 v17, s[20:23], s71 offen offset:1024 lds
    s_add_u32 m0, s82, 0x6000
    s_add_u32 s71, s71, 128
    buffer_load_dwordx4 v16, s[20:23], s71 offen lds
    buffer_load_dwordx4 v17, s[20:23], s71 offen offset:1024 lds
    s_waitcnt vmcnt(8)
    s_barrier
    s_add_u32 m0, s82, 0x10000
    s_add_u32 s70, s82, 0xc28000
    buffer_load_dwordx4 v7, s[8:11], s70 offen sc1 lds
    buffer_load_dwordx4 v7, s[8:11], s70 offen offset:1024 sc1 lds
    s_add_u32 m0, s82, 0x12000
    s_add_u32 s70, s82, 0xc2a000
    buffer_load_dwordx4 v7, s[8:11], s70 offen sc1 lds
    buffer_load_dwordx4 v7, s[8:11], s70 offen offset:1024 sc1 lds
    s_add_u32 m0, s82, 0x14000
    s_add_u32 s70, s82, 0xc2c000
    buffer_load_dwordx4 v7, s[8:11], s70 offen sc1 lds
    buffer_load_dwordx4 v7, s[8:11], s70 offen offset:1024 sc1 lds
    s_add_u32 m0, s82, 0x16000
    s_add_u32 s70, s82, 0xc2e000
    buffer_load_dwordx4 v7, s[8:11], s70 offen sc1 lds
    buffer_load_dwordx4 v7, s[8:11], s70 offen offset:1024 sc1 lds
    s_cmp_le_u32 s78, 0
    s_cselect_b32 s100, 2, 0
    s_add_u32 m0, s81, 0x8000
    s_lshl_b32 s70, s100, 12
    s_add_u32 s70, s70, s85
    s_lshl_b32 s71, s100, 17
    s_add_u32 m0, s82, 0x8000
    s_add_u32 s71, s71, 0
    buffer_load_dwordx4 v16, s[20:23], s71 offen lds
    buffer_load_dwordx4 v17, s[20:23], s71 offen offset:1024 lds
    s_add_u32 m0, s82, 0xa000
    s_add_u32 s71, s71, 128
    buffer_load_dwordx4 v16, s[20:23], s71 offen lds
    buffer_load_dwordx4 v17, s[20:23], s71 offen offset:1024 lds
    s_cmp_le_u32 s78, 128
    s_cselect_b32 s100, 4, 2
    s_add_u32 m0, s81, 0xc000
    s_lshl_b32 s70, s100, 12
    s_add_u32 s70, s70, s85
    s_lshl_b32 s71, s100, 17
    s_add_u32 m0, s82, 0xc000
    s_add_u32 s71, s71, 0
    buffer_load_dwordx4 v16, s[20:23], s71 offen lds
    buffer_load_dwordx4 v17, s[20:23], s71 offen offset:1024 lds
    s_add_u32 m0, s82, 0xe000
    s_add_u32 s71, s71, 128
    buffer_load_dwordx4 v16, s[20:23], s71 offen lds
    buffer_load_dwordx4 v17, s[20:23], s71 offen offset:1024 lds
    s_waitcnt vmcnt(8)
    s_barrier
    s_mov_b32 s72, 0xc60000
    buffer_load_dword v8, v21, s[8:11], s72 offen sc1
    s_waitcnt vmcnt(0)
    v_cmp_eq_u32 vcc, s83, v8
    s_cmp_eq_u64 vcc, exec
    s_cbranch_scc1 L_pd_oy
    s_mov_b32 s73, 131072
    s_mov_b32 s72, 0xc60000
L_pl_oy:
    buffer_load_dword v8, v21, s[8:11], s72 offen sc1
    s_waitcnt vmcnt(0)
    v_cmp_eq_u32 vcc, s83, v8
    s_cmp_eq_u64 vcc, exec
    s_cbranch_scc1 L_pd_oy
    s_sleep 8
    s_sub_u32 s73, s73, 1
    s_cbranch_scc0 L_pl_oy
L_pd_oy:
    s_lshr_b32 s70, s78, 6
    s_add_u32 s100, s70, 0
    s_add_u32 m0, s81, 0x0
    s_lshl_b32 s70, s100, 12
    s_add_u32 s70, s70, s85
    s_lshl_b32 s71, s100, 17
    buffer_load_dwordx4 v7, s[8:11], s70 offen sc1 lds
    buffer_load_dwordx4 v7, s[8:11], s70 offen offset:1024 sc1 lds
    buffer_load_dwordx4 v7, s[8:11], s70 offen offset:2048 sc1 lds
    buffer_load_dwordx4 v7, s[8:11], s70 offen offset:3072 sc1 lds
    s_lshr_b32 s70, s78, 6
    s_add_u32 s100, s70, 8
    s_add_u32 m0, s81, 0x4000
    s_lshl_b32 s70, s100, 12
    s_add_u32 s70, s70, s85
    s_lshl_b32 s71, s100, 17
    buffer_load_dwordx4 v7, s[8:11], s70 offen sc1 lds
    buffer_load_dwordx4 v7, s[8:11], s70 offen offset:1024 sc1 lds
    buffer_load_dwordx4 v7, s[8:11], s70 offen offset:2048 sc1 lds
    buffer_load_dwordx4 v7, s[8:11], s70 offen offset:3072 sc1 lds
    s_cmp_le_u32 s78, 0
    s_cselect_b32 s100, 2, 0
    s_add_u32 m0, s81, 0x8000
    s_lshl_b32 s70, s100, 12
    s_add_u32 s70, s70, s85
    s_lshl_b32 s71, s100, 17
    buffer_load_dwordx4 v7, s[8:11], s70 offen sc1 lds
    buffer_load_dwordx4 v7, s[8:11], s70 offen offset:1024 sc1 lds
    buffer_load_dwordx4 v7, s[8:11], s70 offen offset:2048 sc1 lds
    buffer_load_dwordx4 v7, s[8:11], s70 offen offset:3072 sc1 lds
    s_cmp_le_u32 s78, 128
    s_cselect_b32 s100, 4, 2
    s_add_u32 m0, s81, 0xc000
    s_lshl_b32 s70, s100, 12
    s_add_u32 s70, s70, s85
    s_lshl_b32 s71, s100, 17
    buffer_load_dwordx4 v7, s[8:11], s70 offen sc1 lds
    buffer_load_dwordx4 v7, s[8:11], s70 offen offset:1024 sc1 lds
    buffer_load_dwordx4 v7, s[8:11], s70 offen offset:2048 sc1 lds
    buffer_load_dwordx4 v7, s[8:11], s70 offen offset:3072 sc1 lds
    s_waitcnt vmcnt(8)
    s_barrier
    ds_read_b128 v[124:127], v22 offset:0
    ds_read_b64_tr_b16 v[140:141], v14 offset:0
    ds_read_b64_tr_b16 v[142:143], v14 offset:1024
    ds_read_b64_tr_b16 v[144:145], v15 offset:0
    ds_read_b64_tr_b16 v[146:147], v15 offset:1024
    ds_read_b64_tr_b16 v[148:149], v14 offset:8192
    ds_read_b64_tr_b16 v[150:151], v14 offset:9216
    ds_read_b64_tr_b16 v[152:153], v15 offset:8192
    ds_read_b64_tr_b16 v[154:155], v15 offset:9216
    ds_read_b128 v[128:131], v22 offset:256
    ds_read_b128 v[132:135], v22 offset:4096
    ds_read_b128 v[136:139], v22 offset:4352
    ds_read_b128 v[156:159], v22 offset:2048
    ds_read_b64_tr_b16 v[172:173], v14 offset:4096
    ds_read_b64_tr_b16 v[174:175], v14 offset:5120
    s_waitcnt lgkmcnt(12)
    v_mfma_f32_16x16x32_bf16 v[60:63], v[140:143], v[124:127], 0
    s_waitcnt lgkmcnt(10)
    v_mfma_f32_16x16x32_bf16 v[64:67], v[144:147], v[124:127], 0
    s_waitcnt lgkmcnt(8)
    v_mfma_f32_16x16x32_bf16 v[92:95], v[148:151], v[124:127], 0
    s_waitcnt lgkmcnt(6)
    v_mfma_f32_16x16x32_bf16 v[96:99], v[152:155], v[124:127], 0
    s_waitcnt lgkmcnt(5)
    v_mfma_f32_16x16x32_bf16 v[104:107], v[152:155], v[128:131], 0
    ds_read_b64_tr_b16 v[176:177], v15 offset:4096
    v_mfma_f32_16x16x32_bf16 v[100:103], v[148:151], v[128:131], 0
    ds_read_b64_tr_b16 v[178:179], v15 offset:5120
    v_mfma_f32_16x16x32_bf16 v[72:75], v[144:147], v[128:131], 0
    ds_read_b64_tr_b16 v[180:181], v14 offset:12288
    v_mfma_f32_16x16x32_bf16 v[68:71], v[140:143], v[128:131], 0
    s_waitcnt lgkmcnt(3)
    v_mfma_f32_16x16x32_bf16 v[76:79], v[140:143], v[132:135], 0
    ds_read_b64_tr_b16 v[182:183], v14 offset:13312
    v_mfma_f32_16x16x32_bf16 v[80:83], v[144:147], v[132:135], 0
    ds_read_b64_tr_b16 v[184:185], v15 offset:12288
    v_mfma_f32_16x16x32_bf16 v[108:111], v[148:151], v[132:135], 0
    ds_read_b64_tr_b16 v[186:187], v15 offset:13312
    v_mfma_f32_16x16x32_bf16 v[112:115], v[152:155], v[132:135], 0
    ds_read_b128 v[160:163], v22 offset:2304
    ds_read_b128 v[164:167], v22 offset:6144
    ds_read_b128 v[168:171], v22 offset:6400
    v_mfma_f32_16x16x32_bf16 v[120:123], v[152:155], v[136:139], 0
    ds_read_b128 v[188:191], v22 offset:16384
    v_mfma_f32_16x16x32_bf16 v[116:119], v[148:151], v[136:139], 0
    ds_read_b64_tr_b16 v[204:205], v14 offset:16384
    v_mfma_f32_16x16x32_bf16 v[88:91], v[144:147], v[136:139], 0
    ds_read_b64_tr_b16 v[206:207], v14 offset:17408
    v_mfma_f32_16x16x32_bf16 v[84:87], v[140:143], v[136:139], 0
    ds_read_b64_tr_b16 v[208:209], v15 offset:16384
    v_mfma_f32_16x16x32_bf16 v[60:63], v[172:175], v[156:159], v[60:63]
    s_waitcnt lgkmcnt(8)
    v_mfma_f32_16x16x32_bf16 v[64:67], v[176:179], v[156:159], v[64:67]
    ds_read_b64_tr_b16 v[210:211], v15 offset:17408
    v_mfma_f32_16x16x32_bf16 v[92:95], v[180:183], v[156:159], v[92:95]
    s_waitcnt lgkmcnt(8)
    v_mfma_f32_16x16x32_bf16 v[96:99], v[184:187], v[156:159], v[96:99]
    s_waitcnt lgkmcnt(4)
    v_mfma_f32_16x16x32_bf16 v[104:107], v[184:187], v[160:163], v[104:107]
    ds_read_b64_tr_b16 v[212:213], v14 offset:24576
    v_mfma_f32_16x16x32_bf16 v[100:103], v[180:183], v[160:163], v[100:103]
    ds_read_b64_tr_b16 v[214:215], v14 offset:25600
    v_mfma_f32_16x16x32_bf16 v[72:75], v[176:179], v[160:163], v[72:75]
    ds_read_b64_tr_b16 v[216:217], v15 offset:24576
    v_mfma_f32_16x16x32_bf16 v[68:71], v[172:175], v[160:163], v[68:71]
    ds_read_b64_tr_b16 v[218:219], v15 offset:25600
    v_mfma_f32_16x16x32_bf16 v[76:79], v[172:175], v[164:167], v[76:79]
    ds_read_b128 v[192:195], v22 offset:16640
    v_mfma_f32_16x16x32_bf16 v[80:83], v[176:179], v[164:167], v[80:83]
    ds_read_b128 v[196:199], v22 offset:20480
    v_mfma_f32_16x16x32_bf16 v[108:111], v[180:183], v[164:167], v[108:111]
    ds_read_b128 v[200:203], v22 offset:20736
    v_mfma_f32_16x16x32_bf16 v[112:115], v[184:187], v[164:167], v[112:115]
    ds_read_b128 v[124:127], v22 offset:18432
    v_mfma_f32_16x16x32_bf16 v[120:123], v[184:187], v[168:171], v[120:123]
    ds_read_b64_tr_b16 v[140:141], v14 offset:20480
    v_mfma_f32_16x16x32_bf16 v[116:119], v[180:183], v[168:171], v[116:119]
    ds_read_b64_tr_b16 v[142:143], v14 offset:21504
    v_mfma_f32_16x16x32_bf16 v[88:91], v[176:179], v[168:171], v[88:91]
    ds_read_b64_tr_b16 v[144:145], v15 offset:20480
    v_mfma_f32_16x16x32_bf16 v[84:87], v[172:175], v[168:171], v[84:87]
    s_waitcnt lgkmcnt(6)
    v_mfma_f32_16x16x32_bf16 v[60:63], v[204:207], v[188:191], v[60:63]
    ds_read_b64_tr_b16 v[146:147], v15 offset:21504
    v_mfma_f32_16x16x32_bf16 v[64:67], v[208:211], v[188:191], v[64:67]
    ds_read_b64_tr_b16 v[148:149], v14 offset:28672
    v_mfma_f32_16x16x32_bf16 v[92:95], v[212:215], v[188:191], v[92:95]
    ds_read_b64_tr_b16 v[150:151], v14 offset:29696
    v_mfma_f32_16x16x32_bf16 v[96:99], v[216:219], v[188:191], v[96:99]
    ds_read_b64_tr_b16 v[152:153], v15 offset:28672
    v_mfma_f32_16x16x32_bf16 v[104:107], v[216:219], v[192:195], v[104:107]
    ds_read_b64_tr_b16 v[154:155], v15 offset:29696
    v_mfma_f32_16x16x32_bf16 v[100:103], v[212:215], v[192:195], v[100:103]
    ds_read_b128 v[128:131], v22 offset:18688
    v_mfma_f32_16x16x32_bf16 v[72:75], v[208:211], v[192:195], v[72:75]
    ds_read_b128 v[132:135], v22 offset:22528
    v_mfma_f32_16x16x32_bf16 v[68:71], v[204:207], v[192:195], v[68:71]
    s_waitcnt lgkmcnt(6)
    v_mfma_f32_16x16x32_bf16 v[76:79], v[204:207], v[196:199], v[76:79]
    ds_read_b128 v[136:139], v22 offset:22784
    v_mfma_f32_16x16x32_bf16 v[80:83], v[208:211], v[196:199], v[80:83]
    v_mfma_f32_16x16x32_bf16 v[108:111], v[212:215], v[196:199], v[108:111]
    v_mfma_f32_16x16x32_bf16 v[112:115], v[216:219], v[196:199], v[112:115]
    s_waitcnt lgkmcnt(0)
    s_waitcnt vmcnt(4)
    s_barrier
    v_mfma_f32_16x16x32_bf16 v[120:123], v[216:219], v[200:203], v[120:123]
    ds_read_b128 v[156:159], v22 offset:32768
    v_mfma_f32_16x16x32_bf16 v[116:119], v[212:215], v[200:203], v[116:119]
    ds_read_b64_tr_b16 v[172:173], v14 offset:32768
    v_mfma_f32_16x16x32_bf16 v[88:91], v[208:211], v[200:203], v[88:91]
    ds_read_b64_tr_b16 v[174:175], v14 offset:33792
    v_mfma_f32_16x16x32_bf16 v[84:87], v[204:207], v[200:203], v[84:87]
    ds_read_b64_tr_b16 v[176:177], v15 offset:32768
    v_mfma_f32_16x16x32_bf16 v[60:63], v[140:143], v[124:127], v[60:63]
    ds_read_b64_tr_b16 v[178:179], v15 offset:33792
    v_mfma_f32_16x16x32_bf16 v[64:67], v[144:147], v[124:127], v[64:67]
    ds_read_b64_tr_b16 v[180:181], v14 offset:40960
    v_mfma_f32_16x16x32_bf16 v[92:95], v[148:151], v[124:127], v[92:95]
    ds_read_b64_tr_b16 v[182:183], v14 offset:41984
    v_mfma_f32_16x16x32_bf16 v[96:99], v[152:155], v[124:127], v[96:99]
    ds_read_b64_tr_b16 v[184:185], v15 offset:40960
    v_mfma_f32_16x16x32_bf16 v[104:107], v[152:155], v[128:131], v[104:107]
    ds_read_b64_tr_b16 v[186:187], v15 offset:41984
    v_mfma_f32_16x16x32_bf16 v[100:103], v[148:151], v[128:131], v[100:103]
    ds_read_b128 v[160:163], v22 offset:33024
    v_mfma_f32_16x16x32_bf16 v[72:75], v[144:147], v[128:131], v[72:75]
    ds_read_b128 v[164:167], v22 offset:36864
    v_mfma_f32_16x16x32_bf16 v[68:71], v[140:143], v[128:131], v[68:71]
    ds_read_b128 v[168:171], v22 offset:37120
    v_mfma_f32_16x16x32_bf16 v[76:79], v[140:143], v[132:135], v[76:79]
    ds_read_b128 v[188:191], v22 offset:34816
    v_mfma_f32_16x16x32_bf16 v[80:83], v[144:147], v[132:135], v[80:83]
    ds_read_b64_tr_b16 v[204:205], v14 offset:36864
    v_mfma_f32_16x16x32_bf16 v[108:111], v[148:151], v[132:135], v[108:111]
    ds_read_b64_tr_b16 v[206:207], v14 offset:37888
    v_mfma_f32_16x16x32_bf16 v[112:115], v[152:155], v[132:135], v[112:115]
    s_waitcnt lgkmcnt(14)
    ds_read_b64_tr_b16 v[208:209], v15 offset:36864
    v_mfma_f32_16x16x32_bf16 v[120:123], v[152:155], v[136:139], v[120:123]
    s_waitcnt lgkmcnt(14)
    ds_read_b64_tr_b16 v[210:211], v15 offset:37888
    v_mfma_f32_16x16x32_bf16 v[116:119], v[148:151], v[136:139], v[116:119]
    s_waitcnt lgkmcnt(14)
    ds_read_b64_tr_b16 v[212:213], v14 offset:45056
    v_mfma_f32_16x16x32_bf16 v[88:91], v[144:147], v[136:139], v[88:91]
    s_waitcnt lgkmcnt(14)
    ds_read_b64_tr_b16 v[214:215], v14 offset:46080
    v_mfma_f32_16x16x32_bf16 v[84:87], v[140:143], v[136:139], v[84:87]
    s_waitcnt lgkmcnt(14)
    ds_read_b64_tr_b16 v[216:217], v15 offset:45056
    v_mfma_f32_16x16x32_bf16 v[60:63], v[172:175], v[156:159], v[60:63]
    s_waitcnt lgkmcnt(14)
    ds_read_b64_tr_b16 v[218:219], v15 offset:46080
    v_mfma_f32_16x16x32_bf16 v[64:67], v[176:179], v[156:159], v[64:67]
    s_waitcnt lgkmcnt(6)
    v_mfma_f32_16x16x32_bf16 v[92:95], v[180:183], v[156:159], v[92:95]
    ds_read_b128 v[192:195], v22 offset:35072
    v_mfma_f32_16x16x32_bf16 v[96:99], v[184:187], v[156:159], v[96:99]
    ds_read_b128 v[196:199], v22 offset:38912
    v_mfma_f32_16x16x32_bf16 v[104:107], v[184:187], v[160:163], v[104:107]
    ds_read_b128 v[200:203], v22 offset:39168
    v_mfma_f32_16x16x32_bf16 v[100:103], v[180:183], v[160:163], v[100:103]
    v_mfma_f32_16x16x32_bf16 v[72:75], v[176:179], v[160:163], v[72:75]
    v_mfma_f32_16x16x32_bf16 v[68:71], v[172:175], v[160:163], v[68:71]
    v_mfma_f32_16x16x32_bf16 v[76:79], v[172:175], v[164:167], v[76:79]
    v_mfma_f32_16x16x32_bf16 v[80:83], v[176:179], v[164:167], v[80:83]
    v_mfma_f32_16x16x32_bf16 v[108:111], v[180:183], v[164:167], v[108:111]
    v_mfma_f32_16x16x32_bf16 v[112:115], v[184:187], v[164:167], v[112:115]
    s_waitcnt lgkmcnt(0)
    s_waitcnt vmcnt(0)
    s_barrier
    v_mfma_f32_16x16x32_bf16 v[120:123], v[184:187], v[168:171], v[120:123]
    ds_read_b128 v[124:127], v22 offset:49152
    v_mfma_f32_16x16x32_bf16 v[116:119], v[180:183], v[168:171], v[116:119]
    ds_read_b64_tr_b16 v[140:141], v14 offset:49152
    v_mfma_f32_16x16x32_bf16 v[88:91], v[176:179], v[168:171], v[88:91]
    ds_read_b64_tr_b16 v[142:143], v14 offset:50176
    v_mfma_f32_16x16x32_bf16 v[84:87], v[172:175], v[168:171], v[84:87]
    ds_read_b64_tr_b16 v[144:145], v15 offset:49152
    v_mfma_f32_16x16x32_bf16 v[60:63], v[204:207], v[188:191], v[60:63]
    ds_read_b64_tr_b16 v[146:147], v15 offset:50176
    v_mfma_f32_16x16x32_bf16 v[64:67], v[208:211], v[188:191], v[64:67]
    ds_read_b64_tr_b16 v[148:149], v14 offset:57344
    v_mfma_f32_16x16x32_bf16 v[92:95], v[212:215], v[188:191], v[92:95]
    ds_read_b64_tr_b16 v[150:151], v14 offset:58368
    v_mfma_f32_16x16x32_bf16 v[96:99], v[216:219], v[188:191], v[96:99]
    ds_read_b64_tr_b16 v[152:153], v15 offset:57344
    v_mfma_f32_16x16x32_bf16 v[104:107], v[216:219], v[192:195], v[104:107]
    ds_read_b64_tr_b16 v[154:155], v15 offset:58368
    v_mfma_f32_16x16x32_bf16 v[100:103], v[212:215], v[192:195], v[100:103]
    ds_read_b128 v[128:131], v22 offset:49408
    v_mfma_f32_16x16x32_bf16 v[72:75], v[208:211], v[192:195], v[72:75]
    ds_read_b128 v[132:135], v22 offset:53248
    v_mfma_f32_16x16x32_bf16 v[68:71], v[204:207], v[192:195], v[68:71]
    ds_read_b128 v[136:139], v22 offset:53504
    v_mfma_f32_16x16x32_bf16 v[76:79], v[204:207], v[196:199], v[76:79]
    ds_read_b128 v[156:159], v22 offset:51200
    v_mfma_f32_16x16x32_bf16 v[80:83], v[208:211], v[196:199], v[80:83]
    ds_read_b64_tr_b16 v[172:173], v14 offset:53248
    v_mfma_f32_16x16x32_bf16 v[108:111], v[212:215], v[196:199], v[108:111]
    ds_read_b64_tr_b16 v[174:175], v14 offset:54272
    v_mfma_f32_16x16x32_bf16 v[112:115], v[216:219], v[196:199], v[112:115]
    s_waitcnt lgkmcnt(14)
    ds_read_b64_tr_b16 v[176:177], v15 offset:53248
    v_mfma_f32_16x16x32_bf16 v[120:123], v[216:219], v[200:203], v[120:123]
    s_waitcnt lgkmcnt(14)
    ds_read_b64_tr_b16 v[178:179], v15 offset:54272
    v_mfma_f32_16x16x32_bf16 v[116:119], v[212:215], v[200:203], v[116:119]
    s_waitcnt lgkmcnt(14)
    ds_read_b64_tr_b16 v[180:181], v14 offset:61440
    v_mfma_f32_16x16x32_bf16 v[88:91], v[208:211], v[200:203], v[88:91]
    s_waitcnt lgkmcnt(14)
    ds_read_b64_tr_b16 v[182:183], v14 offset:62464
    v_mfma_f32_16x16x32_bf16 v[84:87], v[204:207], v[200:203], v[84:87]
    s_waitcnt lgkmcnt(14)
    ds_read_b64_tr_b16 v[184:185], v15 offset:61440
    v_mfma_f32_16x16x32_bf16 v[60:63], v[140:143], v[124:127], v[60:63]
    s_waitcnt lgkmcnt(14)
    ds_read_b64_tr_b16 v[186:187], v15 offset:62464
    v_mfma_f32_16x16x32_bf16 v[64:67], v[144:147], v[124:127], v[64:67]
    s_waitcnt lgkmcnt(6)
    v_mfma_f32_16x16x32_bf16 v[92:95], v[148:151], v[124:127], v[92:95]
    ds_read_b128 v[160:163], v22 offset:51456
    v_mfma_f32_16x16x32_bf16 v[96:99], v[152:155], v[124:127], v[96:99]
    ds_read_b128 v[164:167], v22 offset:55296
    v_mfma_f32_16x16x32_bf16 v[104:107], v[152:155], v[128:131], v[104:107]
    ds_read_b128 v[168:171], v22 offset:55552
    v_mfma_f32_16x16x32_bf16 v[100:103], v[148:151], v[128:131], v[100:103]
    v_mfma_f32_16x16x32_bf16 v[72:75], v[144:147], v[128:131], v[72:75]
    v_mfma_f32_16x16x32_bf16 v[68:71], v[140:143], v[128:131], v[68:71]
    v_mfma_f32_16x16x32_bf16 v[76:79], v[140:143], v[132:135], v[76:79]
    v_mfma_f32_16x16x32_bf16 v[80:83], v[144:147], v[132:135], v[80:83]
    v_mfma_f32_16x16x32_bf16 v[108:111], v[148:151], v[132:135], v[108:111]
    v_mfma_f32_16x16x32_bf16 v[112:115], v[152:155], v[132:135], v[112:115]
    s_waitcnt lgkmcnt(0)
    s_barrier
    v_mfma_f32_16x16x32_bf16 v[120:123], v[152:155], v[136:139], v[120:123]
    ds_read_b128 v[188:191], v22 offset:0
    v_mfma_f32_16x16x32_bf16 v[116:119], v[148:151], v[136:139], v[116:119]
    ds_read_b64_tr_b16 v[204:205], v14 offset:0
    v_mfma_f32_16x16x32_bf16 v[88:91], v[144:147], v[136:139], v[88:91]
    ds_read_b64_tr_b16 v[206:207], v14 offset:1024
    v_mfma_f32_16x16x32_bf16 v[84:87], v[140:143], v[136:139], v[84:87]
    ds_read_b64_tr_b16 v[208:209], v15 offset:0
    v_mfma_f32_16x16x32_bf16 v[60:63], v[172:175], v[156:159], v[60:63]
    ds_read_b64_tr_b16 v[210:211], v15 offset:1024
    v_mfma_f32_16x16x32_bf16 v[64:67], v[176:179], v[156:159], v[64:67]
    ds_read_b64_tr_b16 v[212:213], v14 offset:8192
    v_mfma_f32_16x16x32_bf16 v[92:95], v[180:183], v[156:159], v[92:95]
    ds_read_b64_tr_b16 v[214:215], v14 offset:9216
    v_mfma_f32_16x16x32_bf16 v[96:99], v[184:187], v[156:159], v[96:99]
    ds_read_b64_tr_b16 v[216:217], v15 offset:8192
    v_mfma_f32_16x16x32_bf16 v[104:107], v[184:187], v[160:163], v[104:107]
    ds_read_b64_tr_b16 v[218:219], v15 offset:9216
    v_mfma_f32_16x16x32_bf16 v[100:103], v[180:183], v[160:163], v[100:103]
    ds_read_b128 v[192:195], v22 offset:256
    v_mfma_f32_16x16x32_bf16 v[72:75], v[176:179], v[160:163], v[72:75]
    ds_read_b128 v[196:199], v22 offset:4096
    v_mfma_f32_16x16x32_bf16 v[68:71], v[172:175], v[160:163], v[68:71]
    ds_read_b128 v[200:203], v22 offset:4352
    v_mfma_f32_16x16x32_bf16 v[76:79], v[172:175], v[164:167], v[76:79]
    ds_read_b128 v[124:127], v22 offset:2048
    v_mfma_f32_16x16x32_bf16 v[80:83], v[176:179], v[164:167], v[80:83]
    ds_read_b64_tr_b16 v[140:141], v14 offset:4096
    v_mfma_f32_16x16x32_bf16 v[108:111], v[180:183], v[164:167], v[108:111]
    ds_read_b64_tr_b16 v[142:143], v14 offset:5120
    v_mfma_f32_16x16x32_bf16 v[112:115], v[184:187], v[164:167], v[112:115]
    s_waitcnt lgkmcnt(14)
    ds_read_b64_tr_b16 v[144:145], v15 offset:4096
    v_mfma_f32_16x16x32_bf16 v[120:123], v[184:187], v[168:171], v[120:123]
    s_waitcnt lgkmcnt(14)
    ds_read_b64_tr_b16 v[146:147], v15 offset:5120
    v_mfma_f32_16x16x32_bf16 v[116:119], v[180:183], v[168:171], v[116:119]
    s_waitcnt lgkmcnt(14)
    ds_read_b64_tr_b16 v[148:149], v14 offset:12288
    v_mfma_f32_16x16x32_bf16 v[88:91], v[176:179], v[168:171], v[88:91]
    s_waitcnt lgkmcnt(14)
    ds_read_b64_tr_b16 v[150:151], v14 offset:13312
    v_mfma_f32_16x16x32_bf16 v[84:87], v[172:175], v[168:171], v[84:87]
    s_waitcnt lgkmcnt(14)
    ds_read_b64_tr_b16 v[152:153], v15 offset:12288
    v_mfma_f32_16x16x32_bf16 v[60:63], v[204:207], v[188:191], v[60:63]
    s_waitcnt lgkmcnt(14)
    ds_read_b64_tr_b16 v[154:155], v15 offset:13312
    v_mfma_f32_16x16x32_bf16 v[64:67], v[208:211], v[188:191], v[64:67]
    s_waitcnt lgkmcnt(6)
    v_mfma_f32_16x16x32_bf16 v[92:95], v[212:215], v[188:191], v[92:95]
    ds_read_b128 v[128:131], v22 offset:2304
    v_mfma_f32_16x16x32_bf16 v[96:99], v[216:219], v[188:191], v[96:99]
    ds_read_b128 v[132:135], v22 offset:6144
    v_mfma_f32_16x16x32_bf16 v[104:107], v[216:219], v[192:195], v[104:107]
    ds_read_b128 v[136:139], v22 offset:6400
    v_mfma_f32_16x16x32_bf16 v[100:103], v[212:215], v[192:195], v[100:103]
    v_mfma_f32_16x16x32_bf16 v[72:75], v[208:211], v[192:195], v[72:75]
    v_mfma_f32_16x16x32_bf16 v[68:71], v[204:207], v[192:195], v[68:71]
    v_mfma_f32_16x16x32_bf16 v[76:79], v[204:207], v[196:199], v[76:79]
    v_mfma_f32_16x16x32_bf16 v[80:83], v[208:211], v[196:199], v[80:83]
    v_mfma_f32_16x16x32_bf16 v[108:111], v[212:215], v[196:199], v[108:111]
    v_mfma_f32_16x16x32_bf16 v[112:115], v[216:219], v[196:199], v[112:115]
    s_waitcnt lgkmcnt(0)
    s_barrier
    v_mfma_f32_16x16x32_bf16 v[120:123], v[216:219], v[200:203], v[120:123]
    ds_read_b128 v[156:159], v22 offset:16384
    v_mfma_f32_16x16x32_bf16 v[116:119], v[212:215], v[200:203], v[116:119]
    ds_read_b64_tr_b16 v[172:173], v14 offset:16384
    v_mfma_f32_16x16x32_bf16 v[88:91], v[208:211], v[200:203], v[88:91]
    ds_read_b64_tr_b16 v[174:175], v14 offset:17408
    v_mfma_f32_16x16x32_bf16 v[84:87], v[204:207], v[200:203], v[84:87]
    ds_read_b64_tr_b16 v[176:177], v15 offset:16384
    v_mfma_f32_16x16x32_bf16 v[60:63], v[140:143], v[124:127], v[60:63]
    ds_read_b64_tr_b16 v[178:179], v15 offset:17408
    v_mfma_f32_16x16x32_bf16 v[64:67], v[144:147], v[124:127], v[64:67]
    ds_read_b64_tr_b16 v[180:181], v14 offset:24576
    v_mfma_f32_16x16x32_bf16 v[92:95], v[148:151], v[124:127], v[92:95]
    ds_read_b64_tr_b16 v[182:183], v14 offset:25600
    v_mfma_f32_16x16x32_bf16 v[96:99], v[152:155], v[124:127], v[96:99]
    ds_read_b64_tr_b16 v[184:185], v15 offset:24576
    v_mfma_f32_16x16x32_bf16 v[104:107], v[152:155], v[128:131], v[104:107]
    ds_read_b64_tr_b16 v[186:187], v15 offset:25600
    v_mfma_f32_16x16x32_bf16 v[100:103], v[148:151], v[128:131], v[100:103]
    ds_read_b128 v[160:163], v22 offset:16640
    v_mfma_f32_16x16x32_bf16 v[72:75], v[144:147], v[128:131], v[72:75]
    ds_read_b128 v[164:167], v22 offset:20480
    v_mfma_f32_16x16x32_bf16 v[68:71], v[140:143], v[128:131], v[68:71]
    ds_read_b128 v[168:171], v22 offset:20736
    v_mfma_f32_16x16x32_bf16 v[76:79], v[140:143], v[132:135], v[76:79]
    ds_read_b128 v[188:191], v22 offset:18432
    v_mfma_f32_16x16x32_bf16 v[80:83], v[144:147], v[132:135], v[80:83]
    ds_read_b64_tr_b16 v[204:205], v14 offset:20480
    v_mfma_f32_16x16x32_bf16 v[108:111], v[148:151], v[132:135], v[108:111]
    ds_read_b64_tr_b16 v[206:207], v14 offset:21504
    v_mfma_f32_16x16x32_bf16 v[112:115], v[152:155], v[132:135], v[112:115]
    s_waitcnt lgkmcnt(14)
    ds_read_b64_tr_b16 v[208:209], v15 offset:20480
    v_mfma_f32_16x16x32_bf16 v[120:123], v[152:155], v[136:139], v[120:123]
    s_waitcnt lgkmcnt(14)
    ds_read_b64_tr_b16 v[210:211], v15 offset:21504
    v_mfma_f32_16x16x32_bf16 v[116:119], v[148:151], v[136:139], v[116:119]
    s_waitcnt lgkmcnt(14)
    ds_read_b64_tr_b16 v[212:213], v14 offset:28672
    v_mfma_f32_16x16x32_bf16 v[88:91], v[144:147], v[136:139], v[88:91]
    s_waitcnt lgkmcnt(14)
    ds_read_b64_tr_b16 v[214:215], v14 offset:29696
    v_mfma_f32_16x16x32_bf16 v[84:87], v[140:143], v[136:139], v[84:87]
    s_waitcnt lgkmcnt(14)
    ds_read_b64_tr_b16 v[216:217], v15 offset:28672
    v_mfma_f32_16x16x32_bf16 v[60:63], v[172:175], v[156:159], v[60:63]
    s_waitcnt lgkmcnt(14)
    ds_read_b64_tr_b16 v[218:219], v15 offset:29696
    v_mfma_f32_16x16x32_bf16 v[64:67], v[176:179], v[156:159], v[64:67]
    s_waitcnt lgkmcnt(6)
    v_mfma_f32_16x16x32_bf16 v[92:95], v[180:183], v[156:159], v[92:95]
    ds_read_b128 v[192:195], v22 offset:18688
    v_mfma_f32_16x16x32_bf16 v[96:99], v[184:187], v[156:159], v[96:99]
    ds_read_b128 v[196:199], v22 offset:22528
    v_mfma_f32_16x16x32_bf16 v[104:107], v[184:187], v[160:163], v[104:107]
    ds_read_b128 v[200:203], v22 offset:22784
    v_mfma_f32_16x16x32_bf16 v[100:103], v[180:183], v[160:163], v[100:103]
    v_mfma_f32_16x16x32_bf16 v[72:75], v[176:179], v[160:163], v[72:75]
    v_mfma_f32_16x16x32_bf16 v[68:71], v[172:175], v[160:163], v[68:71]
    v_mfma_f32_16x16x32_bf16 v[76:79], v[172:175], v[164:167], v[76:79]
    v_mfma_f32_16x16x32_bf16 v[80:83], v[176:179], v[164:167], v[80:83]
    v_mfma_f32_16x16x32_bf16 v[108:111], v[180:183], v[164:167], v[108:111]
    v_mfma_f32_16x16x32_bf16 v[112:115], v[184:187], v[164:167], v[112:115]
    s_waitcnt lgkmcnt(0)
    s_barrier
    v_mfma_f32_16x16x32_bf16 v[120:123], v[184:187], v[168:171], v[120:123]
    ds_read_b128 v[124:127], v22 offset:32768
    v_mfma_f32_16x16x32_bf16 v[116:119], v[180:183], v[168:171], v[116:119]
    ds_read_b64_tr_b16 v[140:141], v14 offset:32768
    v_mfma_f32_16x16x32_bf16 v[88:91], v[176:179], v[168:171], v[88:91]
    ds_read_b64_tr_b16 v[142:143], v14 offset:33792
    v_mfma_f32_16x16x32_bf16 v[84:87], v[172:175], v[168:171], v[84:87]
    ds_read_b64_tr_b16 v[144:145], v15 offset:32768
    v_mfma_f32_16x16x32_bf16 v[60:63], v[204:207], v[188:191], v[60:63]
    ds_read_b64_tr_b16 v[146:147], v15 offset:33792
    v_mfma_f32_16x16x32_bf16 v[64:67], v[208:211], v[188:191], v[64:67]
    ds_read_b64_tr_b16 v[148:149], v14 offset:40960
    v_mfma_f32_16x16x32_bf16 v[92:95], v[212:215], v[188:191], v[92:95]
    ds_read_b64_tr_b16 v[150:151], v14 offset:41984
    v_mfma_f32_16x16x32_bf16 v[96:99], v[216:219], v[188:191], v[96:99]
    ds_read_b64_tr_b16 v[152:153], v15 offset:40960
    v_mfma_f32_16x16x32_bf16 v[104:107], v[216:219], v[192:195], v[104:107]
    ds_read_b64_tr_b16 v[154:155], v15 offset:41984
    v_mfma_f32_16x16x32_bf16 v[100:103], v[212:215], v[192:195], v[100:103]
    ds_read_b128 v[128:131], v22 offset:33024
    v_mfma_f32_16x16x32_bf16 v[72:75], v[208:211], v[192:195], v[72:75]
    ds_read_b128 v[132:135], v22 offset:36864
    v_mfma_f32_16x16x32_bf16 v[68:71], v[204:207], v[192:195], v[68:71]
L_pad_12:
    s_cbranch_execz L_ret_x2
    ds_read_b128 v[136:139], v22 offset:37120
    v_mfma_f32_16x16x32_bf16 v[76:79], v[204:207], v[196:199], v[76:79]
    ds_read_b128 v[156:159], v22 offset:34816
    v_mfma_f32_16x16x32_bf16 v[80:83], v[208:211], v[196:199], v[80:83]
    ds_read_b64_tr_b16 v[172:173], v14 offset:36864
    v_mfma_f32_16x16x32_bf16 v[108:111], v[212:215], v[196:199], v[108:111]
    ds_read_b64_tr_b16 v[174:175], v14 offset:37888
    v_mfma_f32_16x16x32_bf16 v[112:115], v[216:219], v[196:199], v[112:115]
    s_waitcnt lgkmcnt(14)
    ds_read_b64_tr_b16 v[176:177], v15 offset:36864
    v_mfma_f32_16x16x32_bf16 v[120:123], v[216:219], v[200:203], v[120:123]
    s_waitcnt lgkmcnt(14)
    ds_read_b64_tr_b16 v[178:179], v15 offset:37888
    v_mfma_f32_16x16x32_bf16 v[116:119], v[212:215], v[200:203], v[116:119]
    s_waitcnt lgkmcnt(14)
    ds_read_b64_tr_b16 v[180:181], v14 offset:45056
    v_mfma_f32_16x16x32_bf16 v[88:91], v[208:211], v[200:203], v[88:91]
    s_waitcnt lgkmcnt(14)
    ds_read_b64_tr_b16 v[182:183], v14 offset:46080
    v_mfma_f32_16x16x32_bf16 v[84:87], v[204:207], v[200:203], v[84:87]
    s_waitcnt lgkmcnt(14)
    ds_read_b64_tr_b16 v[184:185], v15 offset:45056
    v_mfma_f32_16x16x32_bf16 v[60:63], v[140:143], v[124:127], v[60:63]
    s_waitcnt lgkmcnt(14)
    ds_read_b64_tr_b16 v[186:187], v15 offset:46080
    v_mfma_f32_16x16x32_bf16 v[64:67], v[144:147], v[124:127], v[64:67]
    s_waitcnt lgkmcnt(6)
    v_mfma_f32_16x16x32_bf16 v[92:95], v[148:151], v[124:127], v[92:95]
    ds_read_b128 v[160:163], v22 offset:35072
    v_mfma_f32_16x16x32_bf16 v[96:99], v[152:155], v[124:127], v[96:99]
    ds_read_b128 v[164:167], v22 offset:38912
    v_mfma_f32_16x16x32_bf16 v[104:107], v[152:155], v[128:131], v[104:107]
    ds_read_b128 v[168:171], v22 offset:39168
    v_mfma_f32_16x16x32_bf16 v[100:103], v[148:151], v[128:131], v[100:103]
    v_mfma_f32_16x16x32_bf16 v[72:75], v[144:147], v[128:131], v[72:75]
    v_mfma_f32_16x16x32_bf16 v[68:71], v[140:143], v[128:131], v[68:71]
    v_mfma_f32_16x16x32_bf16 v[76:79], v[140:143], v[132:135], v[76:79]
    v_mfma_f32_16x16x32_bf16 v[80:83], v[144:147], v[132:135], v[80:83]
    v_mfma_f32_16x16x32_bf16 v[108:111], v[148:151], v[132:135], v[108:111]
    v_mfma_f32_16x16x32_bf16 v[112:115], v[152:155], v[132:135], v[112:115]
    s_waitcnt lgkmcnt(0)
    s_barrier
    v_mfma_f32_16x16x32_bf16 v[120:123], v[152:155], v[136:139], v[120:123]
    ds_read_b128 v[188:191], v22 offset:49152
    v_mfma_f32_16x16x32_bf16 v[116:119], v[148:151], v[136:139], v[116:119]
    ds_read_b64_tr_b16 v[204:205], v14 offset:49152
    v_mfma_f32_16x16x32_bf16 v[88:91], v[144:147], v[136:139], v[88:91]
    ds_read_b64_tr_b16 v[206:207], v14 offset:50176
    v_mfma_f32_16x16x32_bf16 v[84:87], v[140:143], v[136:139], v[84:87]
    ds_read_b64_tr_b16 v[208:209], v15 offset:49152
    v_mfma_f32_16x16x32_bf16 v[60:63], v[172:175], v[156:159], v[60:63]
    ds_read_b64_tr_b16 v[210:211], v15 offset:50176
    v_mfma_f32_16x16x32_bf16 v[64:67], v[176:179], v[156:159], v[64:67]
    ds_read_b64_tr_b16 v[212:213], v14 offset:57344
    v_mfma_f32_16x16x32_bf16 v[92:95], v[180:183], v[156:159], v[92:95]
    ds_read_b64_tr_b16 v[214:215], v14 offset:58368
    v_mfma_f32_16x16x32_bf16 v[96:99], v[184:187], v[156:159], v[96:99]
    ds_read_b64_tr_b16 v[216:217], v15 offset:57344
    v_mfma_f32_16x16x32_bf16 v[104:107], v[184:187], v[160:163], v[104:107]
    ds_read_b64_tr_b16 v[218:219], v15 offset:58368
    v_mfma_f32_16x16x32_bf16 v[100:103], v[180:183], v[160:163], v[100:103]
    ds_read_b128 v[192:195], v22 offset:49408
    v_mfma_f32_16x16x32_bf16 v[72:75], v[176:179], v[160:163], v[72:75]
    ds_read_b128 v[196:199], v22 offset:53248
    v_mfma_f32_16x16x32_bf16 v[68:71], v[172:175], v[160:163], v[68:71]
    ds_read_b128 v[200:203], v22 offset:53504
    v_mfma_f32_16x16x32_bf16 v[76:79], v[172:175], v[164:167], v[76:79]
    ds_read_b128 v[124:127], v22 offset:51200
    v_mfma_f32_16x16x32_bf16 v[80:83], v[176:179], v[164:167], v[80:83]
    ds_read_b64_tr_b16 v[140:141], v14 offset:53248
    v_mfma_f32_16x16x32_bf16 v[108:111], v[180:183], v[164:167], v[108:111]
    ds_read_b64_tr_b16 v[142:143], v14 offset:54272
    v_mfma_f32_16x16x32_bf16 v[112:115], v[184:187], v[164:167], v[112:115]
    s_waitcnt lgkmcnt(14)
    ds_read_b64_tr_b16 v[144:145], v15 offset:53248
    v_mfma_f32_16x16x32_bf16 v[120:123], v[184:187], v[168:171], v[120:123]
    s_waitcnt lgkmcnt(14)
    ds_read_b64_tr_b16 v[146:147], v15 offset:54272
    v_mfma_f32_16x16x32_bf16 v[116:119], v[180:183], v[168:171], v[116:119]
    s_waitcnt lgkmcnt(14)
    ds_read_b64_tr_b16 v[148:149], v14 offset:61440
    v_mfma_f32_16x16x32_bf16 v[88:91], v[176:179], v[168:171], v[88:91]
    s_waitcnt lgkmcnt(14)
    ds_read_b64_tr_b16 v[150:151], v14 offset:62464
    v_mfma_f32_16x16x32_bf16 v[84:87], v[172:175], v[168:171], v[84:87]
    s_waitcnt lgkmcnt(14)
    ds_read_b64_tr_b16 v[152:153], v15 offset:61440
    v_mfma_f32_16x16x32_bf16 v[60:63], v[204:207], v[188:191], v[60:63]
    s_waitcnt lgkmcnt(14)
    ds_read_b64_tr_b16 v[154:155], v15 offset:62464
    v_mfma_f32_16x16x32_bf16 v[64:67], v[208:211], v[188:191], v[64:67]
    s_waitcnt lgkmcnt(6)
    v_mfma_f32_16x16x32_bf16 v[92:95], v[212:215], v[188:191], v[92:95]
    ds_read_b128 v[128:131], v22 offset:51456
    v_mfma_f32_16x16x32_bf16 v[96:99], v[216:219], v[188:191], v[96:99]
    ds_read_b128 v[132:135], v22 offset:55296
    v_mfma_f32_16x16x32_bf16 v[104:107], v[216:219], v[192:195], v[104:107]
    ds_read_b128 v[136:139], v22 offset:55552
    v_mfma_f32_16x16x32_bf16 v[100:103], v[212:215], v[192:195], v[100:103]
    v_mfma_f32_16x16x32_bf16 v[72:75], v[208:211], v[192:195], v[72:75]
    v_mfma_f32_16x16x32_bf16 v[68:71], v[204:207], v[192:195], v[68:71]
    v_mfma_f32_16x16x32_bf16 v[76:79], v[204:207], v[196:199], v[76:79]
    v_mfma_f32_16x16x32_bf16 v[80:83], v[208:211], v[196:199], v[80:83]
    v_mfma_f32_16x16x32_bf16 v[108:111], v[212:215], v[196:199], v[108:111]
    v_mfma_f32_16x16x32_bf16 v[112:115], v[216:219], v[196:199], v[112:115]
    s_waitcnt lgkmcnt(0)
    s_barrier
    v_mfma_f32_16x16x32_bf16 v[120:123], v[216:219], v[200:203], v[120:123]
    ds_read_b128 v[156:159], v22 offset:0
    v_mfma_f32_16x16x32_bf16 v[116:119], v[212:215], v[200:203], v[116:119]
    ds_read_b64_tr_b16 v[172:173], v14 offset:0
    v_mfma_f32_16x16x32_bf16 v[88:91], v[208:211], v[200:203], v[88:91]
    ds_read_b64_tr_b16 v[174:175], v14 offset:1024
    v_mfma_f32_16x16x32_bf16 v[84:87], v[204:207], v[200:203], v[84:87]
    ds_read_b64_tr_b16 v[176:177], v15 offset:0
    v_mfma_f32_16x16x32_bf16 v[60:63], v[140:143], v[124:127], v[60:63]
    ds_read_b64_tr_b16 v[178:179], v15 offset:1024
    v_mfma_f32_16x16x32_bf16 v[64:67], v[144:147], v[124:127], v[64:67]
    ds_read_b64_tr_b16 v[180:181], v14 offset:8192
    v_mfma_f32_16x16x32_bf16 v[92:95], v[148:151], v[124:127], v[92:95]
    ds_read_b64_tr_b16 v[182:183], v14 offset:9216
    v_mfma_f32_16x16x32_bf16 v[96:99], v[152:155], v[124:127], v[96:99]
    ds_read_b64_tr_b16 v[184:185], v15 offset:8192
    v_mfma_f32_16x16x32_bf16 v[104:107], v[152:155], v[128:131], v[104:107]
    ds_read_b64_tr_b16 v[186:187], v15 offset:9216
    v_mfma_f32_16x16x32_bf16 v[100:103], v[148:151], v[128:131], v[100:103]
    ds_read_b128 v[160:163], v22 offset:256
    v_mfma_f32_16x16x32_bf16 v[72:75], v[144:147], v[128:131], v[72:75]
    ds_read_b128 v[164:167], v22 offset:4096
    v_mfma_f32_16x16x32_bf16 v[68:71], v[140:143], v[128:131], v[68:71]
    ds_read_b128 v[168:171], v22 offset:4352
    v_mfma_f32_16x16x32_bf16 v[76:79], v[140:143], v[132:135], v[76:79]
    ds_read_b128 v[188:191], v22 offset:2048
    v_mfma_f32_16x16x32_bf16 v[80:83], v[144:147], v[132:135], v[80:83]
    ds_read_b64_tr_b16 v[204:205], v14 offset:4096
    v_mfma_f32_16x16x32_bf16 v[108:111], v[148:151], v[132:135], v[108:111]
    ds_read_b64_tr_b16 v[206:207], v14 offset:5120
    v_mfma_f32_16x16x32_bf16 v[112:115], v[152:155], v[132:135], v[112:115]
    s_waitcnt lgkmcnt(14)
    ds_read_b64_tr_b16 v[208:209], v15 offset:4096
    v_mfma_f32_16x16x32_bf16 v[120:123], v[152:155], v[136:139], v[120:123]
    s_waitcnt lgkmcnt(14)
    ds_read_b64_tr_b16 v[210:211], v15 offset:5120
    v_mfma_f32_16x16x32_bf16 v[116:119], v[148:151], v[136:139], v[116:119]
    s_waitcnt lgkmcnt(14)
    ds_read_b64_tr_b16 v[212:213], v14 offset:12288
    v_mfma_f32_16x16x32_bf16 v[88:91], v[144:147], v[136:139], v[88:91]
    s_waitcnt lgkmcnt(14)
    ds_read_b64_tr_b16 v[214:215], v14 offset:13312
    v_mfma_f32_16x16x32_bf16 v[84:87], v[140:143], v[136:139], v[84:87]
    s_waitcnt lgkmcnt(14)
    ds_read_b64_tr_b16 v[216:217], v15 offset:12288
    v_mfma_f32_16x16x32_bf16 v[60:63], v[172:175], v[156:159], v[60:63]
    s_waitcnt lgkmcnt(14)
    ds_read_b64_tr_b16 v[218:219], v15 offset:13312
    v_mfma_f32_16x16x32_bf16 v[64:67], v[176:179], v[156:159], v[64:67]
    s_waitcnt lgkmcnt(6)
    v_mfma_f32_16x16x32_bf16 v[92:95], v[180:183], v[156:159], v[92:95]
    ds_read_b128 v[192:195], v22 offset:2304
    v_mfma_f32_16x16x32_bf16 v[96:99], v[184:187], v[156:159], v[96:99]
    ds_read_b128 v[196:199], v22 offset:6144
    v_mfma_f32_16x16x32_bf16 v[104:107], v[184:187], v[160:163], v[104:107]
    ds_read_b128 v[200:203], v22 offset:6400
    v_mfma_f32_16x16x32_bf16 v[100:103], v[180:183], v[160:163], v[100:103]
    v_mfma_f32_16x16x32_bf16 v[72:75], v[176:179], v[160:163], v[72:75]
    v_mfma_f32_16x16x32_bf16 v[68:71], v[172:175], v[160:163], v[68:71]
    v_mfma_f32_16x16x32_bf16 v[76:79], v[172:175], v[164:167], v[76:79]
    v_mfma_f32_16x16x32_bf16 v[80:83], v[176:179], v[164:167], v[80:83]
    v_mfma_f32_16x16x32_bf16 v[108:111], v[180:183], v[164:167], v[108:111]
    v_mfma_f32_16x16x32_bf16 v[112:115], v[184:187], v[164:167], v[112:115]
    s_waitcnt lgkmcnt(0)
    s_barrier
    v_mfma_f32_16x16x32_bf16 v[120:123], v[184:187], v[168:171], v[120:123]
    ds_read_b128 v[124:127], v22 offset:16384
    v_mfma_f32_16x16x32_bf16 v[116:119], v[180:183], v[168:171], v[116:119]
    ds_read_b64_tr_b16 v[140:141], v14 offset:16384
    v_mfma_f32_16x16x32_bf16 v[88:91], v[176:179], v[168:171], v[88:91]
    ds_read_b64_tr_b16 v[142:143], v14 offset:17408
    v_mfma_f32_16x16x32_bf16 v[84:87], v[172:175], v[168:171], v[84:87]
    ds_read_b64_tr_b16 v[144:145], v15 offset:16384
    v_mfma_f32_16x16x32_bf16 v[60:63], v[204:207], v[188:191], v[60:63]
    ds_read_b64_tr_b16 v[146:147], v15 offset:17408
    v_mfma_f32_16x16x32_bf16 v[64:67], v[208:211], v[188:191], v[64:67]
    ds_read_b64_tr_b16 v[148:149], v14 offset:24576
    v_mfma_f32_16x16x32_bf16 v[92:95], v[212:215], v[188:191], v[92:95]
    ds_read_b64_tr_b16 v[150:151], v14 offset:25600
    v_mfma_f32_16x16x32_bf16 v[96:99], v[216:219], v[188:191], v[96:99]
    ds_read_b64_tr_b16 v[152:153], v15 offset:24576
    v_mfma_f32_16x16x32_bf16 v[104:107], v[216:219], v[192:195], v[104:107]
    ds_read_b64_tr_b16 v[154:155], v15 offset:25600
    v_mfma_f32_16x16x32_bf16 v[100:103], v[212:215], v[192:195], v[100:103]
    ds_read_b128 v[128:131], v22 offset:16640
    v_mfma_f32_16x16x32_bf16 v[72:75], v[208:211], v[192:195], v[72:75]
    ds_read_b128 v[132:135], v22 offset:20480
    v_mfma_f32_16x16x32_bf16 v[68:71], v[204:207], v[192:195], v[68:71]
    ds_read_b128 v[136:139], v22 offset:20736
    v_mfma_f32_16x16x32_bf16 v[76:79], v[204:207], v[196:199], v[76:79]
    ds_read_b128 v[156:159], v22 offset:18432
    v_mfma_f32_16x16x32_bf16 v[80:83], v[208:211], v[196:199], v[80:83]
    ds_read_b64_tr_b16 v[172:173], v14 offset:20480
    v_mfma_f32_16x16x32_bf16 v[108:111], v[212:215], v[196:199], v[108:111]
    ds_read_b64_tr_b16 v[174:175], v14 offset:21504
    v_mfma_f32_16x16x32_bf16 v[112:115], v[216:219], v[196:199], v[112:115]
    s_waitcnt lgkmcnt(14)
    ds_read_b64_tr_b16 v[176:177], v15 offset:20480
    v_mfma_f32_16x16x32_bf16 v[120:123], v[216:219], v[200:203], v[120:123]
    s_waitcnt lgkmcnt(14)
    ds_read_b64_tr_b16 v[178:179], v15 offset:21504
    v_mfma_f32_16x16x32_bf16 v[116:119], v[212:215], v[200:203], v[116:119]
    s_waitcnt lgkmcnt(14)
    ds_read_b64_tr_b16 v[180:181], v14 offset:28672
    v_mfma_f32_16x16x32_bf16 v[88:91], v[208:211], v[200:203], v[88:91]
    s_waitcnt lgkmcnt(14)
    ds_read_b64_tr_b16 v[182:183], v14 offset:29696
    v_mfma_f32_16x16x32_bf16 v[84:87], v[204:207], v[200:203], v[84:87]
    s_waitcnt lgkmcnt(14)
    ds_read_b64_tr_b16 v[184:185], v15 offset:28672
    v_mfma_f32_16x16x32_bf16 v[60:63], v[140:143], v[124:127], v[60:63]
    s_waitcnt lgkmcnt(14)
    ds_read_b64_tr_b16 v[186:187], v15 offset:29696
    v_mfma_f32_16x16x32_bf16 v[64:67], v[144:147], v[124:127], v[64:67]
    s_waitcnt lgkmcnt(6)
    v_mfma_f32_16x16x32_bf16 v[92:95], v[148:151], v[124:127], v[92:95]
    ds_read_b128 v[160:163], v22 offset:18688
    v_mfma_f32_16x16x32_bf16 v[96:99], v[152:155], v[124:127], v[96:99]
    ds_read_b128 v[164:167], v22 offset:22528
    v_mfma_f32_16x16x32_bf16 v[104:107], v[152:155], v[128:131], v[104:107]
    ds_read_b128 v[168:171], v22 offset:22784
    v_mfma_f32_16x16x32_bf16 v[100:103], v[148:151], v[128:131], v[100:103]
    v_mfma_f32_16x16x32_bf16 v[72:75], v[144:147], v[128:131], v[72:75]
    v_mfma_f32_16x16x32_bf16 v[68:71], v[140:143], v[128:131], v[68:71]
    v_mfma_f32_16x16x32_bf16 v[76:79], v[140:143], v[132:135], v[76:79]
    v_mfma_f32_16x16x32_bf16 v[80:83], v[144:147], v[132:135], v[80:83]
    v_mfma_f32_16x16x32_bf16 v[108:111], v[148:151], v[132:135], v[108:111]
    v_mfma_f32_16x16x32_bf16 v[112:115], v[152:155], v[132:135], v[112:115]
    s_waitcnt lgkmcnt(0)
    s_barrier
    v_mfma_f32_16x16x32_bf16 v[120:123], v[152:155], v[136:139], v[120:123]
    ds_read_b128 v[188:191], v22 offset:32768
    v_mfma_f32_16x16x32_bf16 v[116:119], v[148:151], v[136:139], v[116:119]
    ds_read_b64_tr_b16 v[204:205], v14 offset:32768
    v_mfma_f32_16x16x32_bf16 v[88:91], v[144:147], v[136:139], v[88:91]
    ds_read_b64_tr_b16 v[206:207], v14 offset:33792
    v_mfma_f32_16x16x32_bf16 v[84:87], v[140:143], v[136:139], v[84:87]
    ds_read_b64_tr_b16 v[208:209], v15 offset:32768
    v_mfma_f32_16x16x32_bf16 v[60:63], v[172:175], v[156:159], v[60:63]
    ds_read_b64_tr_b16 v[210:211], v15 offset:33792
    v_mfma_f32_16x16x32_bf16 v[64:67], v[176:179], v[156:159], v[64:67]
    ds_read_b64_tr_b16 v[212:213], v14 offset:40960
    v_mfma_f32_16x16x32_bf16 v[92:95], v[180:183], v[156:159], v[92:95]
    ds_read_b64_tr_b16 v[214:215], v14 offset:41984
    v_mfma_f32_16x16x32_bf16 v[96:99], v[184:187], v[156:159], v[96:99]
    ds_read_b64_tr_b16 v[216:217], v15 offset:40960
    v_mfma_f32_16x16x32_bf16 v[104:107], v[184:187], v[160:163], v[104:107]
    ds_read_b64_tr_b16 v[218:219], v15 offset:41984
    v_mfma_f32_16x16x32_bf16 v[100:103], v[180:183], v[160:163], v[100:103]
    ds_read_b128 v[192:195], v22 offset:33024
    v_mfma_f32_16x16x32_bf16 v[72:75], v[176:179], v[160:163], v[72:75]
    ds_read_b128 v[196:199], v22 offset:36864
    v_mfma_f32_16x16x32_bf16 v[68:71], v[172:175], v[160:163], v[68:71]
    ds_read_b128 v[200:203], v22 offset:37120
    v_mfma_f32_16x16x32_bf16 v[76:79], v[172:175], v[164:167], v[76:79]
    ds_read_b128 v[124:127], v22 offset:34816
    v_mfma_f32_16x16x32_bf16 v[80:83], v[176:179], v[164:167], v[80:83]
    ds_read_b64_tr_b16 v[140:141], v14 offset:36864
    v_mfma_f32_16x16x32_bf16 v[108:111], v[180:183], v[164:167], v[108:111]
    ds_read_b64_tr_b16 v[142:143], v14 offset:37888
    v_mfma_f32_16x16x32_bf16 v[112:115], v[184:187], v[164:167], v[112:115]
    s_waitcnt lgkmcnt(14)
    ds_read_b64_tr_b16 v[144:145], v15 offset:36864
    v_mfma_f32_16x16x32_bf16 v[120:123], v[184:187], v[168:171], v[120:123]
    s_waitcnt lgkmcnt(14)
    ds_read_b64_tr_b16 v[146:147], v15 offset:37888
    v_mfma_f32_16x16x32_bf16 v[116:119], v[180:183], v[168:171], v[116:119]
    s_waitcnt lgkmcnt(14)
    ds_read_b64_tr_b16 v[148:149], v14 offset:45056
    v_mfma_f32_16x16x32_bf16 v[88:91], v[176:179], v[168:171], v[88:91]
    s_waitcnt lgkmcnt(14)
    ds_read_b64_tr_b16 v[150:151], v14 offset:46080
    v_mfma_f32_16x16x32_bf16 v[84:87], v[172:175], v[168:171], v[84:87]
    s_waitcnt lgkmcnt(14)
    ds_read_b64_tr_b16 v[152:153], v15 offset:45056
    v_mfma_f32_16x16x32_bf16 v[60:63], v[204:207], v[188:191], v[60:63]
    s_waitcnt lgkmcnt(14)
    ds_read_b64_tr_b16 v[154:155], v15 offset:46080
    v_mfma_f32_16x16x32_bf16 v[64:67], v[208:211], v[188:191], v[64:67]
    s_waitcnt lgkmcnt(6)
    v_mfma_f32_16x16x32_bf16 v[92:95], v[212:215], v[188:191], v[92:95]
    ds_read_b128 v[128:131], v22 offset:35072
    v_mfma_f32_16x16x32_bf16 v[96:99], v[216:219], v[188:191], v[96:99]
    ds_read_b128 v[132:135], v22 offset:38912
    v_mfma_f32_16x16x32_bf16 v[104:107], v[216:219], v[192:195], v[104:107]
    ds_read_b128 v[136:139], v22 offset:39168
    v_mfma_f32_16x16x32_bf16 v[100:103], v[212:215], v[192:195], v[100:103]
    v_mfma_f32_16x16x32_bf16 v[72:75], v[208:211], v[192:195], v[72:75]
    v_mfma_f32_16x16x32_bf16 v[68:71], v[204:207], v[192:195], v[68:71]
    v_mfma_f32_16x16x32_bf16 v[76:79], v[204:207], v[196:199], v[76:79]
    v_mfma_f32_16x16x32_bf16 v[80:83], v[208:211], v[196:199], v[80:83]
    v_mfma_f32_16x16x32_bf16 v[108:111], v[212:215], v[196:199], v[108:111]
    v_mfma_f32_16x16x32_bf16 v[112:115], v[216:219], v[196:199], v[112:115]
    s_waitcnt lgkmcnt(0)
    s_barrier
    v_mfma_f32_16x16x32_bf16 v[120:123], v[216:219], v[200:203], v[120:123]
    ds_read_b128 v[156:159], v22 offset:49152
    v_mfma_f32_16x16x32_bf16 v[116:119], v[212:215], v[200:203], v[116:119]
    ds_read_b64_tr_b16 v[172:173], v14 offset:49152
    v_mfma_f32_16x16x32_bf16 v[88:91], v[208:211], v[200:203], v[88:91]
    ds_read_b64_tr_b16 v[174:175], v14 offset:50176
    v_mfma_f32_16x16x32_bf16 v[84:87], v[204:207], v[200:203], v[84:87]
    ds_read_b64_tr_b16 v[176:177], v15 offset:49152
    v_mfma_f32_16x16x32_bf16 v[60:63], v[140:143], v[124:127], v[60:63]
    ds_read_b64_tr_b16 v[178:179], v15 offset:50176
    v_mfma_f32_16x16x32_bf16 v[64:67], v[144:147], v[124:127], v[64:67]
    ds_read_b64_tr_b16 v[180:181], v14 offset:57344
    v_mfma_f32_16x16x32_bf16 v[92:95], v[148:151], v[124:127], v[92:95]
    ds_read_b64_tr_b16 v[182:183], v14 offset:58368
    v_mfma_f32_16x16x32_bf16 v[96:99], v[152:155], v[124:127], v[96:99]
    ds_read_b64_tr_b16 v[184:185], v15 offset:57344
    v_mfma_f32_16x16x32_bf16 v[104:107], v[152:155], v[128:131], v[104:107]
    ds_read_b64_tr_b16 v[186:187], v15 offset:58368
    v_mfma_f32_16x16x32_bf16 v[100:103], v[148:151], v[128:131], v[100:103]
    ds_read_b128 v[160:163], v22 offset:49408
    v_mfma_f32_16x16x32_bf16 v[72:75], v[144:147], v[128:131], v[72:75]
    ds_read_b128 v[164:167], v22 offset:53248
    v_mfma_f32_16x16x32_bf16 v[68:71], v[140:143], v[128:131], v[68:71]
    ds_read_b128 v[168:171], v22 offset:53504
    v_mfma_f32_16x16x32_bf16 v[76:79], v[140:143], v[132:135], v[76:79]
    ds_read_b128 v[188:191], v22 offset:51200
    v_mfma_f32_16x16x32_bf16 v[80:83], v[144:147], v[132:135], v[80:83]
    ds_read_b64_tr_b16 v[204:205], v14 offset:53248
    v_mfma_f32_16x16x32_bf16 v[108:111], v[148:151], v[132:135], v[108:111]
    ds_read_b64_tr_b16 v[206:207], v14 offset:54272
    v_mfma_f32_16x16x32_bf16 v[112:115], v[152:155], v[132:135], v[112:115]
    s_waitcnt lgkmcnt(14)
    ds_read_b64_tr_b16 v[208:209], v15 offset:53248
    v_mfma_f32_16x16x32_bf16 v[120:123], v[152:155], v[136:139], v[120:123]
    s_waitcnt lgkmcnt(14)
    ds_read_b64_tr_b16 v[210:211], v15 offset:54272
    v_mfma_f32_16x16x32_bf16 v[116:119], v[148:151], v[136:139], v[116:119]
    s_waitcnt lgkmcnt(14)
    ds_read_b64_tr_b16 v[212:213], v14 offset:61440
    v_mfma_f32_16x16x32_bf16 v[88:91], v[144:147], v[136:139], v[88:91]
    s_waitcnt lgkmcnt(14)
    ds_read_b64_tr_b16 v[214:215], v14 offset:62464
    v_mfma_f32_16x16x32_bf16 v[84:87], v[140:143], v[136:139], v[84:87]
    s_waitcnt lgkmcnt(14)
    ds_read_b64_tr_b16 v[216:217], v15 offset:61440
    v_mfma_f32_16x16x32_bf16 v[60:63], v[172:175], v[156:159], v[60:63]
    s_waitcnt lgkmcnt(14)
    ds_read_b64_tr_b16 v[218:219], v15 offset:62464
    v_mfma_f32_16x16x32_bf16 v[64:67], v[176:179], v[156:159], v[64:67]
    s_waitcnt lgkmcnt(6)
    v_mfma_f32_16x16x32_bf16 v[92:95], v[180:183], v[156:159], v[92:95]
    ds_read_b128 v[192:195], v22 offset:51456
    v_mfma_f32_16x16x32_bf16 v[96:99], v[184:187], v[156:159], v[96:99]
    ds_read_b128 v[196:199], v22 offset:55296
    v_mfma_f32_16x16x32_bf16 v[104:107], v[184:187], v[160:163], v[104:107]
    ds_read_b128 v[200:203], v22 offset:55552
    v_mfma_f32_16x16x32_bf16 v[100:103], v[180:183], v[160:163], v[100:103]
    v_mfma_f32_16x16x32_bf16 v[72:75], v[176:179], v[160:163], v[72:75]
    v_mfma_f32_16x16x32_bf16 v[68:71], v[172:175], v[160:163], v[68:71]
    v_mfma_f32_16x16x32_bf16 v[76:79], v[172:175], v[164:167], v[76:79]
    v_mfma_f32_16x16x32_bf16 v[80:83], v[176:179], v[164:167], v[80:83]
    v_mfma_f32_16x16x32_bf16 v[108:111], v[180:183], v[164:167], v[108:111]
    v_mfma_f32_16x16x32_bf16 v[112:115], v[184:187], v[164:167], v[112:115]
    s_waitcnt lgkmcnt(0)
    s_barrier
    v_mfma_f32_16x16x32_bf16 v[120:123], v[184:187], v[168:171], v[120:123]
    v_mfma_f32_16x16x32_bf16 v[116:119], v[180:183], v[168:171], v[116:119]
    v_mfma_f32_16x16x32_bf16 v[88:91], v[176:179], v[168:171], v[88:91]
    v_mfma_f32_16x16x32_bf16 v[84:87], v[172:175], v[168:171], v[84:87]
    v_mfma_f32_16x16x32_bf16 v[60:63], v[204:207], v[188:191], v[60:63]
    v_mfma_f32_16x16x32_bf16 v[64:67], v[208:211], v[188:191], v[64:67]
    v_mfma_f32_16x16x32_bf16 v[92:95], v[212:215], v[188:191], v[92:95]
    v_mfma_f32_16x16x32_bf16 v[96:99], v[216:219], v[188:191], v[96:99]
    v_mfma_f32_16x16x32_bf16 v[104:107], v[216:219], v[192:195], v[104:107]
    v_mfma_f32_16x16x32_bf16 v[100:103], v[212:215], v[192:195], v[100:103]
    v_mfma_f32_16x16x32_bf16 v[72:75], v[208:211], v[192:195], v[72:75]
    v_mfma_f32_16x16x32_bf16 v[68:71], v[204:207], v[192:195], v[68:71]
    v_mfma_f32_16x16x32_bf16 v[76:79], v[204:207], v[196:199], v[76:79]
    v_mfma_f32_16x16x32_bf16 v[80:83], v[208:211], v[196:199], v[80:83]
    v_mfma_f32_16x16x32_bf16 v[108:111], v[212:215], v[196:199], v[108:111]
    v_mfma_f32_16x16x32_bf16 v[112:115], v[216:219], v[196:199], v[112:115]
    v_mfma_f32_16x16x32_bf16 v[120:123], v[216:219], v[200:203], v[120:123]
    v_mfma_f32_16x16x32_bf16 v[116:119], v[212:215], v[200:203], v[116:119]
    v_mfma_f32_16x16x32_bf16 v[88:91], v[208:211], v[200:203], v[88:91]
    v_mfma_f32_16x16x32_bf16 v[84:87], v[204:207], v[200:203], v[84:87]
    ds_read_b128 v[124:127], v22 offset:0
    ds_read_b64_tr_b16 v[140:141], v14 offset:0
    ds_read_b64_tr_b16 v[142:143], v14 offset:1024
    ds_read_b64_tr_b16 v[144:145], v15 offset:0
    ds_read_b64_tr_b16 v[146:147], v15 offset:1024
    ds_read_b128 v[128:131], v22 offset:256
    ds_read_b128 v[132:135], v22 offset:4096
    ds_read_b128 v[136:139], v22 offset:4352
    ds_read_b128 v[156:159], v22 offset:2048
    ds_read_b64_tr_b16 v[172:173], v14 offset:4096
    ds_read_b64_tr_b16 v[174:175], v14 offset:5120
    ds_read_b64_tr_b16 v[176:177], v15 offset:4096
    ds_read_b64_tr_b16 v[178:179], v15 offset:5120
    ds_read_b128 v[160:163], v22 offset:2304
    ds_read_b128 v[164:167], v22 offset:6144
    s_waitcnt lgkmcnt(12)
    v_mfma_f32_16x16x32_bf16 v[60:63], v[140:143], v[124:127], v[60:63]
    ds_read_b128 v[168:171], v22 offset:6400
    s_waitcnt lgkmcnt(11)
    v_mfma_f32_16x16x32_bf16 v[64:67], v[144:147], v[124:127], v[64:67]
    s_waitcnt lgkmcnt(10)
    v_mfma_f32_16x16x32_bf16 v[72:75], v[144:147], v[128:131], v[72:75]
    v_mfma_f32_16x16x32_bf16 v[68:71], v[140:143], v[128:131], v[68:71]
    s_waitcnt lgkmcnt(9)
    v_mfma_f32_16x16x32_bf16 v[76:79], v[140:143], v[132:135], v[76:79]
    v_mfma_f32_16x16x32_bf16 v[80:83], v[144:147], v[132:135], v[80:83]
    s_waitcnt lgkmcnt(8)
    v_mfma_f32_16x16x32_bf16 v[88:91], v[144:147], v[136:139], v[88:91]
    v_mfma_f32_16x16x32_bf16 v[84:87], v[140:143], v[136:139], v[84:87]
    s_waitcnt lgkmcnt(0)
    s_barrier
    v_mfma_f32_16x16x32_bf16 v[60:63], v[172:175], v[156:159], v[60:63]
    ds_read_b128 v[188:191], v22 offset:16384
    ds_read_b64_tr_b16 v[204:205], v14 offset:16384
    v_mfma_f32_16x16x32_bf16 v[64:67], v[176:179], v[156:159], v[64:67]
    ds_read_b64_tr_b16 v[206:207], v14 offset:17408
    v_mfma_f32_16x16x32_bf16 v[72:75], v[176:179], v[160:163], v[72:75]
    ds_read_b64_tr_b16 v[208:209], v15 offset:16384
    v_mfma_f32_16x16x32_bf16 v[68:71], v[172:175], v[160:163], v[68:71]
    ds_read_b64_tr_b16 v[210:211], v15 offset:17408
    ds_read_b128 v[192:195], v22 offset:16640
    v_mfma_f32_16x16x32_bf16 v[76:79], v[172:175], v[164:167], v[76:79]
    ds_read_b128 v[196:199], v22 offset:20480
    v_mfma_f32_16x16x32_bf16 v[80:83], v[176:179], v[164:167], v[80:83]
    ds_read_b128 v[200:203], v22 offset:20736
    v_mfma_f32_16x16x32_bf16 v[88:91], v[176:179], v[168:171], v[88:91]
    ds_read_b128 v[124:127], v22 offset:18432
    ds_read_b64_tr_b16 v[140:141], v14 offset:20480
    v_mfma_f32_16x16x32_bf16 v[84:87], v[172:175], v[168:171], v[84:87]
    ds_read_b64_tr_b16 v[142:143], v14 offset:21504
    s_waitcnt lgkmcnt(8)
    v_mfma_f32_16x16x32_bf16 v[60:63], v[204:207], v[188:191], v[60:63]
    ds_read_b64_tr_b16 v[144:145], v15 offset:20480
    s_waitcnt lgkmcnt(7)
    v_mfma_f32_16x16x32_bf16 v[64:67], v[208:211], v[188:191], v[64:67]
    ds_read_b64_tr_b16 v[146:147], v15 offset:21504
    ds_read_b128 v[128:131], v22 offset:18688
    s_waitcnt lgkmcnt(8)
    v_mfma_f32_16x16x32_bf16 v[72:75], v[208:211], v[192:195], v[72:75]
    ds_read_b128 v[132:135], v22 offset:22528
    v_mfma_f32_16x16x32_bf16 v[68:71], v[204:207], v[192:195], v[68:71]
    ds_read_b128 v[136:139], v22 offset:22784
    s_waitcnt lgkmcnt(9)
    v_mfma_f32_16x16x32_bf16 v[76:79], v[204:207], v[196:199], v[76:79]
    v_mfma_f32_16x16x32_bf16 v[80:83], v[208:211], v[196:199], v[80:83]
    s_waitcnt lgkmcnt(8)
    v_mfma_f32_16x16x32_bf16 v[88:91], v[208:211], v[200:203], v[88:91]
    v_mfma_f32_16x16x32_bf16 v[84:87], v[204:207], v[200:203], v[84:87]
    s_waitcnt lgkmcnt(0)
    s_barrier
    v_mfma_f32_16x16x32_bf16 v[60:63], v[140:143], v[124:127], v[60:63]
    ds_read_b128 v[156:159], v22 offset:32768
    v_mfma_f32_16x16x32_bf16 v[64:67], v[144:147], v[124:127], v[64:67]
    ds_read_b64_tr_b16 v[172:173], v14 offset:32768
    v_mfma_f32_16x16x32_bf16 v[72:75], v[144:147], v[128:131], v[72:75]
    ds_read_b64_tr_b16 v[174:175], v14 offset:33792
    ds_read_b64_tr_b16 v[176:177], v15 offset:32768
    v_mfma_f32_16x16x32_bf16 v[68:71], v[140:143], v[128:131], v[68:71]
    ds_read_b64_tr_b16 v[178:179], v15 offset:33792
    v_mfma_f32_16x16x32_bf16 v[76:79], v[140:143], v[132:135], v[76:79]
    ds_read_b128 v[160:163], v22 offset:33024
    v_mfma_f32_16x16x32_bf16 v[80:83], v[144:147], v[132:135], v[80:83]
    ds_read_b128 v[164:167], v22 offset:36864
    ds_read_b128 v[168:171], v22 offset:37120
    v_mfma_f32_16x16x32_bf16 v[88:91], v[144:147], v[136:139], v[88:91]
    ds_read_b128 v[188:191], v22 offset:34816
    v_mfma_f32_16x16x32_bf16 v[84:87], v[140:143], v[136:139], v[84:87]
    ds_read_b64_tr_b16 v[204:205], v14 offset:36864
    s_waitcnt lgkmcnt(7)
    v_mfma_f32_16x16x32_bf16 v[60:63], v[172:175], v[156:159], v[60:63]
    ds_read_b64_tr_b16 v[206:207], v14 offset:37888
    ds_read_b64_tr_b16 v[208:209], v15 offset:36864
    s_waitcnt lgkmcnt(7)
    v_mfma_f32_16x16x32_bf16 v[64:67], v[176:179], v[156:159], v[64:67]
    ds_read_b64_tr_b16 v[210:211], v15 offset:37888
    s_waitcnt lgkmcnt(7)
    v_mfma_f32_16x16x32_bf16 v[72:75], v[176:179], v[160:163], v[72:75]
    ds_read_b128 v[192:195], v22 offset:35072
    v_mfma_f32_16x16x32_bf16 v[68:71], v[172:175], v[160:163], v[68:71]
    ds_read_b128 v[196:199], v22 offset:38912
    ds_read_b128 v[200:203], v22 offset:39168
    s_waitcnt lgkmcnt(9)
    v_mfma_f32_16x16x32_bf16 v[76:79], v[172:175], v[164:167], v[76:79]
    v_mfma_f32_16x16x32_bf16 v[80:83], v[176:179], v[164:167], v[80:83]
    s_waitcnt lgkmcnt(8)
    v_mfma_f32_16x16x32_bf16 v[88:91], v[176:179], v[168:171], v[88:91]
    v_mfma_f32_16x16x32_bf16 v[84:87], v[172:175], v[168:171], v[84:87]
    s_waitcnt lgkmcnt(0)
    s_barrier
    v_mfma_f32_16x16x32_bf16 v[60:63], v[204:207], v[188:191], v[60:63]
    ds_read_b128 v[124:127], v22 offset:49152
    v_mfma_f32_16x16x32_bf16 v[64:67], v[208:211], v[188:191], v[64:67]
    ds_read_b64_tr_b16 v[140:141], v14 offset:49152
    ds_read_b64_tr_b16 v[142:143], v14 offset:50176
    v_mfma_f32_16x16x32_bf16 v[72:75], v[208:211], v[192:195], v[72:75]
    ds_read_b64_tr_b16 v[144:145], v15 offset:49152
    v_mfma_f32_16x16x32_bf16 v[68:71], v[204:207], v[192:195], v[68:71]
    ds_read_b64_tr_b16 v[146:147], v15 offset:50176
    v_mfma_f32_16x16x32_bf16 v[76:79], v[204:207], v[196:199], v[76:79]
    ds_read_b128 v[128:131], v22 offset:49408
    ds_read_b128 v[132:135], v22 offset:53248
    v_mfma_f32_16x16x32_bf16 v[80:83], v[208:211], v[196:199], v[80:83]
    ds_read_b128 v[136:139], v22 offset:53504
    v_mfma_f32_16x16x32_bf16 v[88:91], v[208:211], v[200:203], v[88:91]
    ds_read_b128 v[156:159], v22 offset:51200
    v_mfma_f32_16x16x32_bf16 v[84:87], v[204:207], v[200:203], v[84:87]
    ds_read_b64_tr_b16 v[172:173], v14 offset:53248
    ds_read_b64_tr_b16 v[174:175], v14 offset:54272
    s_waitcnt lgkmcnt(8)
    v_mfma_f32_16x16x32_bf16 v[60:63], v[140:143], v[124:127], v[60:63]
    ds_read_b64_tr_b16 v[176:177], v15 offset:53248
    s_waitcnt lgkmcnt(7)
    v_mfma_f32_16x16x32_bf16 v[64:67], v[144:147], v[124:127], v[64:67]
    ds_read_b64_tr_b16 v[178:179], v15 offset:54272
    ds_read_b128 v[160:163], v22 offset:51456
    s_waitcnt lgkmcnt(8)
    v_mfma_f32_16x16x32_bf16 v[72:75], v[144:147], v[128:131], v[72:75]
    ds_read_b128 v[164:167], v22 offset:55296
    v_mfma_f32_16x16x32_bf16 v[68:71], v[140:143], v[128:131], v[68:71]
    ds_read_b128 v[168:171], v22 offset:55552
    s_waitcnt lgkmcnt(9)
    v_mfma_f32_16x16x32_bf16 v[76:79], v[140:143], v[132:135], v[76:79]
    v_mfma_f32_16x16x32_bf16 v[80:83], v[144:147], v[132:135], v[80:83]
    s_waitcnt lgkmcnt(8)
    v_mfma_f32_16x16x32_bf16 v[88:91], v[144:147], v[136:139], v[88:91]
    v_mfma_f32_16x16x32_bf16 v[84:87], v[140:143], v[136:139], v[84:87]
    s_waitcnt lgkmcnt(5)
    v_mfma_f32_16x16x32_bf16 v[60:63], v[172:175], v[156:159], v[60:63]
    ds_read_b128 v[188:191], v22 offset:0
    s_waitcnt lgkmcnt(4)
    v_mfma_f32_16x16x32_bf16 v[64:67], v[176:179], v[156:159], v[64:67]
    ds_read_b64_tr_b16 v[212:213], v14 offset:8192
    s_waitcnt lgkmcnt(4)
    v_mfma_f32_16x16x32_bf16 v[72:75], v[176:179], v[160:163], v[72:75]
    ds_read_b64_tr_b16 v[214:215], v14 offset:9216
    ds_read_b64_tr_b16 v[216:217], v15 offset:8192
    v_mfma_f32_16x16x32_bf16 v[68:71], v[172:175], v[160:163], v[68:71]
    ds_read_b64_tr_b16 v[218:219], v15 offset:9216
    s_waitcnt lgkmcnt(6)
    v_mfma_f32_16x16x32_bf16 v[76:79], v[172:175], v[164:167], v[76:79]
    ds_read_b128 v[192:195], v22 offset:256
    v_mfma_f32_16x16x32_bf16 v[80:83], v[176:179], v[164:167], v[80:83]
    ds_read_b128 v[196:199], v22 offset:4096
    ds_read_b128 v[200:203], v22 offset:4352
    s_waitcnt lgkmcnt(8)
    v_mfma_f32_16x16x32_bf16 v[88:91], v[176:179], v[168:171], v[88:91]
    ds_read_b128 v[124:127], v22 offset:2048
L_pad_13:
    s_cbranch_execz L_ret_x2
    v_mfma_f32_16x16x32_bf16 v[84:87], v[172:175], v[168:171], v[84:87]
    ds_read_b64_tr_b16 v[148:149], v14 offset:12288
    s_waitcnt lgkmcnt(7)
    v_mfma_f32_16x16x32_bf16 v[92:95], v[212:215], v[188:191], v[92:95]
    ds_read_b64_tr_b16 v[150:151], v14 offset:13312
    ds_read_b64_tr_b16 v[152:153], v15 offset:12288
    s_waitcnt lgkmcnt(7)
    v_mfma_f32_16x16x32_bf16 v[96:99], v[216:219], v[188:191], v[96:99]
    ds_read_b64_tr_b16 v[154:155], v15 offset:13312
    s_waitcnt lgkmcnt(7)
    v_mfma_f32_16x16x32_bf16 v[104:107], v[216:219], v[192:195], v[104:107]
    ds_read_b128 v[128:131], v22 offset:2304
    v_mfma_f32_16x16x32_bf16 v[100:103], v[212:215], v[192:195], v[100:103]
    ds_read_b128 v[132:135], v22 offset:6144
    ds_read_b128 v[136:139], v22 offset:6400
    s_waitcnt lgkmcnt(9)
    v_mfma_f32_16x16x32_bf16 v[108:111], v[212:215], v[196:199], v[108:111]
    v_mfma_f32_16x16x32_bf16 v[112:115], v[216:219], v[196:199], v[112:115]
    s_waitcnt lgkmcnt(8)
    v_mfma_f32_16x16x32_bf16 v[120:123], v[216:219], v[200:203], v[120:123]
    v_mfma_f32_16x16x32_bf16 v[116:119], v[212:215], v[200:203], v[116:119]
    s_waitcnt lgkmcnt(5)
    v_mfma_f32_16x16x32_bf16 v[92:95], v[148:151], v[124:127], v[92:95]
    ds_read_b128 v[156:159], v22 offset:16384
    ds_write_b128 v28, v[60:63] offset:0
    s_waitcnt lgkmcnt(5)
    v_mfma_f32_16x16x32_bf16 v[96:99], v[152:155], v[124:127], v[96:99]
    ds_read_b64_tr_b16 v[180:181], v14 offset:24576
    ds_read_b64_tr_b16 v[182:183], v14 offset:25600
    ds_write_b128 v29, v[64:67] offset:0
    ds_read_b128 v[220:223], v30 offset:0
    s_waitcnt lgkmcnt(8)
    v_mfma_f32_16x16x32_bf16 v[104:107], v[152:155], v[128:131], v[104:107]
    ds_read_b64_tr_b16 v[184:185], v15 offset:24576
    ds_read_b128 v[224:227], v30 offset:1024
    v_mfma_f32_16x16x32_bf16 v[100:103], v[148:151], v[128:131], v[100:103]
    ds_read_b64_tr_b16 v[186:187], v15 offset:25600
    ds_write_b128 v28, v[68:71] offset:2048
    ds_write_b128 v29, v[72:75] offset:2048
    s_waitcnt lgkmcnt(12)
    v_mfma_f32_16x16x32_bf16 v[108:111], v[148:151], v[132:135], v[108:111]
    ds_read_b128 v[160:163], v22 offset:16640
    ds_read_b128 v[164:167], v22 offset:20480
    ds_read_b128 v[228:231], v30 offset:2048
    v_mfma_f32_16x16x32_bf16 v[112:115], v[152:155], v[132:135], v[112:115]
    s_waitcnt lgkmcnt(14)
    ds_read_b128 v[168:171], v22 offset:20736
    s_waitcnt lgkmcnt(14)
    ds_read_b128 v[232:235], v30 offset:3072
    s_mov_b32 s70, 0x1000
    v_mfma_f32_16x16x32_bf16 v[120:123], v[152:155], v[136:139], v[120:123]
    s_waitcnt lgkmcnt(14)
    ds_read_b128 v[188:191], v22 offset:18432
    s_waitcnt lgkmcnt(11)
    buffer_store_dwordx4 v[220:223], v23, s[24:27], s70 offen offset:0 nt
    v_mfma_f32_16x16x32_bf16 v[116:119], v[148:151], v[136:139], v[116:119]
    ds_read_b64_tr_b16 v[212:213], v14 offset:28672
    ds_read_b64_tr_b16 v[214:215], v14 offset:29696
    s_mov_b32 s70, 0x11000
    s_waitcnt lgkmcnt(11)
    buffer_store_dwordx4 v[224:227], v23, s[24:27], s70 offen offset:0 nt
    v_mfma_f32_16x16x32_bf16 v[92:95], v[180:183], v[156:159], v[92:95]
    ds_read_b64_tr_b16 v[216:217], v15 offset:28672
    ds_write_b128 v28, v[76:79] offset:4096
    s_waitcnt lgkmcnt(12)
    v_mfma_f32_16x16x32_bf16 v[96:99], v[184:187], v[156:159], v[96:99]
    ds_read_b64_tr_b16 v[218:219], v15 offset:29696
    ds_write_b128 v29, v[80:83] offset:4096
    ds_read_b128 v[236:239], v30 offset:4096
    s_waitcnt lgkmcnt(12)
    v_mfma_f32_16x16x32_bf16 v[104:107], v[184:187], v[160:163], v[104:107]
    ds_read_b128 v[192:195], v22 offset:18688
    ds_read_b128 v[196:199], v22 offset:22528
    ds_read_b128 v[240:243], v30 offset:5120
    v_mfma_f32_16x16x32_bf16 v[100:103], v[180:183], v[160:163], v[100:103]
    s_waitcnt lgkmcnt(14)
    ds_read_b128 v[200:203], v22 offset:22784
    s_mov_b32 s70, 0x21000
    s_waitcnt lgkmcnt(14)
    buffer_store_dwordx4 v[228:231], v23, s[24:27], s70 offen offset:0 nt
    v_mfma_f32_16x16x32_bf16 v[108:111], v[180:183], v[164:167], v[108:111]
    s_mov_b32 s70, 0x31000
    v_mfma_f32_16x16x32_bf16 v[112:115], v[184:187], v[164:167], v[112:115]
    s_waitcnt lgkmcnt(12)
    buffer_store_dwordx4 v[232:235], v23, s[24:27], s70 offen offset:0 nt
    ds_write_b128 v28, v[84:87] offset:6144
    v_mfma_f32_16x16x32_bf16 v[120:123], v[184:187], v[168:171], v[120:123]
    ds_write_b128 v29, v[88:91] offset:6144
    v_mfma_f32_16x16x32_bf16 v[116:119], v[180:183], v[168:171], v[116:119]
    ds_read_b128 v[244:247], v30 offset:6144
    s_waitcnt lgkmcnt(14)
    ds_read_b128 v[248:251], v30 offset:7168
    s_waitcnt lgkmcnt(13)
    v_mfma_f32_16x16x32_bf16 v[92:95], v[212:215], v[188:191], v[92:95]
    ds_read_b128 v[124:127], v22 offset:32768
    ds_read_b64_tr_b16 v[148:149], v14 offset:40960
    s_mov_b32 s70, 0x41000
    s_waitcnt lgkmcnt(12)
    v_mfma_f32_16x16x32_bf16 v[96:99], v[216:219], v[188:191], v[96:99]
    ds_read_b64_tr_b16 v[150:151], v14 offset:41984
    s_waitcnt lgkmcnt(11)
    buffer_store_dwordx4 v[236:239], v23, s[24:27], s70 offen offset:0 nt
    s_mov_b32 s70, 0x51000
    s_waitcnt lgkmcnt(10)
    v_mfma_f32_16x16x32_bf16 v[104:107], v[216:219], v[192:195], v[104:107]
    ds_read_b64_tr_b16 v[152:153], v15 offset:40960
    s_waitcnt lgkmcnt(9)
    buffer_store_dwordx4 v[240:243], v23, s[24:27], s70 offen offset:0 nt
    v_mfma_f32_16x16x32_bf16 v[100:103], v[212:215], v[192:195], v[100:103]
    ds_read_b64_tr_b16 v[154:155], v15 offset:41984
    ds_read_b128 v[128:131], v22 offset:33024
    s_mov_b32 s70, 0x61000
    s_waitcnt lgkmcnt(7)
    buffer_store_dwordx4 v[244:247], v23, s[24:27], s70 offen offset:0 nt
    v_mfma_f32_16x16x32_bf16 v[108:111], v[212:215], v[196:199], v[108:111]
    ds_read_b128 v[132:135], v22 offset:36864
    s_mov_b32 s70, 0x71000
    v_mfma_f32_16x16x32_bf16 v[112:115], v[216:219], v[196:199], v[112:115]
    ds_read_b128 v[136:139], v22 offset:37120
    s_waitcnt lgkmcnt(8)
    buffer_store_dwordx4 v[248:251], v23, s[24:27], s70 offen offset:0 nt
    v_mfma_f32_16x16x32_bf16 v[120:123], v[216:219], v[200:203], v[120:123]
    ds_read_b128 v[156:159], v22 offset:34816
    ds_read_b64_tr_b16 v[180:181], v14 offset:45056
    v_mfma_f32_16x16x32_bf16 v[116:119], v[212:215], v[200:203], v[116:119]
    ds_read_b64_tr_b16 v[182:183], v14 offset:46080
    s_waitcnt lgkmcnt(8)
    v_mfma_f32_16x16x32_bf16 v[92:95], v[148:151], v[124:127], v[92:95]
    ds_read_b64_tr_b16 v[184:185], v15 offset:45056
    s_waitcnt lgkmcnt(7)
    v_mfma_f32_16x16x32_bf16 v[96:99], v[152:155], v[124:127], v[96:99]
    ds_read_b64_tr_b16 v[186:187], v15 offset:46080
    ds_read_b128 v[160:163], v22 offset:35072
    s_waitcnt lgkmcnt(8)
    v_mfma_f32_16x16x32_bf16 v[104:107], v[152:155], v[128:131], v[104:107]
    ds_read_b128 v[164:167], v22 offset:38912
    v_mfma_f32_16x16x32_bf16 v[100:103], v[148:151], v[128:131], v[100:103]
    ds_read_b128 v[168:171], v22 offset:39168
    s_waitcnt lgkmcnt(9)
    v_mfma_f32_16x16x32_bf16 v[108:111], v[148:151], v[132:135], v[108:111]
    v_mfma_f32_16x16x32_bf16 v[112:115], v[152:155], v[132:135], v[112:115]
    s_waitcnt lgkmcnt(8)
    v_mfma_f32_16x16x32_bf16 v[120:123], v[152:155], v[136:139], v[120:123]
    v_mfma_f32_16x16x32_bf16 v[116:119], v[148:151], v[136:139], v[116:119]
    s_waitcnt lgkmcnt(5)
    v_mfma_f32_16x16x32_bf16 v[92:95], v[180:183], v[156:159], v[92:95]
    ds_read_b128 v[188:191], v22 offset:49152
    s_waitcnt lgkmcnt(4)
    v_mfma_f32_16x16x32_bf16 v[96:99], v[184:187], v[156:159], v[96:99]
    ds_read_b64_tr_b16 v[212:213], v14 offset:57344
    ds_read_b64_tr_b16 v[214:215], v14 offset:58368
    s_waitcnt lgkmcnt(5)
    v_mfma_f32_16x16x32_bf16 v[104:107], v[184:187], v[160:163], v[104:107]
    ds_read_b64_tr_b16 v[216:217], v15 offset:57344
    v_mfma_f32_16x16x32_bf16 v[100:103], v[180:183], v[160:163], v[100:103]
    ds_read_b64_tr_b16 v[218:219], v15 offset:58368
    s_waitcnt lgkmcnt(6)
    v_mfma_f32_16x16x32_bf16 v[108:111], v[180:183], v[164:167], v[108:111]
    ds_read_b128 v[192:195], v22 offset:49408
    ds_read_b128 v[196:199], v22 offset:53248
    v_mfma_f32_16x16x32_bf16 v[112:115], v[184:187], v[164:167], v[112:115]
    ds_read_b128 v[200:203], v22 offset:53504
    s_waitcnt lgkmcnt(8)
    v_mfma_f32_16x16x32_bf16 v[120:123], v[184:187], v[168:171], v[120:123]
    ds_read_b128 v[124:127], v22 offset:51200
    v_mfma_f32_16x16x32_bf16 v[116:119], v[180:183], v[168:171], v[116:119]
    ds_read_b64_tr_b16 v[148:149], v14 offset:61440
    ds_read_b64_tr_b16 v[150:151], v14 offset:62464
    s_waitcnt lgkmcnt(8)
    v_mfma_f32_16x16x32_bf16 v[92:95], v[212:215], v[188:191], v[92:95]
    ds_read_b64_tr_b16 v[152:153], v15 offset:61440
    s_waitcnt lgkmcnt(7)
    v_mfma_f32_16x16x32_bf16 v[96:99], v[216:219], v[188:191], v[96:99]
    ds_read_b64_tr_b16 v[154:155], v15 offset:62464
    s_waitcnt lgkmcnt(7)
    v_mfma_f32_16x16x32_bf16 v[104:107], v[216:219], v[192:195], v[104:107]
    ds_read_b128 v[128:131], v22 offset:51456
    ds_read_b128 v[132:135], v22 offset:55296
    v_mfma_f32_16x16x32_bf16 v[100:103], v[212:215], v[192:195], v[100:103]
    ds_read_b128 v[136:139], v22 offset:55552
    s_waitcnt lgkmcnt(9)
    v_mfma_f32_16x16x32_bf16 v[108:111], v[212:215], v[196:199], v[108:111]
    v_mfma_f32_16x16x32_bf16 v[112:115], v[216:219], v[196:199], v[112:115]
    s_waitcnt lgkmcnt(8)
    v_mfma_f32_16x16x32_bf16 v[120:123], v[216:219], v[200:203], v[120:123]
    v_mfma_f32_16x16x32_bf16 v[116:119], v[212:215], v[200:203], v[116:119]
    s_waitcnt lgkmcnt(5)
    v_mfma_f32_16x16x32_bf16 v[92:95], v[148:151], v[124:127], v[92:95]
    s_waitcnt lgkmcnt(3)
    v_mfma_f32_16x16x32_bf16 v[96:99], v[152:155], v[124:127], v[96:99]
    s_waitcnt lgkmcnt(2)
    v_mfma_f32_16x16x32_bf16 v[104:107], v[152:155], v[128:131], v[104:107]
    v_mfma_f32_16x16x32_bf16 v[100:103], v[148:151], v[128:131], v[100:103]
    s_waitcnt lgkmcnt(1)
    v_mfma_f32_16x16x32_bf16 v[108:111], v[148:151], v[132:135], v[108:111]
    v_mfma_f32_16x16x32_bf16 v[112:115], v[152:155], v[132:135], v[112:115]
    s_waitcnt lgkmcnt(0)
    v_mfma_f32_16x16x32_bf16 v[120:123], v[152:155], v[136:139], v[120:123]
    v_mfma_f32_16x16x32_bf16 v[116:119], v[148:151], v[136:139], v[116:119]
    s_nop 1
    ds_write_b128 v28, v[92:95] offset:0
    ds_write_b128 v29, v[96:99] offset:0
    ds_read_b128 v[124:127], v30 offset:0
    ds_read_b128 v[128:131], v30 offset:1024
    ds_write_b128 v28, v[100:103] offset:2048
    ds_write_b128 v29, v[104:107] offset:2048
    ds_read_b128 v[132:135], v30 offset:2048
    ds_read_b128 v[136:139], v30 offset:3072
    s_mov_b32 s70, 0x1000
    s_waitcnt lgkmcnt(5)
    buffer_store_dwordx4 v[124:127], v23, s[24:27], s70 offen offset:256 nt
    s_mov_b32 s70, 0x11000
    s_waitcnt lgkmcnt(4)
    buffer_store_dwordx4 v[128:131], v23, s[24:27], s70 offen offset:256 nt
    ds_write_b128 v28, v[108:111] offset:4096
    ds_write_b128 v29, v[112:115] offset:4096
    ds_read_b128 v[140:143], v30 offset:4096
    ds_read_b128 v[144:147], v30 offset:5120
    s_mov_b32 s70, 0x21000
    s_waitcnt lgkmcnt(5)
    buffer_store_dwordx4 v[132:135], v23, s[24:27], s70 offen offset:256 nt
    s_mov_b32 s70, 0x31000
    s_waitcnt lgkmcnt(4)
    buffer_store_dwordx4 v[136:139], v23, s[24:27], s70 offen offset:256 nt
    ds_write_b128 v28, v[116:119] offset:6144
    ds_write_b128 v29, v[120:123] offset:6144
    ds_read_b128 v[148:151], v30 offset:6144
    ds_read_b128 v[152:155], v30 offset:7168
    s_mov_b32 s70, 0x41000
    s_waitcnt lgkmcnt(5)
    buffer_store_dwordx4 v[140:143], v23, s[24:27], s70 offen offset:256 nt
    s_mov_b32 s70, 0x51000
    s_waitcnt lgkmcnt(4)
    buffer_store_dwordx4 v[144:147], v23, s[24:27], s70 offen offset:256 nt
    s_mov_b32 s70, 0x61000
    s_waitcnt lgkmcnt(1)
    buffer_store_dwordx4 v[148:151], v23, s[24:27], s70 offen offset:256 nt
    s_mov_b32 s70, 0x71000
    s_waitcnt lgkmcnt(0)
    buffer_store_dwordx4 v[152:155], v23, s[24:27], s70 offen offset:256 nt
    s_endpgm
L_YA2:
L_pad_ya:
    s_cbranch_execz L_ret_y1
    s_waitcnt vmcnt(8)
    s_barrier
    s_add_u32 m0, s81, 0x0
    s_lshl_b32 s71, s100, 10
    buffer_load_dwordx4 v24, s[20:23], s100 offen lds
    buffer_load_dwordx4 v25, s[20:23], s100 offen offset:1024 lds
    buffer_load_dwordx4 v26, s[20:23], s100 offen offset:2048 lds
    buffer_load_dwordx4 v27, s[20:23], s100 offen offset:3072 lds
    s_add_u32 m0, s82, 0x0
    s_add_u32 s71, s71, 0
    buffer_load_dwordx4 v11, s[24:27], s71 offen lds
    buffer_load_dwordx4 v12, s[24:27], s71 offen offset:1024 lds
    s_add_u32 m0, s82, 0x2000
    s_add_u32 s71, s71, 128
    buffer_load_dwordx4 v11, s[24:27], s71 offen lds
    buffer_load_dwordx4 v12, s[24:27], s71 offen offset:1024 lds
    s_add_u32 s70, s78, 1536
    s_cmp_eq_u32 s101, s70
    s_cselect_b32 s70, 128, 0
    s_add_u32 s101, s101, s70
    s_and_b32 s70, s101, 384
    s_cmp_eq_u32 s70, s78
    s_cselect_b32 s70, 512, 0
    s_add_u32 s100, s101, s70
    s_add_u32 s101, s101, 128
    s_add_u32 s100, s100, s80
    s_and_b32 s100, s100, 2047
    s_waitcnt vmcnt(12)
    s_barrier
    s_add_u32 m0, s81, 0x4000
    s_lshl_b32 s71, s100, 10
    buffer_load_dwordx4 v24, s[20:23], s100 offen lds
    buffer_load_dwordx4 v25, s[20:23], s100 offen offset:1024 lds
    buffer_load_dwordx4 v26, s[20:23], s100 offen offset:2048 lds
    buffer_load_dwordx4 v27, s[20:23], s100 offen offset:3072 lds
    s_add_u32 m0, s82, 0x4000
    s_add_u32 s71, s71, 0
    buffer_load_dwordx4 v11, s[24:27], s71 offen lds
    buffer_load_dwordx4 v12, s[24:27], s71 offen offset:1024 lds
    s_add_u32 m0, s82, 0x6000
    s_add_u32 s71, s71, 128
    buffer_load_dwordx4 v11, s[24:27], s71 offen lds
    buffer_load_dwordx4 v12, s[24:27], s71 offen offset:1024 lds
    s_add_u32 s70, s78, 1536
    s_cmp_eq_u32 s101, s70
    s_cselect_b32 s70, 128, 0
    s_add_u32 s101, s101, s70
    s_and_b32 s70, s101, 384
    s_cmp_eq_u32 s70, s78
    s_cselect_b32 s70, 512, 0
    s_add_u32 s100, s101, s70
    s_add_u32 s101, s101, 128
    s_add_u32 s100, s100, s80
    s_and_b32 s100, s100, 2047
    s_waitcnt vmcnt(16)
    s_barrier
    s_add_u32 m0, s81, 0x8000
    s_lshl_b32 s71, s100, 10
    buffer_load_dwordx4 v24, s[20:23], s100 offen lds
    buffer_load_dwordx4 v25, s[20:23], s100 offen offset:1024 lds
    buffer_load_dwordx4 v26, s[20:23], s100 offen offset:2048 lds
    buffer_load_dwordx4 v27, s[20:23], s100 offen offset:3072 lds
    s_add_u32 m0, s82, 0x8000
    s_add_u32 s71, s71, 0
    buffer_load_dwordx4 v11, s[24:27], s71 offen lds
    buffer_load_dwordx4 v12, s[24:27], s71 offen offset:1024 lds
    s_add_u32 m0, s82, 0xa000
    s_add_u32 s71, s71, 128
    buffer_load_dwordx4 v11, s[24:27], s71 offen lds
    buffer_load_dwordx4 v12, s[24:27], s71 offen offset:1024 lds
    s_add_u32 s70, s78, 1536
    s_cmp_eq_u32 s101, s70
    s_cselect_b32 s70, 128, 0
    s_add_u32 s101, s101, s70
    s_and_b32 s70, s101, 384
    s_cmp_eq_u32 s70, s78
    s_cselect_b32 s70, 512, 0
    s_add_u32 s100, s101, s70
    s_add_u32 s101, s101, 128
    s_add_u32 s100, s100, s80
    s_and_b32 s100, s100, 2047
    s_mov_b32 s8, s68
    s_mov_b32 s9, s69
    s_mov_b32 s10, 0x1000000
    s_mov_b32 s11, 0x20000
    s_mov_b32 s16, s66
    s_mov_b32 s17, s67
    s_mov_b32 s18, 0x100
    s_mov_b32 s19, 0x20000
    s_mov_b32 s32, s64
    s_mov_b32 s33, s65
    s_mov_b32 s34, 0x1000000
    s_mov_b32 s35, 0x20000
    s_mov_b32 s84, s36
    s_mov_b32 s85, s37
    s_mov_b32 s86, 0x400000
    s_mov_b32 s87, 0x20000
    v_lshrrev_b32 v3, 4, v0
    v_and_b32 v4, 7, v0
    v_xor_b32 v3, v3, v4
    v_lshlrev_b32 v3, 4, v3
    v_lshrrev_b32 v5, 3, v0
    v_lshl_add_u32 v5, v5, 11, v3
    v_xor_b32 v6, 64, v5
    s_lshl_b32 s70, s76, 1
    s_add_u32 s70, s70, s77
    s_lshl_b32 s73, s5, 2
    s_add_u32 s73, s73, s70
    s_lshl_b32 s73, s73, 16
    s_add_u32 s72, s73, 0x0
    v_add_u32 v28, s72, v5
    s_add_u32 s72, s73, 0x3c00
    v_add_u32 v29, s72, v6
    s_add_u32 s72, s73, 0x7800
    v_add_u32 v30, s72, v5
    s_add_u32 s72, s73, 0xb400
    v_add_u32 v31, s72, v6
    s_lshl_b32 s72, s4, 2
    s_add_u32 s72, s72, s6
    s_lshl_b32 s72, s72, 17
    s_add_u32 s79, s72, 0x400000
    s_mov_b32 s28, s46
    s_mov_b32 s29, s47
    s_mov_b32 s30, 0x200000
    s_mov_b32 s31, 0x20000
    v_and_b32 v1, 31, v0
    v_lshrrev_b32 v2, 5, v0
    s_lshl_b32 s73, s4, 18
    s_waitcnt vmcnt(16)
    s_barrier
    s_add_u32 m0, s81, 0xc000
    s_lshl_b32 s71, s100, 10
    buffer_load_dwordx4 v24, s[20:23], s100 offen lds
    buffer_load_dwordx4 v25, s[20:23], s100 offen offset:1024 lds
    buffer_load_dwordx4 v26, s[20:23], s100 offen offset:2048 lds
    buffer_load_dwordx4 v27, s[20:23], s100 offen offset:3072 lds
    s_add_u32 m0, s82, 0xc000
    s_add_u32 s71, s71, 0
    buffer_load_dwordx4 v11, s[24:27], s71 offen lds
    buffer_load_dwordx4 v12, s[24:27], s71 offen offset:1024 lds
    s_add_u32 m0, s82, 0xe000
    s_add_u32 s71, s71, 128
    buffer_load_dwordx4 v11, s[24:27], s71 offen lds
    buffer_load_dwordx4 v12, s[24:27], s71 offen offset:1024 lds
    s_add_u32 s70, s78, 1536
    s_cmp_eq_u32 s101, s70
    s_cselect_b32 s70, 128, 0
    s_add_u32 s101, s101, s70
    s_and_b32 s70, s101, 384
    s_cmp_eq_u32 s70, s78
    s_cselect_b32 s70, 512, 0
    s_add_u32 s100, s101, s70
    s_add_u32 s101, s101, 128
    s_add_u32 s100, s100, s80
    s_and_b32 s100, s100, 2047
    s_lshl_b32 s72, s6, 14
    s_add_u32 s73, s73, s72
    s_lshl_b32 s72, s5, 8
    s_add_u32 s73, s73, s72
    s_add_u32 s72, s73, 0x0
    v_add_u32 v32, s72, v5
    s_add_u32 s72, s73, 0xfc00
    v_add_u32 v33, s72, v6
    s_add_u32 s72, s73, 0x1f800
    v_add_u32 v34, s72, v5
    s_add_u32 s72, s73, 0x2f400
    v_add_u32 v35, s72, v6
    v_bfe_u32 v3, v0, 1, 3
    v_lshrrev_b32 v4, 4, v0
    v_xor_b32 v3, v3, v4
    v_lshlrev_b32 v3, 4, v3
    v_and_b32 v5, 15, v0
    v_lshl_add_u32 v3, v5, 7, v3
    v_xor_b32 v4, 64, v3
    s_lshl_b32 s73, s77, 13
    s_waitcnt vmcnt(16)
    s_barrier
    s_add_u32 m0, s81, 0x0
    s_lshl_b32 s71, s100, 10
    buffer_load_dwordx4 v24, s[20:23], s100 offen lds
    buffer_load_dwordx4 v25, s[20:23], s100 offen offset:1024 lds
    buffer_load_dwordx4 v26, s[20:23], s100 offen offset:2048 lds
    buffer_load_dwordx4 v27, s[20:23], s100 offen offset:3072 lds
    s_add_u32 m0, s82, 0x0
    s_add_u32 s71, s71, 0
    buffer_load_dwordx4 v11, s[24:27], s71 offen lds
    buffer_load_dwordx4 v12, s[24:27], s71 offen offset:1024 lds
    s_add_u32 m0, s82, 0x2000
    s_add_u32 s71, s71, 128
    buffer_load_dwordx4 v11, s[24:27], s71 offen lds
    buffer_load_dwordx4 v12, s[24:27], s71 offen offset:1024 lds
    s_add_u32 s70, s78, 1536
    s_cmp_eq_u32 s101, s70
    s_cselect_b32 s70, 128, 0
    s_add_u32 s101, s101, s70
    s_and_b32 s70, s101, 384
    s_cmp_eq_u32 s70, s78
    s_cselect_b32 s70, 512, 0
    s_add_u32 s100, s101, s70
    s_add_u32 s101, s101, 128
    s_add_u32 s100, s100, s80
    s_and_b32 s100, s100, 2047
    s_add_u32 s73, s73, 0x10000
    v_add_u32 v9, s73, v3
    v_add_u32 v10, s73, v4
    s_lshl_b32 s72, s77, 6
    v_xor_b32 v22, s72, v3
    s_lshl_b32 s72, s76, 13
    s_add_u32 s72, s72, 0x10000
    v_add_u32 v22, s72, v22
    s_lshl_b32 s73, s6, 10
    v_add_u32 v18, s73, v7
    s_lshr_b32 s73, s4, 1
    s_lshl_b32 s73, s73, 6
    s_and_b32 s72, s4, 1
    s_add_u32 s73, s73, s72
    s_lshl_b32 s73, s73, 7
    v_lshl_add_u32 v19, v1, 8, s73
    s_lshl_b32 s72, s6, 13
    s_add_u32 s72, s72, 0x20000
    v_lshrrev_b32 v3, 4, v0
    v_and_b32 v4, 7, v0
    s_waitcnt vmcnt(16)
    s_barrier
    s_add_u32 m0, s81, 0x4000
    s_lshl_b32 s71, s100, 10
    buffer_load_dwordx4 v24, s[20:23], s100 offen lds
    buffer_load_dwordx4 v25, s[20:23], s100 offen offset:1024 lds
    buffer_load_dwordx4 v26, s[20:23], s100 offen offset:2048 lds
    buffer_load_dwordx4 v27, s[20:23], s100 offen offset:3072 lds
    s_add_u32 m0, s82, 0x4000
    s_add_u32 s71, s71, 0
    buffer_load_dwordx4 v11, s[24:27], s71 offen lds
    buffer_load_dwordx4 v12, s[24:27], s71 offen offset:1024 lds
    s_add_u32 m0, s82, 0x6000
    s_add_u32 s71, s71, 128
    buffer_load_dwordx4 v11, s[24:27], s71 offen lds
    buffer_load_dwordx4 v12, s[24:27], s71 offen offset:1024 lds
    s_add_u32 s70, s78, 1536
    s_cmp_eq_u32 s101, s70
    s_cselect_b32 s70, 128, 0
    s_add_u32 s101, s101, s70
    s_and_b32 s70, s101, 384
    s_cmp_eq_u32 s70, s78
    s_cselect_b32 s70, 512, 0
    s_add_u32 s100, s101, s70
    s_add_u32 s101, s101, 128
    s_add_u32 s100, s100, s80
    s_and_b32 s100, s100, 2047
    v_xor_b32 v3, v3, v4
    v_lshl_add_u32 v3, v3, 4, s72
    v_and_b32 v40, 15, v0
    v_lshl_add_u32 v40, v40, 7, v3
    v_xor_b32 v41, 64, v40
    v_lshrrev_b32 v3, 3, v0
    v_xor_b32 v42, v3, v4
    v_lshl_add_u32 v42, v42, 4, s72
    v_lshl_add_u32 v42, v3, 7, v42
    s_lshl_b32 s72, s4, 20
    s_lshl_b32 s73, s76, 17
    s_add_u32 s72, s72, s73
    s_lshl_b32 s73, s5, 9
    s_add_u32 s72, s72, s73
    s_lshl_b32 s73, s77, 7
    s_add_u32 s72, s72, s73
    v_lshl_add_u32 v21, v4, 4, s72
    v_lshl_add_u32 v21, v3, 13, v21
    v_and_b32 v3, 15, v0
    v_lshlrev_b32 v3, 4, v3
    v_lshrrev_b32 v4, 4, v0
    v_lshl_add_u32 v3, v4, 9, v3
    s_lshl_b32 s70, s76, 13
    v_add_u32 v20, s70, v3
    v_and_b32 v3, 1, v0
    s_waitcnt vmcnt(16)
    s_barrier
    s_add_u32 m0, s81, 0x8000
    s_lshl_b32 s71, s100, 10
    buffer_load_dwordx4 v24, s[20:23], s100 offen lds
    buffer_load_dwordx4 v25, s[20:23], s100 offen offset:1024 lds
    buffer_load_dwordx4 v26, s[20:23], s100 offen offset:2048 lds
    buffer_load_dwordx4 v27, s[20:23], s100 offen offset:3072 lds
    s_add_u32 m0, s82, 0x8000
    s_add_u32 s71, s71, 0
    buffer_load_dwordx4 v11, s[24:27], s71 offen lds
    buffer_load_dwordx4 v12, s[24:27], s71 offen offset:1024 lds
    s_add_u32 m0, s82, 0xa000
    s_add_u32 s71, s71, 128
    buffer_load_dwordx4 v11, s[24:27], s71 offen lds
    buffer_load_dwordx4 v12, s[24:27], s71 offen offset:1024 lds
    s_add_u32 s70, s78, 1536
    s_cmp_eq_u32 s101, s70
    s_cselect_b32 s70, 128, 0
    s_add_u32 s101, s101, s70
    s_and_b32 s70, s101, 384
    s_cmp_eq_u32 s70, s78
    s_cselect_b32 s70, 512, 0
    s_add_u32 s100, s101, s70
    s_add_u32 s101, s101, 128
    s_add_u32 s100, s100, s80
    s_and_b32 s100, s100, 2047
    v_lshlrev_b32 v3, 4, v3
    v_lshlrev_b32 v6, 2, v4
    v_bfe_u32 v4, v0, 1, 3
    v_sub_u32 v4, v4, v6
    v_lshlrev_b32 v13, v3, v13
    v_lshlrev_b32 v14, v3, v14
    v_lshlrev_b32 v15, v3, v15
    v_lshlrev_b32 v16, v3, v16
    v_cmp_eq_i32 vcc, 0, v4
    s_nop 1
    v_cndmask_b32 v44, 0, v13, vcc
    v_cndmask_b32 v52, 0, v15, vcc
    v_cmp_eq_i32 vcc, 1, v4
    s_nop 1
    v_cndmask_b32 v45, 0, v13, vcc
    v_cndmask_b32 v53, 0, v15, vcc
    v_cmp_eq_i32 vcc, 2, v4
    s_nop 1
    v_cndmask_b32 v46, 0, v13, vcc
    v_cndmask_b32 v54, 0, v15, vcc
    s_waitcnt vmcnt(16)
    s_barrier
    s_add_u32 m0, s81, 0xc000
    s_lshl_b32 s71, s100, 10
    buffer_load_dwordx4 v24, s[20:23], s100 offen lds
    buffer_load_dwordx4 v25, s[20:23], s100 offen offset:1024 lds
    buffer_load_dwordx4 v26, s[20:23], s100 offen offset:2048 lds
    buffer_load_dwordx4 v27, s[20:23], s100 offen offset:3072 lds
    s_add_u32 m0, s82, 0xc000
    s_add_u32 s71, s71, 0
    buffer_load_dwordx4 v11, s[24:27], s71 offen lds
    buffer_load_dwordx4 v12, s[24:27], s71 offen offset:1024 lds
    s_add_u32 m0, s82, 0xe000
    s_add_u32 s71, s71, 128
    buffer_load_dwordx4 v11, s[24:27], s71 offen lds
    buffer_load_dwordx4 v12, s[24:27], s71 offen offset:1024 lds
    s_add_u32 s70, s78, 1536
    s_cmp_eq_u32 s101, s70
    s_cselect_b32 s70, 128, 0
    s_add_u32 s101, s101, s70
    s_and_b32 s70, s101, 384
    s_cmp_eq_u32 s70, s78
    s_cselect_b32 s70, 512, 0
    s_add_u32 s100, s101, s70
    s_add_u32 s101, s101, 128
    s_add_u32 s100, s100, s80
    s_and_b32 s100, s100, 2047
    v_cmp_eq_i32 vcc, 3, v4
    s_nop 1
    v_cndmask_b32 v47, 0, v13, vcc
    v_cndmask_b32 v55, 0, v15, vcc
    v_cmp_eq_i32 vcc, -8, v4
    s_nop 1
    v_cndmask_b32 v48, 0, v14, vcc
    v_cndmask_b32 v56, 0, v16, vcc
    v_cmp_eq_i32 vcc, -7, v4
    s_nop 1
    v_cndmask_b32 v49, 0, v14, vcc
    v_cndmask_b32 v57, 0, v16, vcc
    v_cmp_eq_i32 vcc, -6, v4
    s_nop 1
    v_cndmask_b32 v50, 0, v14, vcc
    v_cndmask_b32 v58, 0, v16, vcc
    v_cmp_eq_i32 vcc, -5, v4
    s_nop 1
    v_cndmask_b32 v51, 0, v14, vcc
    v_cndmask_b32 v59, 0, v16, vcc
    s_waitcnt vmcnt(16)
    s_barrier
    s_add_u32 m0, s81, 0x0
    s_lshl_b32 s71, s100, 10
    buffer_load_dwordx4 v24, s[20:23], s100 offen lds
    buffer_load_dwordx4 v25, s[20:23], s100 offen offset:1024 lds
    buffer_load_dwordx4 v26, s[20:23], s100 offen offset:2048 lds
    buffer_load_dwordx4 v27, s[20:23], s100 offen offset:3072 lds
    s_add_u32 m0, s82, 0x0
    s_add_u32 s71, s71, 0
    buffer_load_dwordx4 v11, s[24:27], s71 offen lds
    buffer_load_dwordx4 v12, s[24:27], s71 offen offset:1024 lds
    s_add_u32 m0, s82, 0x2000
    s_add_u32 s71, s71, 128
    buffer_load_dwordx4 v11, s[24:27], s71 offen lds
    buffer_load_dwordx4 v12, s[24:27], s71 offen offset:1024 lds
    s_add_u32 s70, s78, 1536
    s_cmp_eq_u32 s101, s70
    s_cselect_b32 s70, 128, 0
    s_add_u32 s101, s101, s70
    s_and_b32 s70, s101, 384
    s_cmp_eq_u32 s70, s78
    s_cselect_b32 s70, 512, 0
    s_add_u32 s100, s101, s70
    s_add_u32 s101, s101, 128
    s_add_u32 s100, s100, s80
    s_and_b32 s100, s100, 2047
    v_mov_b32 v5, 0
    buffer_load_dword v17, v5, s[16:19], 0 offen sc1
    s_waitcnt vmcnt(17)
    s_barrier
    s_add_u32 m0, s81, 0x4000
    s_lshl_b32 s71, s100, 10
    buffer_load_dwordx4 v24, s[20:23], s100 offen lds
    buffer_load_dwordx4 v25, s[20:23], s100 offen offset:1024 lds
    buffer_load_dwordx4 v26, s[20:23], s100 offen offset:2048 lds
L_pad_14:
    s_cbranch_execz L_ret_y1
    buffer_load_dwordx4 v27, s[20:23], s100 offen offset:3072 lds
    s_add_u32 m0, s82, 0x4000
    s_add_u32 s71, s71, 0
    buffer_load_dwordx4 v11, s[24:27], s71 offen lds
    buffer_load_dwordx4 v12, s[24:27], s71 offen offset:1024 lds
    s_add_u32 m0, s82, 0x6000
    s_add_u32 s71, s71, 128
    buffer_load_dwordx4 v11, s[24:27], s71 offen lds
    buffer_load_dwordx4 v12, s[24:27], s71 offen offset:1024 lds
    s_add_u32 s70, s78, 1536
    s_cmp_eq_u32 s101, s70
    s_cselect_b32 s70, 128, 0
    s_add_u32 s101, s101, s70
    s_and_b32 s70, s101, 384
    s_cmp_eq_u32 s70, s78
    s_cselect_b32 s70, 512, 0
    s_add_u32 s100, s101, s70
    s_add_u32 s101, s101, 128
    s_add_u32 s100, s100, s80
    s_and_b32 s100, s100, 2047
    s_waitcnt vmcnt(17)
    s_barrier
    s_add_u32 m0, s81, 0x8000
    s_lshl_b32 s71, s100, 10
    buffer_load_dwordx4 v24, s[20:23], s100 offen lds
    buffer_load_dwordx4 v25, s[20:23], s100 offen offset:1024 lds
    buffer_load_dwordx4 v26, s[20:23], s100 offen offset:2048 lds
    buffer_load_dwordx4 v27, s[20:23], s100 offen offset:3072 lds
    s_add_u32 m0, s82, 0x8000
    s_add_u32 s71, s71, 0
    buffer_load_dwordx4 v11, s[24:27], s71 offen lds
    buffer_load_dwordx4 v12, s[24:27], s71 offen offset:1024 lds
    s_add_u32 m0, s82, 0xa000
    s_add_u32 s71, s71, 128
    buffer_load_dwordx4 v11, s[24:27], s71 offen lds
    buffer_load_dwordx4 v12, s[24:27], s71 offen offset:1024 lds
    s_add_u32 s70, s78, 1536
    s_cmp_eq_u32 s101, s70
    s_cselect_b32 s70, 128, 0
    s_add_u32 s101, s101, s70
    s_and_b32 s70, s101, 384
    s_cmp_eq_u32 s70, s78
    s_cselect_b32 s70, 512, 0
    s_add_u32 s100, s101, s70
    s_add_u32 s101, s101, 128
    s_add_u32 s100, s100, s80
    s_and_b32 s100, s100, 2047
    s_waitcnt vmcnt(17)
    s_barrier
    s_add_u32 m0, s81, 0xc000
    s_lshl_b32 s71, s100, 10
    buffer_load_dwordx4 v24, s[20:23], s100 offen lds
    buffer_load_dwordx4 v25, s[20:23], s100 offen offset:1024 lds
    buffer_load_dwordx4 v26, s[20:23], s100 offen offset:2048 lds
    buffer_load_dwordx4 v27, s[20:23], s100 offen offset:3072 lds
    s_add_u32 m0, s82, 0xc000
    s_add_u32 s71, s71, 0
    buffer_load_dwordx4 v11, s[24:27], s71 offen lds
    buffer_load_dwordx4 v12, s[24:27], s71 offen offset:1024 lds
    s_add_u32 m0, s82, 0xe000
    s_add_u32 s71, s71, 128
    buffer_load_dwordx4 v11, s[24:27], s71 offen lds
    buffer_load_dwordx4 v12, s[24:27], s71 offen offset:1024 lds
    s_add_u32 s70, s78, 1536
    s_cmp_eq_u32 s101, s70
    s_cselect_b32 s70, 128, 0
    s_add_u32 s101, s101, s70
    s_and_b32 s70, s101, 384
    s_cmp_eq_u32 s70, s78
    s_cselect_b32 s70, 512, 0
    s_add_u32 s100, s101, s70
    s_add_u32 s101, s101, 128
    s_add_u32 s100, s100, s80
    s_and_b32 s100, s100, 2047
    s_waitcnt vmcnt(24)
    v_readfirstlane_b32 s83, v17
    s_nop 0
    s_cmp_eq_u32 s83, 0
    s_cbranch_scc1 L_tagwaitYA
L_tagokYA:
    s_waitcnt vmcnt(16)
    s_barrier
    s_add_u32 m0, s81, 0x0
    s_lshl_b32 s71, s100, 10
    buffer_load_dwordx4 v24, s[20:23], s100 offen lds
    buffer_load_dwordx4 v25, s[20:23], s100 offen offset:1024 lds
    buffer_load_dwordx4 v26, s[20:23], s100 offen offset:2048 lds
    buffer_load_dwordx4 v27, s[20:23], s100 offen offset:3072 lds
    s_add_u32 m0, s82, 0x0
    s_add_u32 s71, s71, 0
    buffer_load_dwordx4 v11, s[24:27], s71 offen lds
    buffer_load_dwordx4 v12, s[24:27], s71 offen offset:1024 lds
    s_add_u32 m0, s82, 0x2000
    s_add_u32 s71, s71, 128
    buffer_load_dwordx4 v11, s[24:27], s71 offen lds
    buffer_load_dwordx4 v12, s[24:27], s71 offen offset:1024 lds
    s_add_u32 s70, s78, 1536
    s_cmp_eq_u32 s101, s70
    s_cselect_b32 s70, 128, 0
    s_add_u32 s101, s101, s70
    s_and_b32 s70, s101, 384
    s_cmp_eq_u32 s70, s78
    s_cselect_b32 s70, 512, 0
    s_add_u32 s100, s101, s70
    s_add_u32 s101, s101, 128
    s_add_u32 s100, s100, s80
    s_and_b32 s100, s100, 2047
    s_waitcnt vmcnt(16)
    s_barrier
    s_add_u32 m0, s81, 0x4000
    s_lshl_b32 s71, s100, 10
    buffer_load_dwordx4 v24, s[20:23], s100 offen lds
    buffer_load_dwordx4 v25, s[20:23], s100 offen offset:1024 lds
    buffer_load_dwordx4 v26, s[20:23], s100 offen offset:2048 lds
    buffer_load_dwordx4 v27, s[20:23], s100 offen offset:3072 lds
    s_add_u32 m0, s82, 0x4000
    s_add_u32 s71, s71, 0
    buffer_load_dwordx4 v11, s[24:27], s71 offen lds
    buffer_load_dwordx4 v12, s[24:27], s71 offen offset:1024 lds
    s_add_u32 m0, s82, 0x6000
    s_add_u32 s71, s71, 128
    buffer_load_dwordx4 v11, s[24:27], s71 offen lds
    buffer_load_dwordx4 v12, s[24:27], s71 offen offset:1024 lds
    s_add_u32 s70, s78, 1536
    s_cmp_eq_u32 s101, s70
    s_cselect_b32 s70, 128, 0
    s_add_u32 s101, s101, s70
    s_and_b32 s70, s101, 384
    s_cmp_eq_u32 s70, s78
    s_cselect_b32 s70, 512, 0
    s_add_u32 s100, s101, s70
    s_add_u32 s101, s101, 128
    s_add_u32 s100, s100, s80
    s_and_b32 s100, s100, 2047
    s_mov_b32 s72, 0xca0000
    buffer_load_dword v8, v18, s[8:11], s72 offen sc1
    s_waitcnt vmcnt(17)
    s_barrier
    s_add_u32 m0, s81, 0x8000
    s_lshl_b32 s71, s100, 10
    buffer_load_dwordx4 v24, s[20:23], s100 offen lds
    buffer_load_dwordx4 v25, s[20:23], s100 offen offset:1024 lds
    buffer_load_dwordx4 v26, s[20:23], s100 offen offset:2048 lds
    buffer_load_dwordx4 v27, s[20:23], s100 offen offset:3072 lds
    s_add_u32 m0, s82, 0x8000
    s_add_u32 s71, s71, 0
    buffer_load_dwordx4 v11, s[24:27], s71 offen lds
    buffer_load_dwordx4 v12, s[24:27], s71 offen offset:1024 lds
    s_add_u32 m0, s82, 0xa000
    s_add_u32 s71, s71, 128
    buffer_load_dwordx4 v11, s[24:27], s71 offen lds
    buffer_load_dwordx4 v12, s[24:27], s71 offen offset:1024 lds
    s_add_u32 s70, s78, 1536
    s_cmp_eq_u32 s101, s70
    s_cselect_b32 s70, 128, 0
    s_add_u32 s101, s101, s70
    s_and_b32 s70, s101, 384
    s_cmp_eq_u32 s70, s78
    s_cselect_b32 s70, 512, 0
    s_add_u32 s100, s101, s70
    s_add_u32 s101, s101, 128
    s_add_u32 s100, s100, s80
    s_and_b32 s100, s100, 2047
    s_waitcnt vmcnt(17)
    s_barrier
    s_add_u32 m0, s81, 0xc000
    s_lshl_b32 s71, s100, 10
    buffer_load_dwordx4 v24, s[20:23], s100 offen lds
    buffer_load_dwordx4 v25, s[20:23], s100 offen offset:1024 lds
    buffer_load_dwordx4 v26, s[20:23], s100 offen offset:2048 lds
    buffer_load_dwordx4 v27, s[20:23], s100 offen offset:3072 lds
    s_add_u32 m0, s82, 0xc000
    s_add_u32 s71, s71, 0
    buffer_load_dwordx4 v11, s[24:27], s71 offen lds
    buffer_load_dwordx4 v12, s[24:27], s71 offen offset:1024 lds
    s_add_u32 m0, s82, 0xe000
    s_add_u32 s71, s71, 128
    buffer_load_dwordx4 v11, s[24:27], s71 offen lds
    buffer_load_dwordx4 v12, s[24:27], s71 offen offset:1024 lds
    s_waitcnt vmcnt(16)
    v_cmp_eq_u32 vcc, s83, v8
    s_cmp_eq_u64 vcc, exec
    s_cbranch_scc1 L_pd_kvy
    s_mov_b32 s73, 131072
    s_mov_b32 s72, 0xca0000
L_pl_kvy:
    buffer_load_dword v8, v18, s[8:11], s72 offen sc1
    s_waitcnt vmcnt(0)
    v_cmp_eq_u32 vcc, s83, v8
    s_cmp_eq_u64 vcc, exec
    s_cbranch_scc1 L_pd_kvy
    s_sleep 8
    s_sub_u32 s73, s73, 1
    s_cbranch_scc0 L_pl_kvy
L_pd_kvy:
    s_barrier
    s_add_u32 m0, s82, 0x10000
    s_add_u32 s70, s82, 0xbf0000
    buffer_load_dwordx4 v7, s[8:11], s70 offen sc1 lds
    buffer_load_dwordx4 v7, s[8:11], s70 offen offset:1024 sc1 lds
    s_add_u32 m0, s82, 0x12000
    s_add_u32 s70, s82, 0xbf2000
    buffer_load_dwordx4 v7, s[8:11], s70 offen sc1 lds
    buffer_load_dwordx4 v7, s[8:11], s70 offen offset:1024 sc1 lds
    s_waitcnt vmcnt(12)
    s_barrier
    s_add_u32 m0, s82, 0x14000
    s_add_u32 s70, s82, 0xbf4000
    buffer_load_dwordx4 v7, s[8:11], s70 offen sc1 lds
    buffer_load_dwordx4 v7, s[8:11], s70 offen offset:1024 sc1 lds
    s_waitcnt vmcnt(6)
    s_barrier
    s_add_u32 m0, s82, 0x16000
    s_add_u32 s70, s82, 0xbf6000
    buffer_load_dwordx4 v7, s[8:11], s70 offen sc1 lds
    buffer_load_dwordx4 v7, s[8:11], s70 offen offset:1024 sc1 lds
    s_waitcnt vmcnt(6)
    s_barrier
    s_add_u32 m0, s82, 0xffff0000
    s_add_u32 s70, s82, 0xbf8000
    buffer_load_dwordx4 v7, s[8:11], s70 offen sc1 lds
    buffer_load_dwordx4 v7, s[8:11], s70 offen offset:1024 sc1 lds
    s_add_u32 m0, s82, 0xffff2000
    s_add_u32 s70, s82, 0xbfa000
    buffer_load_dwordx4 v7, s[8:11], s70 offen sc1 lds
    buffer_load_dwordx4 v7, s[8:11], s70 offen offset:1024 sc1 lds
    s_add_u32 m0, s82, 0xffff4000
    s_add_u32 s70, s82, 0xbfc000
    buffer_load_dwordx4 v7, s[8:11], s70 offen sc1 lds
    buffer_load_dwordx4 v7, s[8:11], s70 offen offset:1024 sc1 lds
    s_add_u32 m0, s82, 0xffff6000
    s_add_u32 s70, s82, 0xbfe000
    buffer_load_dwordx4 v7, s[8:11], s70 offen sc1 lds
    buffer_load_dwordx4 v7, s[8:11], s70 offen offset:1024 sc1 lds
    s_waitcnt vmcnt(12)
    s_barrier
    s_waitcnt vmcnt(8)
    s_barrier
    s_mov_b64 exec, 0
    s_cmp_eq_u32 s6, 0
    s_cbranch_scc1 L_pad_yb3
    s_cmp_eq_u32 s6, 1
    s_cbranch_scc1 L_pad_5
    s_cmp_eq_u32 s6, 2
    s_cbranch_scc1 L_pad_15
    s_branch L_pad_16
L_ret_y2:
    s_mov_b64 exec, -1
    s_waitcnt vmcnt(0)
    s_barrier
    s_add_u32 m0, s82, 0xffff8000
    s_add_u32 s70, s82, 0xc00000
    buffer_load_dwordx4 v7, s[8:11], s70 offen sc1 lds
    buffer_load_dwordx4 v7, s[8:11], s70 offen offset:1024 sc1 lds
    s_add_u32 m0, s82, 0xffffa000
    s_add_u32 s70, s82, 0xc02000
    buffer_load_dwordx4 v7, s[8:11], s70 offen sc1 lds
    buffer_load_dwordx4 v7, s[8:11], s70 offen offset:1024 sc1 lds
    s_add_u32 m0, s82, 0xffffc000
    s_add_u32 s70, s82, 0xc04000
    buffer_load_dwordx4 v7, s[8:11], s70 offen sc1 lds
    buffer_load_dwordx4 v7, s[8:11], s70 offen offset:1024 sc1 lds
    s_add_u32 m0, s82, 0xffffe000
    s_add_u32 s70, s82, 0xc06000
    buffer_load_dwordx4 v7, s[8:11], s70 offen sc1 lds
    buffer_load_dwordx4 v7, s[8:11], s70 offen offset:1024 sc1 lds
    s_add_u32 m0, s81, 0x10000
    s_movk_i32 s70, 0
    buffer_load_dwordx4 v32, s[84:87], s70 offen lds
    buffer_load_dwordx4 v33, s[84:87], s70 offen offset:1024 lds
    buffer_load_dwordx4 v34, s[84:87], s70 offen offset:2048 lds
    buffer_load_dwordx4 v35, s[84:87], s70 offen offset:3072 lds
    s_add_u32 m0, s81, 0x14000
    s_movk_i32 s70, 128
    buffer_load_dwordx4 v32, s[84:87], s70 offen lds
    buffer_load_dwordx4 v33, s[84:87], s70 offen offset:1024 lds
    buffer_load_dwordx4 v34, s[84:87], s70 offen offset:2048 lds
    buffer_load_dwordx4 v35, s[84:87], s70 offen offset:3072 lds
    s_waitcnt vmcnt(0)
    s_barrier
    s_add_u32 m0, s82, 0x10000
    s_add_u32 s70, s82, 0xc08000
    buffer_load_dwordx4 v7, s[8:11], s70 offen sc1 lds
    buffer_load_dwordx4 v7, s[8:11], s70 offen offset:1024 sc1 lds
    s_add_u32 m0, s82, 0x12000
    s_add_u32 s70, s82, 0xc0a000
    buffer_load_dwordx4 v7, s[8:11], s70 offen sc1 lds
    buffer_load_dwordx4 v7, s[8:11], s70 offen offset:1024 sc1 lds
    s_add_u32 m0, s82, 0x14000
    s_add_u32 s70, s82, 0xc0c000
    buffer_load_dwordx4 v7, s[8:11], s70 offen sc1 lds
    buffer_load_dwordx4 v7, s[8:11], s70 offen offset:1024 sc1 lds
    s_add_u32 m0, s82, 0x16000
    s_add_u32 s70, s82, 0xc0e000
    buffer_load_dwordx4 v7, s[8:11], s70 offen sc1 lds
    buffer_load_dwordx4 v7, s[8:11], s70 offen offset:1024 sc1 lds
    ds_read_b128 v[124:127], v22 offset:0
    ds_read_b128 v[128:131], v22 offset:2048
    ds_read_b128 v[132:135], v22 offset:4096
    ds_read_b128 v[136:139], v22 offset:6144
    ds_read_b128 v[140:143], v22 offset:16384
    ds_read_b128 v[144:147], v22 offset:18432
    ds_read_b128 v[148:151], v22 offset:20480
    ds_read_b128 v[152:155], v22 offset:22528
    s_waitcnt lgkmcnt(0)
    v_mfma_f32_16x16x32_bf16 v[60:63], v[44:47], v[124:127], 0
    v_mfma_f32_16x16x32_bf16 v[64:67], v[48:51], v[124:127], 0
    v_mfma_f32_16x16x32_bf16 v[72:75], v[48:51], v[128:131], 0
    v_mfma_f32_16x16x32_bf16 v[68:71], v[44:47], v[128:131], 0
    v_mfma_f32_16x16x32_bf16 v[76:79], v[44:47], v[132:135], 0
    v_mfma_f32_16x16x32_bf16 v[80:83], v[48:51], v[132:135], 0
    v_mfma_f32_16x16x32_bf16 v[88:91], v[48:51], v[136:139], 0
    v_mfma_f32_16x16x32_bf16 v[84:87], v[44:47], v[136:139], 0
    v_mfma_f32_16x16x32_bf16 v[92:95], v[52:55], v[140:143], 0
    v_mfma_f32_16x16x32_bf16 v[96:99], v[56:59], v[140:143], 0
    v_mfma_f32_16x16x32_bf16 v[104:107], v[56:59], v[144:147], 0
    v_mfma_f32_16x16x32_bf16 v[100:103], v[52:55], v[144:147], 0
    v_mfma_f32_16x16x32_bf16 v[108:111], v[52:55], v[148:151], 0
    v_mfma_f32_16x16x32_bf16 v[112:115], v[56:59], v[148:151], 0
    v_mfma_f32_16x16x32_bf16 v[120:123], v[56:59], v[152:155], 0
    v_mfma_f32_16x16x32_bf16 v[116:119], v[52:55], v[152:155], 0
    s_waitcnt vmcnt(0)
    s_barrier
    s_add_u32 m0, s82, 0xffff8000
    s_add_u32 s70, s82, 0xc10000
    buffer_load_dwordx4 v7, s[8:11], s70 offen sc1 lds
    buffer_load_dwordx4 v7, s[8:11], s70 offen offset:1024 sc1 lds
    s_add_u32 m0, s82, 0xffffa000
    s_add_u32 s70, s82, 0xc12000
    buffer_load_dwordx4 v7, s[8:11], s70 offen sc1 lds
    buffer_load_dwordx4 v7, s[8:11], s70 offen offset:1024 sc1 lds
    s_add_u32 m0, s82, 0xffffc000
    s_add_u32 s70, s82, 0xc14000
    buffer_load_dwordx4 v7, s[8:11], s70 offen sc1 lds
    buffer_load_dwordx4 v7, s[8:11], s70 offen offset:1024 sc1 lds
    s_add_u32 m0, s82, 0xffffe000
    s_add_u32 s70, s82, 0xc16000
    buffer_load_dwordx4 v7, s[8:11], s70 offen sc1 lds
    buffer_load_dwordx4 v7, s[8:11], s70 offen offset:1024 sc1 lds
    s_cmp_eq_u32 s76, 0
    s_cselect_b32 s28, s46, s48
    s_cselect_b32 s29, s47, s49
    s_lshl_b32 s70, s5, 5
    s_lshl_b32 s71, s4, 1
    s_add_u32 s70, s70, s71
    s_add_u32 s70, s70, s77
    s_lshl_b32 s70, s70, 13
    v_lshrrev_b32 v3, 3, v0
    v_lshlrev_b32 v3, 11, v3
    v_and_b32 v4, 7, v0
    v_lshl_add_u32 v3, v4, 7, v3
    v_lshl_add_u32 v3, v2, 30, v3
    buffer_load_dword v4, v3, s[28:31], s70 offen offset:1024
    s_waitcnt vmcnt(1)
    s_barrier
    s_add_u32 m0, s82, 0x10000
    s_add_u32 s70, s82, 0xc18000
    buffer_load_dwordx4 v7, s[8:11], s70 offen sc1 lds
    buffer_load_dwordx4 v7, s[8:11], s70 offen offset:1024 sc1 lds
    s_add_u32 m0, s82, 0x12000
    s_add_u32 s70, s82, 0xc1a000
    buffer_load_dwordx4 v7, s[8:11], s70 offen sc1 lds
    buffer_load_dwordx4 v7, s[8:11], s70 offen offset:1024 sc1 lds
    s_add_u32 m0, s82, 0x14000
    s_add_u32 s70, s82, 0xc1c000
    buffer_load_dwordx4 v7, s[8:11], s70 offen sc1 lds
    buffer_load_dwordx4 v7, s[8:11], s70 offen offset:1024 sc1 lds
    s_add_u32 m0, s82, 0x16000
    s_add_u32 s70, s82, 0xc1e000
    buffer_load_dwordx4 v7, s[8:11], s70 offen sc1 lds
    buffer_load_dwordx4 v7, s[8:11], s70 offen offset:1024 sc1 lds
    s_lshr_b32 s70, s78, 7
    s_add_u32 s100, s70, 0
    s_add_u32 m0, s81, 0x0
    s_lshl_b32 s70, s100, 12
    s_add_u32 s70, s70, s79
    s_bitcmp0_b32 s100, 0
    s_cselect_b32 s28, s46, s48
    s_cselect_b32 s29, s47, s49
    s_lshr_b32 s71, s100, 1
    s_lshl_b32 s71, s71, 7
    s_add_u32 m0, m0, 0x10000
    s_nop 0
    buffer_load_dwordx4 v28, s[28:31], s71 offen lds
    buffer_load_dwordx4 v29, s[28:31], s71 offen offset:1024 lds
    buffer_load_dwordx4 v30, s[28:31], s71 offen offset:2048 lds
    buffer_load_dwordx4 v31, s[28:31], s71 offen offset:3072 lds
    s_lshr_b32 s70, s78, 7
    s_add_u32 s100, s70, 4
    s_add_u32 m0, s81, 0x4000
    s_lshl_b32 s70, s100, 12
    s_add_u32 s70, s70, s79
    s_bitcmp0_b32 s100, 0
    s_cselect_b32 s28, s46, s48
    s_cselect_b32 s29, s47, s49
    s_lshr_b32 s71, s100, 1
    s_lshl_b32 s71, s71, 7
    s_add_u32 m0, m0, 0x10000
    s_nop 0
    buffer_load_dwordx4 v28, s[28:31], s71 offen lds
    buffer_load_dwordx4 v29, s[28:31], s71 offen offset:1024 lds
    buffer_load_dwordx4 v30, s[28:31], s71 offen offset:2048 lds
    buffer_load_dwordx4 v31, s[28:31], s71 offen offset:3072 lds
    s_waitcnt vmcnt(8)
    s_barrier
    s_add_u32 m0, s82, 0xffff8000
    s_add_u32 s70, s82, 0xc20000
    buffer_load_dwordx4 v7, s[8:11], s70 offen sc1 lds
    buffer_load_dwordx4 v7, s[8:11], s70 offen offset:1024 sc1 lds
    s_add_u32 m0, s82, 0xffffa000
    s_add_u32 s70, s82, 0xc22000
    buffer_load_dwordx4 v7, s[8:11], s70 offen sc1 lds
    buffer_load_dwordx4 v7, s[8:11], s70 offen offset:1024 sc1 lds
    s_add_u32 m0, s82, 0xffffc000
    s_add_u32 s70, s82, 0xc24000
    buffer_load_dwordx4 v7, s[8:11], s70 offen sc1 lds
    buffer_load_dwordx4 v7, s[8:11], s70 offen offset:1024 sc1 lds
    s_add_u32 m0, s82, 0xffffe000
    s_add_u32 s70, s82, 0xc26000
    buffer_load_dwordx4 v7, s[8:11], s70 offen sc1 lds
    buffer_load_dwordx4 v7, s[8:11], s70 offen offset:1024 sc1 lds
    s_lshr_b32 s70, s78, 7
    s_add_u32 s100, s70, 8
    s_add_u32 m0, s81, 0x8000
    s_lshl_b32 s70, s100, 12
    s_add_u32 s70, s70, s79
    s_bitcmp0_b32 s100, 0
    s_cselect_b32 s28, s46, s48
    s_cselect_b32 s29, s47, s49
    s_lshr_b32 s71, s100, 1
    s_lshl_b32 s71, s71, 7
    s_add_u32 m0, m0, 0x10000
    s_nop 0
    buffer_load_dwordx4 v28, s[28:31], s71 offen lds
    buffer_load_dwordx4 v29, s[28:31], s71 offen offset:1024 lds
    buffer_load_dwordx4 v30, s[28:31], s71 offen offset:2048 lds
    buffer_load_dwordx4 v31, s[28:31], s71 offen offset:3072 lds
    s_lshr_b32 s70, s78, 7
    s_add_u32 s100, s70, 12
    s_add_u32 m0, s81, 0xc000
    s_lshl_b32 s70, s100, 12
    s_add_u32 s70, s70, s79
    s_bitcmp0_b32 s100, 0
    s_cselect_b32 s28, s46, s48
    s_cselect_b32 s29, s47, s49
    s_lshr_b32 s71, s100, 1
    s_lshl_b32 s71, s71, 7
    s_add_u32 m0, m0, 0x10000
    s_nop 0
    buffer_load_dwordx4 v28, s[28:31], s71 offen lds
    buffer_load_dwordx4 v29, s[28:31], s71 offen offset:1024 lds
    buffer_load_dwordx4 v30, s[28:31], s71 offen offset:2048 lds
    buffer_load_dwordx4 v31, s[28:31], s71 offen offset:3072 lds
    s_waitcnt vmcnt(8)
    s_barrier
    s_add_u32 m0, s82, 0x10000
    s_add_u32 s70, s82, 0xc28000
    buffer_load_dwordx4 v7, s[8:11], s70 offen sc1 lds
    buffer_load_dwordx4 v7, s[8:11], s70 offen offset:1024 sc1 lds
    s_add_u32 m0, s82, 0x12000
    s_add_u32 s70, s82, 0xc2a000
    buffer_load_dwordx4 v7, s[8:11], s70 offen sc1 lds
    buffer_load_dwordx4 v7, s[8:11], s70 offen offset:1024 sc1 lds
    s_add_u32 m0, s82, 0x14000
    s_add_u32 s70, s82, 0xc2c000
    buffer_load_dwordx4 v7, s[8:11], s70 offen sc1 lds
    buffer_load_dwordx4 v7, s[8:11], s70 offen offset:1024 sc1 lds
    s_add_u32 m0, s82, 0x16000
    s_add_u32 s70, s82, 0xc2e000
    buffer_load_dwordx4 v7, s[8:11], s70 offen sc1 lds
    buffer_load_dwordx4 v7, s[8:11], s70 offen offset:1024 sc1 lds
    s_mov_b32 s72, 0xc80000
    buffer_load_dword v8, v19, s[8:11], s72 offen sc1
    s_waitcnt vmcnt(0)
    v_cmp_eq_u32 vcc, s83, v8
    s_cmp_eq_u64 vcc, exec
    s_cbranch_scc1 L_pd_h
    s_mov_b32 s73, 131072
    s_mov_b32 s72, 0xc80000
L_pl_h:
    buffer_load_dword v8, v19, s[8:11], s72 offen sc1
    s_waitcnt vmcnt(0)
    v_cmp_eq_u32 vcc, s83, v8
    s_cmp_eq_u64 vcc, exec
    s_cbranch_scc1 L_pd_h
    s_sleep 8
    s_sub_u32 s73, s73, 1
    s_cbranch_scc0 L_pl_h
L_pd_h:
    s_lshr_b32 s70, s78, 7
    s_add_u32 s100, s70, 0
    s_add_u32 m0, s81, 0x0
    s_lshl_b32 s70, s100, 12
    s_add_u32 s70, s70, s79
    s_bitcmp0_b32 s100, 0
    s_cselect_b32 s28, s46, s48
    s_cselect_b32 s29, s47, s49
    s_lshr_b32 s71, s100, 1
    s_lshl_b32 s71, s71, 7
    buffer_load_dwordx4 v7, s[8:11], s70 offen sc1 lds
    buffer_load_dwordx4 v7, s[8:11], s70 offen offset:1024 sc1 lds
    buffer_load_dwordx4 v7, s[8:11], s70 offen offset:2048 sc1 lds
    buffer_load_dwordx4 v7, s[8:11], s70 offen offset:3072 sc1 lds
    s_lshr_b32 s70, s78, 7
    s_add_u32 s100, s70, 4
    s_add_u32 m0, s81, 0x4000
    s_lshl_b32 s70, s100, 12
    s_add_u32 s70, s70, s79
    s_bitcmp0_b32 s100, 0
    s_cselect_b32 s28, s46, s48
    s_cselect_b32 s29, s47, s49
    s_lshr_b32 s71, s100, 1
    s_lshl_b32 s71, s71, 7
    buffer_load_dwordx4 v7, s[8:11], s70 offen sc1 lds
    buffer_load_dwordx4 v7, s[8:11], s70 offen offset:1024 sc1 lds
    buffer_load_dwordx4 v7, s[8:11], s70 offen offset:2048 sc1 lds
    buffer_load_dwordx4 v7, s[8:11], s70 offen offset:3072 sc1 lds
    s_waitcnt vmcnt(0)
    s_barrier
    s_lshr_b32 s70, s78, 7
    s_add_u32 s100, s70, 8
    s_add_u32 m0, s81, 0x8000
    s_lshl_b32 s70, s100, 12
    s_add_u32 s70, s70, s79
    s_bitcmp0_b32 s100, 0
    s_cselect_b32 s28, s46, s48
    s_cselect_b32 s29, s47, s49
    s_lshr_b32 s71, s100, 1
    s_lshl_b32 s71, s71, 7
    buffer_load_dwordx4 v7, s[8:11], s70 offen sc1 lds
    buffer_load_dwordx4 v7, s[8:11], s70 offen offset:1024 sc1 lds
    buffer_load_dwordx4 v7, s[8:11], s70 offen offset:2048 sc1 lds
    buffer_load_dwordx4 v7, s[8:11], s70 offen offset:3072 sc1 lds
    s_lshr_b32 s70, s78, 7
    s_add_u32 s100, s70, 12
    s_add_u32 m0, s81, 0xc000
    s_lshl_b32 s70, s100, 12
    s_add_u32 s70, s70, s79
    s_bitcmp0_b32 s100, 0
    s_cselect_b32 s28, s46, s48
    s_cselect_b32 s29, s47, s49
    s_lshr_b32 s71, s100, 1
    s_lshl_b32 s71, s71, 7
    buffer_load_dwordx4 v7, s[8:11], s70 offen sc1 lds
    buffer_load_dwordx4 v7, s[8:11], s70 offen offset:1024 sc1 lds
    buffer_load_dwordx4 v7, s[8:11], s70 offen offset:2048 sc1 lds
    buffer_load_dwordx4 v7, s[8:11], s70 offen offset:3072 sc1 lds
    ds_read_b128 v[124:127], v20 offset:0
    ds_read_b128 v[140:143], v9 offset:0
    ds_read_b128 v[144:147], v9 offset:2048
    ds_read_b128 v[148:151], v9 offset:4096
    ds_read_b128 v[152:155], v9 offset:6144
    ds_read_b128 v[128:131], v20 offset:256
    ds_read_b128 v[132:135], v20 offset:4096
    ds_read_b128 v[136:139], v20 offset:4352
    ds_read_b128 v[156:159], v20 offset:2048
    ds_read_b128 v[172:175], v10 offset:0
    ds_read_b128 v[176:179], v10 offset:2048
    ds_read_b128 v[180:183], v10 offset:4096
    ds_read_b128 v[184:187], v10 offset:6144
    ds_read_b128 v[160:163], v20 offset:2304
    ds_read_b128 v[164:167], v20 offset:6144
    s_waitcnt lgkmcnt(13)
    v_mfma_f32_16x16x32_bf16 v[60:63], v[140:143], v[124:127], v[60:63]
    s_waitcnt lgkmcnt(12)
    v_mfma_f32_16x16x32_bf16 v[64:67], v[144:147], v[124:127], v[64:67]
    s_waitcnt lgkmcnt(11)
    v_mfma_f32_16x16x32_bf16 v[92:95], v[148:151], v[124:127], v[92:95]
    s_waitcnt lgkmcnt(10)
    v_mfma_f32_16x16x32_bf16 v[96:99], v[152:155], v[124:127], v[96:99]
    s_waitcnt lgkmcnt(9)
    v_mfma_f32_16x16x32_bf16 v[104:107], v[152:155], v[128:131], v[104:107]
    ds_read_b128 v[168:171], v20 offset:6400
    v_mfma_f32_16x16x32_bf16 v[100:103], v[148:151], v[128:131], v[100:103]
    v_mfma_f32_16x16x32_bf16 v[72:75], v[144:147], v[128:131], v[72:75]
    v_mfma_f32_16x16x32_bf16 v[68:71], v[140:143], v[128:131], v[68:71]
    s_waitcnt lgkmcnt(1)
    v_mfma_f32_16x16x32_bf16 v[76:79], v[140:143], v[132:135], v[76:79]
    v_mfma_f32_16x16x32_bf16 v[80:83], v[144:147], v[132:135], v[80:83]
    v_mfma_f32_16x16x32_bf16 v[108:111], v[148:151], v[132:135], v[108:111]
    v_mfma_f32_16x16x32_bf16 v[112:115], v[152:155], v[132:135], v[112:115]
    v_mfma_f32_16x16x32_bf16 v[120:123], v[152:155], v[136:139], v[120:123]
    ds_read_b128 v[188:191], v20 offset:16384
    v_mfma_f32_16x16x32_bf16 v[116:119], v[148:151], v[136:139], v[116:119]
    ds_read_b128 v[204:207], v9 offset:16384
    v_mfma_f32_16x16x32_bf16 v[88:91], v[144:147], v[136:139], v[88:91]
    ds_read_b128 v[208:211], v9 offset:18432
    v_mfma_f32_16x16x32_bf16 v[84:87], v[140:143], v[136:139], v[84:87]
    ds_read_b128 v[212:215], v9 offset:20480
    v_mfma_f32_16x16x32_bf16 v[60:63], v[172:175], v[156:159], v[60:63]
    ds_read_b128 v[216:219], v9 offset:22528
    v_mfma_f32_16x16x32_bf16 v[64:67], v[176:179], v[156:159], v[64:67]
    ds_read_b128 v[192:195], v20 offset:16640
    v_mfma_f32_16x16x32_bf16 v[92:95], v[180:183], v[156:159], v[92:95]
    ds_read_b128 v[196:199], v20 offset:20480
    v_mfma_f32_16x16x32_bf16 v[96:99], v[184:187], v[156:159], v[96:99]
    ds_read_b128 v[200:203], v20 offset:20736
    v_mfma_f32_16x16x32_bf16 v[104:107], v[184:187], v[160:163], v[104:107]
    ds_read_b128 v[124:127], v20 offset:18432
    v_mfma_f32_16x16x32_bf16 v[100:103], v[180:183], v[160:163], v[100:103]
    ds_read_b128 v[140:143], v10 offset:16384
    v_mfma_f32_16x16x32_bf16 v[72:75], v[176:179], v[160:163], v[72:75]
    ds_read_b128 v[144:147], v10 offset:18432
    v_mfma_f32_16x16x32_bf16 v[68:71], v[172:175], v[160:163], v[68:71]
    ds_read_b128 v[148:151], v10 offset:20480
    v_mfma_f32_16x16x32_bf16 v[76:79], v[172:175], v[164:167], v[76:79]
    ds_read_b128 v[152:155], v10 offset:22528
    v_mfma_f32_16x16x32_bf16 v[80:83], v[176:179], v[164:167], v[80:83]
    ds_read_b128 v[128:131], v20 offset:18688
    v_mfma_f32_16x16x32_bf16 v[108:111], v[180:183], v[164:167], v[108:111]
    s_waitcnt lgkmcnt(14)
    ds_read_b128 v[132:135], v20 offset:22528
    v_mfma_f32_16x16x32_bf16 v[112:115], v[184:187], v[164:167], v[112:115]
    s_waitcnt lgkmcnt(14)
    ds_read_b128 v[136:139], v20 offset:22784
    v_mfma_f32_16x16x32_bf16 v[120:123], v[184:187], v[168:171], v[120:123]
    v_mfma_f32_16x16x32_bf16 v[116:119], v[180:183], v[168:171], v[116:119]
    v_mfma_f32_16x16x32_bf16 v[88:91], v[176:179], v[168:171], v[88:91]
    v_mfma_f32_16x16x32_bf16 v[84:87], v[172:175], v[168:171], v[84:87]
    s_waitcnt lgkmcnt(3)
    v_mfma_f32_16x16x32_bf16 v[60:63], v[204:207], v[188:191], v[60:63]
    v_mfma_f32_16x16x32_bf16 v[64:67], v[208:211], v[188:191], v[64:67]
    v_mfma_f32_16x16x32_bf16 v[92:95], v[212:215], v[188:191], v[92:95]
    v_mfma_f32_16x16x32_bf16 v[96:99], v[216:219], v[188:191], v[96:99]
    v_mfma_f32_16x16x32_bf16 v[104:107], v[216:219], v[192:195], v[104:107]
    v_mfma_f32_16x16x32_bf16 v[100:103], v[212:215], v[192:195], v[100:103]
    v_mfma_f32_16x16x32_bf16 v[72:75], v[208:211], v[192:195], v[72:75]
L_pad_15:
    s_cbranch_execz L_ret_y2
    v_mfma_f32_16x16x32_bf16 v[68:71], v[204:207], v[192:195], v[68:71]
    v_mfma_f32_16x16x32_bf16 v[76:79], v[204:207], v[196:199], v[76:79]
    v_mfma_f32_16x16x32_bf16 v[80:83], v[208:211], v[196:199], v[80:83]
    v_mfma_f32_16x16x32_bf16 v[108:111], v[212:215], v[196:199], v[108:111]
    v_mfma_f32_16x16x32_bf16 v[112:115], v[216:219], v[196:199], v[112:115]
    s_waitcnt lgkmcnt(0)
    s_waitcnt vmcnt(0)
    s_barrier
    s_cmp_le_u32 s78, 0
    s_addc_u32 s100, 0, 0
    s_add_u32 m0, s81, 0x0
    s_lshl_b32 s70, s100, 12
    s_add_u32 s70, s70, s79
    s_bitcmp0_b32 s100, 0
    s_cselect_b32 s28, s46, s48
    s_cselect_b32 s29, s47, s49
    s_lshr_b32 s71, s100, 1
    s_lshl_b32 s71, s71, 7
    buffer_load_dwordx4 v7, s[8:11], s70 offen sc1 lds
    buffer_load_dwordx4 v7, s[8:11], s70 offen offset:1024 sc1 lds
    buffer_load_dwordx4 v7, s[8:11], s70 offen offset:2048 sc1 lds
    buffer_load_dwordx4 v7, s[8:11], s70 offen offset:3072 sc1 lds
    s_add_u32 m0, m0, 0x10000
    s_nop 0
    buffer_load_dwordx4 v28, s[28:31], s71 offen lds
    buffer_load_dwordx4 v29, s[28:31], s71 offen offset:1024 lds
    buffer_load_dwordx4 v30, s[28:31], s71 offen offset:2048 lds
    buffer_load_dwordx4 v31, s[28:31], s71 offen offset:3072 lds
    s_cmp_le_u32 s78, 128
    s_addc_u32 s100, 1, 0
    s_add_u32 m0, s81, 0x4000
    s_lshl_b32 s70, s100, 12
    s_add_u32 s70, s70, s79
    s_bitcmp0_b32 s100, 0
    s_cselect_b32 s28, s46, s48
    s_cselect_b32 s29, s47, s49
    s_lshr_b32 s71, s100, 1
    s_lshl_b32 s71, s71, 7
    buffer_load_dwordx4 v7, s[8:11], s70 offen sc1 lds
    buffer_load_dwordx4 v7, s[8:11], s70 offen offset:1024 sc1 lds
    buffer_load_dwordx4 v7, s[8:11], s70 offen offset:2048 sc1 lds
    buffer_load_dwordx4 v7, s[8:11], s70 offen offset:3072 sc1 lds
    s_add_u32 m0, m0, 0x10000
    s_nop 0
    buffer_load_dwordx4 v28, s[28:31], s71 offen lds
    buffer_load_dwordx4 v29, s[28:31], s71 offen offset:1024 lds
    buffer_load_dwordx4 v30, s[28:31], s71 offen offset:2048 lds
    buffer_load_dwordx4 v31, s[28:31], s71 offen offset:3072 lds
    v_mfma_f32_16x16x32_bf16 v[120:123], v[216:219], v[200:203], v[120:123]
    ds_read_b128 v[156:159], v20 offset:32768
    v_mfma_f32_16x16x32_bf16 v[116:119], v[212:215], v[200:203], v[116:119]
    ds_read_b128 v[172:175], v9 offset:32768
    v_mfma_f32_16x16x32_bf16 v[88:91], v[208:211], v[200:203], v[88:91]
    ds_read_b128 v[176:179], v9 offset:34816
    v_mfma_f32_16x16x32_bf16 v[84:87], v[204:207], v[200:203], v[84:87]
    ds_read_b128 v[180:183], v9 offset:36864
    v_mfma_f32_16x16x32_bf16 v[60:63], v[140:143], v[124:127], v[60:63]
    ds_read_b128 v[184:187], v9 offset:38912
    v_mfma_f32_16x16x32_bf16 v[64:67], v[144:147], v[124:127], v[64:67]
    ds_read_b128 v[160:163], v20 offset:33024
    v_mfma_f32_16x16x32_bf16 v[92:95], v[148:151], v[124:127], v[92:95]
    ds_read_b128 v[164:167], v20 offset:36864
    v_mfma_f32_16x16x32_bf16 v[96:99], v[152:155], v[124:127], v[96:99]
    ds_read_b128 v[168:171], v20 offset:37120
    v_mfma_f32_16x16x32_bf16 v[104:107], v[152:155], v[128:131], v[104:107]
    ds_read_b128 v[188:191], v20 offset:34816
    v_mfma_f32_16x16x32_bf16 v[100:103], v[148:151], v[128:131], v[100:103]
    ds_read_b128 v[204:207], v10 offset:32768
    v_mfma_f32_16x16x32_bf16 v[72:75], v[144:147], v[128:131], v[72:75]
    ds_read_b128 v[208:211], v10 offset:34816
    v_mfma_f32_16x16x32_bf16 v[68:71], v[140:143], v[128:131], v[68:71]
    ds_read_b128 v[212:215], v10 offset:36864
    v_mfma_f32_16x16x32_bf16 v[76:79], v[140:143], v[132:135], v[76:79]
    ds_read_b128 v[216:219], v10 offset:38912
    v_mfma_f32_16x16x32_bf16 v[80:83], v[144:147], v[132:135], v[80:83]
    ds_read_b128 v[192:195], v20 offset:35072
    v_mfma_f32_16x16x32_bf16 v[108:111], v[148:151], v[132:135], v[108:111]
    ds_read_b128 v[196:199], v20 offset:38912
    v_mfma_f32_16x16x32_bf16 v[112:115], v[152:155], v[132:135], v[112:115]
    s_waitcnt lgkmcnt(14)
    ds_read_b128 v[200:203], v20 offset:39168
    v_mfma_f32_16x16x32_bf16 v[120:123], v[152:155], v[136:139], v[120:123]
    v_mfma_f32_16x16x32_bf16 v[116:119], v[148:151], v[136:139], v[116:119]
    v_mfma_f32_16x16x32_bf16 v[88:91], v[144:147], v[136:139], v[88:91]
    v_mfma_f32_16x16x32_bf16 v[84:87], v[140:143], v[136:139], v[84:87]
    s_waitcnt lgkmcnt(3)
    v_mfma_f32_16x16x32_bf16 v[60:63], v[172:175], v[156:159], v[60:63]
    v_mfma_f32_16x16x32_bf16 v[64:67], v[176:179], v[156:159], v[64:67]
    v_mfma_f32_16x16x32_bf16 v[92:95], v[180:183], v[156:159], v[92:95]
    v_mfma_f32_16x16x32_bf16 v[96:99], v[184:187], v[156:159], v[96:99]
    v_mfma_f32_16x16x32_bf16 v[104:107], v[184:187], v[160:163], v[104:107]
    v_mfma_f32_16x16x32_bf16 v[100:103], v[180:183], v[160:163], v[100:103]
    v_mfma_f32_16x16x32_bf16 v[72:75], v[176:179], v[160:163], v[72:75]
    v_mfma_f32_16x16x32_bf16 v[68:71], v[172:175], v[160:163], v[68:71]
    v_mfma_f32_16x16x32_bf16 v[76:79], v[172:175], v[164:167], v[76:79]
    v_mfma_f32_16x16x32_bf16 v[80:83], v[176:179], v[164:167], v[80:83]
    v_mfma_f32_16x16x32_bf16 v[108:111], v[180:183], v[164:167], v[108:111]
    v_mfma_f32_16x16x32_bf16 v[112:115], v[184:187], v[164:167], v[112:115]
    v_mfma_f32_16x16x32_bf16 v[120:123], v[184:187], v[168:171], v[120:123]
    ds_read_b128 v[124:127], v20 offset:49152
    v_mfma_f32_16x16x32_bf16 v[116:119], v[180:183], v[168:171], v[116:119]
    ds_read_b128 v[140:143], v9 offset:49152
    v_mfma_f32_16x16x32_bf16 v[88:91], v[176:179], v[168:171], v[88:91]
    ds_read_b128 v[144:147], v9 offset:51200
    v_mfma_f32_16x16x32_bf16 v[84:87], v[172:175], v[168:171], v[84:87]
    ds_read_b128 v[148:151], v9 offset:53248
    v_mfma_f32_16x16x32_bf16 v[60:63], v[204:207], v[188:191], v[60:63]
    ds_read_b128 v[152:155], v9 offset:55296
    v_mfma_f32_16x16x32_bf16 v[64:67], v[208:211], v[188:191], v[64:67]
    ds_read_b128 v[128:131], v20 offset:49408
    v_mfma_f32_16x16x32_bf16 v[92:95], v[212:215], v[188:191], v[92:95]
    ds_read_b128 v[132:135], v20 offset:53248
    v_mfma_f32_16x16x32_bf16 v[96:99], v[216:219], v[188:191], v[96:99]
    s_waitcnt lgkmcnt(6)
    v_mfma_f32_16x16x32_bf16 v[104:107], v[216:219], v[192:195], v[104:107]
    ds_read_b128 v[136:139], v20 offset:53504
    v_mfma_f32_16x16x32_bf16 v[100:103], v[212:215], v[192:195], v[100:103]
    ds_read_b128 v[156:159], v20 offset:51200
    v_mfma_f32_16x16x32_bf16 v[72:75], v[208:211], v[192:195], v[72:75]
    ds_read_b128 v[172:175], v10 offset:49152
    v_mfma_f32_16x16x32_bf16 v[68:71], v[204:207], v[192:195], v[68:71]
    ds_read_b128 v[176:179], v10 offset:51200
    v_mfma_f32_16x16x32_bf16 v[76:79], v[204:207], v[196:199], v[76:79]
    ds_read_b128 v[180:183], v10 offset:53248
    v_mfma_f32_16x16x32_bf16 v[80:83], v[208:211], v[196:199], v[80:83]
    ds_read_b128 v[184:187], v10 offset:55296
    v_mfma_f32_16x16x32_bf16 v[108:111], v[212:215], v[196:199], v[108:111]
    ds_read_b128 v[160:163], v20 offset:51456
    v_mfma_f32_16x16x32_bf16 v[112:115], v[216:219], v[196:199], v[112:115]
    ds_read_b128 v[164:167], v20 offset:55296
    v_mfma_f32_16x16x32_bf16 v[120:123], v[216:219], v[200:203], v[120:123]
    ds_read_b128 v[168:171], v20 offset:55552
    v_mfma_f32_16x16x32_bf16 v[116:119], v[212:215], v[200:203], v[116:119]
    v_mfma_f32_16x16x32_bf16 v[88:91], v[208:211], v[200:203], v[88:91]
    v_mfma_f32_16x16x32_bf16 v[84:87], v[204:207], v[200:203], v[84:87]
    s_waitcnt lgkmcnt(4)
    v_mfma_f32_16x16x32_bf16 v[60:63], v[140:143], v[124:127], v[60:63]
    v_mfma_f32_16x16x32_bf16 v[64:67], v[144:147], v[124:127], v[64:67]
    v_mfma_f32_16x16x32_bf16 v[92:95], v[148:151], v[124:127], v[92:95]
    v_mfma_f32_16x16x32_bf16 v[96:99], v[152:155], v[124:127], v[96:99]
    v_mfma_f32_16x16x32_bf16 v[104:107], v[152:155], v[128:131], v[104:107]
    v_mfma_f32_16x16x32_bf16 v[100:103], v[148:151], v[128:131], v[100:103]
    v_mfma_f32_16x16x32_bf16 v[72:75], v[144:147], v[128:131], v[72:75]
    v_mfma_f32_16x16x32_bf16 v[68:71], v[140:143], v[128:131], v[68:71]
    v_mfma_f32_16x16x32_bf16 v[76:79], v[140:143], v[132:135], v[76:79]
    v_mfma_f32_16x16x32_bf16 v[80:83], v[144:147], v[132:135], v[80:83]
    v_mfma_f32_16x16x32_bf16 v[108:111], v[148:151], v[132:135], v[108:111]
    v_mfma_f32_16x16x32_bf16 v[112:115], v[152:155], v[132:135], v[112:115]
    s_waitcnt lgkmcnt(0)
    s_waitcnt vmcnt(8)
    s_barrier
    v_mfma_f32_16x16x32_bf16 v[120:123], v[152:155], v[136:139], v[120:123]
    ds_read_b128 v[188:191], v20 offset:0
    v_mfma_f32_16x16x32_bf16 v[116:119], v[148:151], v[136:139], v[116:119]
    ds_read_b128 v[204:207], v9 offset:0
    v_mfma_f32_16x16x32_bf16 v[88:91], v[144:147], v[136:139], v[88:91]
    ds_read_b128 v[208:211], v9 offset:2048
    v_mfma_f32_16x16x32_bf16 v[84:87], v[140:143], v[136:139], v[84:87]
    ds_read_b128 v[212:215], v9 offset:4096
    v_mfma_f32_16x16x32_bf16 v[60:63], v[172:175], v[156:159], v[60:63]
    ds_read_b128 v[216:219], v9 offset:6144
    v_mfma_f32_16x16x32_bf16 v[64:67], v[176:179], v[156:159], v[64:67]
    ds_read_b128 v[192:195], v20 offset:256
    v_mfma_f32_16x16x32_bf16 v[92:95], v[180:183], v[156:159], v[92:95]
    ds_read_b128 v[196:199], v20 offset:4096
    v_mfma_f32_16x16x32_bf16 v[96:99], v[184:187], v[156:159], v[96:99]
    ds_read_b128 v[200:203], v20 offset:4352
    v_mfma_f32_16x16x32_bf16 v[104:107], v[184:187], v[160:163], v[104:107]
    ds_read_b128 v[124:127], v20 offset:2048
    v_mfma_f32_16x16x32_bf16 v[100:103], v[180:183], v[160:163], v[100:103]
    ds_read_b128 v[140:143], v10 offset:0
    v_mfma_f32_16x16x32_bf16 v[72:75], v[176:179], v[160:163], v[72:75]
    ds_read_b128 v[144:147], v10 offset:2048
    v_mfma_f32_16x16x32_bf16 v[68:71], v[172:175], v[160:163], v[68:71]
    ds_read_b128 v[148:151], v10 offset:4096
    v_mfma_f32_16x16x32_bf16 v[76:79], v[172:175], v[164:167], v[76:79]
    ds_read_b128 v[152:155], v10 offset:6144
    v_mfma_f32_16x16x32_bf16 v[80:83], v[176:179], v[164:167], v[80:83]
    ds_read_b128 v[128:131], v20 offset:2304
    v_mfma_f32_16x16x32_bf16 v[108:111], v[180:183], v[164:167], v[108:111]
    ds_read_b128 v[132:135], v20 offset:6144
    v_mfma_f32_16x16x32_bf16 v[112:115], v[184:187], v[164:167], v[112:115]
    s_waitcnt lgkmcnt(14)
    ds_read_b128 v[136:139], v20 offset:6400
    v_mfma_f32_16x16x32_bf16 v[120:123], v[184:187], v[168:171], v[120:123]
    v_mfma_f32_16x16x32_bf16 v[116:119], v[180:183], v[168:171], v[116:119]
    v_mfma_f32_16x16x32_bf16 v[88:91], v[176:179], v[168:171], v[88:91]
    v_mfma_f32_16x16x32_bf16 v[84:87], v[172:175], v[168:171], v[84:87]
    s_waitcnt lgkmcnt(3)
    v_mfma_f32_16x16x32_bf16 v[60:63], v[204:207], v[188:191], v[60:63]
    v_mfma_f32_16x16x32_bf16 v[64:67], v[208:211], v[188:191], v[64:67]
    v_mfma_f32_16x16x32_bf16 v[92:95], v[212:215], v[188:191], v[92:95]
    v_mfma_f32_16x16x32_bf16 v[96:99], v[216:219], v[188:191], v[96:99]
    v_mfma_f32_16x16x32_bf16 v[104:107], v[216:219], v[192:195], v[104:107]
    v_mfma_f32_16x16x32_bf16 v[100:103], v[212:215], v[192:195], v[100:103]
    v_mfma_f32_16x16x32_bf16 v[72:75], v[208:211], v[192:195], v[72:75]
    v_mfma_f32_16x16x32_bf16 v[68:71], v[204:207], v[192:195], v[68:71]
    v_mfma_f32_16x16x32_bf16 v[76:79], v[204:207], v[196:199], v[76:79]
    v_mfma_f32_16x16x32_bf16 v[80:83], v[208:211], v[196:199], v[80:83]
    v_mfma_f32_16x16x32_bf16 v[108:111], v[212:215], v[196:199], v[108:111]
    v_mfma_f32_16x16x32_bf16 v[112:115], v[216:219], v[196:199], v[112:115]
    s_waitcnt lgkmcnt(0)
    s_waitcnt vmcnt(0)
    s_barrier
    v_mfma_f32_16x16x32_bf16 v[120:123], v[216:219], v[200:203], v[120:123]
    ds_read_b128 v[156:159], v20 offset:16384
    v_mfma_f32_16x16x32_bf16 v[116:119], v[212:215], v[200:203], v[116:119]
    ds_read_b128 v[172:175], v9 offset:16384
    v_mfma_f32_16x16x32_bf16 v[88:91], v[208:211], v[200:203], v[88:91]
    ds_read_b128 v[176:179], v9 offset:18432
    v_mfma_f32_16x16x32_bf16 v[84:87], v[204:207], v[200:203], v[84:87]
    ds_read_b128 v[180:183], v9 offset:20480
    v_mfma_f32_16x16x32_bf16 v[60:63], v[140:143], v[124:127], v[60:63]
    ds_read_b128 v[184:187], v9 offset:22528
    v_mfma_f32_16x16x32_bf16 v[64:67], v[144:147], v[124:127], v[64:67]
    ds_read_b128 v[160:163], v20 offset:16640
    v_mfma_f32_16x16x32_bf16 v[92:95], v[148:151], v[124:127], v[92:95]
    ds_read_b128 v[164:167], v20 offset:20480
    v_mfma_f32_16x16x32_bf16 v[96:99], v[152:155], v[124:127], v[96:99]
    ds_read_b128 v[168:171], v20 offset:20736
    v_mfma_f32_16x16x32_bf16 v[104:107], v[152:155], v[128:131], v[104:107]
    ds_read_b128 v[188:191], v20 offset:18432
    v_mfma_f32_16x16x32_bf16 v[100:103], v[148:151], v[128:131], v[100:103]
    ds_read_b128 v[204:207], v10 offset:16384
    v_mfma_f32_16x16x32_bf16 v[72:75], v[144:147], v[128:131], v[72:75]
    ds_read_b128 v[208:211], v10 offset:18432
    v_mfma_f32_16x16x32_bf16 v[68:71], v[140:143], v[128:131], v[68:71]
    ds_read_b128 v[212:215], v10 offset:20480
    v_mfma_f32_16x16x32_bf16 v[76:79], v[140:143], v[132:135], v[76:79]
    ds_read_b128 v[216:219], v10 offset:22528
    v_mfma_f32_16x16x32_bf16 v[80:83], v[144:147], v[132:135], v[80:83]
    ds_read_b128 v[192:195], v20 offset:18688
    v_mfma_f32_16x16x32_bf16 v[108:111], v[148:151], v[132:135], v[108:111]
    ds_read_b128 v[196:199], v20 offset:22528
    v_mfma_f32_16x16x32_bf16 v[112:115], v[152:155], v[132:135], v[112:115]
    s_waitcnt lgkmcnt(14)
    ds_read_b128 v[200:203], v20 offset:22784
    v_mfma_f32_16x16x32_bf16 v[120:123], v[152:155], v[136:139], v[120:123]
    v_mfma_f32_16x16x32_bf16 v[116:119], v[148:151], v[136:139], v[116:119]
    v_mfma_f32_16x16x32_bf16 v[88:91], v[144:147], v[136:139], v[88:91]
    v_mfma_f32_16x16x32_bf16 v[84:87], v[140:143], v[136:139], v[84:87]
    s_waitcnt lgkmcnt(3)
    v_mfma_f32_16x16x32_bf16 v[60:63], v[172:175], v[156:159], v[60:63]
    v_mfma_f32_16x16x32_bf16 v[64:67], v[176:179], v[156:159], v[64:67]
    v_mfma_f32_16x16x32_bf16 v[92:95], v[180:183], v[156:159], v[92:95]
    v_mfma_f32_16x16x32_bf16 v[96:99], v[184:187], v[156:159], v[96:99]
    v_mfma_f32_16x16x32_bf16 v[104:107], v[184:187], v[160:163], v[104:107]
    v_mfma_f32_16x16x32_bf16 v[100:103], v[180:183], v[160:163], v[100:103]
    v_mfma_f32_16x16x32_bf16 v[72:75], v[176:179], v[160:163], v[72:75]
    v_mfma_f32_16x16x32_bf16 v[68:71], v[172:175], v[160:163], v[68:71]
    v_mfma_f32_16x16x32_bf16 v[76:79], v[172:175], v[164:167], v[76:79]
    v_mfma_f32_16x16x32_bf16 v[80:83], v[176:179], v[164:167], v[80:83]
    v_mfma_f32_16x16x32_bf16 v[108:111], v[180:183], v[164:167], v[108:111]
    v_mfma_f32_16x16x32_bf16 v[112:115], v[184:187], v[164:167], v[112:115]
    s_waitcnt lgkmcnt(0)
    s_barrier
    v_mfma_f32_16x16x32_bf16 v[120:123], v[184:187], v[168:171], v[120:123]
    ds_read_b128 v[124:127], v20 offset:32768
    v_mfma_f32_16x16x32_bf16 v[116:119], v[180:183], v[168:171], v[116:119]
    ds_read_b128 v[140:143], v9 offset:32768
    v_mfma_f32_16x16x32_bf16 v[88:91], v[176:179], v[168:171], v[88:91]
    ds_read_b128 v[144:147], v9 offset:34816
    v_mfma_f32_16x16x32_bf16 v[84:87], v[172:175], v[168:171], v[84:87]
    ds_read_b128 v[148:151], v9 offset:36864
    v_mfma_f32_16x16x32_bf16 v[60:63], v[204:207], v[188:191], v[60:63]
    ds_read_b128 v[152:155], v9 offset:38912
    v_mfma_f32_16x16x32_bf16 v[64:67], v[208:211], v[188:191], v[64:67]
    ds_read_b128 v[128:131], v20 offset:33024
    v_mfma_f32_16x16x32_bf16 v[92:95], v[212:215], v[188:191], v[92:95]
    ds_read_b128 v[132:135], v20 offset:36864
    v_mfma_f32_16x16x32_bf16 v[96:99], v[216:219], v[188:191], v[96:99]
    ds_read_b128 v[136:139], v20 offset:37120
    v_mfma_f32_16x16x32_bf16 v[104:107], v[216:219], v[192:195], v[104:107]
    ds_read_b128 v[156:159], v20 offset:34816
    v_mfma_f32_16x16x32_bf16 v[100:103], v[212:215], v[192:195], v[100:103]
    ds_read_b128 v[172:175], v10 offset:32768
    v_mfma_f32_16x16x32_bf16 v[72:75], v[208:211], v[192:195], v[72:75]
    ds_read_b128 v[176:179], v10 offset:34816
    v_mfma_f32_16x16x32_bf16 v[68:71], v[204:207], v[192:195], v[68:71]
    ds_read_b128 v[180:183], v10 offset:36864
    v_mfma_f32_16x16x32_bf16 v[76:79], v[204:207], v[196:199], v[76:79]
    ds_read_b128 v[184:187], v10 offset:38912
    v_mfma_f32_16x16x32_bf16 v[80:83], v[208:211], v[196:199], v[80:83]
    ds_read_b128 v[160:163], v20 offset:35072
    v_mfma_f32_16x16x32_bf16 v[108:111], v[212:215], v[196:199], v[108:111]
    ds_read_b128 v[164:167], v20 offset:38912
    v_mfma_f32_16x16x32_bf16 v[112:115], v[216:219], v[196:199], v[112:115]
    s_waitcnt lgkmcnt(14)
    ds_read_b128 v[168:171], v20 offset:39168
    v_mfma_f32_16x16x32_bf16 v[120:123], v[216:219], v[200:203], v[120:123]
    v_mfma_f32_16x16x32_bf16 v[116:119], v[212:215], v[200:203], v[116:119]
    v_mfma_f32_16x16x32_bf16 v[88:91], v[208:211], v[200:203], v[88:91]
    v_mfma_f32_16x16x32_bf16 v[84:87], v[204:207], v[200:203], v[84:87]
    s_waitcnt lgkmcnt(3)
    v_mfma_f32_16x16x32_bf16 v[60:63], v[140:143], v[124:127], v[60:63]
    v_mfma_f32_16x16x32_bf16 v[64:67], v[144:147], v[124:127], v[64:67]
    v_mfma_f32_16x16x32_bf16 v[92:95], v[148:151], v[124:127], v[92:95]
    v_mfma_f32_16x16x32_bf16 v[96:99], v[152:155], v[124:127], v[96:99]
    v_mfma_f32_16x16x32_bf16 v[104:107], v[152:155], v[128:131], v[104:107]
    v_mfma_f32_16x16x32_bf16 v[100:103], v[148:151], v[128:131], v[100:103]
    v_mfma_f32_16x16x32_bf16 v[72:75], v[144:147], v[128:131], v[72:75]
    v_mfma_f32_16x16x32_bf16 v[68:71], v[140:143], v[128:131], v[68:71]
    v_mfma_f32_16x16x32_bf16 v[76:79], v[140:143], v[132:135], v[76:79]
    v_mfma_f32_16x16x32_bf16 v[80:83], v[144:147], v[132:135], v[80:83]
    v_mfma_f32_16x16x32_bf16 v[108:111], v[148:151], v[132:135], v[108:111]
    v_mfma_f32_16x16x32_bf16 v[112:115], v[152:155], v[132:135], v[112:115]
    s_waitcnt lgkmcnt(0)
    s_barrier
    v_mfma_f32_16x16x32_bf16 v[120:123], v[152:155], v[136:139], v[120:123]
    ds_read_b128 v[188:191], v20 offset:49152
    v_mfma_f32_16x16x32_bf16 v[116:119], v[148:151], v[136:139], v[116:119]
    ds_read_b128 v[204:207], v9 offset:49152
    v_mfma_f32_16x16x32_bf16 v[88:91], v[144:147], v[136:139], v[88:91]
    ds_read_b128 v[208:211], v9 offset:51200
    v_mfma_f32_16x16x32_bf16 v[84:87], v[140:143], v[136:139], v[84:87]
    ds_read_b128 v[212:215], v9 offset:53248
    v_mfma_f32_16x16x32_bf16 v[60:63], v[172:175], v[156:159], v[60:63]
    ds_read_b128 v[216:219], v9 offset:55296
    v_mfma_f32_16x16x32_bf16 v[64:67], v[176:179], v[156:159], v[64:67]
    ds_read_b128 v[192:195], v20 offset:49408
    v_mfma_f32_16x16x32_bf16 v[92:95], v[180:183], v[156:159], v[92:95]
    ds_read_b128 v[196:199], v20 offset:53248
    v_mfma_f32_16x16x32_bf16 v[96:99], v[184:187], v[156:159], v[96:99]
    ds_read_b128 v[200:203], v20 offset:53504
    v_mfma_f32_16x16x32_bf16 v[104:107], v[184:187], v[160:163], v[104:107]
    ds_read_b128 v[124:127], v20 offset:51200
    v_mfma_f32_16x16x32_bf16 v[100:103], v[180:183], v[160:163], v[100:103]
    ds_read_b128 v[140:143], v10 offset:49152
    v_mfma_f32_16x16x32_bf16 v[72:75], v[176:179], v[160:163], v[72:75]
    ds_read_b128 v[144:147], v10 offset:51200
    v_mfma_f32_16x16x32_bf16 v[68:71], v[172:175], v[160:163], v[68:71]
    ds_read_b128 v[148:151], v10 offset:53248
    v_mfma_f32_16x16x32_bf16 v[76:79], v[172:175], v[164:167], v[76:79]
    ds_read_b128 v[152:155], v10 offset:55296
    v_mfma_f32_16x16x32_bf16 v[80:83], v[176:179], v[164:167], v[80:83]
    ds_read_b128 v[128:131], v20 offset:51456
    v_mfma_f32_16x16x32_bf16 v[108:111], v[180:183], v[164:167], v[108:111]
    ds_read_b128 v[132:135], v20 offset:55296
    v_mfma_f32_16x16x32_bf16 v[112:115], v[184:187], v[164:167], v[112:115]
    s_waitcnt lgkmcnt(14)
    ds_read_b128 v[136:139], v20 offset:55552
    v_mfma_f32_16x16x32_bf16 v[120:123], v[184:187], v[168:171], v[120:123]
    v_mfma_f32_16x16x32_bf16 v[116:119], v[180:183], v[168:171], v[116:119]
    v_mfma_f32_16x16x32_bf16 v[88:91], v[176:179], v[168:171], v[88:91]
    v_mfma_f32_16x16x32_bf16 v[84:87], v[172:175], v[168:171], v[84:87]
    s_waitcnt lgkmcnt(3)
    v_mfma_f32_16x16x32_bf16 v[60:63], v[204:207], v[188:191], v[60:63]
    v_mfma_f32_16x16x32_bf16 v[64:67], v[208:211], v[188:191], v[64:67]
    v_mfma_f32_16x16x32_bf16 v[92:95], v[212:215], v[188:191], v[92:95]
    v_mfma_f32_16x16x32_bf16 v[96:99], v[216:219], v[188:191], v[96:99]
    v_mfma_f32_16x16x32_bf16 v[104:107], v[216:219], v[192:195], v[104:107]
    v_mfma_f32_16x16x32_bf16 v[100:103], v[212:215], v[192:195], v[100:103]
    v_mfma_f32_16x16x32_bf16 v[72:75], v[208:211], v[192:195], v[72:75]
    v_mfma_f32_16x16x32_bf16 v[68:71], v[204:207], v[192:195], v[68:71]
    v_mfma_f32_16x16x32_bf16 v[76:79], v[204:207], v[196:199], v[76:79]
    v_mfma_f32_16x16x32_bf16 v[80:83], v[208:211], v[196:199], v[80:83]
    v_mfma_f32_16x16x32_bf16 v[108:111], v[212:215], v[196:199], v[108:111]
    v_mfma_f32_16x16x32_bf16 v[112:115], v[216:219], v[196:199], v[112:115]
    s_waitcnt lgkmcnt(0)
    s_barrier
    v_mfma_f32_16x16x32_bf16 v[120:123], v[216:219], v[200:203], v[120:123]
    ds_read_b128 v[156:159], v20 offset:0
    v_mfma_f32_16x16x32_bf16 v[116:119], v[212:215], v[200:203], v[116:119]
    ds_read_b128 v[172:175], v9 offset:0
    v_mfma_f32_16x16x32_bf16 v[88:91], v[208:211], v[200:203], v[88:91]
    ds_read_b128 v[176:179], v9 offset:2048
    v_mfma_f32_16x16x32_bf16 v[84:87], v[204:207], v[200:203], v[84:87]
    ds_read_b128 v[180:183], v9 offset:4096
    v_mfma_f32_16x16x32_bf16 v[60:63], v[140:143], v[124:127], v[60:63]
    ds_read_b128 v[184:187], v9 offset:6144
    v_mfma_f32_16x16x32_bf16 v[64:67], v[144:147], v[124:127], v[64:67]
    ds_read_b128 v[160:163], v20 offset:256
    v_mfma_f32_16x16x32_bf16 v[92:95], v[148:151], v[124:127], v[92:95]
    ds_read_b128 v[164:167], v20 offset:4096
    v_mfma_f32_16x16x32_bf16 v[96:99], v[152:155], v[124:127], v[96:99]
    ds_read_b128 v[168:171], v20 offset:4352
    v_mfma_f32_16x16x32_bf16 v[104:107], v[152:155], v[128:131], v[104:107]
    ds_read_b128 v[188:191], v20 offset:2048
    v_mfma_f32_16x16x32_bf16 v[100:103], v[148:151], v[128:131], v[100:103]
    ds_read_b128 v[204:207], v10 offset:0
    v_mfma_f32_16x16x32_bf16 v[72:75], v[144:147], v[128:131], v[72:75]
    ds_read_b128 v[208:211], v10 offset:2048
    v_mfma_f32_16x16x32_bf16 v[68:71], v[140:143], v[128:131], v[68:71]
    ds_read_b128 v[212:215], v10 offset:4096
    v_mfma_f32_16x16x32_bf16 v[76:79], v[140:143], v[132:135], v[76:79]
    ds_read_b128 v[216:219], v10 offset:6144
    v_mfma_f32_16x16x32_bf16 v[80:83], v[144:147], v[132:135], v[80:83]
    ds_read_b128 v[192:195], v20 offset:2304
    v_mfma_f32_16x16x32_bf16 v[108:111], v[148:151], v[132:135], v[108:111]
    ds_read_b128 v[196:199], v20 offset:6144
    v_mfma_f32_16x16x32_bf16 v[112:115], v[152:155], v[132:135], v[112:115]
    s_waitcnt lgkmcnt(14)
    ds_read_b128 v[200:203], v20 offset:6400
    v_mfma_f32_16x16x32_bf16 v[120:123], v[152:155], v[136:139], v[120:123]
    v_mfma_f32_16x16x32_bf16 v[116:119], v[148:151], v[136:139], v[116:119]
    v_mfma_f32_16x16x32_bf16 v[88:91], v[144:147], v[136:139], v[88:91]
    v_mfma_f32_16x16x32_bf16 v[84:87], v[140:143], v[136:139], v[84:87]
    s_waitcnt lgkmcnt(3)
    v_mfma_f32_16x16x32_bf16 v[60:63], v[172:175], v[156:159], v[60:63]
    v_mfma_f32_16x16x32_bf16 v[64:67], v[176:179], v[156:159], v[64:67]
    v_mfma_f32_16x16x32_bf16 v[92:95], v[180:183], v[156:159], v[92:95]
    v_mfma_f32_16x16x32_bf16 v[96:99], v[184:187], v[156:159], v[96:99]
    v_mfma_f32_16x16x32_bf16 v[104:107], v[184:187], v[160:163], v[104:107]
    v_mfma_f32_16x16x32_bf16 v[100:103], v[180:183], v[160:163], v[100:103]
    v_mfma_f32_16x16x32_bf16 v[72:75], v[176:179], v[160:163], v[72:75]
    v_mfma_f32_16x16x32_bf16 v[68:71], v[172:175], v[160:163], v[68:71]
    v_mfma_f32_16x16x32_bf16 v[76:79], v[172:175], v[164:167], v[76:79]
    v_mfma_f32_16x16x32_bf16 v[80:83], v[176:179], v[164:167], v[80:83]
    v_mfma_f32_16x16x32_bf16 v[108:111], v[180:183], v[164:167], v[108:111]
    v_mfma_f32_16x16x32_bf16 v[112:115], v[184:187], v[164:167], v[112:115]
    s_waitcnt lgkmcnt(0)
    s_barrier
    v_mfma_f32_16x16x32_bf16 v[120:123], v[184:187], v[168:171], v[120:123]
    ds_read_b128 v[124:127], v20 offset:16384
    v_mfma_f32_16x16x32_bf16 v[116:119], v[180:183], v[168:171], v[116:119]
    ds_read_b128 v[140:143], v9 offset:16384
    v_mfma_f32_16x16x32_bf16 v[88:91], v[176:179], v[168:171], v[88:91]
    ds_read_b128 v[144:147], v9 offset:18432
    v_mfma_f32_16x16x32_bf16 v[84:87], v[172:175], v[168:171], v[84:87]
    ds_read_b128 v[148:151], v9 offset:20480
    v_mfma_f32_16x16x32_bf16 v[60:63], v[204:207], v[188:191], v[60:63]
    ds_read_b128 v[152:155], v9 offset:22528
    v_mfma_f32_16x16x32_bf16 v[64:67], v[208:211], v[188:191], v[64:67]
    ds_read_b128 v[128:131], v20 offset:16640
    v_mfma_f32_16x16x32_bf16 v[92:95], v[212:215], v[188:191], v[92:95]
    ds_read_b128 v[132:135], v20 offset:20480
    v_mfma_f32_16x16x32_bf16 v[96:99], v[216:219], v[188:191], v[96:99]
    ds_read_b128 v[136:139], v20 offset:20736
    v_mfma_f32_16x16x32_bf16 v[104:107], v[216:219], v[192:195], v[104:107]
    ds_read_b128 v[156:159], v20 offset:18432
    v_mfma_f32_16x16x32_bf16 v[100:103], v[212:215], v[192:195], v[100:103]
    ds_read_b128 v[172:175], v10 offset:16384
    v_mfma_f32_16x16x32_bf16 v[72:75], v[208:211], v[192:195], v[72:75]
    ds_read_b128 v[176:179], v10 offset:18432
    v_mfma_f32_16x16x32_bf16 v[68:71], v[204:207], v[192:195], v[68:71]
    ds_read_b128 v[180:183], v10 offset:20480
    v_mfma_f32_16x16x32_bf16 v[76:79], v[204:207], v[196:199], v[76:79]
    ds_read_b128 v[184:187], v10 offset:22528
    v_mfma_f32_16x16x32_bf16 v[80:83], v[208:211], v[196:199], v[80:83]
    ds_read_b128 v[160:163], v20 offset:18688
    v_mfma_f32_16x16x32_bf16 v[108:111], v[212:215], v[196:199], v[108:111]
    ds_read_b128 v[164:167], v20 offset:22528
    v_mfma_f32_16x16x32_bf16 v[112:115], v[216:219], v[196:199], v[112:115]
    s_waitcnt lgkmcnt(14)
    ds_read_b128 v[168:171], v20 offset:22784
    v_mfma_f32_16x16x32_bf16 v[120:123], v[216:219], v[200:203], v[120:123]
    v_mfma_f32_16x16x32_bf16 v[116:119], v[212:215], v[200:203], v[116:119]
    v_mfma_f32_16x16x32_bf16 v[88:91], v[208:211], v[200:203], v[88:91]
    v_mfma_f32_16x16x32_bf16 v[84:87], v[204:207], v[200:203], v[84:87]
    s_waitcnt lgkmcnt(3)
    v_mfma_f32_16x16x32_bf16 v[60:63], v[140:143], v[124:127], v[60:63]
    v_mfma_f32_16x16x32_bf16 v[64:67], v[144:147], v[124:127], v[64:67]
    v_mfma_f32_16x16x32_bf16 v[92:95], v[148:151], v[124:127], v[92:95]
    v_mfma_f32_16x16x32_bf16 v[96:99], v[152:155], v[124:127], v[96:99]
    v_mfma_f32_16x16x32_bf16 v[104:107], v[152:155], v[128:131], v[104:107]
    v_mfma_f32_16x16x32_bf16 v[100:103], v[148:151], v[128:131], v[100:103]
    v_mfma_f32_16x16x32_bf16 v[72:75], v[144:147], v[128:131], v[72:75]
    v_mfma_f32_16x16x32_bf16 v[68:71], v[140:143], v[128:131], v[68:71]
    v_mfma_f32_16x16x32_bf16 v[76:79], v[140:143], v[132:135], v[76:79]
    v_mfma_f32_16x16x32_bf16 v[80:83], v[144:147], v[132:135], v[80:83]
    v_mfma_f32_16x16x32_bf16 v[108:111], v[148:151], v[132:135], v[108:111]
    v_mfma_f32_16x16x32_bf16 v[112:115], v[152:155], v[132:135], v[112:115]
    s_waitcnt lgkmcnt(0)
    s_barrier
    v_mfma_f32_16x16x32_bf16 v[120:123], v[152:155], v[136:139], v[120:123]
    ds_read_b128 v[188:191], v20 offset:32768
    v_mfma_f32_16x16x32_bf16 v[116:119], v[148:151], v[136:139], v[116:119]
    ds_read_b128 v[204:207], v9 offset:32768
    v_mfma_f32_16x16x32_bf16 v[88:91], v[144:147], v[136:139], v[88:91]
    ds_read_b128 v[208:211], v9 offset:34816
    v_mfma_f32_16x16x32_bf16 v[84:87], v[140:143], v[136:139], v[84:87]
    ds_read_b128 v[212:215], v9 offset:36864
    v_mfma_f32_16x16x32_bf16 v[60:63], v[172:175], v[156:159], v[60:63]
    ds_read_b128 v[216:219], v9 offset:38912
    v_mfma_f32_16x16x32_bf16 v[64:67], v[176:179], v[156:159], v[64:67]
    ds_read_b128 v[192:195], v20 offset:33024
    v_mfma_f32_16x16x32_bf16 v[92:95], v[180:183], v[156:159], v[92:95]
    ds_read_b128 v[196:199], v20 offset:36864
    v_mfma_f32_16x16x32_bf16 v[96:99], v[184:187], v[156:159], v[96:99]
    ds_read_b128 v[200:203], v20 offset:37120
    v_mfma_f32_16x16x32_bf16 v[104:107], v[184:187], v[160:163], v[104:107]
    ds_read_b128 v[124:127], v20 offset:34816
    v_mfma_f32_16x16x32_bf16 v[100:103], v[180:183], v[160:163], v[100:103]
    ds_read_b128 v[140:143], v10 offset:32768
    v_mfma_f32_16x16x32_bf16 v[72:75], v[176:179], v[160:163], v[72:75]
    ds_read_b128 v[144:147], v10 offset:34816
    v_mfma_f32_16x16x32_bf16 v[68:71], v[172:175], v[160:163], v[68:71]
    ds_read_b128 v[148:151], v10 offset:36864
    v_mfma_f32_16x16x32_bf16 v[76:79], v[172:175], v[164:167], v[76:79]
    ds_read_b128 v[152:155], v10 offset:38912
    v_mfma_f32_16x16x32_bf16 v[80:83], v[176:179], v[164:167], v[80:83]
    ds_read_b128 v[128:131], v20 offset:35072
    v_mfma_f32_16x16x32_bf16 v[108:111], v[180:183], v[164:167], v[108:111]
    ds_read_b128 v[132:135], v20 offset:38912
    v_mfma_f32_16x16x32_bf16 v[112:115], v[184:187], v[164:167], v[112:115]
    s_waitcnt lgkmcnt(14)
    ds_read_b128 v[136:139], v20 offset:39168
    v_mfma_f32_16x16x32_bf16 v[120:123], v[184:187], v[168:171], v[120:123]
    v_mfma_f32_16x16x32_bf16 v[116:119], v[180:183], v[168:171], v[116:119]
    v_mfma_f32_16x16x32_bf16 v[88:91], v[176:179], v[168:171], v[88:91]
    v_mfma_f32_16x16x32_bf16 v[84:87], v[172:175], v[168:171], v[84:87]
    s_waitcnt lgkmcnt(3)
    v_mfma_f32_16x16x32_bf16 v[60:63], v[204:207], v[188:191], v[60:63]
    v_mfma_f32_16x16x32_bf16 v[64:67], v[208:211], v[188:191], v[64:67]
    v_mfma_f32_16x16x32_bf16 v[92:95], v[212:215], v[188:191], v[92:95]
    v_mfma_f32_16x16x32_bf16 v[96:99], v[216:219], v[188:191], v[96:99]
    v_mfma_f32_16x16x32_bf16 v[104:107], v[216:219], v[192:195], v[104:107]
    v_mfma_f32_16x16x32_bf16 v[100:103], v[212:215], v[192:195], v[100:103]
    v_mfma_f32_16x16x32_bf16 v[72:75], v[208:211], v[192:195], v[72:75]
    v_mfma_f32_16x16x32_bf16 v[68:71], v[204:207], v[192:195], v[68:71]
    v_mfma_f32_16x16x32_bf16 v[76:79], v[204:207], v[196:199], v[76:79]
    v_mfma_f32_16x16x32_bf16 v[80:83], v[208:211], v[196:199], v[80:83]
    v_mfma_f32_16x16x32_bf16 v[108:111], v[212:215], v[196:199], v[108:111]
    v_mfma_f32_16x16x32_bf16 v[112:115], v[216:219], v[196:199], v[112:115]
    s_waitcnt lgkmcnt(0)
    s_barrier
    v_mfma_f32_16x16x32_bf16 v[120:123], v[216:219], v[200:203], v[120:123]
    ds_read_b128 v[156:159], v20 offset:49152
    v_mfma_f32_16x16x32_bf16 v[116:119], v[212:215], v[200:203], v[116:119]
    ds_read_b128 v[172:175], v9 offset:49152
    v_mfma_f32_16x16x32_bf16 v[88:91], v[208:211], v[200:203], v[88:91]
    ds_read_b128 v[176:179], v9 offset:51200
    v_mfma_f32_16x16x32_bf16 v[84:87], v[204:207], v[200:203], v[84:87]
    ds_read_b128 v[180:183], v9 offset:53248
    v_mfma_f32_16x16x32_bf16 v[60:63], v[140:143], v[124:127], v[60:63]
    ds_read_b128 v[184:187], v9 offset:55296
    v_mfma_f32_16x16x32_bf16 v[64:67], v[144:147], v[124:127], v[64:67]
    ds_read_b128 v[160:163], v20 offset:49408
    v_mfma_f32_16x16x32_bf16 v[92:95], v[148:151], v[124:127], v[92:95]
    ds_read_b128 v[164:167], v20 offset:53248
    v_mfma_f32_16x16x32_bf16 v[96:99], v[152:155], v[124:127], v[96:99]
    ds_read_b128 v[168:171], v20 offset:53504
    v_mfma_f32_16x16x32_bf16 v[104:107], v[152:155], v[128:131], v[104:107]
    ds_read_b128 v[188:191], v20 offset:51200
    v_mfma_f32_16x16x32_bf16 v[100:103], v[148:151], v[128:131], v[100:103]
    ds_read_b128 v[204:207], v10 offset:49152
    v_mfma_f32_16x16x32_bf16 v[72:75], v[144:147], v[128:131], v[72:75]
    ds_read_b128 v[208:211], v10 offset:51200
    v_mfma_f32_16x16x32_bf16 v[68:71], v[140:143], v[128:131], v[68:71]
    ds_read_b128 v[212:215], v10 offset:53248
    v_mfma_f32_16x16x32_bf16 v[76:79], v[140:143], v[132:135], v[76:79]
L_pad_16:
    s_cbranch_execz L_ret_y2
    ds_read_b128 v[216:219], v10 offset:55296
    v_mfma_f32_16x16x32_bf16 v[80:83], v[144:147], v[132:135], v[80:83]
    ds_read_b128 v[192:195], v20 offset:51456
    v_mfma_f32_16x16x32_bf16 v[108:111], v[148:151], v[132:135], v[108:111]
    ds_read_b128 v[196:199], v20 offset:55296
    v_mfma_f32_16x16x32_bf16 v[112:115], v[152:155], v[132:135], v[112:115]
    s_waitcnt lgkmcnt(14)
    ds_read_b128 v[200:203], v20 offset:55552
    v_mfma_f32_16x16x32_bf16 v[120:123], v[152:155], v[136:139], v[120:123]
    v_mfma_f32_16x16x32_bf16 v[116:119], v[148:151], v[136:139], v[116:119]
    v_mfma_f32_16x16x32_bf16 v[88:91], v[144:147], v[136:139], v[88:91]
    v_mfma_f32_16x16x32_bf16 v[84:87], v[140:143], v[136:139], v[84:87]
    s_waitcnt lgkmcnt(3)
    v_mfma_f32_16x16x32_bf16 v[60:63], v[172:175], v[156:159], v[60:63]
    v_mfma_f32_16x16x32_bf16 v[64:67], v[176:179], v[156:159], v[64:67]
    v_mfma_f32_16x16x32_bf16 v[92:95], v[180:183], v[156:159], v[92:95]
    v_mfma_f32_16x16x32_bf16 v[96:99], v[184:187], v[156:159], v[96:99]
    v_mfma_f32_16x16x32_bf16 v[104:107], v[184:187], v[160:163], v[104:107]
    v_mfma_f32_16x16x32_bf16 v[100:103], v[180:183], v[160:163], v[100:103]
    v_mfma_f32_16x16x32_bf16 v[72:75], v[176:179], v[160:163], v[72:75]
    v_mfma_f32_16x16x32_bf16 v[68:71], v[172:175], v[160:163], v[68:71]
    v_mfma_f32_16x16x32_bf16 v[76:79], v[172:175], v[164:167], v[76:79]
    v_mfma_f32_16x16x32_bf16 v[80:83], v[176:179], v[164:167], v[80:83]
    v_mfma_f32_16x16x32_bf16 v[108:111], v[180:183], v[164:167], v[108:111]
    v_mfma_f32_16x16x32_bf16 v[112:115], v[184:187], v[164:167], v[112:115]
    s_waitcnt lgkmcnt(0)
    s_barrier
    v_mfma_f32_16x16x32_bf16 v[120:123], v[184:187], v[168:171], v[120:123]
    ds_read_b128 v[124:127], v20 offset:0
    v_mfma_f32_16x16x32_bf16 v[116:119], v[180:183], v[168:171], v[116:119]
    ds_read_b128 v[140:143], v9 offset:0
    v_mfma_f32_16x16x32_bf16 v[88:91], v[176:179], v[168:171], v[88:91]
    ds_read_b128 v[144:147], v9 offset:2048
    v_mfma_f32_16x16x32_bf16 v[84:87], v[172:175], v[168:171], v[84:87]
    ds_read_b128 v[148:151], v9 offset:4096
    v_mfma_f32_16x16x32_bf16 v[60:63], v[204:207], v[188:191], v[60:63]
    ds_read_b128 v[152:155], v9 offset:6144
    v_mfma_f32_16x16x32_bf16 v[64:67], v[208:211], v[188:191], v[64:67]
    ds_read_b128 v[128:131], v20 offset:256
    v_mfma_f32_16x16x32_bf16 v[92:95], v[212:215], v[188:191], v[92:95]
    ds_read_b128 v[132:135], v20 offset:4096
    v_mfma_f32_16x16x32_bf16 v[96:99], v[216:219], v[188:191], v[96:99]
    ds_read_b128 v[136:139], v20 offset:4352
    v_mfma_f32_16x16x32_bf16 v[104:107], v[216:219], v[192:195], v[104:107]
    ds_read_b128 v[156:159], v20 offset:2048
    v_mfma_f32_16x16x32_bf16 v[100:103], v[212:215], v[192:195], v[100:103]
    ds_read_b128 v[172:175], v10 offset:0
    v_mfma_f32_16x16x32_bf16 v[72:75], v[208:211], v[192:195], v[72:75]
    ds_read_b128 v[176:179], v10 offset:2048
    v_mfma_f32_16x16x32_bf16 v[68:71], v[204:207], v[192:195], v[68:71]
    ds_read_b128 v[180:183], v10 offset:4096
    v_mfma_f32_16x16x32_bf16 v[76:79], v[204:207], v[196:199], v[76:79]
    ds_read_b128 v[184:187], v10 offset:6144
    v_mfma_f32_16x16x32_bf16 v[80:83], v[208:211], v[196:199], v[80:83]
    ds_read_b128 v[160:163], v20 offset:2304
    v_mfma_f32_16x16x32_bf16 v[108:111], v[212:215], v[196:199], v[108:111]
    ds_read_b128 v[164:167], v20 offset:6144
    v_mfma_f32_16x16x32_bf16 v[112:115], v[216:219], v[196:199], v[112:115]
    s_waitcnt lgkmcnt(14)
    ds_read_b128 v[168:171], v20 offset:6400
    v_mfma_f32_16x16x32_bf16 v[120:123], v[216:219], v[200:203], v[120:123]
    v_mfma_f32_16x16x32_bf16 v[116:119], v[212:215], v[200:203], v[116:119]
    v_mfma_f32_16x16x32_bf16 v[88:91], v[208:211], v[200:203], v[88:91]
    v_mfma_f32_16x16x32_bf16 v[84:87], v[204:207], v[200:203], v[84:87]
    s_waitcnt lgkmcnt(3)
    v_mfma_f32_16x16x32_bf16 v[60:63], v[140:143], v[124:127], v[60:63]
    v_mfma_f32_16x16x32_bf16 v[64:67], v[144:147], v[124:127], v[64:67]
    v_mfma_f32_16x16x32_bf16 v[92:95], v[148:151], v[124:127], v[92:95]
    v_mfma_f32_16x16x32_bf16 v[96:99], v[152:155], v[124:127], v[96:99]
    v_mfma_f32_16x16x32_bf16 v[104:107], v[152:155], v[128:131], v[104:107]
    v_mfma_f32_16x16x32_bf16 v[100:103], v[148:151], v[128:131], v[100:103]
    v_mfma_f32_16x16x32_bf16 v[72:75], v[144:147], v[128:131], v[72:75]
    v_mfma_f32_16x16x32_bf16 v[68:71], v[140:143], v[128:131], v[68:71]
    v_mfma_f32_16x16x32_bf16 v[76:79], v[140:143], v[132:135], v[76:79]
    v_mfma_f32_16x16x32_bf16 v[80:83], v[144:147], v[132:135], v[80:83]
    v_mfma_f32_16x16x32_bf16 v[108:111], v[148:151], v[132:135], v[108:111]
    v_mfma_f32_16x16x32_bf16 v[112:115], v[152:155], v[132:135], v[112:115]
    s_waitcnt lgkmcnt(0)
    s_barrier
    v_mfma_f32_16x16x32_bf16 v[120:123], v[152:155], v[136:139], v[120:123]
    ds_read_b128 v[188:191], v20 offset:16384
    v_mfma_f32_16x16x32_bf16 v[116:119], v[148:151], v[136:139], v[116:119]
    ds_read_b128 v[204:207], v9 offset:16384
    v_mfma_f32_16x16x32_bf16 v[88:91], v[144:147], v[136:139], v[88:91]
    ds_read_b128 v[208:211], v9 offset:18432
    v_mfma_f32_16x16x32_bf16 v[84:87], v[140:143], v[136:139], v[84:87]
    ds_read_b128 v[212:215], v9 offset:20480
    v_mfma_f32_16x16x32_bf16 v[60:63], v[172:175], v[156:159], v[60:63]
    ds_read_b128 v[216:219], v9 offset:22528
    v_mfma_f32_16x16x32_bf16 v[64:67], v[176:179], v[156:159], v[64:67]
    ds_read_b128 v[192:195], v20 offset:16640
    v_mfma_f32_16x16x32_bf16 v[92:95], v[180:183], v[156:159], v[92:95]
    ds_read_b128 v[196:199], v20 offset:20480
    v_mfma_f32_16x16x32_bf16 v[96:99], v[184:187], v[156:159], v[96:99]
    ds_read_b128 v[200:203], v20 offset:20736
    v_mfma_f32_16x16x32_bf16 v[104:107], v[184:187], v[160:163], v[104:107]
    ds_read_b128 v[124:127], v20 offset:18432
    v_mfma_f32_16x16x32_bf16 v[100:103], v[180:183], v[160:163], v[100:103]
    ds_read_b128 v[140:143], v10 offset:16384
    v_mfma_f32_16x16x32_bf16 v[72:75], v[176:179], v[160:163], v[72:75]
    ds_read_b128 v[144:147], v10 offset:18432
    v_mfma_f32_16x16x32_bf16 v[68:71], v[172:175], v[160:163], v[68:71]
    ds_read_b128 v[148:151], v10 offset:20480
    v_mfma_f32_16x16x32_bf16 v[76:79], v[172:175], v[164:167], v[76:79]
    ds_read_b128 v[152:155], v10 offset:22528
    v_mfma_f32_16x16x32_bf16 v[80:83], v[176:179], v[164:167], v[80:83]
    ds_read_b128 v[128:131], v20 offset:18688
    v_mfma_f32_16x16x32_bf16 v[108:111], v[180:183], v[164:167], v[108:111]
    ds_read_b128 v[132:135], v20 offset:22528
    v_mfma_f32_16x16x32_bf16 v[112:115], v[184:187], v[164:167], v[112:115]
    s_waitcnt lgkmcnt(14)
    ds_read_b128 v[136:139], v20 offset:22784
    v_mfma_f32_16x16x32_bf16 v[120:123], v[184:187], v[168:171], v[120:123]
    v_mfma_f32_16x16x32_bf16 v[116:119], v[180:183], v[168:171], v[116:119]
    v_mfma_f32_16x16x32_bf16 v[88:91], v[176:179], v[168:171], v[88:91]
    v_mfma_f32_16x16x32_bf16 v[84:87], v[172:175], v[168:171], v[84:87]
    s_waitcnt lgkmcnt(3)
    v_mfma_f32_16x16x32_bf16 v[60:63], v[204:207], v[188:191], v[60:63]
    v_mfma_f32_16x16x32_bf16 v[64:67], v[208:211], v[188:191], v[64:67]
    v_mfma_f32_16x16x32_bf16 v[92:95], v[212:215], v[188:191], v[92:95]
    v_mfma_f32_16x16x32_bf16 v[96:99], v[216:219], v[188:191], v[96:99]
    v_mfma_f32_16x16x32_bf16 v[104:107], v[216:219], v[192:195], v[104:107]
    v_mfma_f32_16x16x32_bf16 v[100:103], v[212:215], v[192:195], v[100:103]
    v_mfma_f32_16x16x32_bf16 v[72:75], v[208:211], v[192:195], v[72:75]
    v_mfma_f32_16x16x32_bf16 v[68:71], v[204:207], v[192:195], v[68:71]
    v_mfma_f32_16x16x32_bf16 v[76:79], v[204:207], v[196:199], v[76:79]
    v_mfma_f32_16x16x32_bf16 v[80:83], v[208:211], v[196:199], v[80:83]
    v_mfma_f32_16x16x32_bf16 v[108:111], v[212:215], v[196:199], v[108:111]
    v_mfma_f32_16x16x32_bf16 v[112:115], v[216:219], v[196:199], v[112:115]
    s_waitcnt lgkmcnt(0)
    s_barrier
    v_mfma_f32_16x16x32_bf16 v[120:123], v[216:219], v[200:203], v[120:123]
    ds_read_b128 v[156:159], v20 offset:32768
    v_mfma_f32_16x16x32_bf16 v[116:119], v[212:215], v[200:203], v[116:119]
    ds_read_b128 v[172:175], v9 offset:32768
    v_mfma_f32_16x16x32_bf16 v[88:91], v[208:211], v[200:203], v[88:91]
    ds_read_b128 v[176:179], v9 offset:34816
    v_mfma_f32_16x16x32_bf16 v[84:87], v[204:207], v[200:203], v[84:87]
    ds_read_b128 v[180:183], v9 offset:36864
    v_mfma_f32_16x16x32_bf16 v[60:63], v[140:143], v[124:127], v[60:63]
    ds_read_b128 v[184:187], v9 offset:38912
    v_mfma_f32_16x16x32_bf16 v[64:67], v[144:147], v[124:127], v[64:67]
    ds_read_b128 v[160:163], v20 offset:33024
    v_mfma_f32_16x16x32_bf16 v[92:95], v[148:151], v[124:127], v[92:95]
    ds_read_b128 v[164:167], v20 offset:36864
    v_mfma_f32_16x16x32_bf16 v[96:99], v[152:155], v[124:127], v[96:99]
    ds_read_b128 v[168:171], v20 offset:37120
    v_mfma_f32_16x16x32_bf16 v[104:107], v[152:155], v[128:131], v[104:107]
    ds_read_b128 v[188:191], v20 offset:34816
    v_mfma_f32_16x16x32_bf16 v[100:103], v[148:151], v[128:131], v[100:103]
    ds_read_b128 v[204:207], v10 offset:32768
    v_mfma_f32_16x16x32_bf16 v[72:75], v[144:147], v[128:131], v[72:75]
    ds_read_b128 v[208:211], v10 offset:34816
    v_mfma_f32_16x16x32_bf16 v[68:71], v[140:143], v[128:131], v[68:71]
    ds_read_b128 v[212:215], v10 offset:36864
    v_mfma_f32_16x16x32_bf16 v[76:79], v[140:143], v[132:135], v[76:79]
    ds_read_b128 v[216:219], v10 offset:38912
    v_mfma_f32_16x16x32_bf16 v[80:83], v[144:147], v[132:135], v[80:83]
    ds_read_b128 v[192:195], v20 offset:35072
    v_mfma_f32_16x16x32_bf16 v[108:111], v[148:151], v[132:135], v[108:111]
    ds_read_b128 v[196:199], v20 offset:38912
    v_mfma_f32_16x16x32_bf16 v[112:115], v[152:155], v[132:135], v[112:115]
    s_waitcnt lgkmcnt(14)
    ds_read_b128 v[200:203], v20 offset:39168
    v_mfma_f32_16x16x32_bf16 v[120:123], v[152:155], v[136:139], v[120:123]
    v_mfma_f32_16x16x32_bf16 v[116:119], v[148:151], v[136:139], v[116:119]
    v_mfma_f32_16x16x32_bf16 v[88:91], v[144:147], v[136:139], v[88:91]
    v_mfma_f32_16x16x32_bf16 v[84:87], v[140:143], v[136:139], v[84:87]
    s_waitcnt lgkmcnt(3)
    v_mfma_f32_16x16x32_bf16 v[60:63], v[172:175], v[156:159], v[60:63]
    v_mfma_f32_16x16x32_bf16 v[64:67], v[176:179], v[156:159], v[64:67]
    v_mfma_f32_16x16x32_bf16 v[92:95], v[180:183], v[156:159], v[92:95]
    v_mfma_f32_16x16x32_bf16 v[96:99], v[184:187], v[156:159], v[96:99]
    v_mfma_f32_16x16x32_bf16 v[104:107], v[184:187], v[160:163], v[104:107]
    v_mfma_f32_16x16x32_bf16 v[100:103], v[180:183], v[160:163], v[100:103]
    v_mfma_f32_16x16x32_bf16 v[72:75], v[176:179], v[160:163], v[72:75]
    v_mfma_f32_16x16x32_bf16 v[68:71], v[172:175], v[160:163], v[68:71]
    v_mfma_f32_16x16x32_bf16 v[76:79], v[172:175], v[164:167], v[76:79]
    v_mfma_f32_16x16x32_bf16 v[80:83], v[176:179], v[164:167], v[80:83]
    v_mfma_f32_16x16x32_bf16 v[108:111], v[180:183], v[164:167], v[108:111]
    v_mfma_f32_16x16x32_bf16 v[112:115], v[184:187], v[164:167], v[112:115]
    s_waitcnt lgkmcnt(0)
    s_barrier
    v_mfma_f32_16x16x32_bf16 v[120:123], v[184:187], v[168:171], v[120:123]
    ds_read_b128 v[124:127], v20 offset:49152
    v_mfma_f32_16x16x32_bf16 v[116:119], v[180:183], v[168:171], v[116:119]
    ds_read_b128 v[140:143], v9 offset:49152
    v_mfma_f32_16x16x32_bf16 v[88:91], v[176:179], v[168:171], v[88:91]
    ds_read_b128 v[144:147], v9 offset:51200
    v_mfma_f32_16x16x32_bf16 v[84:87], v[172:175], v[168:171], v[84:87]
    ds_read_b128 v[148:151], v9 offset:53248
    v_mfma_f32_16x16x32_bf16 v[60:63], v[204:207], v[188:191], v[60:63]
    ds_read_b128 v[152:155], v9 offset:55296
    v_mfma_f32_16x16x32_bf16 v[64:67], v[208:211], v[188:191], v[64:67]
    ds_read_b128 v[128:131], v20 offset:49408
    v_mfma_f32_16x16x32_bf16 v[92:95], v[212:215], v[188:191], v[92:95]
    ds_read_b128 v[132:135], v20 offset:53248
    v_mfma_f32_16x16x32_bf16 v[96:99], v[216:219], v[188:191], v[96:99]
    ds_read_b128 v[136:139], v20 offset:53504
    v_mfma_f32_16x16x32_bf16 v[104:107], v[216:219], v[192:195], v[104:107]
    ds_read_b128 v[156:159], v20 offset:51200
    v_mfma_f32_16x16x32_bf16 v[100:103], v[212:215], v[192:195], v[100:103]
    ds_read_b128 v[172:175], v10 offset:49152
    v_mfma_f32_16x16x32_bf16 v[72:75], v[208:211], v[192:195], v[72:75]
    ds_read_b128 v[176:179], v10 offset:51200
    v_mfma_f32_16x16x32_bf16 v[68:71], v[204:207], v[192:195], v[68:71]
    ds_read_b128 v[180:183], v10 offset:53248
    v_mfma_f32_16x16x32_bf16 v[76:79], v[204:207], v[196:199], v[76:79]
    ds_read_b128 v[184:187], v10 offset:55296
    v_mfma_f32_16x16x32_bf16 v[80:83], v[208:211], v[196:199], v[80:83]
    ds_read_b128 v[160:163], v20 offset:51456
    v_mfma_f32_16x16x32_bf16 v[108:111], v[212:215], v[196:199], v[108:111]
    ds_read_b128 v[164:167], v20 offset:55296
    v_mfma_f32_16x16x32_bf16 v[112:115], v[216:219], v[196:199], v[112:115]
    s_waitcnt lgkmcnt(14)
    ds_read_b128 v[168:171], v20 offset:55552
    v_mfma_f32_16x16x32_bf16 v[120:123], v[216:219], v[200:203], v[120:123]
    v_mfma_f32_16x16x32_bf16 v[116:119], v[212:215], v[200:203], v[116:119]
    v_mfma_f32_16x16x32_bf16 v[88:91], v[208:211], v[200:203], v[88:91]
    v_mfma_f32_16x16x32_bf16 v[84:87], v[204:207], v[200:203], v[84:87]
    s_waitcnt lgkmcnt(3)
    v_mfma_f32_16x16x32_bf16 v[60:63], v[140:143], v[124:127], v[60:63]
    v_mfma_f32_16x16x32_bf16 v[64:67], v[144:147], v[124:127], v[64:67]
    v_mfma_f32_16x16x32_bf16 v[92:95], v[148:151], v[124:127], v[92:95]
    v_mfma_f32_16x16x32_bf16 v[96:99], v[152:155], v[124:127], v[96:99]
    v_mfma_f32_16x16x32_bf16 v[104:107], v[152:155], v[128:131], v[104:107]
    v_mfma_f32_16x16x32_bf16 v[100:103], v[148:151], v[128:131], v[100:103]
    v_mfma_f32_16x16x32_bf16 v[72:75], v[144:147], v[128:131], v[72:75]
    v_mfma_f32_16x16x32_bf16 v[68:71], v[140:143], v[128:131], v[68:71]
    v_mfma_f32_16x16x32_bf16 v[76:79], v[140:143], v[132:135], v[76:79]
    v_mfma_f32_16x16x32_bf16 v[80:83], v[144:147], v[132:135], v[80:83]
    v_mfma_f32_16x16x32_bf16 v[108:111], v[148:151], v[132:135], v[108:111]
    v_mfma_f32_16x16x32_bf16 v[112:115], v[152:155], v[132:135], v[112:115]
    s_waitcnt lgkmcnt(0)
    s_barrier
    v_mfma_f32_16x16x32_bf16 v[120:123], v[152:155], v[136:139], v[120:123]
    ds_read_b128 v[188:191], v20 offset:0
    v_mfma_f32_16x16x32_bf16 v[116:119], v[148:151], v[136:139], v[116:119]
    ds_read_b128 v[204:207], v9 offset:0
    v_mfma_f32_16x16x32_bf16 v[88:91], v[144:147], v[136:139], v[88:91]
    ds_read_b128 v[208:211], v9 offset:2048
    v_mfma_f32_16x16x32_bf16 v[84:87], v[140:143], v[136:139], v[84:87]
    ds_read_b128 v[212:215], v9 offset:4096
    v_mfma_f32_16x16x32_bf16 v[60:63], v[172:175], v[156:159], v[60:63]
    ds_read_b128 v[216:219], v9 offset:6144
    v_mfma_f32_16x16x32_bf16 v[64:67], v[176:179], v[156:159], v[64:67]
    ds_read_b128 v[192:195], v20 offset:256
    v_mfma_f32_16x16x32_bf16 v[92:95], v[180:183], v[156:159], v[92:95]
    ds_read_b128 v[196:199], v20 offset:4096
    v_mfma_f32_16x16x32_bf16 v[96:99], v[184:187], v[156:159], v[96:99]
    ds_read_b128 v[200:203], v20 offset:4352
    v_mfma_f32_16x16x32_bf16 v[104:107], v[184:187], v[160:163], v[104:107]
    ds_read_b128 v[124:127], v20 offset:2048
    v_mfma_f32_16x16x32_bf16 v[100:103], v[180:183], v[160:163], v[100:103]
    ds_read_b128 v[140:143], v10 offset:0
    v_mfma_f32_16x16x32_bf16 v[72:75], v[176:179], v[160:163], v[72:75]
    ds_read_b128 v[144:147], v10 offset:2048
    v_mfma_f32_16x16x32_bf16 v[68:71], v[172:175], v[160:163], v[68:71]
    ds_read_b128 v[148:151], v10 offset:4096
    v_mfma_f32_16x16x32_bf16 v[76:79], v[172:175], v[164:167], v[76:79]
    ds_read_b128 v[152:155], v10 offset:6144
    v_mfma_f32_16x16x32_bf16 v[80:83], v[176:179], v[164:167], v[80:83]
    ds_read_b128 v[128:131], v20 offset:2304
    v_mfma_f32_16x16x32_bf16 v[108:111], v[180:183], v[164:167], v[108:111]
    ds_read_b128 v[132:135], v20 offset:6144
    v_mfma_f32_16x16x32_bf16 v[112:115], v[184:187], v[164:167], v[112:115]
    s_waitcnt lgkmcnt(14)
    ds_read_b128 v[136:139], v20 offset:6400
    v_mfma_f32_16x16x32_bf16 v[120:123], v[184:187], v[168:171], v[120:123]
    v_mfma_f32_16x16x32_bf16 v[116:119], v[180:183], v[168:171], v[116:119]
    v_mfma_f32_16x16x32_bf16 v[88:91], v[176:179], v[168:171], v[88:91]
    v_mfma_f32_16x16x32_bf16 v[84:87], v[172:175], v[168:171], v[84:87]
    s_waitcnt lgkmcnt(3)
    v_mfma_f32_16x16x32_bf16 v[60:63], v[204:207], v[188:191], v[60:63]
    v_mfma_f32_16x16x32_bf16 v[64:67], v[208:211], v[188:191], v[64:67]
    v_mfma_f32_16x16x32_bf16 v[92:95], v[212:215], v[188:191], v[92:95]
    v_mfma_f32_16x16x32_bf16 v[96:99], v[216:219], v[188:191], v[96:99]
    v_mfma_f32_16x16x32_bf16 v[104:107], v[216:219], v[192:195], v[104:107]
    v_mfma_f32_16x16x32_bf16 v[100:103], v[212:215], v[192:195], v[100:103]
    v_mfma_f32_16x16x32_bf16 v[72:75], v[208:211], v[192:195], v[72:75]
    v_mfma_f32_16x16x32_bf16 v[68:71], v[204:207], v[192:195], v[68:71]
    v_mfma_f32_16x16x32_bf16 v[76:79], v[204:207], v[196:199], v[76:79]
    v_mfma_f32_16x16x32_bf16 v[80:83], v[208:211], v[196:199], v[80:83]
    v_mfma_f32_16x16x32_bf16 v[108:111], v[212:215], v[196:199], v[108:111]
    v_mfma_f32_16x16x32_bf16 v[112:115], v[216:219], v[196:199], v[112:115]
    s_waitcnt lgkmcnt(0)
    s_barrier
    v_mfma_f32_16x16x32_bf16 v[120:123], v[216:219], v[200:203], v[120:123]
    ds_read_b128 v[156:159], v20 offset:16384
    v_mfma_f32_16x16x32_bf16 v[116:119], v[212:215], v[200:203], v[116:119]
    ds_read_b128 v[172:175], v9 offset:16384
    v_mfma_f32_16x16x32_bf16 v[88:91], v[208:211], v[200:203], v[88:91]
    ds_read_b128 v[176:179], v9 offset:18432
    v_mfma_f32_16x16x32_bf16 v[84:87], v[204:207], v[200:203], v[84:87]
    ds_read_b128 v[180:183], v9 offset:20480
    v_mfma_f32_16x16x32_bf16 v[60:63], v[140:143], v[124:127], v[60:63]
    ds_read_b128 v[184:187], v9 offset:22528
    v_mfma_f32_16x16x32_bf16 v[64:67], v[144:147], v[124:127], v[64:67]
    ds_read_b128 v[160:163], v20 offset:16640
    v_mfma_f32_16x16x32_bf16 v[92:95], v[148:151], v[124:127], v[92:95]
    ds_read_b128 v[164:167], v20 offset:20480
    v_mfma_f32_16x16x32_bf16 v[96:99], v[152:155], v[124:127], v[96:99]
    ds_read_b128 v[168:171], v20 offset:20736
    v_mfma_f32_16x16x32_bf16 v[104:107], v[152:155], v[128:131], v[104:107]
    ds_read_b128 v[188:191], v20 offset:18432
    v_mfma_f32_16x16x32_bf16 v[100:103], v[148:151], v[128:131], v[100:103]
    ds_read_b128 v[204:207], v10 offset:16384
    v_mfma_f32_16x16x32_bf16 v[72:75], v[144:147], v[128:131], v[72:75]
    ds_read_b128 v[208:211], v10 offset:18432
    v_mfma_f32_16x16x32_bf16 v[68:71], v[140:143], v[128:131], v[68:71]
    ds_read_b128 v[212:215], v10 offset:20480
    v_mfma_f32_16x16x32_bf16 v[76:79], v[140:143], v[132:135], v[76:79]
    ds_read_b128 v[216:219], v10 offset:22528
    v_mfma_f32_16x16x32_bf16 v[80:83], v[144:147], v[132:135], v[80:83]
    ds_read_b128 v[192:195], v20 offset:18688
    v_mfma_f32_16x16x32_bf16 v[108:111], v[148:151], v[132:135], v[108:111]
    ds_read_b128 v[196:199], v20 offset:22528
    v_mfma_f32_16x16x32_bf16 v[112:115], v[152:155], v[132:135], v[112:115]
    s_waitcnt lgkmcnt(14)
    ds_read_b128 v[200:203], v20 offset:22784
    v_mfma_f32_16x16x32_bf16 v[120:123], v[152:155], v[136:139], v[120:123]
    v_mfma_f32_16x16x32_bf16 v[116:119], v[148:151], v[136:139], v[116:119]
    v_mfma_f32_16x16x32_bf16 v[88:91], v[144:147], v[136:139], v[88:91]
    v_mfma_f32_16x16x32_bf16 v[84:87], v[140:143], v[136:139], v[84:87]
    s_waitcnt lgkmcnt(3)
    v_mfma_f32_16x16x32_bf16 v[60:63], v[172:175], v[156:159], v[60:63]
    v_mfma_f32_16x16x32_bf16 v[64:67], v[176:179], v[156:159], v[64:67]
    v_mfma_f32_16x16x32_bf16 v[92:95], v[180:183], v[156:159], v[92:95]
    v_mfma_f32_16x16x32_bf16 v[96:99], v[184:187], v[156:159], v[96:99]
    v_mfma_f32_16x16x32_bf16 v[104:107], v[184:187], v[160:163], v[104:107]
    v_mfma_f32_16x16x32_bf16 v[100:103], v[180:183], v[160:163], v[100:103]
    v_mfma_f32_16x16x32_bf16 v[72:75], v[176:179], v[160:163], v[72:75]
    v_mfma_f32_16x16x32_bf16 v[68:71], v[172:175], v[160:163], v[68:71]
    v_mfma_f32_16x16x32_bf16 v[76:79], v[172:175], v[164:167], v[76:79]
    v_mfma_f32_16x16x32_bf16 v[80:83], v[176:179], v[164:167], v[80:83]
    v_mfma_f32_16x16x32_bf16 v[108:111], v[180:183], v[164:167], v[108:111]
    v_mfma_f32_16x16x32_bf16 v[112:115], v[184:187], v[164:167], v[112:115]
    s_waitcnt lgkmcnt(0)
    s_barrier
    v_mfma_f32_16x16x32_bf16 v[120:123], v[184:187], v[168:171], v[120:123]
    ds_read_b128 v[124:127], v20 offset:32768
    v_mfma_f32_16x16x32_bf16 v[116:119], v[180:183], v[168:171], v[116:119]
    ds_read_b128 v[140:143], v9 offset:32768
    v_mfma_f32_16x16x32_bf16 v[88:91], v[176:179], v[168:171], v[88:91]
    ds_read_b128 v[144:147], v9 offset:34816
    v_mfma_f32_16x16x32_bf16 v[84:87], v[172:175], v[168:171], v[84:87]
    ds_read_b128 v[148:151], v9 offset:36864
    v_mfma_f32_16x16x32_bf16 v[60:63], v[204:207], v[188:191], v[60:63]
    ds_read_b128 v[152:155], v9 offset:38912
    v_mfma_f32_16x16x32_bf16 v[64:67], v[208:211], v[188:191], v[64:67]
    ds_read_b128 v[128:131], v20 offset:33024
    v_mfma_f32_16x16x32_bf16 v[92:95], v[212:215], v[188:191], v[92:95]
    ds_read_b128 v[132:135], v20 offset:36864
    v_mfma_f32_16x16x32_bf16 v[96:99], v[216:219], v[188:191], v[96:99]
    ds_read_b128 v[136:139], v20 offset:37120
    v_mfma_f32_16x16x32_bf16 v[104:107], v[216:219], v[192:195], v[104:107]
    ds_read_b128 v[156:159], v20 offset:34816
    v_mfma_f32_16x16x32_bf16 v[100:103], v[212:215], v[192:195], v[100:103]
    ds_read_b128 v[172:175], v10 offset:32768
    v_mfma_f32_16x16x32_bf16 v[72:75], v[208:211], v[192:195], v[72:75]
    ds_read_b128 v[176:179], v10 offset:34816
    v_mfma_f32_16x16x32_bf16 v[68:71], v[204:207], v[192:195], v[68:71]
    ds_read_b128 v[180:183], v10 offset:36864
    v_mfma_f32_16x16x32_bf16 v[76:79], v[204:207], v[196:199], v[76:79]
    ds_read_b128 v[184:187], v10 offset:38912
    v_mfma_f32_16x16x32_bf16 v[80:83], v[208:211], v[196:199], v[80:83]
    ds_read_b128 v[160:163], v20 offset:35072
    v_mfma_f32_16x16x32_bf16 v[108:111], v[212:215], v[196:199], v[108:111]
    ds_read_b128 v[164:167], v20 offset:38912
    v_mfma_f32_16x16x32_bf16 v[112:115], v[216:219], v[196:199], v[112:115]
    s_waitcnt lgkmcnt(14)
    ds_read_b128 v[168:171], v20 offset:39168
    v_mfma_f32_16x16x32_bf16 v[120:123], v[216:219], v[200:203], v[120:123]
    v_mfma_f32_16x16x32_bf16 v[116:119], v[212:215], v[200:203], v[116:119]
    v_mfma_f32_16x16x32_bf16 v[88:91], v[208:211], v[200:203], v[88:91]
    v_mfma_f32_16x16x32_bf16 v[84:87], v[204:207], v[200:203], v[84:87]
    s_waitcnt lgkmcnt(3)
    v_mfma_f32_16x16x32_bf16 v[60:63], v[140:143], v[124:127], v[60:63]
    v_mfma_f32_16x16x32_bf16 v[64:67], v[144:147], v[124:127], v[64:67]
    v_mfma_f32_16x16x32_bf16 v[92:95], v[148:151], v[124:127], v[92:95]
    v_mfma_f32_16x16x32_bf16 v[96:99], v[152:155], v[124:127], v[96:99]
    v_mfma_f32_16x16x32_bf16 v[104:107], v[152:155], v[128:131], v[104:107]
    v_mfma_f32_16x16x32_bf16 v[100:103], v[148:151], v[128:131], v[100:103]
    v_mfma_f32_16x16x32_bf16 v[72:75], v[144:147], v[128:131], v[72:75]
    v_mfma_f32_16x16x32_bf16 v[68:71], v[140:143], v[128:131], v[68:71]
    v_mfma_f32_16x16x32_bf16 v[76:79], v[140:143], v[132:135], v[76:79]
    v_mfma_f32_16x16x32_bf16 v[80:83], v[144:147], v[132:135], v[80:83]
    v_mfma_f32_16x16x32_bf16 v[108:111], v[148:151], v[132:135], v[108:111]
    v_mfma_f32_16x16x32_bf16 v[112:115], v[152:155], v[132:135], v[112:115]
    s_waitcnt lgkmcnt(0)
    s_barrier
    v_mfma_f32_16x16x32_bf16 v[120:123], v[152:155], v[136:139], v[120:123]
    ds_read_b128 v[188:191], v20 offset:49152
    v_mfma_f32_16x16x32_bf16 v[116:119], v[148:151], v[136:139], v[116:119]
    ds_read_b128 v[204:207], v9 offset:49152
    v_mfma_f32_16x16x32_bf16 v[88:91], v[144:147], v[136:139], v[88:91]
    ds_read_b128 v[208:211], v9 offset:51200
    v_mfma_f32_16x16x32_bf16 v[84:87], v[140:143], v[136:139], v[84:87]
    ds_read_b128 v[212:215], v9 offset:53248
    v_mfma_f32_16x16x32_bf16 v[60:63], v[172:175], v[156:159], v[60:63]
    ds_read_b128 v[216:219], v9 offset:55296
    v_mfma_f32_16x16x32_bf16 v[64:67], v[176:179], v[156:159], v[64:67]
    ds_read_b128 v[192:195], v20 offset:49408
    v_mfma_f32_16x16x32_bf16 v[92:95], v[180:183], v[156:159], v[92:95]
    ds_read_b128 v[196:199], v20 offset:53248
    v_mfma_f32_16x16x32_bf16 v[96:99], v[184:187], v[156:159], v[96:99]
    ds_read_b128 v[200:203], v20 offset:53504
    v_mfma_f32_16x16x32_bf16 v[104:107], v[184:187], v[160:163], v[104:107]
    ds_read_b128 v[124:127], v20 offset:51200
    v_mfma_f32_16x16x32_bf16 v[100:103], v[180:183], v[160:163], v[100:103]
    ds_read_b128 v[140:143], v10 offset:49152
    v_mfma_f32_16x16x32_bf16 v[72:75], v[176:179], v[160:163], v[72:75]
    ds_read_b128 v[144:147], v10 offset:51200
    v_mfma_f32_16x16x32_bf16 v[68:71], v[172:175], v[160:163], v[68:71]
    ds_read_b128 v[148:151], v10 offset:53248
    v_mfma_f32_16x16x32_bf16 v[76:79], v[172:175], v[164:167], v[76:79]
    ds_read_b128 v[152:155], v10 offset:55296
    v_mfma_f32_16x16x32_bf16 v[80:83], v[176:179], v[164:167], v[80:83]
    ds_read_b128 v[128:131], v20 offset:51456
    v_mfma_f32_16x16x32_bf16 v[108:111], v[180:183], v[164:167], v[108:111]
    ds_read_b128 v[132:135], v20 offset:55296
    v_mfma_f32_16x16x32_bf16 v[112:115], v[184:187], v[164:167], v[112:115]
    s_waitcnt lgkmcnt(14)
    ds_read_b128 v[136:139], v20 offset:55552
    v_mfma_f32_16x16x32_bf16 v[120:123], v[184:187], v[168:171], v[120:123]
    v_mfma_f32_16x16x32_bf16 v[116:119], v[180:183], v[168:171], v[116:119]
    v_mfma_f32_16x16x32_bf16 v[88:91], v[176:179], v[168:171], v[88:91]
    v_mfma_f32_16x16x32_bf16 v[84:87], v[172:175], v[168:171], v[84:87]
    s_waitcnt lgkmcnt(3)
    v_mfma_f32_16x16x32_bf16 v[60:63], v[204:207], v[188:191], v[60:63]
    v_mfma_f32_16x16x32_bf16 v[64:67], v[208:211], v[188:191], v[64:67]
    v_mfma_f32_16x16x32_bf16 v[92:95], v[212:215], v[188:191], v[92:95]
    v_mfma_f32_16x16x32_bf16 v[96:99], v[216:219], v[188:191], v[96:99]
    v_mfma_f32_16x16x32_bf16 v[104:107], v[216:219], v[192:195], v[104:107]
    v_mfma_f32_16x16x32_bf16 v[100:103], v[212:215], v[192:195], v[100:103]
    v_mfma_f32_16x16x32_bf16 v[72:75], v[208:211], v[192:195], v[72:75]
    v_mfma_f32_16x16x32_bf16 v[68:71], v[204:207], v[192:195], v[68:71]
    v_mfma_f32_16x16x32_bf16 v[76:79], v[204:207], v[196:199], v[76:79]
    v_mfma_f32_16x16x32_bf16 v[80:83], v[208:211], v[196:199], v[80:83]
    v_mfma_f32_16x16x32_bf16 v[108:111], v[212:215], v[196:199], v[108:111]
    v_mfma_f32_16x16x32_bf16 v[112:115], v[216:219], v[196:199], v[112:115]
    s_waitcnt lgkmcnt(0)
    s_barrier
    v_mfma_f32_16x16x32_bf16 v[120:123], v[216:219], v[200:203], v[120:123]
    ds_read_b128 v[156:159], v20 offset:0
    v_mfma_f32_16x16x32_bf16 v[116:119], v[212:215], v[200:203], v[116:119]
    ds_read_b128 v[172:175], v9 offset:0
    v_mfma_f32_16x16x32_bf16 v[88:91], v[208:211], v[200:203], v[88:91]
    ds_read_b128 v[176:179], v9 offset:2048
    v_mfma_f32_16x16x32_bf16 v[84:87], v[204:207], v[200:203], v[84:87]
    ds_read_b128 v[180:183], v9 offset:4096
    v_mfma_f32_16x16x32_bf16 v[60:63], v[140:143], v[124:127], v[60:63]
    ds_read_b128 v[184:187], v9 offset:6144
    v_mfma_f32_16x16x32_bf16 v[64:67], v[144:147], v[124:127], v[64:67]
    ds_read_b128 v[160:163], v20 offset:256
    v_mfma_f32_16x16x32_bf16 v[92:95], v[148:151], v[124:127], v[92:95]
    ds_read_b128 v[164:167], v20 offset:4096
    v_mfma_f32_16x16x32_bf16 v[96:99], v[152:155], v[124:127], v[96:99]
    ds_read_b128 v[168:171], v20 offset:4352
    v_mfma_f32_16x16x32_bf16 v[104:107], v[152:155], v[128:131], v[104:107]
    ds_read_b128 v[188:191], v20 offset:2048
    v_mfma_f32_16x16x32_bf16 v[100:103], v[148:151], v[128:131], v[100:103]
    ds_read_b128 v[204:207], v10 offset:0
    v_mfma_f32_16x16x32_bf16 v[72:75], v[144:147], v[128:131], v[72:75]
    ds_read_b128 v[208:211], v10 offset:2048
    v_mfma_f32_16x16x32_bf16 v[68:71], v[140:143], v[128:131], v[68:71]
    ds_read_b128 v[212:215], v10 offset:4096
    v_mfma_f32_16x16x32_bf16 v[76:79], v[140:143], v[132:135], v[76:79]
    ds_read_b128 v[216:219], v10 offset:6144
    v_mfma_f32_16x16x32_bf16 v[80:83], v[144:147], v[132:135], v[80:83]
    ds_read_b128 v[192:195], v20 offset:2304
    v_mfma_f32_16x16x32_bf16 v[108:111], v[148:151], v[132:135], v[108:111]
    ds_read_b128 v[196:199], v20 offset:6144
    v_mfma_f32_16x16x32_bf16 v[112:115], v[152:155], v[132:135], v[112:115]
    s_waitcnt lgkmcnt(14)
    ds_read_b128 v[200:203], v20 offset:6400
    v_mfma_f32_16x16x32_bf16 v[120:123], v[152:155], v[136:139], v[120:123]
    v_mfma_f32_16x16x32_bf16 v[116:119], v[148:151], v[136:139], v[116:119]
    v_mfma_f32_16x16x32_bf16 v[88:91], v[144:147], v[136:139], v[88:91]
    v_mfma_f32_16x16x32_bf16 v[84:87], v[140:143], v[136:139], v[84:87]
    s_waitcnt lgkmcnt(3)
    v_mfma_f32_16x16x32_bf16 v[60:63], v[172:175], v[156:159], v[60:63]
    v_mfma_f32_16x16x32_bf16 v[64:67], v[176:179], v[156:159], v[64:67]
    v_mfma_f32_16x16x32_bf16 v[92:95], v[180:183], v[156:159], v[92:95]
    v_mfma_f32_16x16x32_bf16 v[96:99], v[184:187], v[156:159], v[96:99]
    v_mfma_f32_16x16x32_bf16 v[104:107], v[184:187], v[160:163], v[104:107]
    v_mfma_f32_16x16x32_bf16 v[100:103], v[180:183], v[160:163], v[100:103]
    v_mfma_f32_16x16x32_bf16 v[72:75], v[176:179], v[160:163], v[72:75]
    v_mfma_f32_16x16x32_bf16 v[68:71], v[172:175], v[160:163], v[68:71]
    v_mfma_f32_16x16x32_bf16 v[76:79], v[172:175], v[164:167], v[76:79]
    v_mfma_f32_16x16x32_bf16 v[80:83], v[176:179], v[164:167], v[80:83]
    v_mfma_f32_16x16x32_bf16 v[108:111], v[180:183], v[164:167], v[108:111]
    v_mfma_f32_16x16x32_bf16 v[112:115], v[184:187], v[164:167], v[112:115]
    s_waitcnt lgkmcnt(0)
    s_barrier
    v_mfma_f32_16x16x32_bf16 v[120:123], v[184:187], v[168:171], v[120:123]
    ds_read_b128 v[124:127], v20 offset:16384
    v_mfma_f32_16x16x32_bf16 v[116:119], v[180:183], v[168:171], v[116:119]
    ds_read_b128 v[140:143], v9 offset:16384
    v_mfma_f32_16x16x32_bf16 v[88:91], v[176:179], v[168:171], v[88:91]
    ds_read_b128 v[144:147], v9 offset:18432
    v_mfma_f32_16x16x32_bf16 v[84:87], v[172:175], v[168:171], v[84:87]
    ds_read_b128 v[148:151], v9 offset:20480
    v_mfma_f32_16x16x32_bf16 v[60:63], v[204:207], v[188:191], v[60:63]
    ds_read_b128 v[152:155], v9 offset:22528
    v_mfma_f32_16x16x32_bf16 v[64:67], v[208:211], v[188:191], v[64:67]
    ds_read_b128 v[128:131], v20 offset:16640
    v_mfma_f32_16x16x32_bf16 v[92:95], v[212:215], v[188:191], v[92:95]
    ds_read_b128 v[132:135], v20 offset:20480
    v_mfma_f32_16x16x32_bf16 v[96:99], v[216:219], v[188:191], v[96:99]
    ds_read_b128 v[136:139], v20 offset:20736
    v_mfma_f32_16x16x32_bf16 v[104:107], v[216:219], v[192:195], v[104:107]
    ds_read_b128 v[156:159], v20 offset:18432
    v_mfma_f32_16x16x32_bf16 v[100:103], v[212:215], v[192:195], v[100:103]
    ds_read_b128 v[172:175], v10 offset:16384
    v_mfma_f32_16x16x32_bf16 v[72:75], v[208:211], v[192:195], v[72:75]
    ds_read_b128 v[176:179], v10 offset:18432
    v_mfma_f32_16x16x32_bf16 v[68:71], v[204:207], v[192:195], v[68:71]
    ds_read_b128 v[180:183], v10 offset:20480
    v_mfma_f32_16x16x32_bf16 v[76:79], v[204:207], v[196:199], v[76:79]
    ds_read_b128 v[184:187], v10 offset:22528
    v_mfma_f32_16x16x32_bf16 v[80:83], v[208:211], v[196:199], v[80:83]
    ds_read_b128 v[160:163], v20 offset:18688
    v_mfma_f32_16x16x32_bf16 v[108:111], v[212:215], v[196:199], v[108:111]
    ds_read_b128 v[164:167], v20 offset:22528
    v_mfma_f32_16x16x32_bf16 v[112:115], v[216:219], v[196:199], v[112:115]
    s_waitcnt lgkmcnt(14)
    ds_read_b128 v[168:171], v20 offset:22784
    v_mfma_f32_16x16x32_bf16 v[120:123], v[216:219], v[200:203], v[120:123]
    v_mfma_f32_16x16x32_bf16 v[116:119], v[212:215], v[200:203], v[116:119]
    v_mfma_f32_16x16x32_bf16 v[88:91], v[208:211], v[200:203], v[88:91]
    v_mfma_f32_16x16x32_bf16 v[84:87], v[204:207], v[200:203], v[84:87]
    s_waitcnt lgkmcnt(3)
    v_mfma_f32_16x16x32_bf16 v[60:63], v[140:143], v[124:127], v[60:63]
L_pad_17:
    s_cbranch_execz L_ret_y2
    v_mfma_f32_16x16x32_bf16 v[64:67], v[144:147], v[124:127], v[64:67]
    v_mfma_f32_16x16x32_bf16 v[92:95], v[148:151], v[124:127], v[92:95]
    v_mfma_f32_16x16x32_bf16 v[96:99], v[152:155], v[124:127], v[96:99]
    v_mfma_f32_16x16x32_bf16 v[104:107], v[152:155], v[128:131], v[104:107]
    v_mfma_f32_16x16x32_bf16 v[100:103], v[148:151], v[128:131], v[100:103]
    v_mfma_f32_16x16x32_bf16 v[72:75], v[144:147], v[128:131], v[72:75]
    v_mfma_f32_16x16x32_bf16 v[68:71], v[140:143], v[128:131], v[68:71]
    v_mfma_f32_16x16x32_bf16 v[76:79], v[140:143], v[132:135], v[76:79]
    v_mfma_f32_16x16x32_bf16 v[80:83], v[144:147], v[132:135], v[80:83]
    v_mfma_f32_16x16x32_bf16 v[108:111], v[148:151], v[132:135], v[108:111]
    v_mfma_f32_16x16x32_bf16 v[112:115], v[152:155], v[132:135], v[112:115]
    s_waitcnt lgkmcnt(0)
    s_barrier
    v_mfma_f32_16x16x32_bf16 v[120:123], v[152:155], v[136:139], v[120:123]
    ds_read_b128 v[188:191], v20 offset:32768
    v_mfma_f32_16x16x32_bf16 v[116:119], v[148:151], v[136:139], v[116:119]
    ds_read_b128 v[204:207], v9 offset:32768
    v_mfma_f32_16x16x32_bf16 v[88:91], v[144:147], v[136:139], v[88:91]
    ds_read_b128 v[208:211], v9 offset:34816
    v_mfma_f32_16x16x32_bf16 v[84:87], v[140:143], v[136:139], v[84:87]
    ds_read_b128 v[212:215], v9 offset:36864
    v_mfma_f32_16x16x32_bf16 v[60:63], v[172:175], v[156:159], v[60:63]
    ds_read_b128 v[216:219], v9 offset:38912
    v_mfma_f32_16x16x32_bf16 v[64:67], v[176:179], v[156:159], v[64:67]
    ds_read_b128 v[192:195], v20 offset:33024
    v_mfma_f32_16x16x32_bf16 v[92:95], v[180:183], v[156:159], v[92:95]
    ds_read_b128 v[196:199], v20 offset:36864
    v_mfma_f32_16x16x32_bf16 v[96:99], v[184:187], v[156:159], v[96:99]
    ds_read_b128 v[200:203], v20 offset:37120
    v_mfma_f32_16x16x32_bf16 v[104:107], v[184:187], v[160:163], v[104:107]
    ds_read_b128 v[124:127], v20 offset:34816
    v_mfma_f32_16x16x32_bf16 v[100:103], v[180:183], v[160:163], v[100:103]
    ds_read_b128 v[140:143], v10 offset:32768
    v_mfma_f32_16x16x32_bf16 v[72:75], v[176:179], v[160:163], v[72:75]
    ds_read_b128 v[144:147], v10 offset:34816
    v_mfma_f32_16x16x32_bf16 v[68:71], v[172:175], v[160:163], v[68:71]
    ds_read_b128 v[148:151], v10 offset:36864
    v_mfma_f32_16x16x32_bf16 v[76:79], v[172:175], v[164:167], v[76:79]
    ds_read_b128 v[152:155], v10 offset:38912
    v_mfma_f32_16x16x32_bf16 v[80:83], v[176:179], v[164:167], v[80:83]
    ds_read_b128 v[128:131], v20 offset:35072
    v_mfma_f32_16x16x32_bf16 v[108:111], v[180:183], v[164:167], v[108:111]
    ds_read_b128 v[132:135], v20 offset:38912
    v_mfma_f32_16x16x32_bf16 v[112:115], v[184:187], v[164:167], v[112:115]
    s_waitcnt lgkmcnt(14)
    ds_read_b128 v[136:139], v20 offset:39168
    v_mfma_f32_16x16x32_bf16 v[120:123], v[184:187], v[168:171], v[120:123]
    v_mfma_f32_16x16x32_bf16 v[116:119], v[180:183], v[168:171], v[116:119]
    v_mfma_f32_16x16x32_bf16 v[88:91], v[176:179], v[168:171], v[88:91]
    v_mfma_f32_16x16x32_bf16 v[84:87], v[172:175], v[168:171], v[84:87]
    s_waitcnt lgkmcnt(3)
    v_mfma_f32_16x16x32_bf16 v[60:63], v[204:207], v[188:191], v[60:63]
    v_mfma_f32_16x16x32_bf16 v[64:67], v[208:211], v[188:191], v[64:67]
    v_mfma_f32_16x16x32_bf16 v[92:95], v[212:215], v[188:191], v[92:95]
    v_mfma_f32_16x16x32_bf16 v[96:99], v[216:219], v[188:191], v[96:99]
    v_mfma_f32_16x16x32_bf16 v[104:107], v[216:219], v[192:195], v[104:107]
    v_mfma_f32_16x16x32_bf16 v[100:103], v[212:215], v[192:195], v[100:103]
    v_mfma_f32_16x16x32_bf16 v[72:75], v[208:211], v[192:195], v[72:75]
    v_mfma_f32_16x16x32_bf16 v[68:71], v[204:207], v[192:195], v[68:71]
    v_mfma_f32_16x16x32_bf16 v[76:79], v[204:207], v[196:199], v[76:79]
    v_mfma_f32_16x16x32_bf16 v[80:83], v[208:211], v[196:199], v[80:83]
    v_mfma_f32_16x16x32_bf16 v[108:111], v[212:215], v[196:199], v[108:111]
    v_mfma_f32_16x16x32_bf16 v[112:115], v[216:219], v[196:199], v[112:115]
    s_waitcnt lgkmcnt(0)
    s_barrier
    v_mfma_f32_16x16x32_bf16 v[120:123], v[216:219], v[200:203], v[120:123]
    ds_read_b128 v[156:159], v20 offset:49152
    v_mfma_f32_16x16x32_bf16 v[116:119], v[212:215], v[200:203], v[116:119]
    ds_read_b128 v[172:175], v9 offset:49152
    v_mfma_f32_16x16x32_bf16 v[88:91], v[208:211], v[200:203], v[88:91]
    ds_read_b128 v[176:179], v9 offset:51200
    v_mfma_f32_16x16x32_bf16 v[84:87], v[204:207], v[200:203], v[84:87]
    ds_read_b128 v[180:183], v9 offset:53248
    v_mfma_f32_16x16x32_bf16 v[60:63], v[140:143], v[124:127], v[60:63]
    ds_read_b128 v[184:187], v9 offset:55296
    v_mfma_f32_16x16x32_bf16 v[64:67], v[144:147], v[124:127], v[64:67]
    ds_read_b128 v[160:163], v20 offset:49408
    v_mfma_f32_16x16x32_bf16 v[92:95], v[148:151], v[124:127], v[92:95]
    ds_read_b128 v[164:167], v20 offset:53248
    v_mfma_f32_16x16x32_bf16 v[96:99], v[152:155], v[124:127], v[96:99]
    ds_read_b128 v[168:171], v20 offset:53504
    v_mfma_f32_16x16x32_bf16 v[104:107], v[152:155], v[128:131], v[104:107]
    ds_read_b128 v[188:191], v20 offset:51200
    v_mfma_f32_16x16x32_bf16 v[100:103], v[148:151], v[128:131], v[100:103]
    ds_read_b128 v[204:207], v10 offset:49152
    v_mfma_f32_16x16x32_bf16 v[72:75], v[144:147], v[128:131], v[72:75]
    ds_read_b128 v[208:211], v10 offset:51200
    v_mfma_f32_16x16x32_bf16 v[68:71], v[140:143], v[128:131], v[68:71]
    ds_read_b128 v[212:215], v10 offset:53248
    v_mfma_f32_16x16x32_bf16 v[76:79], v[140:143], v[132:135], v[76:79]
    ds_read_b128 v[216:219], v10 offset:55296
    v_mfma_f32_16x16x32_bf16 v[80:83], v[144:147], v[132:135], v[80:83]
    ds_read_b128 v[192:195], v20 offset:51456
    v_mfma_f32_16x16x32_bf16 v[108:111], v[148:151], v[132:135], v[108:111]
    ds_read_b128 v[196:199], v20 offset:55296
    v_mfma_f32_16x16x32_bf16 v[112:115], v[152:155], v[132:135], v[112:115]
    s_waitcnt lgkmcnt(14)
    ds_read_b128 v[200:203], v20 offset:55552
    v_mfma_f32_16x16x32_bf16 v[120:123], v[152:155], v[136:139], v[120:123]
    v_mfma_f32_16x16x32_bf16 v[116:119], v[148:151], v[136:139], v[116:119]
    v_mfma_f32_16x16x32_bf16 v[88:91], v[144:147], v[136:139], v[88:91]
    v_mfma_f32_16x16x32_bf16 v[84:87], v[140:143], v[136:139], v[84:87]
    s_waitcnt lgkmcnt(3)
    v_mfma_f32_16x16x32_bf16 v[60:63], v[172:175], v[156:159], v[60:63]
    v_mfma_f32_16x16x32_bf16 v[64:67], v[176:179], v[156:159], v[64:67]
    v_mfma_f32_16x16x32_bf16 v[92:95], v[180:183], v[156:159], v[92:95]
    v_mfma_f32_16x16x32_bf16 v[96:99], v[184:187], v[156:159], v[96:99]
    v_mfma_f32_16x16x32_bf16 v[104:107], v[184:187], v[160:163], v[104:107]
    v_mfma_f32_16x16x32_bf16 v[100:103], v[180:183], v[160:163], v[100:103]
    v_mfma_f32_16x16x32_bf16 v[72:75], v[176:179], v[160:163], v[72:75]
    v_mfma_f32_16x16x32_bf16 v[68:71], v[172:175], v[160:163], v[68:71]
    v_mfma_f32_16x16x32_bf16 v[76:79], v[172:175], v[164:167], v[76:79]
    v_mfma_f32_16x16x32_bf16 v[80:83], v[176:179], v[164:167], v[80:83]
    v_mfma_f32_16x16x32_bf16 v[108:111], v[180:183], v[164:167], v[108:111]
    v_mfma_f32_16x16x32_bf16 v[112:115], v[184:187], v[164:167], v[112:115]
    s_waitcnt lgkmcnt(0)
    s_barrier
    v_mfma_f32_16x16x32_bf16 v[120:123], v[184:187], v[168:171], v[120:123]
    ds_read_b128 v[124:127], v20 offset:0
    v_mfma_f32_16x16x32_bf16 v[116:119], v[180:183], v[168:171], v[116:119]
    ds_read_b128 v[140:143], v9 offset:0
    v_mfma_f32_16x16x32_bf16 v[88:91], v[176:179], v[168:171], v[88:91]
    ds_read_b128 v[144:147], v9 offset:2048
    v_mfma_f32_16x16x32_bf16 v[84:87], v[172:175], v[168:171], v[84:87]
    ds_read_b128 v[148:151], v9 offset:4096
    v_mfma_f32_16x16x32_bf16 v[60:63], v[204:207], v[188:191], v[60:63]
    ds_read_b128 v[152:155], v9 offset:6144
    v_mfma_f32_16x16x32_bf16 v[64:67], v[208:211], v[188:191], v[64:67]
    ds_read_b128 v[128:131], v20 offset:256
    v_mfma_f32_16x16x32_bf16 v[92:95], v[212:215], v[188:191], v[92:95]
    ds_read_b128 v[132:135], v20 offset:4096
    v_mfma_f32_16x16x32_bf16 v[96:99], v[216:219], v[188:191], v[96:99]
    ds_read_b128 v[136:139], v20 offset:4352
    v_mfma_f32_16x16x32_bf16 v[104:107], v[216:219], v[192:195], v[104:107]
    ds_read_b128 v[156:159], v20 offset:2048
    v_mfma_f32_16x16x32_bf16 v[100:103], v[212:215], v[192:195], v[100:103]
    ds_read_b128 v[172:175], v10 offset:0
    v_mfma_f32_16x16x32_bf16 v[72:75], v[208:211], v[192:195], v[72:75]
    ds_read_b128 v[176:179], v10 offset:2048
    v_mfma_f32_16x16x32_bf16 v[68:71], v[204:207], v[192:195], v[68:71]
    ds_read_b128 v[180:183], v10 offset:4096
    v_mfma_f32_16x16x32_bf16 v[76:79], v[204:207], v[196:199], v[76:79]
    ds_read_b128 v[184:187], v10 offset:6144
    v_mfma_f32_16x16x32_bf16 v[80:83], v[208:211], v[196:199], v[80:83]
    ds_read_b128 v[160:163], v20 offset:2304
    v_mfma_f32_16x16x32_bf16 v[108:111], v[212:215], v[196:199], v[108:111]
    ds_read_b128 v[164:167], v20 offset:6144
    v_mfma_f32_16x16x32_bf16 v[112:115], v[216:219], v[196:199], v[112:115]
    s_waitcnt lgkmcnt(14)
    ds_read_b128 v[168:171], v20 offset:6400
    v_mfma_f32_16x16x32_bf16 v[120:123], v[216:219], v[200:203], v[120:123]
    v_mfma_f32_16x16x32_bf16 v[116:119], v[212:215], v[200:203], v[116:119]
    v_mfma_f32_16x16x32_bf16 v[88:91], v[208:211], v[200:203], v[88:91]
    v_mfma_f32_16x16x32_bf16 v[84:87], v[204:207], v[200:203], v[84:87]
    s_waitcnt lgkmcnt(3)
    v_mfma_f32_16x16x32_bf16 v[60:63], v[140:143], v[124:127], v[60:63]
    v_mfma_f32_16x16x32_bf16 v[64:67], v[144:147], v[124:127], v[64:67]
    v_mfma_f32_16x16x32_bf16 v[92:95], v[148:151], v[124:127], v[92:95]
    v_mfma_f32_16x16x32_bf16 v[96:99], v[152:155], v[124:127], v[96:99]
    v_mfma_f32_16x16x32_bf16 v[104:107], v[152:155], v[128:131], v[104:107]
    v_mfma_f32_16x16x32_bf16 v[100:103], v[148:151], v[128:131], v[100:103]
    v_mfma_f32_16x16x32_bf16 v[72:75], v[144:147], v[128:131], v[72:75]
    v_mfma_f32_16x16x32_bf16 v[68:71], v[140:143], v[128:131], v[68:71]
    v_mfma_f32_16x16x32_bf16 v[76:79], v[140:143], v[132:135], v[76:79]
    v_mfma_f32_16x16x32_bf16 v[80:83], v[144:147], v[132:135], v[80:83]
    v_mfma_f32_16x16x32_bf16 v[108:111], v[148:151], v[132:135], v[108:111]
    v_mfma_f32_16x16x32_bf16 v[112:115], v[152:155], v[132:135], v[112:115]
    s_waitcnt lgkmcnt(0)
    s_barrier
    v_mfma_f32_16x16x32_bf16 v[120:123], v[152:155], v[136:139], v[120:123]
    ds_read_b128 v[188:191], v20 offset:16384
    v_mfma_f32_16x16x32_bf16 v[116:119], v[148:151], v[136:139], v[116:119]
    ds_read_b128 v[204:207], v9 offset:16384
    v_mfma_f32_16x16x32_bf16 v[88:91], v[144:147], v[136:139], v[88:91]
    ds_read_b128 v[208:211], v9 offset:18432
    v_mfma_f32_16x16x32_bf16 v[84:87], v[140:143], v[136:139], v[84:87]
    ds_read_b128 v[212:215], v9 offset:20480
    v_mfma_f32_16x16x32_bf16 v[60:63], v[172:175], v[156:159], v[60:63]
    ds_read_b128 v[216:219], v9 offset:22528
    v_mfma_f32_16x16x32_bf16 v[64:67], v[176:179], v[156:159], v[64:67]
    ds_read_b128 v[192:195], v20 offset:16640
    v_mfma_f32_16x16x32_bf16 v[92:95], v[180:183], v[156:159], v[92:95]
    ds_read_b128 v[196:199], v20 offset:20480
    v_mfma_f32_16x16x32_bf16 v[96:99], v[184:187], v[156:159], v[96:99]
    ds_read_b128 v[200:203], v20 offset:20736
    v_mfma_f32_16x16x32_bf16 v[104:107], v[184:187], v[160:163], v[104:107]
    ds_read_b128 v[124:127], v20 offset:18432
    v_mfma_f32_16x16x32_bf16 v[100:103], v[180:183], v[160:163], v[100:103]
    ds_read_b128 v[140:143], v10 offset:16384
    v_mfma_f32_16x16x32_bf16 v[72:75], v[176:179], v[160:163], v[72:75]
    ds_read_b128 v[144:147], v10 offset:18432
    v_mfma_f32_16x16x32_bf16 v[68:71], v[172:175], v[160:163], v[68:71]
    ds_read_b128 v[148:151], v10 offset:20480
    v_mfma_f32_16x16x32_bf16 v[76:79], v[172:175], v[164:167], v[76:79]
    ds_read_b128 v[152:155], v10 offset:22528
    v_mfma_f32_16x16x32_bf16 v[80:83], v[176:179], v[164:167], v[80:83]
    ds_read_b128 v[128:131], v20 offset:18688
    v_mfma_f32_16x16x32_bf16 v[108:111], v[180:183], v[164:167], v[108:111]
    ds_read_b128 v[132:135], v20 offset:22528
    v_mfma_f32_16x16x32_bf16 v[112:115], v[184:187], v[164:167], v[112:115]
    s_waitcnt lgkmcnt(14)
    ds_read_b128 v[136:139], v20 offset:22784
    v_mfma_f32_16x16x32_bf16 v[120:123], v[184:187], v[168:171], v[120:123]
    v_mfma_f32_16x16x32_bf16 v[116:119], v[180:183], v[168:171], v[116:119]
    v_mfma_f32_16x16x32_bf16 v[88:91], v[176:179], v[168:171], v[88:91]
    v_mfma_f32_16x16x32_bf16 v[84:87], v[172:175], v[168:171], v[84:87]
    s_waitcnt lgkmcnt(3)
    v_mfma_f32_16x16x32_bf16 v[60:63], v[204:207], v[188:191], v[60:63]
    v_mfma_f32_16x16x32_bf16 v[64:67], v[208:211], v[188:191], v[64:67]
    v_mfma_f32_16x16x32_bf16 v[92:95], v[212:215], v[188:191], v[92:95]
    v_mfma_f32_16x16x32_bf16 v[96:99], v[216:219], v[188:191], v[96:99]
    v_mfma_f32_16x16x32_bf16 v[104:107], v[216:219], v[192:195], v[104:107]
    v_mfma_f32_16x16x32_bf16 v[100:103], v[212:215], v[192:195], v[100:103]
    v_mfma_f32_16x16x32_bf16 v[72:75], v[208:211], v[192:195], v[72:75]
    v_mfma_f32_16x16x32_bf16 v[68:71], v[204:207], v[192:195], v[68:71]
    v_mfma_f32_16x16x32_bf16 v[76:79], v[204:207], v[196:199], v[76:79]
    v_mfma_f32_16x16x32_bf16 v[80:83], v[208:211], v[196:199], v[80:83]
    v_mfma_f32_16x16x32_bf16 v[108:111], v[212:215], v[196:199], v[108:111]
    v_mfma_f32_16x16x32_bf16 v[112:115], v[216:219], v[196:199], v[112:115]
    s_waitcnt lgkmcnt(0)
    s_barrier
    v_mfma_f32_16x16x32_bf16 v[120:123], v[216:219], v[200:203], v[120:123]
    ds_read_b128 v[156:159], v20 offset:32768
    v_mfma_f32_16x16x32_bf16 v[116:119], v[212:215], v[200:203], v[116:119]
    ds_read_b128 v[172:175], v9 offset:32768
    v_mfma_f32_16x16x32_bf16 v[88:91], v[208:211], v[200:203], v[88:91]
    ds_read_b128 v[176:179], v9 offset:34816
    v_mfma_f32_16x16x32_bf16 v[84:87], v[204:207], v[200:203], v[84:87]
    ds_read_b128 v[180:183], v9 offset:36864
    v_mfma_f32_16x16x32_bf16 v[60:63], v[140:143], v[124:127], v[60:63]
    ds_read_b128 v[184:187], v9 offset:38912
    v_mfma_f32_16x16x32_bf16 v[64:67], v[144:147], v[124:127], v[64:67]
    ds_read_b128 v[160:163], v20 offset:33024
    v_mfma_f32_16x16x32_bf16 v[92:95], v[148:151], v[124:127], v[92:95]
    ds_read_b128 v[164:167], v20 offset:36864
    v_mfma_f32_16x16x32_bf16 v[96:99], v[152:155], v[124:127], v[96:99]
    ds_read_b128 v[168:171], v20 offset:37120
    v_mfma_f32_16x16x32_bf16 v[104:107], v[152:155], v[128:131], v[104:107]
    ds_read_b128 v[188:191], v20 offset:34816
    v_mfma_f32_16x16x32_bf16 v[100:103], v[148:151], v[128:131], v[100:103]
    ds_read_b128 v[204:207], v10 offset:32768
    v_mfma_f32_16x16x32_bf16 v[72:75], v[144:147], v[128:131], v[72:75]
    ds_read_b128 v[208:211], v10 offset:34816
    v_mfma_f32_16x16x32_bf16 v[68:71], v[140:143], v[128:131], v[68:71]
    ds_read_b128 v[212:215], v10 offset:36864
    v_mfma_f32_16x16x32_bf16 v[76:79], v[140:143], v[132:135], v[76:79]
    ds_read_b128 v[216:219], v10 offset:38912
    v_mfma_f32_16x16x32_bf16 v[80:83], v[144:147], v[132:135], v[80:83]
    ds_read_b128 v[192:195], v20 offset:35072
    v_mfma_f32_16x16x32_bf16 v[108:111], v[148:151], v[132:135], v[108:111]
    ds_read_b128 v[196:199], v20 offset:38912
    v_mfma_f32_16x16x32_bf16 v[112:115], v[152:155], v[132:135], v[112:115]
    s_waitcnt lgkmcnt(14)
    ds_read_b128 v[200:203], v20 offset:39168
    v_mfma_f32_16x16x32_bf16 v[120:123], v[152:155], v[136:139], v[120:123]
    v_mfma_f32_16x16x32_bf16 v[116:119], v[148:151], v[136:139], v[116:119]
    v_mfma_f32_16x16x32_bf16 v[88:91], v[144:147], v[136:139], v[88:91]
    v_mfma_f32_16x16x32_bf16 v[84:87], v[140:143], v[136:139], v[84:87]
    s_waitcnt lgkmcnt(3)
    v_mfma_f32_16x16x32_bf16 v[60:63], v[172:175], v[156:159], v[60:63]
    v_mfma_f32_16x16x32_bf16 v[64:67], v[176:179], v[156:159], v[64:67]
    v_mfma_f32_16x16x32_bf16 v[92:95], v[180:183], v[156:159], v[92:95]
    v_mfma_f32_16x16x32_bf16 v[96:99], v[184:187], v[156:159], v[96:99]
    v_mfma_f32_16x16x32_bf16 v[104:107], v[184:187], v[160:163], v[104:107]
    v_mfma_f32_16x16x32_bf16 v[100:103], v[180:183], v[160:163], v[100:103]
    v_mfma_f32_16x16x32_bf16 v[72:75], v[176:179], v[160:163], v[72:75]
    v_mfma_f32_16x16x32_bf16 v[68:71], v[172:175], v[160:163], v[68:71]
    v_mfma_f32_16x16x32_bf16 v[76:79], v[172:175], v[164:167], v[76:79]
    v_mfma_f32_16x16x32_bf16 v[80:83], v[176:179], v[164:167], v[80:83]
    v_mfma_f32_16x16x32_bf16 v[108:111], v[180:183], v[164:167], v[108:111]
    v_mfma_f32_16x16x32_bf16 v[112:115], v[184:187], v[164:167], v[112:115]
    s_waitcnt lgkmcnt(0)
    s_barrier
    v_mfma_f32_16x16x32_bf16 v[120:123], v[184:187], v[168:171], v[120:123]
    ds_read_b128 v[124:127], v20 offset:49152
    v_mfma_f32_16x16x32_bf16 v[116:119], v[180:183], v[168:171], v[116:119]
    ds_read_b128 v[140:143], v9 offset:49152
    v_mfma_f32_16x16x32_bf16 v[88:91], v[176:179], v[168:171], v[88:91]
    ds_read_b128 v[144:147], v9 offset:51200
    v_mfma_f32_16x16x32_bf16 v[84:87], v[172:175], v[168:171], v[84:87]
    ds_read_b128 v[148:151], v9 offset:53248
    v_mfma_f32_16x16x32_bf16 v[60:63], v[204:207], v[188:191], v[60:63]
    ds_read_b128 v[152:155], v9 offset:55296
    v_mfma_f32_16x16x32_bf16 v[64:67], v[208:211], v[188:191], v[64:67]
    ds_read_b128 v[128:131], v20 offset:49408
    v_mfma_f32_16x16x32_bf16 v[92:95], v[212:215], v[188:191], v[92:95]
    ds_read_b128 v[132:135], v20 offset:53248
    v_mfma_f32_16x16x32_bf16 v[96:99], v[216:219], v[188:191], v[96:99]
    ds_read_b128 v[136:139], v20 offset:53504
    v_mfma_f32_16x16x32_bf16 v[104:107], v[216:219], v[192:195], v[104:107]
    ds_read_b128 v[156:159], v20 offset:51200
    v_mfma_f32_16x16x32_bf16 v[100:103], v[212:215], v[192:195], v[100:103]
    ds_read_b128 v[172:175], v10 offset:49152
    v_mfma_f32_16x16x32_bf16 v[72:75], v[208:211], v[192:195], v[72:75]
    ds_read_b128 v[176:179], v10 offset:51200
    v_mfma_f32_16x16x32_bf16 v[68:71], v[204:207], v[192:195], v[68:71]
    ds_read_b128 v[180:183], v10 offset:53248
    v_mfma_f32_16x16x32_bf16 v[76:79], v[204:207], v[196:199], v[76:79]
    ds_read_b128 v[184:187], v10 offset:55296
    v_mfma_f32_16x16x32_bf16 v[80:83], v[208:211], v[196:199], v[80:83]
    ds_read_b128 v[160:163], v20 offset:51456
    v_mfma_f32_16x16x32_bf16 v[108:111], v[212:215], v[196:199], v[108:111]
    ds_read_b128 v[164:167], v20 offset:55296
    v_mfma_f32_16x16x32_bf16 v[112:115], v[216:219], v[196:199], v[112:115]
    s_waitcnt lgkmcnt(14)
    ds_read_b128 v[168:171], v20 offset:55552
    v_mfma_f32_16x16x32_bf16 v[120:123], v[216:219], v[200:203], v[120:123]
    v_mfma_f32_16x16x32_bf16 v[116:119], v[212:215], v[200:203], v[116:119]
    v_mfma_f32_16x16x32_bf16 v[88:91], v[208:211], v[200:203], v[88:91]
    v_mfma_f32_16x16x32_bf16 v[84:87], v[204:207], v[200:203], v[84:87]
    s_waitcnt lgkmcnt(3)
    v_mfma_f32_16x16x32_bf16 v[60:63], v[140:143], v[124:127], v[60:63]
    v_mfma_f32_16x16x32_bf16 v[64:67], v[144:147], v[124:127], v[64:67]
    v_mfma_f32_16x16x32_bf16 v[92:95], v[148:151], v[124:127], v[92:95]
    v_mfma_f32_16x16x32_bf16 v[96:99], v[152:155], v[124:127], v[96:99]
    v_mfma_f32_16x16x32_bf16 v[104:107], v[152:155], v[128:131], v[104:107]
    v_mfma_f32_16x16x32_bf16 v[100:103], v[148:151], v[128:131], v[100:103]
    v_mfma_f32_16x16x32_bf16 v[72:75], v[144:147], v[128:131], v[72:75]
    v_mfma_f32_16x16x32_bf16 v[68:71], v[140:143], v[128:131], v[68:71]
    v_mfma_f32_16x16x32_bf16 v[76:79], v[140:143], v[132:135], v[76:79]
    v_mfma_f32_16x16x32_bf16 v[80:83], v[144:147], v[132:135], v[80:83]
    v_mfma_f32_16x16x32_bf16 v[108:111], v[148:151], v[132:135], v[108:111]
    v_mfma_f32_16x16x32_bf16 v[112:115], v[152:155], v[132:135], v[112:115]
    s_waitcnt lgkmcnt(0)
    s_barrier
    v_mfma_f32_16x16x32_bf16 v[120:123], v[152:155], v[136:139], v[120:123]
    v_mfma_f32_16x16x32_bf16 v[116:119], v[148:151], v[136:139], v[116:119]
    v_mfma_f32_16x16x32_bf16 v[88:91], v[144:147], v[136:139], v[88:91]
    v_mfma_f32_16x16x32_bf16 v[84:87], v[140:143], v[136:139], v[84:87]
    v_mfma_f32_16x16x32_bf16 v[60:63], v[172:175], v[156:159], v[60:63]
    v_mfma_f32_16x16x32_bf16 v[64:67], v[176:179], v[156:159], v[64:67]
    v_mfma_f32_16x16x32_bf16 v[92:95], v[180:183], v[156:159], v[92:95]
    v_mfma_f32_16x16x32_bf16 v[96:99], v[184:187], v[156:159], v[96:99]
    v_mfma_f32_16x16x32_bf16 v[104:107], v[184:187], v[160:163], v[104:107]
    v_mfma_f32_16x16x32_bf16 v[100:103], v[180:183], v[160:163], v[100:103]
    v_mfma_f32_16x16x32_bf16 v[72:75], v[176:179], v[160:163], v[72:75]
    v_mfma_f32_16x16x32_bf16 v[68:71], v[172:175], v[160:163], v[68:71]
    v_mfma_f32_16x16x32_bf16 v[76:79], v[172:175], v[164:167], v[76:79]
    v_mfma_f32_16x16x32_bf16 v[80:83], v[176:179], v[164:167], v[80:83]
    v_mfma_f32_16x16x32_bf16 v[108:111], v[180:183], v[164:167], v[108:111]
    v_mfma_f32_16x16x32_bf16 v[112:115], v[184:187], v[164:167], v[112:115]
    v_mfma_f32_16x16x32_bf16 v[120:123], v[184:187], v[168:171], v[120:123]
    v_mfma_f32_16x16x32_bf16 v[116:119], v[180:183], v[168:171], v[116:119]
    v_mfma_f32_16x16x32_bf16 v[88:91], v[176:179], v[168:171], v[88:91]
    v_mfma_f32_16x16x32_bf16 v[84:87], v[172:175], v[168:171], v[84:87]
    ds_read_b128 v[124:127], v20 offset:0
    ds_read_b128 v[140:143], v9 offset:0
    ds_read_b128 v[144:147], v9 offset:2048
    ds_read_b128 v[128:131], v20 offset:256
    ds_read_b128 v[132:135], v20 offset:4096
    ds_read_b128 v[136:139], v20 offset:4352
    ds_read_b128 v[156:159], v20 offset:2048
    ds_read_b128 v[172:175], v10 offset:0
    ds_read_b128 v[176:179], v10 offset:2048
    ds_read_b128 v[160:163], v20 offset:2304
    ds_read_b128 v[164:167], v20 offset:6144
    ds_read_b128 v[168:171], v20 offset:6400
    s_waitcnt lgkmcnt(10)
    v_mfma_f32_16x16x32_bf16 v[60:63], v[140:143], v[124:127], v[60:63]
    s_waitcnt lgkmcnt(9)
    v_mfma_f32_16x16x32_bf16 v[64:67], v[144:147], v[124:127], v[64:67]
    s_waitcnt lgkmcnt(8)
    v_mfma_f32_16x16x32_bf16 v[72:75], v[144:147], v[128:131], v[72:75]
    v_mfma_f32_16x16x32_bf16 v[68:71], v[140:143], v[128:131], v[68:71]
    s_waitcnt lgkmcnt(7)
    v_mfma_f32_16x16x32_bf16 v[76:79], v[140:143], v[132:135], v[76:79]
    v_mfma_f32_16x16x32_bf16 v[80:83], v[144:147], v[132:135], v[80:83]
    s_waitcnt lgkmcnt(6)
    v_mfma_f32_16x16x32_bf16 v[88:91], v[144:147], v[136:139], v[88:91]
    v_mfma_f32_16x16x32_bf16 v[84:87], v[140:143], v[136:139], v[84:87]
    s_waitcnt lgkmcnt(0)
    s_barrier
    v_mfma_f32_16x16x32_bf16 v[60:63], v[172:175], v[156:159], v[60:63]
    ds_read_b128 v[188:191], v20 offset:16384
    ds_read_b128 v[204:207], v9 offset:16384
    v_mfma_f32_16x16x32_bf16 v[64:67], v[176:179], v[156:159], v[64:67]
    ds_read_b128 v[208:211], v9 offset:18432
    v_mfma_f32_16x16x32_bf16 v[72:75], v[176:179], v[160:163], v[72:75]
    ds_read_b128 v[192:195], v20 offset:16640
    v_mfma_f32_16x16x32_bf16 v[68:71], v[172:175], v[160:163], v[68:71]
    ds_read_b128 v[196:199], v20 offset:20480
    ds_read_b128 v[200:203], v20 offset:20736
    v_mfma_f32_16x16x32_bf16 v[76:79], v[172:175], v[164:167], v[76:79]
    ds_read_b128 v[124:127], v20 offset:18432
    v_mfma_f32_16x16x32_bf16 v[80:83], v[176:179], v[164:167], v[80:83]
    ds_read_b128 v[140:143], v10 offset:16384
    v_mfma_f32_16x16x32_bf16 v[88:91], v[176:179], v[168:171], v[88:91]
    ds_read_b128 v[144:147], v10 offset:18432
    ds_read_b128 v[128:131], v20 offset:18688
    v_mfma_f32_16x16x32_bf16 v[84:87], v[172:175], v[168:171], v[84:87]
    ds_read_b128 v[132:135], v20 offset:22528
    s_waitcnt lgkmcnt(9)
    v_mfma_f32_16x16x32_bf16 v[60:63], v[204:207], v[188:191], v[60:63]
    ds_read_b128 v[136:139], v20 offset:22784
    s_waitcnt lgkmcnt(9)
    v_mfma_f32_16x16x32_bf16 v[64:67], v[208:211], v[188:191], v[64:67]
    s_waitcnt lgkmcnt(8)
    v_mfma_f32_16x16x32_bf16 v[72:75], v[208:211], v[192:195], v[72:75]
    v_mfma_f32_16x16x32_bf16 v[68:71], v[204:207], v[192:195], v[68:71]
    s_waitcnt lgkmcnt(7)
    v_mfma_f32_16x16x32_bf16 v[76:79], v[204:207], v[196:199], v[76:79]
    v_mfma_f32_16x16x32_bf16 v[80:83], v[208:211], v[196:199], v[80:83]
    s_waitcnt lgkmcnt(6)
    v_mfma_f32_16x16x32_bf16 v[88:91], v[208:211], v[200:203], v[88:91]
    v_mfma_f32_16x16x32_bf16 v[84:87], v[204:207], v[200:203], v[84:87]
    s_waitcnt lgkmcnt(0)
    s_barrier
    v_mfma_f32_16x16x32_bf16 v[60:63], v[140:143], v[124:127], v[60:63]
    ds_read_b128 v[156:159], v20 offset:32768
    v_mfma_f32_16x16x32_bf16 v[64:67], v[144:147], v[124:127], v[64:67]
    ds_read_b128 v[172:175], v9 offset:32768
    v_mfma_f32_16x16x32_bf16 v[72:75], v[144:147], v[128:131], v[72:75]
    ds_read_b128 v[176:179], v9 offset:34816
    ds_read_b128 v[160:163], v20 offset:33024
    v_mfma_f32_16x16x32_bf16 v[68:71], v[140:143], v[128:131], v[68:71]
    ds_read_b128 v[164:167], v20 offset:36864
    v_mfma_f32_16x16x32_bf16 v[76:79], v[140:143], v[132:135], v[76:79]
    ds_read_b128 v[168:171], v20 offset:37120
    v_mfma_f32_16x16x32_bf16 v[80:83], v[144:147], v[132:135], v[80:83]
    ds_read_b128 v[188:191], v20 offset:34816
    ds_read_b128 v[204:207], v10 offset:32768
    v_mfma_f32_16x16x32_bf16 v[88:91], v[144:147], v[136:139], v[88:91]
    ds_read_b128 v[208:211], v10 offset:34816
    v_mfma_f32_16x16x32_bf16 v[84:87], v[140:143], v[136:139], v[84:87]
    ds_read_b128 v[192:195], v20 offset:35072
    s_waitcnt lgkmcnt(8)
    v_mfma_f32_16x16x32_bf16 v[60:63], v[172:175], v[156:159], v[60:63]
    ds_read_b128 v[196:199], v20 offset:38912
    ds_read_b128 v[200:203], v20 offset:39168
    s_waitcnt lgkmcnt(9)
    v_mfma_f32_16x16x32_bf16 v[64:67], v[176:179], v[156:159], v[64:67]
    s_waitcnt lgkmcnt(8)
    v_mfma_f32_16x16x32_bf16 v[72:75], v[176:179], v[160:163], v[72:75]
    v_mfma_f32_16x16x32_bf16 v[68:71], v[172:175], v[160:163], v[68:71]
    s_waitcnt lgkmcnt(7)
    v_mfma_f32_16x16x32_bf16 v[76:79], v[172:175], v[164:167], v[76:79]
    v_mfma_f32_16x16x32_bf16 v[80:83], v[176:179], v[164:167], v[80:83]
    s_waitcnt lgkmcnt(6)
    v_mfma_f32_16x16x32_bf16 v[88:91], v[176:179], v[168:171], v[88:91]
    v_mfma_f32_16x16x32_bf16 v[84:87], v[172:175], v[168:171], v[84:87]
    s_waitcnt lgkmcnt(0)
    s_barrier
    v_mfma_f32_16x16x32_bf16 v[60:63], v[204:207], v[188:191], v[60:63]
    ds_read_b128 v[124:127], v20 offset:49152
    v_mfma_f32_16x16x32_bf16 v[64:67], v[208:211], v[188:191], v[64:67]
    ds_read_b128 v[140:143], v9 offset:49152
    ds_read_b128 v[144:147], v9 offset:51200
    v_mfma_f32_16x16x32_bf16 v[72:75], v[208:211], v[192:195], v[72:75]
    ds_read_b128 v[128:131], v20 offset:49408
    v_mfma_f32_16x16x32_bf16 v[68:71], v[204:207], v[192:195], v[68:71]
    ds_read_b128 v[132:135], v20 offset:53248
    v_mfma_f32_16x16x32_bf16 v[76:79], v[204:207], v[196:199], v[76:79]
    ds_read_b128 v[136:139], v20 offset:53504
    ds_read_b128 v[156:159], v20 offset:51200
    v_mfma_f32_16x16x32_bf16 v[80:83], v[208:211], v[196:199], v[80:83]
    ds_read_b128 v[172:175], v10 offset:49152
    v_mfma_f32_16x16x32_bf16 v[88:91], v[208:211], v[200:203], v[88:91]
    ds_read_b128 v[176:179], v10 offset:51200
    v_mfma_f32_16x16x32_bf16 v[84:87], v[204:207], v[200:203], v[84:87]
    ds_read_b128 v[160:163], v20 offset:51456
    ds_read_b128 v[164:167], v20 offset:55296
    s_waitcnt lgkmcnt(9)
    v_mfma_f32_16x16x32_bf16 v[60:63], v[140:143], v[124:127], v[60:63]
    ds_read_b128 v[168:171], v20 offset:55552
    s_waitcnt lgkmcnt(9)
    v_mfma_f32_16x16x32_bf16 v[64:67], v[144:147], v[124:127], v[64:67]
    s_waitcnt lgkmcnt(8)
    v_mfma_f32_16x16x32_bf16 v[72:75], v[144:147], v[128:131], v[72:75]
    v_mfma_f32_16x16x32_bf16 v[68:71], v[140:143], v[128:131], v[68:71]
    s_waitcnt lgkmcnt(7)
    v_mfma_f32_16x16x32_bf16 v[76:79], v[140:143], v[132:135], v[76:79]
    v_mfma_f32_16x16x32_bf16 v[80:83], v[144:147], v[132:135], v[80:83]
    s_waitcnt lgkmcnt(6)
    v_mfma_f32_16x16x32_bf16 v[88:91], v[144:147], v[136:139], v[88:91]
    v_mfma_f32_16x16x32_bf16 v[84:87], v[140:143], v[136:139], v[84:87]
    s_waitcnt lgkmcnt(4)
    v_mfma_f32_16x16x32_bf16 v[60:63], v[172:175], v[156:159], v[60:63]
    ds_read_b128 v[188:191], v20 offset:0
    s_waitcnt lgkmcnt(4)
    v_mfma_f32_16x16x32_bf16 v[64:67], v[176:179], v[156:159], v[64:67]
    ds_read_b128 v[212:215], v9 offset:4096
    s_waitcnt lgkmcnt(4)
    v_mfma_f32_16x16x32_bf16 v[72:75], v[176:179], v[160:163], v[72:75]
    ds_read_b128 v[216:219], v9 offset:6144
    ds_read_b128 v[192:195], v20 offset:256
    v_mfma_f32_16x16x32_bf16 v[68:71], v[172:175], v[160:163], v[68:71]
    ds_read_b128 v[196:199], v20 offset:4096
    s_waitcnt lgkmcnt(6)
    v_mfma_f32_16x16x32_bf16 v[76:79], v[172:175], v[164:167], v[76:79]
    ds_read_b128 v[200:203], v20 offset:4352
    v_mfma_f32_16x16x32_bf16 v[80:83], v[176:179], v[164:167], v[80:83]
    ds_read_b128 v[124:127], v20 offset:2048
    ds_read_b128 v[148:151], v10 offset:4096
    s_waitcnt lgkmcnt(8)
    v_mfma_f32_16x16x32_bf16 v[88:91], v[176:179], v[168:171], v[88:91]
    ds_read_b128 v[152:155], v10 offset:6144
    v_mfma_f32_16x16x32_bf16 v[84:87], v[172:175], v[168:171], v[84:87]
    ds_read_b128 v[128:131], v20 offset:2304
    s_waitcnt lgkmcnt(8)
    v_mfma_f32_16x16x32_bf16 v[92:95], v[212:215], v[188:191], v[92:95]
    ds_read_b128 v[132:135], v20 offset:6144
    ds_read_b128 v[136:139], v20 offset:6400
    s_waitcnt lgkmcnt(9)
    v_mfma_f32_16x16x32_bf16 v[96:99], v[216:219], v[188:191], v[96:99]
    s_waitcnt lgkmcnt(8)
    v_mfma_f32_16x16x32_bf16 v[104:107], v[216:219], v[192:195], v[104:107]
    v_mfma_f32_16x16x32_bf16 v[100:103], v[212:215], v[192:195], v[100:103]
    s_waitcnt lgkmcnt(7)
    v_mfma_f32_16x16x32_bf16 v[108:111], v[212:215], v[196:199], v[108:111]
    v_mfma_f32_16x16x32_bf16 v[112:115], v[216:219], v[196:199], v[112:115]
    s_waitcnt lgkmcnt(6)
    v_mfma_f32_16x16x32_bf16 v[120:123], v[216:219], v[200:203], v[120:123]
    v_mfma_f32_16x16x32_bf16 v[116:119], v[212:215], v[200:203], v[116:119]
    s_waitcnt lgkmcnt(4)
    v_mfma_f32_16x16x32_bf16 v[92:95], v[148:151], v[124:127], v[92:95]
    ds_read_b128 v[156:159], v20 offset:16384
    ds_write_b128 v40, v[60:63] offset:0
    s_waitcnt lgkmcnt(5)
    v_mfma_f32_16x16x32_bf16 v[96:99], v[152:155], v[124:127], v[96:99]
    ds_read_b128 v[180:183], v9 offset:20480
    ds_read_b128 v[184:187], v9 offset:22528
    ds_write_b128 v41, v[64:67] offset:0
    ds_read_b128 v[220:223], v42 offset:0
    s_waitcnt lgkmcnt(8)
    v_mfma_f32_16x16x32_bf16 v[104:107], v[152:155], v[128:131], v[104:107]
    ds_read_b128 v[160:163], v20 offset:16640
    ds_read_b128 v[224:227], v42 offset:1024
    v_mfma_f32_16x16x32_bf16 v[100:103], v[148:151], v[128:131], v[100:103]
    ds_read_b128 v[164:167], v20 offset:20480
    ds_write_b128 v40, v[68:71] offset:2048
    ds_write_b128 v41, v[72:75] offset:2048
    s_waitcnt lgkmcnt(12)
    v_mfma_f32_16x16x32_bf16 v[108:111], v[148:151], v[132:135], v[108:111]
    ds_read_b128 v[168:171], v20 offset:20736
    ds_read_b128 v[188:191], v20 offset:18432
    ds_read_b128 v[228:231], v42 offset:2048
    v_mfma_f32_16x16x32_bf16 v[112:115], v[152:155], v[132:135], v[112:115]
    s_waitcnt lgkmcnt(14)
    ds_read_b128 v[212:215], v10 offset:20480
    s_waitcnt lgkmcnt(14)
    ds_read_b128 v[232:235], v42 offset:3072
    s_mov_b32 s70, 0x0
    v_mfma_f32_16x16x32_bf16 v[120:123], v[152:155], v[136:139], v[120:123]
    s_waitcnt lgkmcnt(14)
    ds_read_b128 v[216:219], v10 offset:22528
L_pad_18:
    s_cbranch_execz L_ret_y2
    s_waitcnt lgkmcnt(11)
    buffer_store_dwordx4 v[220:223], v21, s[32:35], s70 offen offset:0 nt
    v_mfma_f32_16x16x32_bf16 v[116:119], v[148:151], v[136:139], v[116:119]
    ds_read_b128 v[192:195], v20 offset:18688
    ds_read_b128 v[196:199], v20 offset:22528
    s_mov_b32 s70, 0x40000
    s_waitcnt lgkmcnt(11)
    buffer_store_dwordx4 v[224:227], v21, s[32:35], s70 offen offset:0 nt
    v_mfma_f32_16x16x32_bf16 v[92:95], v[180:183], v[156:159], v[92:95]
    ds_read_b128 v[200:203], v20 offset:22784
    ds_write_b128 v40, v[76:79] offset:4096
    v_mfma_f32_16x16x32_bf16 v[96:99], v[184:187], v[156:159], v[96:99]
    ds_write_b128 v41, v[80:83] offset:4096
    ds_read_b128 v[236:239], v42 offset:4096
    v_mfma_f32_16x16x32_bf16 v[104:107], v[184:187], v[160:163], v[104:107]
    s_waitcnt lgkmcnt(14)
    ds_read_b128 v[240:243], v42 offset:5120
    v_mfma_f32_16x16x32_bf16 v[100:103], v[180:183], v[160:163], v[100:103]
    s_mov_b32 s70, 0x80000
    s_waitcnt lgkmcnt(10)
    buffer_store_dwordx4 v[228:231], v21, s[32:35], s70 offen offset:0 nt
    v_mfma_f32_16x16x32_bf16 v[108:111], v[180:183], v[164:167], v[108:111]
    s_mov_b32 s70, 0xc0000
    v_mfma_f32_16x16x32_bf16 v[112:115], v[184:187], v[164:167], v[112:115]
    s_waitcnt lgkmcnt(8)
    buffer_store_dwordx4 v[232:235], v21, s[32:35], s70 offen offset:0 nt
    ds_write_b128 v40, v[84:87] offset:6144
    v_mfma_f32_16x16x32_bf16 v[120:123], v[184:187], v[168:171], v[120:123]
    ds_write_b128 v41, v[88:91] offset:6144
    v_mfma_f32_16x16x32_bf16 v[116:119], v[180:183], v[168:171], v[116:119]
    ds_read_b128 v[244:247], v42 offset:6144
    ds_read_b128 v[248:251], v42 offset:7168
    v_mfma_f32_16x16x32_bf16 v[92:95], v[212:215], v[188:191], v[92:95]
    ds_read_b128 v[124:127], v20 offset:32768
    ds_read_b128 v[148:151], v9 offset:36864
    s_mov_b32 s70, 0x10000
    s_waitcnt lgkmcnt(13)
    v_mfma_f32_16x16x32_bf16 v[96:99], v[216:219], v[188:191], v[96:99]
    ds_read_b128 v[152:155], v9 offset:38912
    s_waitcnt lgkmcnt(8)
    buffer_store_dwordx4 v[236:239], v21, s[32:35], s70 offen offset:0 nt
    s_mov_b32 s70, 0x50000
    v_mfma_f32_16x16x32_bf16 v[104:107], v[216:219], v[192:195], v[104:107]
    ds_read_b128 v[128:131], v20 offset:33024
    s_waitcnt lgkmcnt(8)
    buffer_store_dwordx4 v[240:243], v21, s[32:35], s70 offen offset:0 nt
    v_mfma_f32_16x16x32_bf16 v[100:103], v[212:215], v[192:195], v[100:103]
    ds_read_b128 v[132:135], v20 offset:36864
    ds_read_b128 v[136:139], v20 offset:37120
    s_mov_b32 s70, 0x90000
    s_waitcnt lgkmcnt(7)
    buffer_store_dwordx4 v[244:247], v21, s[32:35], s70 offen offset:0 nt
    v_mfma_f32_16x16x32_bf16 v[108:111], v[212:215], v[196:199], v[108:111]
    ds_read_b128 v[156:159], v20 offset:34816
    s_mov_b32 s70, 0xd0000
    v_mfma_f32_16x16x32_bf16 v[112:115], v[216:219], v[196:199], v[112:115]
    ds_read_b128 v[180:183], v10 offset:36864
    s_waitcnt lgkmcnt(8)
    buffer_store_dwordx4 v[248:251], v21, s[32:35], s70 offen offset:0 nt
    v_mfma_f32_16x16x32_bf16 v[120:123], v[216:219], v[200:203], v[120:123]
    ds_read_b128 v[184:187], v10 offset:38912
    ds_read_b128 v[160:163], v20 offset:35072
    v_mfma_f32_16x16x32_bf16 v[116:119], v[212:215], v[200:203], v[116:119]
    ds_read_b128 v[164:167], v20 offset:38912
    s_waitcnt lgkmcnt(9)
    v_mfma_f32_16x16x32_bf16 v[92:95], v[148:151], v[124:127], v[92:95]
    ds_read_b128 v[168:171], v20 offset:39168
    s_waitcnt lgkmcnt(9)
    v_mfma_f32_16x16x32_bf16 v[96:99], v[152:155], v[124:127], v[96:99]
    s_waitcnt lgkmcnt(8)
    v_mfma_f32_16x16x32_bf16 v[104:107], v[152:155], v[128:131], v[104:107]
    v_mfma_f32_16x16x32_bf16 v[100:103], v[148:151], v[128:131], v[100:103]
    s_waitcnt lgkmcnt(7)
    v_mfma_f32_16x16x32_bf16 v[108:111], v[148:151], v[132:135], v[108:111]
    v_mfma_f32_16x16x32_bf16 v[112:115], v[152:155], v[132:135], v[112:115]
    s_waitcnt lgkmcnt(6)
    v_mfma_f32_16x16x32_bf16 v[120:123], v[152:155], v[136:139], v[120:123]
    v_mfma_f32_16x16x32_bf16 v[116:119], v[148:151], v[136:139], v[116:119]
    s_waitcnt lgkmcnt(4)
    v_mfma_f32_16x16x32_bf16 v[92:95], v[180:183], v[156:159], v[92:95]
    ds_read_b128 v[188:191], v20 offset:49152
    s_waitcnt lgkmcnt(4)
    v_mfma_f32_16x16x32_bf16 v[96:99], v[184:187], v[156:159], v[96:99]
    ds_read_b128 v[212:215], v9 offset:53248
    ds_read_b128 v[216:219], v9 offset:55296
    s_waitcnt lgkmcnt(5)
    v_mfma_f32_16x16x32_bf16 v[104:107], v[184:187], v[160:163], v[104:107]
    ds_read_b128 v[192:195], v20 offset:49408
    v_mfma_f32_16x16x32_bf16 v[100:103], v[180:183], v[160:163], v[100:103]
    ds_read_b128 v[196:199], v20 offset:53248
    s_waitcnt lgkmcnt(6)
    v_mfma_f32_16x16x32_bf16 v[108:111], v[180:183], v[164:167], v[108:111]
    ds_read_b128 v[200:203], v20 offset:53504
    ds_read_b128 v[124:127], v20 offset:51200
    v_mfma_f32_16x16x32_bf16 v[112:115], v[184:187], v[164:167], v[112:115]
    ds_read_b128 v[148:151], v10 offset:53248
    s_waitcnt lgkmcnt(8)
    v_mfma_f32_16x16x32_bf16 v[120:123], v[184:187], v[168:171], v[120:123]
    ds_read_b128 v[152:155], v10 offset:55296
    v_mfma_f32_16x16x32_bf16 v[116:119], v[180:183], v[168:171], v[116:119]
    ds_read_b128 v[128:131], v20 offset:51456
    ds_read_b128 v[132:135], v20 offset:55296
    s_waitcnt lgkmcnt(9)
    v_mfma_f32_16x16x32_bf16 v[92:95], v[212:215], v[188:191], v[92:95]
    ds_read_b128 v[136:139], v20 offset:55552
    s_waitcnt lgkmcnt(9)
    v_mfma_f32_16x16x32_bf16 v[96:99], v[216:219], v[188:191], v[96:99]
    s_waitcnt lgkmcnt(8)
    v_mfma_f32_16x16x32_bf16 v[104:107], v[216:219], v[192:195], v[104:107]
    v_mfma_f32_16x16x32_bf16 v[100:103], v[212:215], v[192:195], v[100:103]
    s_waitcnt lgkmcnt(7)
    v_mfma_f32_16x16x32_bf16 v[108:111], v[212:215], v[196:199], v[108:111]
    v_mfma_f32_16x16x32_bf16 v[112:115], v[216:219], v[196:199], v[112:115]
    s_waitcnt lgkmcnt(6)
    v_mfma_f32_16x16x32_bf16 v[120:123], v[216:219], v[200:203], v[120:123]
    v_mfma_f32_16x16x32_bf16 v[116:119], v[212:215], v[200:203], v[116:119]
    s_waitcnt lgkmcnt(4)
    v_mfma_f32_16x16x32_bf16 v[92:95], v[148:151], v[124:127], v[92:95]
    s_waitcnt lgkmcnt(3)
    v_mfma_f32_16x16x32_bf16 v[96:99], v[152:155], v[124:127], v[96:99]
    s_waitcnt lgkmcnt(2)
    v_mfma_f32_16x16x32_bf16 v[104:107], v[152:155], v[128:131], v[104:107]
    v_mfma_f32_16x16x32_bf16 v[100:103], v[148:151], v[128:131], v[100:103]
    s_waitcnt lgkmcnt(1)
    v_mfma_f32_16x16x32_bf16 v[108:111], v[148:151], v[132:135], v[108:111]
    v_mfma_f32_16x16x32_bf16 v[112:115], v[152:155], v[132:135], v[112:115]
    s_waitcnt lgkmcnt(0)
    v_mfma_f32_16x16x32_bf16 v[120:123], v[152:155], v[136:139], v[120:123]
    v_mfma_f32_16x16x32_bf16 v[116:119], v[148:151], v[136:139], v[116:119]
    s_nop 1
    ds_write_b128 v40, v[92:95] offset:0
    ds_write_b128 v41, v[96:99] offset:0
    ds_read_b128 v[124:127], v42 offset:0
    ds_read_b128 v[128:131], v42 offset:1024
    ds_write_b128 v40, v[100:103] offset:2048
    ds_write_b128 v41, v[104:107] offset:2048
    ds_read_b128 v[132:135], v42 offset:2048
    ds_read_b128 v[136:139], v42 offset:3072
    s_mov_b32 s70, 0x0
    s_waitcnt lgkmcnt(5)
    buffer_store_dwordx4 v[124:127], v21, s[32:35], s70 offen offset:256 nt
    s_mov_b32 s70, 0x40000
    s_waitcnt lgkmcnt(4)
    buffer_store_dwordx4 v[128:131], v21, s[32:35], s70 offen offset:256 nt
    ds_write_b128 v40, v[108:111] offset:4096
    ds_write_b128 v41, v[112:115] offset:4096
    ds_read_b128 v[140:143], v42 offset:4096
    ds_read_b128 v[144:147], v42 offset:5120
    s_mov_b32 s70, 0x80000
    s_waitcnt lgkmcnt(5)
    buffer_store_dwordx4 v[132:135], v21, s[32:35], s70 offen offset:256 nt
    s_mov_b32 s70, 0xc0000
    s_waitcnt lgkmcnt(4)
    buffer_store_dwordx4 v[136:139], v21, s[32:35], s70 offen offset:256 nt
    ds_write_b128 v40, v[116:119] offset:6144
    ds_write_b128 v41, v[120:123] offset:6144
    ds_read_b128 v[148:151], v42 offset:6144
    ds_read_b128 v[152:155], v42 offset:7168
    s_mov_b32 s70, 0x10000
    s_waitcnt lgkmcnt(5)
    buffer_store_dwordx4 v[140:143], v21, s[32:35], s70 offen offset:256 nt
    s_mov_b32 s70, 0x50000
    s_waitcnt lgkmcnt(4)
    buffer_store_dwordx4 v[144:147], v21, s[32:35], s70 offen offset:256 nt
    s_mov_b32 s70, 0x90000
    s_waitcnt lgkmcnt(1)
    buffer_store_dwordx4 v[148:151], v21, s[32:35], s70 offen offset:256 nt
    s_mov_b32 s70, 0xd0000
    s_waitcnt lgkmcnt(0)
    buffer_store_dwordx4 v[152:155], v21, s[32:35], s70 offen offset:256 nt
    s_endpgm
L_tagwaitXA:
    s_mov_b32 s73, 131072
L_tagwXA:
    s_sub_u32 s73, s73, 1
    s_cbranch_scc1 L_tagokXA
    buffer_load_dword v20, v5, s[16:19], 0 offen sc1
    s_waitcnt vmcnt(0)
    v_readfirstlane_b32 s83, v20
    s_cmp_eq_u32 s83, 0
    s_cbranch_scc1 L_tagwXA
    s_branch L_tagokXA
L_eretry:
    s_sub_u32 s73, s73, 1
    s_cbranch_scc1 L_eok
    s_sleep 8
    v_lshlrev_b32 v3, 14, v2
    v_sub_u32 v3, v19, v3
    v_subrev_u32 v4, 0x4000, v3
    buffer_load_dwordx4 v[188:191], v4, s[12:15], 0 offen sc1
    v_subrev_u32 v4, 0xc000, v3
    buffer_load_dwordx4 v[192:195], v4, s[12:15], 0 offen sc1
    v_subrev_u32 v4, 0x14000, v3
    buffer_load_dwordx4 v[196:199], v4, s[12:15], 0 offen sc1
    v_subrev_u32 v4, 0x1c000, v3
    buffer_load_dwordx4 v[200:203], v4, s[12:15], 0 offen sc1
    s_waitcnt vmcnt(0)
    s_branch L_echk
L_tagwaitYA:
    s_mov_b32 s73, 131072
L_tagwYA:
    s_sub_u32 s73, s73, 1
    s_cbranch_scc1 L_tagokYA
    buffer_load_dword v17, v5, s[16:19], 0 offen sc1
    s_waitcnt vmcnt(0)
    v_readfirstlane_b32 s83, v17
    s_cmp_eq_u32 s83, 0
    s_cbranch_scc1 L_tagwYA
    s_branch L_tagokYA
L_tagwaitXB:
    s_mov_b32 s73, 131072
L_tagwXB:
    s_sub_u32 s73, s73, 1
    s_cbranch_scc1 L_tagokXB
    buffer_load_dword v25, v5, s[16:19], 0 offen sc1
    s_waitcnt vmcnt(0)
    v_readfirstlane_b32 s83, v25
    s_cmp_eq_u32 s83, 0
    s_cbranch_scc1 L_tagwXB
    s_branch L_tagokXB
L_tagwaitYB:
    s_mov_b32 s73, 131072
L_tagwYB:
    s_sub_u32 s73, s73, 1
    s_cbranch_scc1 L_tagokYB
    buffer_load_dword v25, v5, s[16:19], 0 offen sc1
    s_waitcnt vmcnt(0)
    v_readfirstlane_b32 s83, v25
    s_cmp_eq_u32 s83, 0
    s_cbranch_scc1 L_tagwYB
    s_branch L_tagokYB
L_slow:
    s_mov_b32 s70, 0xc00000
    v_mov_b32 v6, 0xff800000
L_smax0:
    buffer_load_dwordx4 v[144:147], v7, s[8:11], s70 offen sc1
    buffer_load_dwordx4 v[148:151], v7, s[8:11], s70 offen offset:1024 sc1
    s_waitcnt vmcnt(0)
    v_mfma_f32_32x32x16_bf16 v[96:111], v[144:147], v[80:83], 0
    v_mfma_f32_32x32x16_bf16 v[96:111], v[148:151], v[84:87], v[96:111]
    s_nop 15
    v_max3_f32 v6, v96, v97, v6
    v_max3_f32 v6, v98, v99, v6
    v_max3_f32 v6, v100, v101, v6
    v_max3_f32 v6, v102, v103, v6
    v_max3_f32 v6, v104, v105, v6
    v_max3_f32 v6, v106, v107, v6
    v_max3_f32 v6, v108, v109, v6
    v_max3_f32 v6, v110, v111, v6
    s_add_u32 s70, s70, 0x1000
    s_cmp_lt_u32 s70, 0xc40000
    s_cbranch_scc1 L_smax0
    v_mov_b32 v5, v6
    s_nop 1
    v_permlane32_swap_b32 v5, v6
    s_nop 1
    v_max_f32 v6, v5, v6
    v_sub_f32 v112, 0, v6
    v_mov_b32 v40, 0
    v_sub_f32 v113, 0, v6
    v_mov_b32 v41, 0
    v_sub_f32 v114, 0, v6
    v_mov_b32 v42, 0
    v_sub_f32 v115, 0, v6
    v_mov_b32 v43, 0
    v_sub_f32 v116, 0, v6
    v_mov_b32 v44, 0
    v_sub_f32 v117, 0, v6
    v_mov_b32 v45, 0
    v_sub_f32 v118, 0, v6
    v_mov_b32 v46, 0
    v_sub_f32 v119, 0, v6
    v_mov_b32 v47, 0
    v_sub_f32 v120, 0, v6
    v_mov_b32 v48, 0
    v_sub_f32 v121, 0, v6
    v_mov_b32 v49, 0
    v_sub_f32 v122, 0, v6
    v_mov_b32 v50, 0
    v_sub_f32 v123, 0, v6
    v_mov_b32 v51, 0
    v_sub_f32 v124, 0, v6
    v_mov_b32 v52, 0
    v_sub_f32 v125, 0, v6
    v_mov_b32 v53, 0
    v_sub_f32 v126, 0, v6
    v_mov_b32 v54, 0
    v_sub_f32 v127, 0, v6
    v_mov_b32 v55, 0
    v_mov_b32 v72, 0
    v_mov_b32 v73, 0
    v_mov_b32 v74, 0
    v_mov_b32 v75, 0
    s_mov_b32 s70, 0xc00000
L_sloop0:
    buffer_load_dwordx4 v[144:147], v7, s[8:11], s70 offen sc1
    buffer_load_dwordx4 v[148:151], v7, s[8:11], s70 offen offset:1024 sc1
    buffer_load_dwordx4 v[160:163], v7, s[8:11], s70 offen offset:2048 sc1
    buffer_load_dwordx4 v[164:167], v7, s[8:11], s70 offen offset:3072 sc1
    s_waitcnt vmcnt(0)
    v_mfma_f32_32x32x16_bf16 v[96:111], v[144:147], v[80:83], v[112:127]
    v_mfma_f32_32x32x16_bf16 v[96:111], v[148:151], v[84:87], v[96:111]
    s_nop 15
    v_exp_f32 v96, v96
    v_exp_f32 v97, v97
    v_exp_f32 v98, v98
    v_exp_f32 v99, v99
    v_exp_f32 v100, v100
    v_exp_f32 v101, v101
    v_exp_f32 v102, v102
    v_exp_f32 v103, v103
    v_exp_f32 v104, v104
    v_exp_f32 v105, v105
    v_exp_f32 v106, v106
    v_exp_f32 v107, v107
    v_exp_f32 v108, v108
    v_exp_f32 v109, v109
    v_exp_f32 v110, v110
    v_exp_f32 v111, v111
    s_nop 0
    v_cvt_pk_bf16_f32 v128, v96, v97
    v_cvt_pk_bf16_f32 v129, v98, v99
    v_cvt_pk_bf16_f32 v130, v100, v101
    v_cvt_pk_bf16_f32 v131, v102, v103
    v_cvt_pk_bf16_f32 v132, v104, v105
    v_cvt_pk_bf16_f32 v133, v106, v107
    v_cvt_pk_bf16_f32 v134, v108, v109
    v_cvt_pk_bf16_f32 v135, v110, v111
    s_nop 1
    v_mfma_f32_32x32x16_bf16 v[40:55], v[160:163], v[128:131], v[40:55]
    v_mfma_f32_32x32x16_bf16 v[40:55], v[164:167], v[132:135], v[40:55]
    v_smfmac_f32_16x16x64_bf16 v[72:75], v[36:39], v[128:135], v26
    s_add_u32 s70, s70, 0x1000
    s_cmp_lt_u32 s70, 0xc40000
    s_cbranch_scc1 L_sloop0
    s_nop 15
    v_add_f32 v72, v72, v73
    s_mov_b32 s70, 0xc00000
    v_mov_b32 v6, 0xff800000
L_smax1:
    buffer_load_dwordx4 v[144:147], v7, s[8:11], s70 offen sc1
    buffer_load_dwordx4 v[148:151], v7, s[8:11], s70 offen offset:1024 sc1
    s_waitcnt vmcnt(0)
    v_mfma_f32_32x32x16_bf16 v[96:111], v[144:147], v[88:91], 0
    v_mfma_f32_32x32x16_bf16 v[96:111], v[148:151], v[92:95], v[96:111]
    s_nop 15
    v_max3_f32 v6, v96, v97, v6
    v_max3_f32 v6, v98, v99, v6
    v_max3_f32 v6, v100, v101, v6
    v_max3_f32 v6, v102, v103, v6
    v_max3_f32 v6, v104, v105, v6
    v_max3_f32 v6, v106, v107, v6
    v_max3_f32 v6, v108, v109, v6
    v_max3_f32 v6, v110, v111, v6
    s_add_u32 s70, s70, 0x1000
    s_cmp_lt_u32 s70, 0xc40000
    s_cbranch_scc1 L_smax1
    v_mov_b32 v5, v6
    s_nop 1
    v_permlane32_swap_b32 v5, v6
    s_nop 1
    v_max_f32 v6, v5, v6
    v_sub_f32 v112, 0, v6
    v_mov_b32 v56, 0
    v_sub_f32 v113, 0, v6
    v_mov_b32 v57, 0
    v_sub_f32 v114, 0, v6
    v_mov_b32 v58, 0
    v_sub_f32 v115, 0, v6
    v_mov_b32 v59, 0
    v_sub_f32 v116, 0, v6
    v_mov_b32 v60, 0
    v_sub_f32 v117, 0, v6
    v_mov_b32 v61, 0
    v_sub_f32 v118, 0, v6
    v_mov_b32 v62, 0
    v_sub_f32 v119, 0, v6
    v_mov_b32 v63, 0
    v_sub_f32 v120, 0, v6
    v_mov_b32 v64, 0
    v_sub_f32 v121, 0, v6
    v_mov_b32 v65, 0
    v_sub_f32 v122, 0, v6
    v_mov_b32 v66, 0
    v_sub_f32 v123, 0, v6
    v_mov_b32 v67, 0
    v_sub_f32 v124, 0, v6
    v_mov_b32 v68, 0
    v_sub_f32 v125, 0, v6
    v_mov_b32 v69, 0
    v_sub_f32 v126, 0, v6
    v_mov_b32 v70, 0
    v_sub_f32 v127, 0, v6
    v_mov_b32 v71, 0
    v_mov_b32 v76, 0
    v_mov_b32 v77, 0
    v_mov_b32 v78, 0
    v_mov_b32 v79, 0
    s_mov_b32 s70, 0xc00000
L_sloop1:
    buffer_load_dwordx4 v[144:147], v7, s[8:11], s70 offen sc1
    buffer_load_dwordx4 v[148:151], v7, s[8:11], s70 offen offset:1024 sc1
    buffer_load_dwordx4 v[160:163], v7, s[8:11], s70 offen offset:2048 sc1
    buffer_load_dwordx4 v[164:167], v7, s[8:11], s70 offen offset:3072 sc1
    s_waitcnt vmcnt(0)
    v_mfma_f32_32x32x16_bf16 v[96:111], v[144:147], v[88:91], v[112:127]
    v_mfma_f32_32x32x16_bf16 v[96:111], v[148:151], v[92:95], v[96:111]
    s_nop 15
    v_exp_f32 v96, v96
    v_exp_f32 v97, v97
    v_exp_f32 v98, v98
    v_exp_f32 v99, v99
    v_exp_f32 v100, v100
    v_exp_f32 v101, v101
    v_exp_f32 v102, v102
    v_exp_f32 v103, v103
    v_exp_f32 v104, v104
    v_exp_f32 v105, v105
    v_exp_f32 v106, v106
    v_exp_f32 v107, v107
    v_exp_f32 v108, v108
    v_exp_f32 v109, v109
    v_exp_f32 v110, v110
    v_exp_f32 v111, v111
    s_nop 0
    v_cvt_pk_bf16_f32 v128, v96, v97
    v_cvt_pk_bf16_f32 v129, v98, v99
    v_cvt_pk_bf16_f32 v130, v100, v101
    v_cvt_pk_bf16_f32 v131, v102, v103
    v_cvt_pk_bf16_f32 v132, v104, v105
    v_cvt_pk_bf16_f32 v133, v106, v107
    v_cvt_pk_bf16_f32 v134, v108, v109
    v_cvt_pk_bf16_f32 v135, v110, v111
    s_nop 1
    v_mfma_f32_32x32x16_bf16 v[56:71], v[160:163], v[128:131], v[56:71]
    v_mfma_f32_32x32x16_bf16 v[56:71], v[164:167], v[132:135], v[56:71]
    v_smfmac_f32_16x16x64_bf16 v[76:79], v[36:39], v[128:135], v26
    s_add_u32 s70, s70, 0x1000
    s_cmp_lt_u32 s70, 0xc40000
    s_cbranch_scc1 L_sloop1
    s_nop 15
    v_add_f32 v76, v76, v77
    s_branch L_fin
L_code_end:
    s_endpgm
.section .rodata,"a"
.p2align 6
.amdhsa_kernel concat_heads__ssm_conv_s5__grouped_kv_mqa__prompt_kernel
  .amdhsa_next_free_vgpr 256
  .amdhsa_next_free_sgpr 102
  .amdhsa_accum_offset 256
  .amdhsa_group_segment_fixed_size 0
  .amdhsa_kernarg_size 136
  .amdhsa_user_sgpr_count 2
  .amdhsa_user_sgpr_kernarg_segment_ptr 1
  .amdhsa_system_sgpr_workgroup_id_x 1
.end_amdhsa_kernel
```
